```python
import torch

def _softmax(x, axis=-1):
    return torch.softmax(x, dim=axis)

def _gelu(x):
    return torch.nn.functional.gelu(x, approximate='tanh')

def _silu(x):
    return torch.nn.functional.silu(x)

def _sigmoid(x):
    return torch.sigmoid(x)

def _layernorm(x, axis=-1, eps=1e-05):
    m = x.mean(dim=axis, keepdim=True)
    v = x.var(dim=axis, keepdim=True, unbiased=False)
    return (x - m) / torch.sqrt(v + eps)

def _scatter_add(tgt, idx, src, axis=0):
    return tgt.clone().index_add_(axis, idx, src)

def _segment_sum(src, seg, n):
    out = torch.zeros((n,) + src.shape[1:], dtype=src.dtype)
    return out.index_add_(0, seg, src)

def _pad(x, pw):
    flat = tuple((v for pair in reversed(pw) for v in pair))
    return torch.nn.functional.pad(x, flat)
kernel_name = 'interleave_layers__memory_aug_recurrent_mem_tr__dense_activation_relu__prompt'

def setup_inputs():

    _w = lambda a: (lambda t: t.to(torch.bfloat16) if t.is_floating_point() else t)(torch.as_tensor(a))

    def _A_setup():
        B, S, Dm = (1, 2048, 640)
        H, Dh = (32, 192)
        M, seg = (8, 32)
        seg = min(seg, S)
        S = S // seg * seg
        return {'x': _w((lambda *s: torch.randn(*s, dtype=torch.bfloat16) * 0.05)(B, S, Dm)), 'mem0': _w((lambda *s: torch.randn(*s, dtype=torch.bfloat16) * 0.8)(B, M, Dm)), 'Wq': _w((lambda *s: torch.randn(*s, dtype=torch.bfloat16) * 0.8)(Dm, H, Dh) * Dm ** (-0.5)), 'Wk': _w((lambda *s: torch.randn(*s, dtype=torch.bfloat16) * 0.8)(Dm, H, Dh) * Dm ** (-0.5)), 'Wv': _w((lambda *s: torch.randn(*s, dtype=torch.bfloat16) * 0.8)(Dm, H, Dh) * Dm ** (-0.5)), 'Wo': _w((lambda *s: torch.randn(*s, dtype=torch.bfloat16) * 0.8)(H, Dh, Dm) * (H * Dh) ** (-0.5)), 'seg_len': seg}
    _A_in = _A_setup()

    def _B_setup():
        B, S, D, Dff = (1, 2048, 640, 1536)
        return {'x': _w((lambda *s: torch.randn(*s, dtype=torch.bfloat16) * 0.05)(B, S, D)), 'w1': _w((lambda *s: torch.randn(*s, dtype=torch.bfloat16) * 0.05)(D, Dff)), 'w2': _w((lambda *s: torch.randn(*s, dtype=torch.bfloat16) * 0.05)(Dff, D))}
    _B_in = _B_setup()
    return {'A_x': _A_in['x'], 'A_mem0': _A_in['mem0'], 'A_Wq': _A_in['Wq'], 'A_Wk': _A_in['Wk'], 'A_Wv': _A_in['Wv'], 'A_Wo': _A_in['Wo'], 'A_seg_len': _A_in['seg_len'], 'B_x': _B_in['x'], 'B_w1': _B_in['w1'], 'B_w2': _B_in['w2']}

def reference(A_x, A_mem0, A_Wq, A_Wk, A_Wv, A_Wo, A_seg_len, B_x, B_w1, B_w2):

    def _A_ref(x, mem0, Wq, Wk, Wv, Wo, seg_len):
        B, S, Dm = x.shape
        H, Dh = (Wq.shape[1], Wq.shape[2])
        M = mem0.shape[1]
        scale = Dh ** (-0.5)
        n_seg = S // seg_len
        L = M + seg_len
        idx = torch.arange(L)
        mask = (idx[:, None] < M) | (idx[:, None] >= idx[None, :])
        mem = mem0
        outs = []
        for s in range(n_seg):
            xs = x[:, s * seg_len:(s + 1) * seg_len, :].clone()
            h = torch.concatenate([mem, xs], axis=1)
            q = torch.einsum('btd,dhe->bhte', h, Wq)
            k = torch.einsum('btd,dhe->bhte', h, Wk)
            v = torch.einsum('btd,dhe->bhte', h, Wv)
            scores = torch.einsum('bhqe,bhke->bhqk', q, k) * scale
            scores = torch.where(mask[None, None], scores, -1000000000.0)
            p = _softmax(scores, axis=-1)
            o = torch.einsum('bhqk,bhke->bhqe', p, v)
            o = torch.einsum('bhte,hed->btd', o, Wo)
            mem = o[:, :M, :].clone()
            outs.append(o[:, M:, :])
        return torch.concatenate(outs, axis=1)

    def _B_ref(x, w1, w2):
        h = torch.einsum('bsd,df->bsf', x, w1)
        zero = torch.zeros_like(h)
        h = torch.maximum(h, zero)
        return torch.einsum('bsf,fd->bsd', h, w2)
    x = A_x
    x = x + _A_ref(_layernorm(x, axis=-1), A_mem0, A_Wq, A_Wk, A_Wv, A_Wo, A_seg_len)
    x = x + _B_ref(_layernorm(x, axis=-1), B_w1, B_w2)
    x = x + _A_ref(_layernorm(x, axis=-1), A_mem0, A_Wq, A_Wk, A_Wv, A_Wo, A_seg_len)
    x = x + _B_ref(_layernorm(x, axis=-1), B_w1, B_w2)
    return x
```

```asm
; @launch grid=(256,1,1) block=(256,1,1) lds=163840
.amdgcn_target "amdgcn-amd-amdhsa--gfx950"
.text
.globl interleave_layers__memory_aug_recurrent_mem_tr__dense_activation_relu__prompt_kernel
.p2align 8
.type interleave_layers__memory_aug_recurrent_mem_tr__dense_activation_relu__prompt_kernel,@function
interleave_layers__memory_aug_recurrent_mem_tr__dense_activation_relu__prompt_kernel:
    s_cmp_ge_u32 s2, 256
    s_cbranch_scc1 L_end
    s_load_dwordx16 s[16:31], s[0:1], 0
    s_load_dwordx8 s[32:39], s[0:1], 64
    s_load_dwordx2 s[40:41], s[0:1], 96
    s_getreg_b32 s3, hwreg(HW_REG_XCC_ID, 0, 3)
    v_lshrrev_b32 v1, 6, v0
    v_and_b32 v0, 63, v0
    v_readfirstlane_b32 s4, v1
    s_mov_b32 s6, 0x200000
    s_mov_b32 s7, 0
    s_waitcnt lgkmcnt(0)
    s_mov_b32 s8, s40
    s_and_b32 s9, s41, 0xffff
    s_mov_b32 s10, 0x10000000
    s_mov_b32 s11, 0x20000
    s_mov_b32 s12, s38
    s_and_b32 s13, s39, 0xffff
    s_mov_b32 s14, 256
    s_mov_b32 s15, 0x20000
    v_mov_b32 v3, 0
    s_cmp_lg_u32 s4, 0
    s_cbranch_scc1 L_tk
    s_lshl_b32 s60, s3, 5
    v_mov_b32 v2, 1
    s_mov_b64 exec, 1
    buffer_atomic_add v2, off, s[12:15], s60 sc0
    s_waitcnt vmcnt(0)
    ds_write_b32 v3, v2
    s_waitcnt lgkmcnt(0)
    s_mov_b64 exec, -1
    s_branch L_tk2
L_tk:
    s_cmp_eq_u32 s4, 2
    s_cselect_b32 s44, s22, s20
    s_cselect_b32 s45, s23, s21
    s_cmp_eq_u32 s4, 3
    s_cselect_b32 s44, s24, s44
    s_cselect_b32 s45, s25, s45
    s_and_b32 s45, s45, 0xffff
    s_mov_b32 s46, 7864320
    s_mov_b32 s47, 0x20000
    s_lshr_b32 s60, s2, 3
    s_mul_i32 s60, s60, 122880
    s_mul_i32 s61, s3, 1536
    s_add_u32 s60, s60, s61
    v_lshlrev_b32 v4, 4, v0
    v_and_b32 v5, 31, v0
    v_lshlrev_b32 v5, 4, v5
    v_lshrrev_b32 v6, 5, v0
    v_mul_u32_u24 v6, 12288, v6
    v_add3_u32 v5, v5, v6, 4
    v_add_u32 v5, 1020, v5
    buffer_load_dwordx4 v[8:11], v4, s[44:47], s60 offen
    buffer_load_dwordx4 v[8:11], v5, s[44:47], s60 offen
    s_add_u32 s60, s60, 12288
    buffer_load_dwordx4 v[8:11], v4, s[44:47], s60 offen
    s_add_u32 s60, s60, 12288
    buffer_load_dwordx4 v[8:11], v4, s[44:47], s60 offen
    buffer_load_dwordx4 v[8:11], v5, s[44:47], s60 offen
    s_add_u32 s60, s60, 12288
    buffer_load_dwordx4 v[8:11], v4, s[44:47], s60 offen
    s_add_u32 s60, s60, 12288
    buffer_load_dwordx4 v[8:11], v4, s[44:47], s60 offen
    buffer_load_dwordx4 v[8:11], v5, s[44:47], s60 offen
    s_add_u32 s60, s60, 12288
    buffer_load_dwordx4 v[8:11], v4, s[44:47], s60 offen
    s_add_u32 s60, s60, 12288
    buffer_load_dwordx4 v[8:11], v4, s[44:47], s60 offen
    buffer_load_dwordx4 v[8:11], v5, s[44:47], s60 offen
    s_add_u32 s60, s60, 12288
    buffer_load_dwordx4 v[8:11], v4, s[44:47], s60 offen
    s_add_u32 s60, s60, 12288
    buffer_load_dwordx4 v[8:11], v4, s[44:47], s60 offen
    buffer_load_dwordx4 v[8:11], v5, s[44:47], s60 offen
    s_add_u32 s60, s60, 12288
    buffer_load_dwordx4 v[8:11], v4, s[44:47], s60 offen
    s_add_u32 s60, s60, 12288
L_tk2:
    s_barrier
    ds_read_b32 v2, v3
    s_waitcnt lgkmcnt(0)
    v_readfirstlane_b32 s5, v2
    s_barrier
    s_cmp_ge_u32 s5, 32
    s_cbranch_scc1 L_over
L_placed:
    s_cmp_lt_u32 s5, 12
    s_cbranch_scc1 L_chain
    s_cmp_lt_u32 s5, 21
    s_cbranch_scc1 L_qkv
    s_mov_b32 s44, s16
    s_and_b32 s45, s17, 0xffff
    s_mov_b32 s46, 2621440
    s_mov_b32 s47, 0x20000
    s_sub_u32 s64, s5, 21
    s_lshl_b32 s64, s64, 2
    s_add_u32 s64, s64, s4
    v_lshrrev_b32 v2, 5, v0
    v_mul_u32_u24 v2, 1280, v2
    v_and_b32 v3, 15, v0
    v_lshl_add_u32 v2, v3, 4, v2
    v_bfe_u32 v3, v0, 4, 1
    v_lshl_add_u32 v2, v3, 3, v2
    v_mov_b32 v4, 0
    s_mov_b64 exec, 1
    s_lshl_b32 s65, s64, 5
    s_lshl_b32 s66, s3, 2
    s_add_u32 s65, s65, s66
    buffer_store_dword v4, off, s[8:11], s65 offset:0 sc1
    s_cmp_ge_u32 s64, 20
    s_cbranch_scc1 L_z2_1
    buffer_store_dword v4, off, s[8:11], s65 offset:1408 sc1
L_z2_1:
    s_mov_b64 exec, -1
    s_cmp_lt_u32 s5, 26
    s_cbranch_scc1 L_op
    s_cmp_lt_u32 s5, 29
    s_cbranch_scc1 L_f
    s_sub_u32 s70, s5, 29
    s_lshl_b32 s70, s70, 2
    s_add_u32 s70, s70, s4
    s_lshl_b32 s70, s70, 2
    s_mov_b32 s72, 0x96528410
    s_mov_b32 s73, 0xba73
    s_lshr_b64 s[72:73], s[72:73], s70
    s_and_b32 s70, s72, 15
    s_lshr_b32 s71, s70, 2
    s_lshl_b32 s71, s71, 10
    s_lshl_b32 s72, s3, 7
    s_add_u32 s71, s71, s72
    s_and_b32 s72, s70, 3
    s_lshl_b32 s72, s72, 2
    s_add_u32 s71, s71, s72
    s_add_u32 s71, s71, 8192
    s_and_b32 s72, s70, 1
    s_lshl_b32 s72, s72, 11
    s_bfe_u32 s73, s70, 0x10001
    s_lshl_b32 s73, s73, 10
    s_add_u32 s72, s72, s73
    s_lshl_b32 s73, s3, 7
    s_add_u32 s72, s72, s73
    s_add_u32 s72, s72, 20480
    s_cmp_ge_u32 s70, 8
    s_cselect_b32 s71, s72, s71
    v_mov_b32 v4, 0
    s_mov_b64 exec, 1
    buffer_store_dword v4, off, s[8:11], s71 sc1
    s_mov_b64 exec, -1
    s_waitcnt vmcnt(0)
    s_barrier
    s_cmp_lg_u32 s4, 0
    s_cbranch_scc1 L_arr_2
    s_and_b32 s60, s2, 7
    s_lshl_b32 s60, s60, 5
    s_add_u32 s60, s60, 16
    v_mov_b32 v1, 1
    s_mov_b64 exec, 1
    buffer_atomic_add v1, off, s[12:15], s60
    s_mov_b64 exec, -1
L_arr_2:
    s_mul_i32 s66, s3, 5120
    s_mul_i32 s67, s64, 40960
    s_add_u32 s67, s67, s66
    buffer_load_dwordx2 v[16:17], v2, s[44:47], s67 offen offset:0
    buffer_load_dwordx2 v[18:19], v2, s[44:47], s67 offen offset:256
    buffer_load_dwordx2 v[20:21], v2, s[44:47], s67 offen offset:512
    buffer_load_dwordx2 v[22:23], v2, s[44:47], s67 offen offset:768
    buffer_load_dwordx2 v[24:25], v2, s[44:47], s67 offen offset:1024
    buffer_load_dwordx2 v[26:27], v2, s[44:47], s67 offen offset:2560
    buffer_load_dwordx2 v[28:29], v2, s[44:47], s67 offen offset:2816
    buffer_load_dwordx2 v[30:31], v2, s[44:47], s67 offen offset:3072
    buffer_load_dwordx2 v[32:33], v2, s[44:47], s67 offen offset:3328
    buffer_load_dwordx2 v[34:35], v2, s[44:47], s67 offen offset:3584
    s_add_u32 s68, s67, 4194304
    s_waitcnt vmcnt(5)
    v_lshlrev_b32 v40, 16, v16
    v_and_b32 v41, 0xffff0000, v16
    v_lshlrev_b32 v42, 16, v17
    v_and_b32 v43, 0xffff0000, v17
    v_lshlrev_b32 v44, 16, v18
    v_and_b32 v45, 0xffff0000, v18
    v_lshlrev_b32 v46, 16, v19
    v_and_b32 v47, 0xffff0000, v19
    v_lshlrev_b32 v48, 16, v20
    v_and_b32 v49, 0xffff0000, v20
    v_lshlrev_b32 v50, 16, v21
    v_and_b32 v51, 0xffff0000, v21
    v_lshlrev_b32 v52, 16, v22
    v_and_b32 v53, 0xffff0000, v22
    v_lshlrev_b32 v54, 16, v23
    v_and_b32 v55, 0xffff0000, v23
    v_lshlrev_b32 v56, 16, v24
    v_and_b32 v57, 0xffff0000, v24
    v_lshlrev_b32 v58, 16, v25
    v_and_b32 v59, 0xffff0000, v25
    v_pk_add_f32 v[80:81], v[40:41], v[42:43]
    v_pk_add_f32 v[82:83], v[44:45], v[46:47]
    v_pk_add_f32 v[80:81], v[80:81], v[48:49]
    v_pk_add_f32 v[82:83], v[82:83], v[50:51]
    v_pk_add_f32 v[80:81], v[80:81], v[52:53]
    v_pk_add_f32 v[82:83], v[82:83], v[54:55]
    v_pk_add_f32 v[80:81], v[80:81], v[56:57]
    v_pk_add_f32 v[82:83], v[82:83], v[58:59]
    v_pk_add_f32 v[80:81], v[80:81], v[82:83]
    v_add_f32 v80, v80, v81
    v_mul_f32 v80, 0xbd4ccccd, v80
    v_mov_b32 v81, v80
    v_mov_b32 v86, v80
    v_pk_add_f32 v[84:85], v[40:41], v[80:81]
    v_pk_mul_f32 v[82:83], v[84:85], v[84:85]
    v_pk_add_f32 v[84:85], v[42:43], v[80:81]
    v_add_f32_dpp v86, v86, v86 row_ror:8 row_mask:0xf bank_mask:0xf
    v_pk_fma_f32 v[82:83], v[84:85], v[84:85], v[82:83]
    v_pk_add_f32 v[84:85], v[44:45], v[80:81]
    v_add_f32_dpp v86, v86, v86 row_ror:4 row_mask:0xf bank_mask:0xf
    v_pk_fma_f32 v[82:83], v[84:85], v[84:85], v[82:83]
    v_pk_add_f32 v[84:85], v[46:47], v[80:81]
    v_add_f32_dpp v86, v86, v86 row_ror:2 row_mask:0xf bank_mask:0xf
    v_pk_fma_f32 v[82:83], v[84:85], v[84:85], v[82:83]
    v_pk_add_f32 v[84:85], v[48:49], v[80:81]
    v_add_f32_dpp v86, v86, v86 row_ror:1 row_mask:0xf bank_mask:0xf
    v_pk_fma_f32 v[82:83], v[84:85], v[84:85], v[82:83]
    v_pk_add_f32 v[84:85], v[50:51], v[80:81]
    v_pk_fma_f32 v[82:83], v[84:85], v[84:85], v[82:83]
    v_pk_add_f32 v[84:85], v[52:53], v[80:81]
    v_mov_b32 v87, v86
    v_pk_fma_f32 v[82:83], v[84:85], v[84:85], v[82:83]
    v_pk_add_f32 v[84:85], v[54:55], v[80:81]
    v_pk_fma_f32 v[82:83], v[84:85], v[84:85], v[82:83]
    v_pk_add_f32 v[84:85], v[56:57], v[80:81]
    v_permlane16_swap_b32 v87, v86
    v_pk_fma_f32 v[82:83], v[84:85], v[84:85], v[82:83]
    v_pk_add_f32 v[84:85], v[58:59], v[80:81]
    v_pk_fma_f32 v[82:83], v[84:85], v[84:85], v[82:83]
    v_add_f32 v86, v86, v87
    v_add_f32 v82, v82, v83
    v_mul_f32 v86, 0x3d000000, v86
    v_sub_f32 v84, v80, v86
    v_mul_f32 v85, 0x41a00000, v84
    v_fmac_f32 v82, v84, v85
    v_cvt_pk_bf16_f32 v80, v86, v86
    v_and_b32 v80, 0xffff0000, v80
    v_mov_b32 v81, v80
    v_add_f32_dpp v82, v82, v82 row_ror:8 row_mask:0xf bank_mask:0xf
    v_pk_add_f32 v[40:41], v[40:41], v[80:81]
    v_pk_add_f32 v[42:43], v[42:43], v[80:81]
    v_add_f32_dpp v82, v82, v82 row_ror:4 row_mask:0xf bank_mask:0xf
    v_pk_add_f32 v[44:45], v[44:45], v[80:81]
    v_pk_add_f32 v[46:47], v[46:47], v[80:81]
    v_add_f32_dpp v82, v82, v82 row_ror:2 row_mask:0xf bank_mask:0xf
    v_pk_add_f32 v[48:49], v[48:49], v[80:81]
    v_pk_add_f32 v[50:51], v[50:51], v[80:81]
    v_add_f32_dpp v82, v82, v82 row_ror:1 row_mask:0xf bank_mask:0xf
    v_pk_add_f32 v[52:53], v[52:53], v[80:81]
    v_pk_add_f32 v[54:55], v[54:55], v[80:81]
    v_mov_b32 v83, v82
    v_pk_add_f32 v[56:57], v[56:57], v[80:81]
    v_pk_add_f32 v[58:59], v[58:59], v[80:81]
    v_permlane16_swap_b32 v83, v82
    v_add_f32 v82, v82, v83
    v_mul_f32 v82, 0x3acccccd, v82
    v_cvt_pk_bf16_f32 v82, v82, v82
    v_and_b32 v82, 0xffff0000, v82
    v_add_f32 v82, 0x3727c5ac, v82
    v_cvt_pk_bf16_f32 v82, v82, v82
    v_and_b32 v82, 0xffff0000, v82
    v_sqrt_f32 v82, v82
    v_cvt_pk_bf16_f32 v41, v40, v41
    v_cvt_pk_bf16_f32 v43, v42, v43
    v_cvt_pk_bf16_f32 v45, v44, v45
    v_cvt_pk_bf16_f32 v47, v46, v47
    v_cvt_pk_bf16_f32 v49, v48, v49
    v_cvt_pk_bf16_f32 v51, v50, v51
    v_cvt_pk_bf16_f32 v53, v52, v53
    v_cvt_pk_bf16_f32 v55, v54, v55
    v_cvt_pk_bf16_f32 v57, v56, v57
    v_cvt_pk_bf16_f32 v59, v58, v59
    v_cvt_pk_bf16_f32 v82, v82, v82
    v_and_b32 v82, 0xffff0000, v82
    v_rcp_f32 v82, v82
    v_lshlrev_b32 v40, 16, v41
    v_and_b32 v41, 0xffff0000, v41
    v_lshlrev_b32 v42, 16, v43
    v_and_b32 v43, 0xffff0000, v43
    v_lshlrev_b32 v44, 16, v45
    v_and_b32 v45, 0xffff0000, v45
    v_lshlrev_b32 v46, 16, v47
    v_and_b32 v47, 0xffff0000, v47
    v_lshlrev_b32 v48, 16, v49
    v_and_b32 v49, 0xffff0000, v49
    v_lshlrev_b32 v50, 16, v51
    v_and_b32 v51, 0xffff0000, v51
    v_lshlrev_b32 v52, 16, v53
    v_and_b32 v53, 0xffff0000, v53
    v_lshlrev_b32 v54, 16, v55
    v_and_b32 v55, 0xffff0000, v55
    v_lshlrev_b32 v56, 16, v57
    v_and_b32 v57, 0xffff0000, v57
    v_lshlrev_b32 v58, 16, v59
    v_and_b32 v59, 0xffff0000, v59
    v_mov_b32 v83, v82
    v_pk_mul_f32 v[40:41], v[40:41], v[82:83]
    v_pk_mul_f32 v[42:43], v[42:43], v[82:83]
    v_pk_mul_f32 v[44:45], v[44:45], v[82:83]
    v_pk_mul_f32 v[46:47], v[46:47], v[82:83]
    v_pk_mul_f32 v[48:49], v[48:49], v[82:83]
    v_pk_mul_f32 v[50:51], v[50:51], v[82:83]
    v_pk_mul_f32 v[52:53], v[52:53], v[82:83]
    v_pk_mul_f32 v[54:55], v[54:55], v[82:83]
    v_pk_mul_f32 v[56:57], v[56:57], v[82:83]
    v_pk_mul_f32 v[58:59], v[58:59], v[82:83]
    v_cvt_pk_bf16_f32 v60, v40, v41
    v_cvt_pk_bf16_f32 v61, v42, v43
    v_cvt_pk_bf16_f32 v62, v44, v45
    v_cvt_pk_bf16_f32 v63, v46, v47
    v_cvt_pk_bf16_f32 v64, v48, v49
    v_cvt_pk_bf16_f32 v65, v50, v51
    v_cvt_pk_bf16_f32 v66, v52, v53
    v_cvt_pk_bf16_f32 v67, v54, v55
    v_cvt_pk_bf16_f32 v68, v56, v57
    v_cvt_pk_bf16_f32 v69, v58, v59
    buffer_store_dwordx2 v[60:61], v2, s[8:11], s68 offen offset:0 sc1
    buffer_store_dwordx2 v[62:63], v2, s[8:11], s68 offen offset:256 sc1
    buffer_store_dwordx2 v[64:65], v2, s[8:11], s68 offen offset:512 sc1
    buffer_store_dwordx2 v[66:67], v2, s[8:11], s68 offen offset:768 sc1
    buffer_store_dwordx2 v[68:69], v2, s[8:11], s68 offen offset:1024 sc1
    s_waitcnt vmcnt(5)
    v_lshlrev_b32 v40, 16, v26
    v_and_b32 v41, 0xffff0000, v26
    v_lshlrev_b32 v42, 16, v27
    v_and_b32 v43, 0xffff0000, v27
    v_lshlrev_b32 v44, 16, v28
    v_and_b32 v45, 0xffff0000, v28
    v_lshlrev_b32 v46, 16, v29
    v_and_b32 v47, 0xffff0000, v29
    v_lshlrev_b32 v48, 16, v30
    v_and_b32 v49, 0xffff0000, v30
    v_lshlrev_b32 v50, 16, v31
    v_and_b32 v51, 0xffff0000, v31
    v_lshlrev_b32 v52, 16, v32
    v_and_b32 v53, 0xffff0000, v32
    v_lshlrev_b32 v54, 16, v33
    v_and_b32 v55, 0xffff0000, v33
    v_lshlrev_b32 v56, 16, v34
    v_and_b32 v57, 0xffff0000, v34
    v_lshlrev_b32 v58, 16, v35
    v_and_b32 v59, 0xffff0000, v35
    v_pk_add_f32 v[80:81], v[40:41], v[42:43]
    v_pk_add_f32 v[82:83], v[44:45], v[46:47]
    v_pk_add_f32 v[80:81], v[80:81], v[48:49]
    v_pk_add_f32 v[82:83], v[82:83], v[50:51]
    v_pk_add_f32 v[80:81], v[80:81], v[52:53]
    v_pk_add_f32 v[82:83], v[82:83], v[54:55]
    v_pk_add_f32 v[80:81], v[80:81], v[56:57]
    v_pk_add_f32 v[82:83], v[82:83], v[58:59]
    v_pk_add_f32 v[80:81], v[80:81], v[82:83]
    v_add_f32 v80, v80, v81
    v_mul_f32 v80, 0xbd4ccccd, v80
    v_mov_b32 v81, v80
    v_mov_b32 v86, v80
    v_pk_add_f32 v[84:85], v[40:41], v[80:81]
    v_pk_mul_f32 v[82:83], v[84:85], v[84:85]
    v_pk_add_f32 v[84:85], v[42:43], v[80:81]
    v_add_f32_dpp v86, v86, v86 row_ror:8 row_mask:0xf bank_mask:0xf
    v_pk_fma_f32 v[82:83], v[84:85], v[84:85], v[82:83]
    v_pk_add_f32 v[84:85], v[44:45], v[80:81]
    v_add_f32_dpp v86, v86, v86 row_ror:4 row_mask:0xf bank_mask:0xf
    v_pk_fma_f32 v[82:83], v[84:85], v[84:85], v[82:83]
    v_pk_add_f32 v[84:85], v[46:47], v[80:81]
    v_add_f32_dpp v86, v86, v86 row_ror:2 row_mask:0xf bank_mask:0xf
    v_pk_fma_f32 v[82:83], v[84:85], v[84:85], v[82:83]
    v_pk_add_f32 v[84:85], v[48:49], v[80:81]
    v_add_f32_dpp v86, v86, v86 row_ror:1 row_mask:0xf bank_mask:0xf
    v_pk_fma_f32 v[82:83], v[84:85], v[84:85], v[82:83]
    v_pk_add_f32 v[84:85], v[50:51], v[80:81]
    v_pk_fma_f32 v[82:83], v[84:85], v[84:85], v[82:83]
    v_pk_add_f32 v[84:85], v[52:53], v[80:81]
    v_mov_b32 v87, v86
    v_pk_fma_f32 v[82:83], v[84:85], v[84:85], v[82:83]
    v_pk_add_f32 v[84:85], v[54:55], v[80:81]
    v_pk_fma_f32 v[82:83], v[84:85], v[84:85], v[82:83]
    v_pk_add_f32 v[84:85], v[56:57], v[80:81]
    v_permlane16_swap_b32 v87, v86
    v_pk_fma_f32 v[82:83], v[84:85], v[84:85], v[82:83]
    v_pk_add_f32 v[84:85], v[58:59], v[80:81]
    v_pk_fma_f32 v[82:83], v[84:85], v[84:85], v[82:83]
    v_add_f32 v86, v86, v87
    v_add_f32 v82, v82, v83
    v_mul_f32 v86, 0x3d000000, v86
    v_sub_f32 v84, v80, v86
    v_mul_f32 v85, 0x41a00000, v84
    v_fmac_f32 v82, v84, v85
    v_cvt_pk_bf16_f32 v80, v86, v86
    v_and_b32 v80, 0xffff0000, v80
    v_mov_b32 v81, v80
    v_add_f32_dpp v82, v82, v82 row_ror:8 row_mask:0xf bank_mask:0xf
    v_pk_add_f32 v[40:41], v[40:41], v[80:81]
    v_pk_add_f32 v[42:43], v[42:43], v[80:81]
    v_add_f32_dpp v82, v82, v82 row_ror:4 row_mask:0xf bank_mask:0xf
    v_pk_add_f32 v[44:45], v[44:45], v[80:81]
    v_pk_add_f32 v[46:47], v[46:47], v[80:81]
    v_add_f32_dpp v82, v82, v82 row_ror:2 row_mask:0xf bank_mask:0xf
    v_pk_add_f32 v[48:49], v[48:49], v[80:81]
    v_pk_add_f32 v[50:51], v[50:51], v[80:81]
    v_add_f32_dpp v82, v82, v82 row_ror:1 row_mask:0xf bank_mask:0xf
    v_pk_add_f32 v[52:53], v[52:53], v[80:81]
    v_pk_add_f32 v[54:55], v[54:55], v[80:81]
    v_mov_b32 v83, v82
    v_pk_add_f32 v[56:57], v[56:57], v[80:81]
    v_pk_add_f32 v[58:59], v[58:59], v[80:81]
    v_permlane16_swap_b32 v83, v82
    v_add_f32 v82, v82, v83
    v_mul_f32 v82, 0x3acccccd, v82
    v_cvt_pk_bf16_f32 v82, v82, v82
    v_and_b32 v82, 0xffff0000, v82
    v_add_f32 v82, 0x3727c5ac, v82
    v_cvt_pk_bf16_f32 v82, v82, v82
    v_and_b32 v82, 0xffff0000, v82
    v_sqrt_f32 v82, v82
    v_cvt_pk_bf16_f32 v41, v40, v41
    v_cvt_pk_bf16_f32 v43, v42, v43
    v_cvt_pk_bf16_f32 v45, v44, v45
    v_cvt_pk_bf16_f32 v47, v46, v47
    v_cvt_pk_bf16_f32 v49, v48, v49
    v_cvt_pk_bf16_f32 v51, v50, v51
    v_cvt_pk_bf16_f32 v53, v52, v53
    v_cvt_pk_bf16_f32 v55, v54, v55
    v_cvt_pk_bf16_f32 v57, v56, v57
    v_cvt_pk_bf16_f32 v59, v58, v59
    v_cvt_pk_bf16_f32 v82, v82, v82
    v_and_b32 v82, 0xffff0000, v82
    v_rcp_f32 v82, v82
    v_lshlrev_b32 v40, 16, v41
    v_and_b32 v41, 0xffff0000, v41
    v_lshlrev_b32 v42, 16, v43
    v_and_b32 v43, 0xffff0000, v43
    v_lshlrev_b32 v44, 16, v45
    v_and_b32 v45, 0xffff0000, v45
    v_lshlrev_b32 v46, 16, v47
    v_and_b32 v47, 0xffff0000, v47
    v_lshlrev_b32 v48, 16, v49
    v_and_b32 v49, 0xffff0000, v49
    v_lshlrev_b32 v50, 16, v51
    v_and_b32 v51, 0xffff0000, v51
    v_lshlrev_b32 v52, 16, v53
    v_and_b32 v53, 0xffff0000, v53
    v_lshlrev_b32 v54, 16, v55
    v_and_b32 v55, 0xffff0000, v55
    v_lshlrev_b32 v56, 16, v57
    v_and_b32 v57, 0xffff0000, v57
    v_lshlrev_b32 v58, 16, v59
    v_and_b32 v59, 0xffff0000, v59
    v_mov_b32 v83, v82
    v_pk_mul_f32 v[40:41], v[40:41], v[82:83]
    v_pk_mul_f32 v[42:43], v[42:43], v[82:83]
    v_pk_mul_f32 v[44:45], v[44:45], v[82:83]
    v_pk_mul_f32 v[46:47], v[46:47], v[82:83]
    v_pk_mul_f32 v[48:49], v[48:49], v[82:83]
    v_pk_mul_f32 v[50:51], v[50:51], v[82:83]
    v_pk_mul_f32 v[52:53], v[52:53], v[82:83]
    v_pk_mul_f32 v[54:55], v[54:55], v[82:83]
    v_pk_mul_f32 v[56:57], v[56:57], v[82:83]
    v_pk_mul_f32 v[58:59], v[58:59], v[82:83]
    v_cvt_pk_bf16_f32 v70, v40, v41
    v_cvt_pk_bf16_f32 v71, v42, v43
    v_cvt_pk_bf16_f32 v72, v44, v45
    v_cvt_pk_bf16_f32 v73, v46, v47
    v_cvt_pk_bf16_f32 v74, v48, v49
    v_cvt_pk_bf16_f32 v75, v50, v51
    v_cvt_pk_bf16_f32 v76, v52, v53
    v_cvt_pk_bf16_f32 v77, v54, v55
    v_cvt_pk_bf16_f32 v78, v56, v57
    v_cvt_pk_bf16_f32 v79, v58, v59
    buffer_store_dwordx2 v[70:71], v2, s[8:11], s68 offen offset:2560 sc1
    buffer_store_dwordx2 v[72:73], v2, s[8:11], s68 offen offset:2816 sc1
    buffer_store_dwordx2 v[74:75], v2, s[8:11], s68 offen offset:3072 sc1
    buffer_store_dwordx2 v[76:77], v2, s[8:11], s68 offen offset:3328 sc1
    buffer_store_dwordx2 v[78:79], v2, s[8:11], s68 offen offset:3584 sc1
    s_waitcnt vmcnt(0)
    s_add_u32 s68, s65, 0
    v_mov_b32 v4, 1
    s_mov_b64 exec, 1
    buffer_store_dword v4, off, s[8:11], s68 sc1
    s_mov_b64 exec, -1
    s_cmp_ge_u32 s64, 20
    s_cbranch_scc1 L_ln1d_3
    s_add_u32 s64, s64, 44
    s_add_u32 s65, s65, 1408
    s_mul_i32 s67, s64, 40960
    s_add_u32 s67, s67, s66
    buffer_load_dwordx2 v[16:17], v2, s[44:47], s67 offen offset:0
    buffer_load_dwordx2 v[18:19], v2, s[44:47], s67 offen offset:256
    buffer_load_dwordx2 v[20:21], v2, s[44:47], s67 offen offset:512
    buffer_load_dwordx2 v[22:23], v2, s[44:47], s67 offen offset:768
    buffer_load_dwordx2 v[24:25], v2, s[44:47], s67 offen offset:1024
    buffer_load_dwordx2 v[26:27], v2, s[44:47], s67 offen offset:2560
    buffer_load_dwordx2 v[28:29], v2, s[44:47], s67 offen offset:2816
    buffer_load_dwordx2 v[30:31], v2, s[44:47], s67 offen offset:3072
    buffer_load_dwordx2 v[32:33], v2, s[44:47], s67 offen offset:3328
    buffer_load_dwordx2 v[34:35], v2, s[44:47], s67 offen offset:3584
    s_add_u32 s68, s67, 4194304
    s_waitcnt vmcnt(5)
    v_lshlrev_b32 v40, 16, v16
    v_and_b32 v41, 0xffff0000, v16
    v_lshlrev_b32 v42, 16, v17
    v_and_b32 v43, 0xffff0000, v17
    v_lshlrev_b32 v44, 16, v18
    v_and_b32 v45, 0xffff0000, v18
    v_lshlrev_b32 v46, 16, v19
    v_and_b32 v47, 0xffff0000, v19
    v_lshlrev_b32 v48, 16, v20
    v_and_b32 v49, 0xffff0000, v20
    v_lshlrev_b32 v50, 16, v21
    v_and_b32 v51, 0xffff0000, v21
    v_lshlrev_b32 v52, 16, v22
    v_and_b32 v53, 0xffff0000, v22
    v_lshlrev_b32 v54, 16, v23
    v_and_b32 v55, 0xffff0000, v23
    v_lshlrev_b32 v56, 16, v24
    v_and_b32 v57, 0xffff0000, v24
    v_lshlrev_b32 v58, 16, v25
    v_and_b32 v59, 0xffff0000, v25
    v_pk_add_f32 v[80:81], v[40:41], v[42:43]
    v_pk_add_f32 v[82:83], v[44:45], v[46:47]
    v_pk_add_f32 v[80:81], v[80:81], v[48:49]
    v_pk_add_f32 v[82:83], v[82:83], v[50:51]
    v_pk_add_f32 v[80:81], v[80:81], v[52:53]
    v_pk_add_f32 v[82:83], v[82:83], v[54:55]
    v_pk_add_f32 v[80:81], v[80:81], v[56:57]
    v_pk_add_f32 v[82:83], v[82:83], v[58:59]
    v_pk_add_f32 v[80:81], v[80:81], v[82:83]
    v_add_f32 v80, v80, v81
    v_mul_f32 v80, 0xbd4ccccd, v80
    v_mov_b32 v81, v80
    v_mov_b32 v86, v80
    v_pk_add_f32 v[84:85], v[40:41], v[80:81]
    v_pk_mul_f32 v[82:83], v[84:85], v[84:85]
    v_pk_add_f32 v[84:85], v[42:43], v[80:81]
    v_add_f32_dpp v86, v86, v86 row_ror:8 row_mask:0xf bank_mask:0xf
    v_pk_fma_f32 v[82:83], v[84:85], v[84:85], v[82:83]
    v_pk_add_f32 v[84:85], v[44:45], v[80:81]
    v_add_f32_dpp v86, v86, v86 row_ror:4 row_mask:0xf bank_mask:0xf
    v_pk_fma_f32 v[82:83], v[84:85], v[84:85], v[82:83]
    v_pk_add_f32 v[84:85], v[46:47], v[80:81]
    v_add_f32_dpp v86, v86, v86 row_ror:2 row_mask:0xf bank_mask:0xf
    v_pk_fma_f32 v[82:83], v[84:85], v[84:85], v[82:83]
    v_pk_add_f32 v[84:85], v[48:49], v[80:81]
    v_add_f32_dpp v86, v86, v86 row_ror:1 row_mask:0xf bank_mask:0xf
    v_pk_fma_f32 v[82:83], v[84:85], v[84:85], v[82:83]
    v_pk_add_f32 v[84:85], v[50:51], v[80:81]
    v_pk_fma_f32 v[82:83], v[84:85], v[84:85], v[82:83]
    v_pk_add_f32 v[84:85], v[52:53], v[80:81]
    v_mov_b32 v87, v86
    v_pk_fma_f32 v[82:83], v[84:85], v[84:85], v[82:83]
    v_pk_add_f32 v[84:85], v[54:55], v[80:81]
    v_pk_fma_f32 v[82:83], v[84:85], v[84:85], v[82:83]
    v_pk_add_f32 v[84:85], v[56:57], v[80:81]
    v_permlane16_swap_b32 v87, v86
    v_pk_fma_f32 v[82:83], v[84:85], v[84:85], v[82:83]
    v_pk_add_f32 v[84:85], v[58:59], v[80:81]
    v_pk_fma_f32 v[82:83], v[84:85], v[84:85], v[82:83]
    v_add_f32 v86, v86, v87
    v_add_f32 v82, v82, v83
    v_mul_f32 v86, 0x3d000000, v86
    v_sub_f32 v84, v80, v86
    v_mul_f32 v85, 0x41a00000, v84
    v_fmac_f32 v82, v84, v85
    v_cvt_pk_bf16_f32 v80, v86, v86
    v_and_b32 v80, 0xffff0000, v80
    v_mov_b32 v81, v80
    v_add_f32_dpp v82, v82, v82 row_ror:8 row_mask:0xf bank_mask:0xf
    v_pk_add_f32 v[40:41], v[40:41], v[80:81]
    v_pk_add_f32 v[42:43], v[42:43], v[80:81]
    v_add_f32_dpp v82, v82, v82 row_ror:4 row_mask:0xf bank_mask:0xf
    v_pk_add_f32 v[44:45], v[44:45], v[80:81]
    v_pk_add_f32 v[46:47], v[46:47], v[80:81]
    v_add_f32_dpp v82, v82, v82 row_ror:2 row_mask:0xf bank_mask:0xf
    v_pk_add_f32 v[48:49], v[48:49], v[80:81]
    v_pk_add_f32 v[50:51], v[50:51], v[80:81]
    v_add_f32_dpp v82, v82, v82 row_ror:1 row_mask:0xf bank_mask:0xf
    v_pk_add_f32 v[52:53], v[52:53], v[80:81]
    v_pk_add_f32 v[54:55], v[54:55], v[80:81]
    v_mov_b32 v83, v82
    v_pk_add_f32 v[56:57], v[56:57], v[80:81]
    v_pk_add_f32 v[58:59], v[58:59], v[80:81]
    v_permlane16_swap_b32 v83, v82
    v_add_f32 v82, v82, v83
    v_mul_f32 v82, 0x3acccccd, v82
    v_cvt_pk_bf16_f32 v82, v82, v82
    v_and_b32 v82, 0xffff0000, v82
    v_add_f32 v82, 0x3727c5ac, v82
    v_cvt_pk_bf16_f32 v82, v82, v82
    v_and_b32 v82, 0xffff0000, v82
    v_sqrt_f32 v82, v82
    v_cvt_pk_bf16_f32 v41, v40, v41
    v_cvt_pk_bf16_f32 v43, v42, v43
    v_cvt_pk_bf16_f32 v45, v44, v45
    v_cvt_pk_bf16_f32 v47, v46, v47
    v_cvt_pk_bf16_f32 v49, v48, v49
    v_cvt_pk_bf16_f32 v51, v50, v51
    v_cvt_pk_bf16_f32 v53, v52, v53
    v_cvt_pk_bf16_f32 v55, v54, v55
    v_cvt_pk_bf16_f32 v57, v56, v57
    v_cvt_pk_bf16_f32 v59, v58, v59
    v_cvt_pk_bf16_f32 v82, v82, v82
    v_and_b32 v82, 0xffff0000, v82
    v_rcp_f32 v82, v82
    v_lshlrev_b32 v40, 16, v41
    v_and_b32 v41, 0xffff0000, v41
    v_lshlrev_b32 v42, 16, v43
    v_and_b32 v43, 0xffff0000, v43
    v_lshlrev_b32 v44, 16, v45
    v_and_b32 v45, 0xffff0000, v45
    v_lshlrev_b32 v46, 16, v47
    v_and_b32 v47, 0xffff0000, v47
    v_lshlrev_b32 v48, 16, v49
    v_and_b32 v49, 0xffff0000, v49
    v_lshlrev_b32 v50, 16, v51
    v_and_b32 v51, 0xffff0000, v51
    v_lshlrev_b32 v52, 16, v53
    v_and_b32 v53, 0xffff0000, v53
    v_lshlrev_b32 v54, 16, v55
    v_and_b32 v55, 0xffff0000, v55
    v_lshlrev_b32 v56, 16, v57
    v_and_b32 v57, 0xffff0000, v57
    v_lshlrev_b32 v58, 16, v59
    v_and_b32 v59, 0xffff0000, v59
    v_mov_b32 v83, v82
    v_pk_mul_f32 v[40:41], v[40:41], v[82:83]
    v_pk_mul_f32 v[42:43], v[42:43], v[82:83]
    v_pk_mul_f32 v[44:45], v[44:45], v[82:83]
    v_pk_mul_f32 v[46:47], v[46:47], v[82:83]
    v_pk_mul_f32 v[48:49], v[48:49], v[82:83]
    v_pk_mul_f32 v[50:51], v[50:51], v[82:83]
    v_pk_mul_f32 v[52:53], v[52:53], v[82:83]
    v_pk_mul_f32 v[54:55], v[54:55], v[82:83]
    v_pk_mul_f32 v[56:57], v[56:57], v[82:83]
    v_pk_mul_f32 v[58:59], v[58:59], v[82:83]
    v_cvt_pk_bf16_f32 v60, v40, v41
    v_cvt_pk_bf16_f32 v61, v42, v43
    v_cvt_pk_bf16_f32 v62, v44, v45
    v_cvt_pk_bf16_f32 v63, v46, v47
    v_cvt_pk_bf16_f32 v64, v48, v49
    v_cvt_pk_bf16_f32 v65, v50, v51
    v_cvt_pk_bf16_f32 v66, v52, v53
    v_cvt_pk_bf16_f32 v67, v54, v55
    v_cvt_pk_bf16_f32 v68, v56, v57
    v_cvt_pk_bf16_f32 v69, v58, v59
    buffer_store_dwordx2 v[60:61], v2, s[8:11], s68 offen offset:0 sc1
    buffer_store_dwordx2 v[62:63], v2, s[8:11], s68 offen offset:256 sc1
    buffer_store_dwordx2 v[64:65], v2, s[8:11], s68 offen offset:512 sc1
    buffer_store_dwordx2 v[66:67], v2, s[8:11], s68 offen offset:768 sc1
    buffer_store_dwordx2 v[68:69], v2, s[8:11], s68 offen offset:1024 sc1
    s_waitcnt vmcnt(5)
    v_lshlrev_b32 v40, 16, v26
    v_and_b32 v41, 0xffff0000, v26
    v_lshlrev_b32 v42, 16, v27
    v_and_b32 v43, 0xffff0000, v27
    v_lshlrev_b32 v44, 16, v28
    v_and_b32 v45, 0xffff0000, v28
    v_lshlrev_b32 v46, 16, v29
    v_and_b32 v47, 0xffff0000, v29
    v_lshlrev_b32 v48, 16, v30
    v_and_b32 v49, 0xffff0000, v30
    v_lshlrev_b32 v50, 16, v31
    v_and_b32 v51, 0xffff0000, v31
    v_lshlrev_b32 v52, 16, v32
    v_and_b32 v53, 0xffff0000, v32
    v_lshlrev_b32 v54, 16, v33
    v_and_b32 v55, 0xffff0000, v33
    v_lshlrev_b32 v56, 16, v34
    v_and_b32 v57, 0xffff0000, v34
    v_lshlrev_b32 v58, 16, v35
    v_and_b32 v59, 0xffff0000, v35
    v_pk_add_f32 v[80:81], v[40:41], v[42:43]
    v_pk_add_f32 v[82:83], v[44:45], v[46:47]
    v_pk_add_f32 v[80:81], v[80:81], v[48:49]
    v_pk_add_f32 v[82:83], v[82:83], v[50:51]
    v_pk_add_f32 v[80:81], v[80:81], v[52:53]
    v_pk_add_f32 v[82:83], v[82:83], v[54:55]
    v_pk_add_f32 v[80:81], v[80:81], v[56:57]
    v_pk_add_f32 v[82:83], v[82:83], v[58:59]
    v_pk_add_f32 v[80:81], v[80:81], v[82:83]
    v_add_f32 v80, v80, v81
    v_mul_f32 v80, 0xbd4ccccd, v80
    v_mov_b32 v81, v80
    v_mov_b32 v86, v80
    v_pk_add_f32 v[84:85], v[40:41], v[80:81]
    v_pk_mul_f32 v[82:83], v[84:85], v[84:85]
    v_pk_add_f32 v[84:85], v[42:43], v[80:81]
    v_add_f32_dpp v86, v86, v86 row_ror:8 row_mask:0xf bank_mask:0xf
    v_pk_fma_f32 v[82:83], v[84:85], v[84:85], v[82:83]
    v_pk_add_f32 v[84:85], v[44:45], v[80:81]
    v_add_f32_dpp v86, v86, v86 row_ror:4 row_mask:0xf bank_mask:0xf
    v_pk_fma_f32 v[82:83], v[84:85], v[84:85], v[82:83]
    v_pk_add_f32 v[84:85], v[46:47], v[80:81]
    v_add_f32_dpp v86, v86, v86 row_ror:2 row_mask:0xf bank_mask:0xf
    v_pk_fma_f32 v[82:83], v[84:85], v[84:85], v[82:83]
    v_pk_add_f32 v[84:85], v[48:49], v[80:81]
    v_add_f32_dpp v86, v86, v86 row_ror:1 row_mask:0xf bank_mask:0xf
    v_pk_fma_f32 v[82:83], v[84:85], v[84:85], v[82:83]
    v_pk_add_f32 v[84:85], v[50:51], v[80:81]
    v_pk_fma_f32 v[82:83], v[84:85], v[84:85], v[82:83]
    v_pk_add_f32 v[84:85], v[52:53], v[80:81]
    v_mov_b32 v87, v86
    v_pk_fma_f32 v[82:83], v[84:85], v[84:85], v[82:83]
    v_pk_add_f32 v[84:85], v[54:55], v[80:81]
    v_pk_fma_f32 v[82:83], v[84:85], v[84:85], v[82:83]
    v_pk_add_f32 v[84:85], v[56:57], v[80:81]
    v_permlane16_swap_b32 v87, v86
    v_pk_fma_f32 v[82:83], v[84:85], v[84:85], v[82:83]
    v_pk_add_f32 v[84:85], v[58:59], v[80:81]
    v_pk_fma_f32 v[82:83], v[84:85], v[84:85], v[82:83]
    v_add_f32 v86, v86, v87
    v_add_f32 v82, v82, v83
    v_mul_f32 v86, 0x3d000000, v86
    v_sub_f32 v84, v80, v86
    v_mul_f32 v85, 0x41a00000, v84
    v_fmac_f32 v82, v84, v85
    v_cvt_pk_bf16_f32 v80, v86, v86
    v_and_b32 v80, 0xffff0000, v80
    v_mov_b32 v81, v80
    v_add_f32_dpp v82, v82, v82 row_ror:8 row_mask:0xf bank_mask:0xf
    v_pk_add_f32 v[40:41], v[40:41], v[80:81]
    v_pk_add_f32 v[42:43], v[42:43], v[80:81]
    v_add_f32_dpp v82, v82, v82 row_ror:4 row_mask:0xf bank_mask:0xf
    v_pk_add_f32 v[44:45], v[44:45], v[80:81]
    v_pk_add_f32 v[46:47], v[46:47], v[80:81]
    v_add_f32_dpp v82, v82, v82 row_ror:2 row_mask:0xf bank_mask:0xf
    v_pk_add_f32 v[48:49], v[48:49], v[80:81]
    v_pk_add_f32 v[50:51], v[50:51], v[80:81]
    v_add_f32_dpp v82, v82, v82 row_ror:1 row_mask:0xf bank_mask:0xf
    v_pk_add_f32 v[52:53], v[52:53], v[80:81]
    v_pk_add_f32 v[54:55], v[54:55], v[80:81]
    v_mov_b32 v83, v82
    v_pk_add_f32 v[56:57], v[56:57], v[80:81]
    v_pk_add_f32 v[58:59], v[58:59], v[80:81]
    v_permlane16_swap_b32 v83, v82
    v_add_f32 v82, v82, v83
    v_mul_f32 v82, 0x3acccccd, v82
    v_cvt_pk_bf16_f32 v82, v82, v82
    v_and_b32 v82, 0xffff0000, v82
    v_add_f32 v82, 0x3727c5ac, v82
    v_cvt_pk_bf16_f32 v82, v82, v82
    v_and_b32 v82, 0xffff0000, v82
    v_sqrt_f32 v82, v82
    v_cvt_pk_bf16_f32 v41, v40, v41
    v_cvt_pk_bf16_f32 v43, v42, v43
    v_cvt_pk_bf16_f32 v45, v44, v45
    v_cvt_pk_bf16_f32 v47, v46, v47
    v_cvt_pk_bf16_f32 v49, v48, v49
    v_cvt_pk_bf16_f32 v51, v50, v51
    v_cvt_pk_bf16_f32 v53, v52, v53
    v_cvt_pk_bf16_f32 v55, v54, v55
    v_cvt_pk_bf16_f32 v57, v56, v57
    v_cvt_pk_bf16_f32 v59, v58, v59
    v_cvt_pk_bf16_f32 v82, v82, v82
    v_and_b32 v82, 0xffff0000, v82
    v_rcp_f32 v82, v82
    v_lshlrev_b32 v40, 16, v41
    v_and_b32 v41, 0xffff0000, v41
    v_lshlrev_b32 v42, 16, v43
    v_and_b32 v43, 0xffff0000, v43
    v_lshlrev_b32 v44, 16, v45
    v_and_b32 v45, 0xffff0000, v45
    v_lshlrev_b32 v46, 16, v47
    v_and_b32 v47, 0xffff0000, v47
    v_lshlrev_b32 v48, 16, v49
    v_and_b32 v49, 0xffff0000, v49
    v_lshlrev_b32 v50, 16, v51
    v_and_b32 v51, 0xffff0000, v51
    v_lshlrev_b32 v52, 16, v53
    v_and_b32 v53, 0xffff0000, v53
    v_lshlrev_b32 v54, 16, v55
    v_and_b32 v55, 0xffff0000, v55
    v_lshlrev_b32 v56, 16, v57
    v_and_b32 v57, 0xffff0000, v57
    v_lshlrev_b32 v58, 16, v59
    v_and_b32 v59, 0xffff0000, v59
    v_mov_b32 v83, v82
    v_pk_mul_f32 v[40:41], v[40:41], v[82:83]
    v_pk_mul_f32 v[42:43], v[42:43], v[82:83]
    v_pk_mul_f32 v[44:45], v[44:45], v[82:83]
    v_pk_mul_f32 v[46:47], v[46:47], v[82:83]
    v_pk_mul_f32 v[48:49], v[48:49], v[82:83]
    v_pk_mul_f32 v[50:51], v[50:51], v[82:83]
    v_pk_mul_f32 v[52:53], v[52:53], v[82:83]
    v_pk_mul_f32 v[54:55], v[54:55], v[82:83]
    v_pk_mul_f32 v[56:57], v[56:57], v[82:83]
    v_pk_mul_f32 v[58:59], v[58:59], v[82:83]
    v_cvt_pk_bf16_f32 v70, v40, v41
    v_cvt_pk_bf16_f32 v71, v42, v43
    v_cvt_pk_bf16_f32 v72, v44, v45
    v_cvt_pk_bf16_f32 v73, v46, v47
    v_cvt_pk_bf16_f32 v74, v48, v49
    v_cvt_pk_bf16_f32 v75, v50, v51
    v_cvt_pk_bf16_f32 v76, v52, v53
    v_cvt_pk_bf16_f32 v77, v54, v55
    v_cvt_pk_bf16_f32 v78, v56, v57
    v_cvt_pk_bf16_f32 v79, v58, v59
    buffer_store_dwordx2 v[70:71], v2, s[8:11], s68 offen offset:2560 sc1
    buffer_store_dwordx2 v[72:73], v2, s[8:11], s68 offen offset:2816 sc1
    buffer_store_dwordx2 v[74:75], v2, s[8:11], s68 offen offset:3072 sc1
    buffer_store_dwordx2 v[76:77], v2, s[8:11], s68 offen offset:3328 sc1
    buffer_store_dwordx2 v[78:79], v2, s[8:11], s68 offen offset:3584 sc1
    s_waitcnt vmcnt(0)
    s_add_u32 s68, s65, 0
    v_mov_b32 v4, 1
    s_mov_b64 exec, 1
    buffer_store_dword v4, off, s[8:11], s68 sc1
    s_mov_b64 exec, -1
L_ln1d_3:
    v_lshlrev_b32 v7, 2, v0
L_wi_4:
    buffer_load_dword v6, v7, s[12:15], 0 offen sc1
    s_waitcnt vmcnt(0)
    v_cmp_ne_u32 vcc, 32, v6
    s_mov_b32 s60, 0x10101010
    s_mov_b32 s61, 0x10101010
    s_and_b64 s[62:63], vcc, s[60:61]
    s_cbranch_scc0 L_wid_5
    s_sleep 2
    s_sub_u32 s6, s6, 1
    s_cbranch_scc0 L_wi_4
    s_branch L_fail
L_wid_5:
    s_mov_b32 s60, 0x01010101
    s_mov_b32 s61, 0x01010101
    s_and_b64 s[62:63], vcc, s[60:61]
    s_cselect_b32 s7, 0, 1
    s_cmp_ge_u32 s70, 8
    s_cbranch_scc1 L_r
    s_lshr_b32 s72, s70, 2
    s_and_b32 s73, s70, 3
    s_lshl_b32 s60, s3, 2
    s_add_u32 s60, s60, s73
    s_mul_i32 s81, s60, 36864
    s_mul_i32 s61, s3, 1032192
    s_add_u32 s81, s81, s61
    s_mul_i32 s61, s72, 589824
    s_add_u32 s81, s81, s61
    s_add_u32 s81, s81, 116391936
    s_mul_i32 s82, s60, 6144
    s_mul_i32 s61, s3, 172032
    s_add_u32 s82, s82, s61
    s_mul_i32 s61, s72, 98304
    s_add_u32 s82, s82, s61
    s_add_u32 s82, s82, 91226112
    s_lshl_b32 s77, s72, 11
    s_lshl_b32 s61, s3, 8
    s_add_u32 s77, s77, s61
    s_mul_i32 s62, s73, 36
    s_add_u32 s77, s77, s62
    s_add_u32 s77, s77, 12288
    s_mul_i32 s62, s73, 48
    s_add_u32 s78, s61, s62
    s_add_u32 s78, s78, 16384
    s_mul_i32 s83, s72, 7
    v_lshlrev_b32 v2, 4, v0
    v_lshlrev_b32 v3, 3, v0
    v_and_b32 v8, 7, v0
    v_lshrrev_b32 v9, 5, v0
    v_lshlrev_b32 v8, 4, v8
    v_lshl_add_u32 v5, v9, 7, v8
    v_min_u32 v8, 8, v0
    v_lshlrev_b32 v6, 2, v8
    v_min_u32 v8, 11, v0
    v_lshlrev_b32 v7, 2, v8
    v_and_b32 v8, 31, v0
    v_lshlrev_b32 v9, 2, v9
    v_sub_u32 v8, v8, v9
    v_mov_b32 v10, 0xf149f2ca
    v_cmp_gt_i32 vcc, 0, v8
    s_nop 1
    v_cndmask_b32 v16, 0, v10, vcc
    v_cmp_gt_i32 vcc, 1, v8
    s_nop 1
    v_cndmask_b32 v17, 0, v10, vcc
    v_cmp_gt_i32 vcc, 2, v8
    s_nop 1
    v_cndmask_b32 v18, 0, v10, vcc
    v_cmp_gt_i32 vcc, 3, v8
    s_nop 1
    v_cndmask_b32 v19, 0, v10, vcc
    v_cmp_gt_i32 vcc, 8, v8
    s_nop 1
    v_cndmask_b32 v20, 0, v10, vcc
    v_cmp_gt_i32 vcc, 9, v8
    s_nop 1
    v_cndmask_b32 v21, 0, v10, vcc
    v_cmp_gt_i32 vcc, 10, v8
    s_nop 1
    v_cndmask_b32 v22, 0, v10, vcc
    v_cmp_gt_i32 vcc, 11, v8
    s_nop 1
    v_cndmask_b32 v23, 0, v10, vcc
    v_cmp_gt_i32 vcc, 16, v8
    s_nop 1
    v_cndmask_b32 v24, 0, v10, vcc
    v_cmp_gt_i32 vcc, 17, v8
    s_nop 1
    v_cndmask_b32 v25, 0, v10, vcc
    v_cmp_gt_i32 vcc, 18, v8
    s_nop 1
    v_cndmask_b32 v26, 0, v10, vcc
    v_cmp_gt_i32 vcc, 19, v8
    s_nop 1
    v_cndmask_b32 v27, 0, v10, vcc
    v_cmp_gt_i32 vcc, 24, v8
    s_nop 1
    v_cndmask_b32 v28, 0, v10, vcc
    v_cmp_gt_i32 vcc, 25, v8
    s_nop 1
    v_cndmask_b32 v29, 0, v10, vcc
    v_cmp_gt_i32 vcc, 26, v8
    s_nop 1
    v_cndmask_b32 v30, 0, v10, vcc
    v_cmp_gt_i32 vcc, 27, v8
    s_nop 1
    v_cndmask_b32 v31, 0, v10, vcc
    s_mov_b32 s84, 0x3dd53b95
    s_mov_b32 s74, 0
    s_mov_b32 s80, 1
L_at_loop:
L_poll_6:
    buffer_load_dword v4, v6, s[8:11], s77 offen offset:0 sc1
    s_waitcnt vmcnt(0)
    v_cmp_gt_u32 vcc, s80, v4
    s_cbranch_vccz L_pok_7
    s_sleep 1
    s_sub_u32 s6, s6, 1
    s_cbranch_scc0 L_poll_6
    s_branch L_fail
L_pok_7:
L_at_go:
    s_and_b32 s60, s74, 3
    s_mul_i32 s75, s60, 147456
    s_add_u32 s75, s75, s81
    s_mul_i32 s76, s60, 24576
    s_add_u32 s76, s76, s82
    s_add_u32 s85, s75, 4096
    s_add_u32 s86, s75, 8192
    s_add_u32 s87, s75, 12288
    s_add_u32 s88, s75, 16384
    s_add_u32 s89, s75, 20480
    s_add_u32 s90, s75, 24576
    s_add_u32 s91, s75, 28672
    s_add_u32 s92, s75, 32768
    buffer_load_dwordx4 a[48:51], v2, s[8:11], s87 offen offset:0 sc1
    buffer_load_dwordx4 a[0:3], v2, s[8:11], s75 offen offset:0 sc1
    buffer_load_dwordx4 a[52:55], v2, s[8:11], s87 offen offset:1024 sc1
    buffer_load_dwordx4 a[4:7], v2, s[8:11], s75 offen offset:1024 sc1
    buffer_load_dwordx4 a[56:59], v2, s[8:11], s87 offen offset:2048 sc1
    buffer_load_dwordx4 a[8:11], v2, s[8:11], s75 offen offset:2048 sc1
    buffer_load_dwordx4 a[60:63], v2, s[8:11], s87 offen offset:3072 sc1
    buffer_load_dwordx4 a[12:15], v2, s[8:11], s75 offen offset:3072 sc1
    buffer_load_dwordx4 a[64:67], v2, s[8:11], s88 offen offset:0 sc1
    buffer_load_dwordx4 a[16:19], v2, s[8:11], s85 offen offset:0 sc1
    buffer_load_dwordx4 a[68:71], v2, s[8:11], s88 offen offset:1024 sc1
    buffer_load_dwordx4 a[20:23], v2, s[8:11], s85 offen offset:1024 sc1
    buffer_load_dwordx4 a[72:75], v2, s[8:11], s88 offen offset:2048 sc1
    buffer_load_dwordx4 a[24:27], v2, s[8:11], s85 offen offset:2048 sc1
    buffer_load_dwordx4 a[76:79], v2, s[8:11], s88 offen offset:3072 sc1
    buffer_load_dwordx4 a[28:31], v2, s[8:11], s85 offen offset:3072 sc1
    buffer_load_dwordx4 a[80:83], v2, s[8:11], s89 offen offset:0 sc1
    buffer_load_dwordx4 a[32:35], v2, s[8:11], s86 offen offset:0 sc1
    buffer_load_dwordx4 a[84:87], v2, s[8:11], s89 offen offset:1024 sc1
    buffer_load_dwordx4 a[36:39], v2, s[8:11], s86 offen offset:1024 sc1
    buffer_load_dwordx4 a[88:91], v2, s[8:11], s89 offen offset:2048 sc1
    buffer_load_dwordx4 a[40:43], v2, s[8:11], s86 offen offset:2048 sc1
    buffer_load_dwordx4 a[92:95], v2, s[8:11], s89 offen offset:3072 sc1
    buffer_load_dwordx4 a[44:47], v2, s[8:11], s86 offen offset:3072 sc1
    buffer_load_dwordx4 a[96:99], v2, s[8:11], s90 offen offset:0 sc1
    buffer_load_dwordx4 a[100:103], v2, s[8:11], s90 offen offset:1024 sc1
    buffer_load_dwordx4 a[104:107], v2, s[8:11], s90 offen offset:2048 sc1
    buffer_load_dwordx4 a[108:111], v2, s[8:11], s90 offen offset:3072 sc1
    buffer_load_dwordx4 a[112:115], v2, s[8:11], s91 offen offset:0 sc1
    buffer_load_dwordx4 a[116:119], v2, s[8:11], s91 offen offset:1024 sc1
    buffer_load_dwordx4 a[120:123], v2, s[8:11], s91 offen offset:2048 sc1
    buffer_load_dwordx4 a[124:127], v2, s[8:11], s91 offen offset:3072 sc1
    buffer_load_dwordx4 a[128:131], v2, s[8:11], s92 offen offset:0 sc1
    buffer_load_dwordx4 a[132:135], v2, s[8:11], s92 offen offset:1024 sc1
    buffer_load_dwordx4 a[136:139], v2, s[8:11], s92 offen offset:2048 sc1
    buffer_load_dwordx4 a[140:143], v2, s[8:11], s92 offen offset:3072 sc1
L_at_have:
    s_waitcnt vmcnt(34)
    v_mfma_f32_32x32x16_bf16 v[32:47], a[48:51], a[0:3], v[16:31]
    s_waitcnt vmcnt(32)
    v_mfma_f32_32x32x16_bf16 v[32:47], a[52:55], a[4:7], v[32:47]
    s_waitcnt vmcnt(30)
    v_mfma_f32_32x32x16_bf16 v[32:47], a[56:59], a[8:11], v[32:47]
    s_waitcnt vmcnt(28)
    v_mfma_f32_32x32x16_bf16 v[32:47], a[60:63], a[12:15], v[32:47]
    s_waitcnt vmcnt(26)
    v_mfma_f32_32x32x16_bf16 v[32:47], a[64:67], a[16:19], v[32:47]
    s_waitcnt vmcnt(24)
    v_mfma_f32_32x32x16_bf16 v[32:47], a[68:71], a[20:23], v[32:47]
    s_waitcnt vmcnt(22)
    v_mfma_f32_32x32x16_bf16 v[32:47], a[72:75], a[24:27], v[32:47]
    s_waitcnt vmcnt(20)
    v_mfma_f32_32x32x16_bf16 v[32:47], a[76:79], a[28:31], v[32:47]
    s_waitcnt vmcnt(18)
    v_mfma_f32_32x32x16_bf16 v[32:47], a[80:83], a[32:35], v[32:47]
    s_waitcnt vmcnt(16)
    v_mfma_f32_32x32x16_bf16 v[32:47], a[84:87], a[36:39], v[32:47]
    s_waitcnt vmcnt(14)
    v_mfma_f32_32x32x16_bf16 v[32:47], a[88:91], a[40:43], v[32:47]
    s_waitcnt vmcnt(12)
    v_mfma_f32_32x32x16_bf16 v[32:47], a[92:95], a[44:47], v[32:47]
    s_nop 11
    v_max3_f32 v8, v32, v33, v34
    v_max3_f32 v9, v35, v36, v37
    v_max3_f32 v8, v8, v38, v39
    v_max3_f32 v9, v9, v40, v41
    v_max3_f32 v8, v8, v42, v43
    v_max3_f32 v9, v9, v44, v45
    v_max3_f32 v8, v8, v46, v47
    v_max_f32 v8, v8, v9
    v_mov_b32 v9, v8
    s_nop 1
    v_permlane32_swap_b32 v9, v8
    v_max_f32 v8, v8, v9
    v_mul_f32 v12, s84, v8
    v_fma_f32 v32, v32, s84, -v12
    v_fma_f32 v33, v33, s84, -v12
    v_fma_f32 v34, v34, s84, -v12
    v_fma_f32 v35, v35, s84, -v12
    v_fma_f32 v36, v36, s84, -v12
    v_fma_f32 v37, v37, s84, -v12
    v_fma_f32 v38, v38, s84, -v12
    v_fma_f32 v39, v39, s84, -v12
    v_fma_f32 v40, v40, s84, -v12
    v_fma_f32 v41, v41, s84, -v12
    v_fma_f32 v42, v42, s84, -v12
    v_fma_f32 v43, v43, s84, -v12
    v_fma_f32 v44, v44, s84, -v12
    v_fma_f32 v45, v45, s84, -v12
    v_fma_f32 v46, v46, s84, -v12
    v_fma_f32 v47, v47, s84, -v12
    v_exp_f32 v32, v32
    v_exp_f32 v33, v33
    v_exp_f32 v34, v34
    v_exp_f32 v35, v35
    v_exp_f32 v36, v36
    v_exp_f32 v37, v37
    v_exp_f32 v38, v38
    v_exp_f32 v39, v39
    v_exp_f32 v40, v40
    v_exp_f32 v41, v41
    v_exp_f32 v42, v42
    v_exp_f32 v43, v43
    v_exp_f32 v44, v44
    v_exp_f32 v45, v45
    v_exp_f32 v46, v46
    v_exp_f32 v47, v47
    v_cvt_pk_bf16_f32 v124, v32, v33
    v_cvt_pk_bf16_f32 v125, v34, v35
    v_cvt_pk_bf16_f32 v126, v36, v37
    v_cvt_pk_bf16_f32 v127, v38, v39
    v_cvt_pk_bf16_f32 v128, v40, v41
    v_cvt_pk_bf16_f32 v129, v42, v43
    v_cvt_pk_bf16_f32 v130, v44, v45
    v_cvt_pk_bf16_f32 v131, v46, v47
    s_waitcnt vmcnt(0)
    buffer_load_dword v4, v7, s[8:11], s78 offen sc1
    v_mfma_f32_32x32x16_bf16 v[136:151], a[96:99], v[124:127], 0
    v_mfma_f32_32x32x16_bf16 v[136:151], a[100:103], v[128:131], v[136:151]
    v_pk_add_f32 v[8:9], v[32:33], v[34:35]
    v_pk_add_f32 v[10:11], v[36:37], v[38:39]
    v_mfma_f32_32x32x16_bf16 v[152:167], a[104:107], v[124:127], 0
    v_mfma_f32_32x32x16_bf16 v[152:167], a[108:111], v[128:131], v[152:167]
    v_pk_add_f32 v[8:9], v[8:9], v[40:41]
    v_pk_add_f32 v[10:11], v[10:11], v[42:43]
    v_mfma_f32_32x32x16_bf16 v[168:183], a[112:115], v[124:127], 0
    v_mfma_f32_32x32x16_bf16 v[168:183], a[116:119], v[128:131], v[168:183]
    v_pk_add_f32 v[8:9], v[8:9], v[44:45]
    v_pk_add_f32 v[10:11], v[10:11], v[46:47]
    v_mfma_f32_32x32x16_bf16 v[184:199], a[120:123], v[124:127], 0
    v_mfma_f32_32x32x16_bf16 v[184:199], a[124:127], v[128:131], v[184:199]
    v_pk_add_f32 v[8:9], v[8:9], v[10:11]
    v_add_f32 v13, v8, v9
    v_mfma_f32_32x32x16_bf16 v[200:215], a[128:131], v[124:127], 0
    v_mfma_f32_32x32x16_bf16 v[200:215], a[132:135], v[128:131], v[200:215]
    v_mfma_f32_32x32x16_bf16 v[216:231], a[136:139], v[124:127], 0
    v_mfma_f32_32x32x16_bf16 v[216:231], a[140:143], v[128:131], v[216:231]
    s_add_u32 s80, s80, s83
    s_waitcnt vmcnt(0)
    v_cmp_gt_u32 vcc, s80, v4
    s_cbranch_vccz L_at_ch
L_poll_8:
    buffer_load_dword v4, v7, s[8:11], s78 offen offset:0 sc1
    s_waitcnt vmcnt(0)
    v_cmp_gt_u32 vcc, s80, v4
    s_cbranch_vccz L_pok_9
    s_sleep 1
    s_sub_u32 s6, s6, 1
    s_cbranch_scc0 L_poll_8
    s_branch L_fail
L_pok_9:
    s_cmp_eq_u32 s72, 0
    s_cbranch_scc1 L_at_ch
    s_cmp_ge_u32 s74, 57
    s_cbranch_scc1 L_at_ch
    s_sleep 6
L_at_ch:
    buffer_load_dwordx4 v[64:67], v2, s[8:11], s76 offen offset:0 sc1
    buffer_load_dwordx4 v[68:71], v2, s[8:11], s76 offen offset:1024 sc1
    buffer_load_dwordx4 v[72:75], v2, s[8:11], s76 offen offset:2048 sc1
    s_add_u32 s79, s76, 3072
    buffer_load_dwordx4 v[112:115], v2, s[8:11], s79 offen offset:0 sc1
    buffer_load_dwordx4 v[116:119], v2, s[8:11], s79 offen offset:1024 sc1
    buffer_load_dwordx4 v[120:123], v2, s[8:11], s79 offen offset:2048 sc1
    buffer_load_dword v5, v6, s[8:11], s77 offen sc1
    buffer_load_dword v3, v7, s[8:11], s78 offen sc1
    s_waitcnt vmcnt(7)
    v_mfma_f32_32x32x16_bf16 v[48:63], v[64:67], a[0:3], 0
    v_mfma_f32_32x32x16_bf16 v[76:91], v[64:67], a[4:7], 0
    v_mfma_f32_32x32x16_bf16 v[92:107], v[64:67], a[8:11], 0
    v_mfma_f32_32x32x16_bf16 v[32:47], v[64:67], a[12:15], 0
    s_waitcnt vmcnt(6)
    v_mfma_f32_32x32x16_bf16 v[48:63], v[68:71], a[16:19], v[48:63]
    v_mfma_f32_32x32x16_bf16 v[76:91], v[68:71], a[20:23], v[76:91]
    v_mfma_f32_32x32x16_bf16 v[92:107], v[68:71], a[24:27], v[92:107]
    v_mfma_f32_32x32x16_bf16 v[32:47], v[68:71], a[28:31], v[32:47]
    s_waitcnt vmcnt(5)
    v_mfma_f32_32x32x16_bf16 v[48:63], v[72:75], a[32:35], v[48:63]
    v_mfma_f32_32x32x16_bf16 v[76:91], v[72:75], a[36:39], v[76:91]
    v_mfma_f32_32x32x16_bf16 v[92:107], v[72:75], a[40:43], v[92:107]
    v_mfma_f32_32x32x16_bf16 v[32:47], v[72:75], a[44:47], v[32:47]
    s_nop 9
    v_pk_add_f32 v[48:49], v[48:49], v[80:81]
    v_pk_add_f32 v[50:51], v[50:51], v[82:83]
    v_pk_add_f32 v[48:49], v[48:49], v[100:101]
    v_pk_add_f32 v[50:51], v[50:51], v[102:103]
    v_pk_add_f32 v[48:49], v[48:49], v[44:45]
    v_pk_add_f32 v[50:51], v[50:51], v[46:47]
    v_max3_f32 v8, v48, v49, v50
    v_max_f32 v8, v8, v51
    v_mov_b32 v9, v8
    s_nop 1
    v_permlane32_swap_b32 v9, v8
    v_max_f32 v8, v8, v9
    v_mul_f32 v8, s84, v8
    v_max_f32 v8, v8, v12
    v_sub_f32 v10, v12, v8
    v_fma_f32 v48, v48, s84, -v8
    v_fma_f32 v49, v49, s84, -v8
    v_fma_f32 v50, v50, s84, -v8
    v_fma_f32 v51, v51, s84, -v8
    v_exp_f32 v10, v10
    v_exp_f32 v48, v48
    v_exp_f32 v49, v49
    v_exp_f32 v50, v50
    v_exp_f32 v51, v51
    v_add_f32 v8, v48, v49
    v_add_f32 v9, v50, v51
    v_fma_f32 v8, v13, v10, v8
    v_add_f32 v8, v8, v9
    v_mov_b32 v9, v8
    s_nop 1
    v_permlane32_swap_b32 v9, v8
    v_add_f32 v8, v8, v9
    v_rcp_f32 v8, v8
    s_nop 0
    v_mul_f32 v10, v10, v8
    v_mul_f32 v48, v48, v8
    v_mul_f32 v49, v49, v8
    v_mul_f32 v50, v50, v8
    v_mul_f32 v51, v51, v8
    v_mov_b32 v11, v10
    v_cvt_pk_bf16_f32 v132, v48, v49
    v_cvt_pk_bf16_f32 v133, v50, v51
    s_cmp_eq_u32 s7, 0
    s_cbranch_scc1 L_at_os
    v_pk_mul_f32 v[136:137], v[136:137], v[10:11]
    v_pk_mul_f32 v[138:139], v[138:139], v[10:11]
    v_pk_mul_f32 v[140:141], v[140:141], v[10:11]
    v_pk_mul_f32 v[142:143], v[142:143], v[10:11]
    v_pk_mul_f32 v[144:145], v[144:145], v[10:11]
    v_pk_mul_f32 v[146:147], v[146:147], v[10:11]
    v_pk_mul_f32 v[148:149], v[148:149], v[10:11]
    v_pk_mul_f32 v[150:151], v[150:151], v[10:11]
    s_waitcnt vmcnt(0)
    s_nop 0
    v_mfma_f32_32x32x8_bf16 v[136:151], v[112:113], v[132:133], v[136:151]
    v_pk_mul_f32 v[152:153], v[152:153], v[10:11]
    v_pk_mul_f32 v[154:155], v[154:155], v[10:11]
    v_pk_mul_f32 v[156:157], v[156:157], v[10:11]
    v_pk_mul_f32 v[158:159], v[158:159], v[10:11]
    v_pk_mul_f32 v[160:161], v[160:161], v[10:11]
    v_pk_mul_f32 v[162:163], v[162:163], v[10:11]
    v_pk_mul_f32 v[164:165], v[164:165], v[10:11]
    v_pk_mul_f32 v[166:167], v[166:167], v[10:11]
    s_nop 1
    v_mfma_f32_32x32x8_bf16 v[152:167], v[114:115], v[132:133], v[152:167]
    v_pk_mul_f32 v[168:169], v[168:169], v[10:11]
    v_pk_mul_f32 v[170:171], v[170:171], v[10:11]
    v_pk_mul_f32 v[172:173], v[172:173], v[10:11]
    v_pk_mul_f32 v[174:175], v[174:175], v[10:11]
    v_pk_mul_f32 v[176:177], v[176:177], v[10:11]
    v_pk_mul_f32 v[178:179], v[178:179], v[10:11]
    v_pk_mul_f32 v[180:181], v[180:181], v[10:11]
    v_pk_mul_f32 v[182:183], v[182:183], v[10:11]
    s_nop 1
    v_mfma_f32_32x32x8_bf16 v[168:183], v[116:117], v[132:133], v[168:183]
    v_cvt_pk_bf16_f32 v64, v136, v137
    v_cvt_pk_bf16_f32 v65, v138, v139
    v_cvt_pk_bf16_f32 v66, v140, v141
    v_cvt_pk_bf16_f32 v67, v142, v143
    v_cvt_pk_bf16_f32 v68, v144, v145
    v_cvt_pk_bf16_f32 v69, v146, v147
    v_cvt_pk_bf16_f32 v70, v148, v149
    v_cvt_pk_bf16_f32 v71, v150, v151
    s_add_u32 s79, s75, 0
    buffer_store_dwordx4 v[64:67], v2, s[8:11], s79 offen offset:0
    buffer_store_dwordx4 v[68:71], v2, s[8:11], s79 offen offset:1024
    v_pk_mul_f32 v[184:185], v[184:185], v[10:11]
    v_pk_mul_f32 v[186:187], v[186:187], v[10:11]
    v_pk_mul_f32 v[188:189], v[188:189], v[10:11]
    v_pk_mul_f32 v[190:191], v[190:191], v[10:11]
    v_pk_mul_f32 v[192:193], v[192:193], v[10:11]
    v_pk_mul_f32 v[194:195], v[194:195], v[10:11]
    v_pk_mul_f32 v[196:197], v[196:197], v[10:11]
    v_pk_mul_f32 v[198:199], v[198:199], v[10:11]
    s_nop 1
    v_mfma_f32_32x32x8_bf16 v[184:199], v[118:119], v[132:133], v[184:199]
    v_cvt_pk_bf16_f32 v72, v152, v153
    v_cvt_pk_bf16_f32 v73, v154, v155
    v_cvt_pk_bf16_f32 v74, v156, v157
    v_cvt_pk_bf16_f32 v75, v158, v159
    v_cvt_pk_bf16_f32 v76, v160, v161
    v_cvt_pk_bf16_f32 v77, v162, v163
    v_cvt_pk_bf16_f32 v78, v164, v165
    v_cvt_pk_bf16_f32 v79, v166, v167
    buffer_store_dwordx4 v[72:75], v2, s[8:11], s79 offen offset:2048
    buffer_store_dwordx4 v[76:79], v2, s[8:11], s79 offen offset:3072
    v_pk_mul_f32 v[200:201], v[200:201], v[10:11]
    v_pk_mul_f32 v[202:203], v[202:203], v[10:11]
    v_pk_mul_f32 v[204:205], v[204:205], v[10:11]
    v_pk_mul_f32 v[206:207], v[206:207], v[10:11]
    v_pk_mul_f32 v[208:209], v[208:209], v[10:11]
    v_pk_mul_f32 v[210:211], v[210:211], v[10:11]
    v_pk_mul_f32 v[212:213], v[212:213], v[10:11]
    v_pk_mul_f32 v[214:215], v[214:215], v[10:11]
    s_nop 1
    v_mfma_f32_32x32x8_bf16 v[200:215], v[120:121], v[132:133], v[200:215]
    v_cvt_pk_bf16_f32 v80, v168, v169
    v_cvt_pk_bf16_f32 v81, v170, v171
    v_cvt_pk_bf16_f32 v82, v172, v173
    v_cvt_pk_bf16_f32 v83, v174, v175
    v_cvt_pk_bf16_f32 v84, v176, v177
    v_cvt_pk_bf16_f32 v85, v178, v179
    v_cvt_pk_bf16_f32 v86, v180, v181
    v_cvt_pk_bf16_f32 v87, v182, v183
    s_add_u32 s79, s75, 4096
    buffer_store_dwordx4 v[80:83], v2, s[8:11], s79 offen offset:0
    buffer_store_dwordx4 v[84:87], v2, s[8:11], s79 offen offset:1024
    v_pk_mul_f32 v[216:217], v[216:217], v[10:11]
    v_pk_mul_f32 v[218:219], v[218:219], v[10:11]
    v_pk_mul_f32 v[220:221], v[220:221], v[10:11]
    v_pk_mul_f32 v[222:223], v[222:223], v[10:11]
    v_pk_mul_f32 v[224:225], v[224:225], v[10:11]
    v_pk_mul_f32 v[226:227], v[226:227], v[10:11]
    v_pk_mul_f32 v[228:229], v[228:229], v[10:11]
    v_pk_mul_f32 v[230:231], v[230:231], v[10:11]
    s_nop 1
    v_mfma_f32_32x32x8_bf16 v[216:231], v[122:123], v[132:133], v[216:231]
    v_cvt_pk_bf16_f32 v88, v184, v185
    v_cvt_pk_bf16_f32 v89, v186, v187
    v_cvt_pk_bf16_f32 v90, v188, v189
    v_cvt_pk_bf16_f32 v91, v190, v191
    v_cvt_pk_bf16_f32 v92, v192, v193
    v_cvt_pk_bf16_f32 v93, v194, v195
    v_cvt_pk_bf16_f32 v94, v196, v197
    v_cvt_pk_bf16_f32 v95, v198, v199
    buffer_store_dwordx4 v[88:91], v2, s[8:11], s79 offen offset:2048
    buffer_store_dwordx4 v[92:95], v2, s[8:11], s79 offen offset:3072
    v_cvt_pk_bf16_f32 v96, v200, v201
    v_cvt_pk_bf16_f32 v97, v202, v203
    v_cvt_pk_bf16_f32 v98, v204, v205
    v_cvt_pk_bf16_f32 v99, v206, v207
    v_cvt_pk_bf16_f32 v100, v208, v209
    v_cvt_pk_bf16_f32 v101, v210, v211
    v_cvt_pk_bf16_f32 v102, v212, v213
    v_cvt_pk_bf16_f32 v103, v214, v215
    s_add_u32 s79, s75, 8192
    buffer_store_dwordx4 v[96:99], v2, s[8:11], s79 offen offset:0
    buffer_store_dwordx4 v[100:103], v2, s[8:11], s79 offen offset:1024
    v_cvt_pk_bf16_f32 v104, v216, v217
    v_cvt_pk_bf16_f32 v105, v218, v219
    v_cvt_pk_bf16_f32 v106, v220, v221
    v_cvt_pk_bf16_f32 v107, v222, v223
    v_cvt_pk_bf16_f32 v108, v224, v225
    v_cvt_pk_bf16_f32 v109, v226, v227
    v_cvt_pk_bf16_f32 v110, v228, v229
    v_cvt_pk_bf16_f32 v111, v230, v231
    buffer_store_dwordx4 v[104:107], v2, s[8:11], s79 offen offset:2048
    buffer_store_dwordx4 v[108:111], v2, s[8:11], s79 offen offset:3072
    s_branch L_at_oe
L_at_os:
    v_pk_mul_f32 v[136:137], v[136:137], v[10:11]
    v_pk_mul_f32 v[138:139], v[138:139], v[10:11]
    v_pk_mul_f32 v[140:141], v[140:141], v[10:11]
    v_pk_mul_f32 v[142:143], v[142:143], v[10:11]
    v_pk_mul_f32 v[144:145], v[144:145], v[10:11]
    v_pk_mul_f32 v[146:147], v[146:147], v[10:11]
    v_pk_mul_f32 v[148:149], v[148:149], v[10:11]
    v_pk_mul_f32 v[150:151], v[150:151], v[10:11]
    s_waitcnt vmcnt(0)
    s_nop 0
    v_mfma_f32_32x32x8_bf16 v[136:151], v[112:113], v[132:133], v[136:151]
    v_pk_mul_f32 v[152:153], v[152:153], v[10:11]
    v_pk_mul_f32 v[154:155], v[154:155], v[10:11]
    v_pk_mul_f32 v[156:157], v[156:157], v[10:11]
    v_pk_mul_f32 v[158:159], v[158:159], v[10:11]
    v_pk_mul_f32 v[160:161], v[160:161], v[10:11]
    v_pk_mul_f32 v[162:163], v[162:163], v[10:11]
    v_pk_mul_f32 v[164:165], v[164:165], v[10:11]
    v_pk_mul_f32 v[166:167], v[166:167], v[10:11]
    s_nop 1
    v_mfma_f32_32x32x8_bf16 v[152:167], v[114:115], v[132:133], v[152:167]
    v_pk_mul_f32 v[168:169], v[168:169], v[10:11]
    v_pk_mul_f32 v[170:171], v[170:171], v[10:11]
    v_pk_mul_f32 v[172:173], v[172:173], v[10:11]
    v_pk_mul_f32 v[174:175], v[174:175], v[10:11]
    v_pk_mul_f32 v[176:177], v[176:177], v[10:11]
    v_pk_mul_f32 v[178:179], v[178:179], v[10:11]
    v_pk_mul_f32 v[180:181], v[180:181], v[10:11]
    v_pk_mul_f32 v[182:183], v[182:183], v[10:11]
    s_nop 1
    v_mfma_f32_32x32x8_bf16 v[168:183], v[116:117], v[132:133], v[168:183]
    v_cvt_pk_bf16_f32 v64, v136, v137
    v_cvt_pk_bf16_f32 v65, v138, v139
    v_cvt_pk_bf16_f32 v66, v140, v141
    v_cvt_pk_bf16_f32 v67, v142, v143
    v_cvt_pk_bf16_f32 v68, v144, v145
    v_cvt_pk_bf16_f32 v69, v146, v147
    v_cvt_pk_bf16_f32 v70, v148, v149
    v_cvt_pk_bf16_f32 v71, v150, v151
    s_add_u32 s79, s75, 0
    buffer_store_dwordx4 v[64:67], v2, s[8:11], s79 offen offset:0 sc1
    buffer_store_dwordx4 v[68:71], v2, s[8:11], s79 offen offset:1024 sc1
    v_pk_mul_f32 v[184:185], v[184:185], v[10:11]
    v_pk_mul_f32 v[186:187], v[186:187], v[10:11]
    v_pk_mul_f32 v[188:189], v[188:189], v[10:11]
    v_pk_mul_f32 v[190:191], v[190:191], v[10:11]
    v_pk_mul_f32 v[192:193], v[192:193], v[10:11]
    v_pk_mul_f32 v[194:195], v[194:195], v[10:11]
    v_pk_mul_f32 v[196:197], v[196:197], v[10:11]
    v_pk_mul_f32 v[198:199], v[198:199], v[10:11]
    s_nop 1
    v_mfma_f32_32x32x8_bf16 v[184:199], v[118:119], v[132:133], v[184:199]
    v_cvt_pk_bf16_f32 v72, v152, v153
    v_cvt_pk_bf16_f32 v73, v154, v155
    v_cvt_pk_bf16_f32 v74, v156, v157
    v_cvt_pk_bf16_f32 v75, v158, v159
    v_cvt_pk_bf16_f32 v76, v160, v161
    v_cvt_pk_bf16_f32 v77, v162, v163
    v_cvt_pk_bf16_f32 v78, v164, v165
    v_cvt_pk_bf16_f32 v79, v166, v167
    buffer_store_dwordx4 v[72:75], v2, s[8:11], s79 offen offset:2048 sc1
    buffer_store_dwordx4 v[76:79], v2, s[8:11], s79 offen offset:3072 sc1
    v_pk_mul_f32 v[200:201], v[200:201], v[10:11]
    v_pk_mul_f32 v[202:203], v[202:203], v[10:11]
    v_pk_mul_f32 v[204:205], v[204:205], v[10:11]
    v_pk_mul_f32 v[206:207], v[206:207], v[10:11]
    v_pk_mul_f32 v[208:209], v[208:209], v[10:11]
    v_pk_mul_f32 v[210:211], v[210:211], v[10:11]
    v_pk_mul_f32 v[212:213], v[212:213], v[10:11]
    v_pk_mul_f32 v[214:215], v[214:215], v[10:11]
    s_nop 1
    v_mfma_f32_32x32x8_bf16 v[200:215], v[120:121], v[132:133], v[200:215]
    v_cvt_pk_bf16_f32 v80, v168, v169
    v_cvt_pk_bf16_f32 v81, v170, v171
    v_cvt_pk_bf16_f32 v82, v172, v173
    v_cvt_pk_bf16_f32 v83, v174, v175
    v_cvt_pk_bf16_f32 v84, v176, v177
    v_cvt_pk_bf16_f32 v85, v178, v179
    v_cvt_pk_bf16_f32 v86, v180, v181
    v_cvt_pk_bf16_f32 v87, v182, v183
    s_add_u32 s79, s75, 4096
    buffer_store_dwordx4 v[80:83], v2, s[8:11], s79 offen offset:0 sc1
    buffer_store_dwordx4 v[84:87], v2, s[8:11], s79 offen offset:1024 sc1
    v_pk_mul_f32 v[216:217], v[216:217], v[10:11]
    v_pk_mul_f32 v[218:219], v[218:219], v[10:11]
    v_pk_mul_f32 v[220:221], v[220:221], v[10:11]
    v_pk_mul_f32 v[222:223], v[222:223], v[10:11]
    v_pk_mul_f32 v[224:225], v[224:225], v[10:11]
    v_pk_mul_f32 v[226:227], v[226:227], v[10:11]
    v_pk_mul_f32 v[228:229], v[228:229], v[10:11]
    v_pk_mul_f32 v[230:231], v[230:231], v[10:11]
    s_nop 1
    v_mfma_f32_32x32x8_bf16 v[216:231], v[122:123], v[132:133], v[216:231]
    v_cvt_pk_bf16_f32 v88, v184, v185
    v_cvt_pk_bf16_f32 v89, v186, v187
    v_cvt_pk_bf16_f32 v90, v188, v189
    v_cvt_pk_bf16_f32 v91, v190, v191
    v_cvt_pk_bf16_f32 v92, v192, v193
    v_cvt_pk_bf16_f32 v93, v194, v195
    v_cvt_pk_bf16_f32 v94, v196, v197
    v_cvt_pk_bf16_f32 v95, v198, v199
    buffer_store_dwordx4 v[88:91], v2, s[8:11], s79 offen offset:2048 sc1
    buffer_store_dwordx4 v[92:95], v2, s[8:11], s79 offen offset:3072 sc1
    v_cvt_pk_bf16_f32 v96, v200, v201
    v_cvt_pk_bf16_f32 v97, v202, v203
    v_cvt_pk_bf16_f32 v98, v204, v205
    v_cvt_pk_bf16_f32 v99, v206, v207
    v_cvt_pk_bf16_f32 v100, v208, v209
    v_cvt_pk_bf16_f32 v101, v210, v211
    v_cvt_pk_bf16_f32 v102, v212, v213
    v_cvt_pk_bf16_f32 v103, v214, v215
    s_add_u32 s79, s75, 8192
    buffer_store_dwordx4 v[96:99], v2, s[8:11], s79 offen offset:0 sc1
    buffer_store_dwordx4 v[100:103], v2, s[8:11], s79 offen offset:1024 sc1
    v_cvt_pk_bf16_f32 v104, v216, v217
    v_cvt_pk_bf16_f32 v105, v218, v219
    v_cvt_pk_bf16_f32 v106, v220, v221
    v_cvt_pk_bf16_f32 v107, v222, v223
    v_cvt_pk_bf16_f32 v108, v224, v225
    v_cvt_pk_bf16_f32 v109, v226, v227
    v_cvt_pk_bf16_f32 v110, v228, v229
    v_cvt_pk_bf16_f32 v111, v230, v231
    buffer_store_dwordx4 v[104:107], v2, s[8:11], s79 offen offset:2048 sc1
    buffer_store_dwordx4 v[108:111], v2, s[8:11], s79 offen offset:3072 sc1
L_at_oe:
    s_add_u32 s74, s74, 1
    s_add_u32 s80, s74, 1
    v_cmp_gt_u32 vcc, s80, v5
    s_cbranch_vccnz L_at_plain
    s_cmp_lg_u32 s72, 0
    s_cbranch_scc1 L_at_ov
    v_cmp_gt_u32 vcc, s80, v3
    s_cbranch_vccnz L_at_plain
L_at_ov:
    s_and_b32 s60, s74, 3
    s_mul_i32 s75, s60, 147456
    s_add_u32 s75, s75, s81
    s_mul_i32 s76, s60, 24576
    s_add_u32 s76, s76, s82
    s_add_u32 s85, s75, 4096
    s_add_u32 s86, s75, 8192
    s_add_u32 s87, s75, 12288
    s_add_u32 s88, s75, 16384
    s_add_u32 s89, s75, 20480
    s_add_u32 s90, s75, 24576
    s_add_u32 s91, s75, 28672
    s_add_u32 s92, s75, 32768
    buffer_load_dwordx4 a[48:51], v2, s[8:11], s87 offen offset:0 sc1
    buffer_load_dwordx4 a[0:3], v2, s[8:11], s75 offen offset:0 sc1
    buffer_load_dwordx4 a[52:55], v2, s[8:11], s87 offen offset:1024 sc1
    buffer_load_dwordx4 a[4:7], v2, s[8:11], s75 offen offset:1024 sc1
    buffer_load_dwordx4 a[56:59], v2, s[8:11], s87 offen offset:2048 sc1
    buffer_load_dwordx4 a[8:11], v2, s[8:11], s75 offen offset:2048 sc1
    buffer_load_dwordx4 a[60:63], v2, s[8:11], s87 offen offset:3072 sc1
    buffer_load_dwordx4 a[12:15], v2, s[8:11], s75 offen offset:3072 sc1
    buffer_load_dwordx4 a[64:67], v2, s[8:11], s88 offen offset:0 sc1
    buffer_load_dwordx4 a[16:19], v2, s[8:11], s85 offen offset:0 sc1
    buffer_load_dwordx4 a[68:71], v2, s[8:11], s88 offen offset:1024 sc1
    buffer_load_dwordx4 a[20:23], v2, s[8:11], s85 offen offset:1024 sc1
    buffer_load_dwordx4 a[72:75], v2, s[8:11], s88 offen offset:2048 sc1
    buffer_load_dwordx4 a[24:27], v2, s[8:11], s85 offen offset:2048 sc1
    buffer_load_dwordx4 a[76:79], v2, s[8:11], s88 offen offset:3072 sc1
    buffer_load_dwordx4 a[28:31], v2, s[8:11], s85 offen offset:3072 sc1
    buffer_load_dwordx4 a[80:83], v2, s[8:11], s89 offen offset:0 sc1
    buffer_load_dwordx4 a[32:35], v2, s[8:11], s86 offen offset:0 sc1
    buffer_load_dwordx4 a[84:87], v2, s[8:11], s89 offen offset:1024 sc1
    buffer_load_dwordx4 a[36:39], v2, s[8:11], s86 offen offset:1024 sc1
    buffer_load_dwordx4 a[88:91], v2, s[8:11], s89 offen offset:2048 sc1
    buffer_load_dwordx4 a[40:43], v2, s[8:11], s86 offen offset:2048 sc1
    buffer_load_dwordx4 a[92:95], v2, s[8:11], s89 offen offset:3072 sc1
    buffer_load_dwordx4 a[44:47], v2, s[8:11], s86 offen offset:3072 sc1
    buffer_load_dwordx4 a[96:99], v2, s[8:11], s90 offen offset:0 sc1
    buffer_load_dwordx4 a[100:103], v2, s[8:11], s90 offen offset:1024 sc1
    buffer_load_dwordx4 a[104:107], v2, s[8:11], s90 offen offset:2048 sc1
    buffer_load_dwordx4 a[108:111], v2, s[8:11], s90 offen offset:3072 sc1
    buffer_load_dwordx4 a[112:115], v2, s[8:11], s91 offen offset:0 sc1
    buffer_load_dwordx4 a[116:119], v2, s[8:11], s91 offen offset:1024 sc1
    buffer_load_dwordx4 a[120:123], v2, s[8:11], s91 offen offset:2048 sc1
    buffer_load_dwordx4 a[124:127], v2, s[8:11], s91 offen offset:3072 sc1
    buffer_load_dwordx4 a[128:131], v2, s[8:11], s92 offen offset:0 sc1
    buffer_load_dwordx4 a[132:135], v2, s[8:11], s92 offen offset:1024 sc1
    buffer_load_dwordx4 a[136:139], v2, s[8:11], s92 offen offset:2048 sc1
    buffer_load_dwordx4 a[140:143], v2, s[8:11], s92 offen offset:3072 sc1
    s_waitcnt vmcnt(0)
    v_mov_b32 v4, s74
    s_mov_b64 exec, 1
    s_cmp_eq_u32 s7, 0
    s_cbranch_scc1 L_sl_10
    buffer_store_dword v4, off, s[8:11], s71
    s_branch L_sd_11
L_sl_10:
    buffer_store_dword v4, off, s[8:11], s71 sc1
L_sd_11:
    s_mov_b64 exec, -1
    s_branch L_at_have
L_at_plain:
    buffer_load_dword v11, v6, s[8:11], s77 offen sc1
    s_waitcnt vmcnt(0)
    v_mov_b32 v4, s74
    s_mov_b64 exec, 1
    s_cmp_eq_u32 s7, 0
    s_cbranch_scc1 L_sl_12
    buffer_store_dword v4, off, s[8:11], s71
    s_branch L_sd_13
L_sl_12:
    buffer_store_dword v4, off, s[8:11], s71 sc1
L_sd_13:
    s_mov_b64 exec, -1
    s_cmp_ge_u32 s74, 64
    s_cbranch_scc1 L_end
    v_cmp_gt_u32 vcc, s80, v11
    s_cbranch_vccz L_at_go
    s_branch L_at_loop
L_r:
    s_and_b32 s72, s70, 3
    s_mov_b32 s74, 23068672
    s_cmp_eq_u32 s72, 1
    s_cselect_b32 s74, 234881024, s74
    s_cmp_eq_u32 s72, 2
    s_cselect_b32 s74, 44040192, s74
    s_cmp_eq_u32 s72, 3
    s_cselect_b32 s74, 65011712, s74
    s_mov_b32 s75, 63
    s_cmp_eq_u32 s72, 1
    s_cselect_b32 s75, 63, s75
    s_cmp_eq_u32 s72, 2
    s_cselect_b32 s75, 63, s75
    s_cmp_eq_u32 s72, 3
    s_cselect_b32 s75, 63, s75
    s_mov_b32 s76, 327680
    s_cmp_eq_u32 s72, 1
    s_cselect_b32 s76, 163840, s76
    s_cmp_eq_u32 s72, 2
    s_cselect_b32 s76, 327680, s76
    s_cmp_eq_u32 s72, 3
    s_cselect_b32 s76, 163840, s76
    s_mov_b32 s77, 28672
    s_cmp_eq_u32 s72, 1
    s_cselect_b32 s77, 24576, s77
    s_cmp_eq_u32 s72, 2
    s_cselect_b32 s77, 36864, s77
    s_cmp_eq_u32 s72, 3
    s_cselect_b32 s77, 26624, s77
    s_mov_b32 s78, 0
    s_cmp_eq_u32 s72, 1
    s_cselect_b32 s78, 6815744, s78
    s_cmp_eq_u32 s72, 2
    s_cselect_b32 s78, 12058624, s78
    s_cmp_eq_u32 s72, 3
    s_cselect_b32 s78, 17301504, s78
    s_mov_b32 s79, 6815744
    s_cmp_eq_u32 s72, 1
    s_cselect_b32 s79, 12058624, s79
    s_cmp_eq_u32 s72, 2
    s_cselect_b32 s79, 17301504, s79
    s_cmp_eq_u32 s72, 3
    s_cselect_b32 s79, 0, s79
    s_mov_b32 s80, 9437184
    s_cmp_eq_u32 s72, 1
    s_cselect_b32 s80, 14680064, s80
    s_cmp_eq_u32 s72, 2
    s_cselect_b32 s80, 19922944, s80
    s_cmp_eq_u32 s72, 3
    s_cselect_b32 s80, 0, s80
    s_mul_i32 s60, s3, 5120
    s_add_u32 s74, s74, s60
    s_add_u32 s78, s78, s60
    s_add_u32 s79, s79, s60
    s_add_u32 s80, s80, s60
    s_cmp_eq_u32 s72, 0
    s_cselect_b32 s48, s16, s40
    s_cselect_b32 s49, s17, s41
    s_cselect_b32 s50, 2621440, s10
    s_and_b32 s49, s49, 0xffff
    s_mov_b32 s51, 0x20000
    s_cmp_eq_u32 s72, 3
    s_cselect_b32 s52, s36, s40
    s_cselect_b32 s53, s37, s41
    s_cselect_b32 s54, 2621440, s10
    s_and_b32 s53, s53, 0xffff
    s_mov_b32 s55, 0x20000
    v_bfe_u32 v5, v0, 4, 1
    v_lshrrev_b32 v6, 5, v0
    v_mul_u32_u24 v6, 1280, v6
    v_and_b32 v7, 15, v0
    v_lshl_add_u32 v6, v7, 4, v6
    v_lshl_add_u32 v2, v5, 8, v6
    v_mul_u32_u24 v5, 40960, v5
    v_add_u32 v3, v5, v6
    s_and_b32 s60, s72, 1
    s_cmp_eq_u32 s60, 0
    s_cselect_b32 s60, 39, 11
    v_min_u32 v12, s60, v0
    v_lshlrev_b32 v5, 7, v12
    v_cmp_ge_u32 s[84:85], s60, v0
    v_bfe_u32 v12, v0, 3, 1
    v_lshrrev_b32 v13, 5, v0
    v_and_b32 v56, 7, v0
    v_cmp_ne_u32 vcc, v12, v13
    s_nop 1
    v_cndmask_b32 v56, v56, 15, vcc
    v_mov_b32 v12, 0x3f80
    v_mov_b32 v13, 0x3f800000
    v_cmp_eq_u32 vcc, 0, v56
    s_nop 1
    v_cndmask_b32 v8, 0, v12, vcc
    v_cmp_eq_u32 vcc, 1, v56
    s_nop 1
    v_cndmask_b32 v8, v8, v13, vcc
    v_cmp_eq_u32 vcc, 2, v56
    s_nop 1
    v_cndmask_b32 v9, 0, v12, vcc
    v_cmp_eq_u32 vcc, 3, v56
    s_nop 1
    v_cndmask_b32 v9, v9, v13, vcc
    v_cmp_eq_u32 vcc, 4, v56
    s_nop 1
    v_cndmask_b32 v10, 0, v12, vcc
    v_cmp_eq_u32 vcc, 5, v56
    s_nop 1
    v_cndmask_b32 v10, v10, v13, vcc
    v_cmp_eq_u32 vcc, 6, v56
    s_nop 1
    v_cndmask_b32 v11, 0, v12, vcc
    v_cmp_eq_u32 vcc, 7, v56
    s_nop 1
    v_cndmask_b32 v11, v11, v13, vcc
    v_bfe_u32 v1, v0, 4, 1
    v_lshl_add_u32 v1, v1, 3, v6
    s_mov_b32 s73, 0
    s_mov_b32 s83, 1
L_r_poll:
    v_mov_b32 v56, -1
    s_mov_b64 exec, s[84:85]
    v_mov_b32 v56, 0
    buffer_atomic_add v56, v5, s[8:11], s77 offen sc0
    s_mov_b64 exec, -1
    s_waitcnt vmcnt(0)
    v_cmp_gt_u32 vcc, s83, v56
    s_cbranch_vccz L_r_go
    s_sleep 1
    s_sub_u32 s6, s6, 1
    s_cbranch_scc0 L_r_poll
    s_branch L_fail
L_r_go:
    s_and_b32 s81, s73, s75
    s_mul_i32 s81, s81, s76
    s_add_u32 s81, s81, s74
    s_mul_i32 s82, s73, 40960
    s_add_u32 s60, s82, s78
    s_mov_b32 s86, s81
    s_add_u32 s87, s81, 81920
    s_add_u32 s88, s81, 163840
    s_add_u32 s89, s81, 245760
    s_add_u32 s61, s82, s80
    s_add_u32 s62, s82, s79
    s_bitcmp1_b32 s72, 0
    s_cbranch_scc1 L_r_b
    buffer_load_dwordx4 v[220:223], v2, s[48:51], s60 offen offset:0 sc1
    buffer_load_dwordx4 v[224:227], v2, s[48:51], s60 offen offset:512 sc1
    buffer_load_dwordx2 v[228:229], v1, s[48:51], s60 offen offset:1024 sc1
    buffer_load_dwordx4 v[60:63], v3, s[8:11], s86 offen offset:0 sc1 nt
    buffer_load_dwordx4 v[64:67], v3, s[8:11], s86 offen offset:256 sc1 nt
    buffer_load_dwordx4 v[68:71], v3, s[8:11], s86 offen offset:512 sc1 nt
    buffer_load_dwordx4 v[72:75], v3, s[8:11], s86 offen offset:768 sc1 nt
    buffer_load_dwordx4 v[76:79], v3, s[8:11], s86 offen offset:1024 sc1 nt
    buffer_load_dwordx4 v[80:83], v3, s[8:11], s87 offen offset:0 sc1 nt
    buffer_load_dwordx4 v[84:87], v3, s[8:11], s87 offen offset:256 sc1 nt
    buffer_load_dwordx4 v[88:91], v3, s[8:11], s87 offen offset:512 sc1 nt
    buffer_load_dwordx4 v[92:95], v3, s[8:11], s87 offen offset:768 sc1 nt
    buffer_load_dwordx4 v[96:99], v3, s[8:11], s87 offen offset:1024 sc1 nt
    buffer_load_dwordx4 v[100:103], v3, s[8:11], s88 offen offset:0 sc1 nt
    buffer_load_dwordx4 v[104:107], v3, s[8:11], s88 offen offset:256 sc1 nt
    buffer_load_dwordx4 v[108:111], v3, s[8:11], s88 offen offset:512 sc1 nt
    buffer_load_dwordx4 v[112:115], v3, s[8:11], s88 offen offset:768 sc1 nt
    buffer_load_dwordx4 v[116:119], v3, s[8:11], s88 offen offset:1024 sc1 nt
    buffer_load_dwordx4 v[120:123], v3, s[8:11], s89 offen offset:0 sc1 nt
    buffer_load_dwordx4 v[124:127], v3, s[8:11], s89 offen offset:256 sc1 nt
    buffer_load_dwordx4 v[128:131], v3, s[8:11], s89 offen offset:512 sc1 nt
    buffer_load_dwordx4 v[132:135], v3, s[8:11], s89 offen offset:768 sc1 nt
    buffer_load_dwordx4 v[136:139], v3, s[8:11], s89 offen offset:1024 sc1 nt
    buffer_load_dwordx4 v[230:233], v2, s[48:51], s60 offen offset:2560 sc1
    buffer_load_dwordx4 v[234:237], v2, s[48:51], s60 offen offset:3072 sc1
    buffer_load_dwordx2 v[238:239], v1, s[48:51], s60 offen offset:3584 sc1
    buffer_load_dwordx4 v[140:143], v3, s[8:11], s86 offen offset:2560 sc1 nt
    buffer_load_dwordx4 v[144:147], v3, s[8:11], s86 offen offset:2816 sc1 nt
    buffer_load_dwordx4 v[148:151], v3, s[8:11], s86 offen offset:3072 sc1 nt
    buffer_load_dwordx4 v[152:155], v3, s[8:11], s86 offen offset:3328 sc1 nt
    buffer_load_dwordx4 v[156:159], v3, s[8:11], s86 offen offset:3584 sc1 nt
    buffer_load_dwordx4 v[160:163], v3, s[8:11], s87 offen offset:2560 sc1 nt
    buffer_load_dwordx4 v[164:167], v3, s[8:11], s87 offen offset:2816 sc1 nt
    buffer_load_dwordx4 v[168:171], v3, s[8:11], s87 offen offset:3072 sc1 nt
    buffer_load_dwordx4 v[172:175], v3, s[8:11], s87 offen offset:3328 sc1 nt
    buffer_load_dwordx4 v[176:179], v3, s[8:11], s87 offen offset:3584 sc1 nt
    buffer_load_dwordx4 v[180:183], v3, s[8:11], s88 offen offset:2560 sc1 nt
    buffer_load_dwordx4 v[184:187], v3, s[8:11], s88 offen offset:2816 sc1 nt
    buffer_load_dwordx4 v[188:191], v3, s[8:11], s88 offen offset:3072 sc1 nt
    buffer_load_dwordx4 v[192:195], v3, s[8:11], s88 offen offset:3328 sc1 nt
    buffer_load_dwordx4 v[196:199], v3, s[8:11], s88 offen offset:3584 sc1 nt
    buffer_load_dwordx4 v[200:203], v3, s[8:11], s89 offen offset:2560 sc1 nt
    buffer_load_dwordx4 v[204:207], v3, s[8:11], s89 offen offset:2816 sc1 nt
    buffer_load_dwordx4 v[208:211], v3, s[8:11], s89 offen offset:3072 sc1 nt
    buffer_load_dwordx4 v[212:215], v3, s[8:11], s89 offen offset:3328 sc1 nt
    buffer_load_dwordx4 v[216:219], v3, s[8:11], s89 offen offset:3584 sc1 nt
    s_waitcnt vmcnt(42)
    v_mfma_f32_16x16x32_bf16 v[16:19], v[8:11], v[60:63], 0
    s_waitcnt vmcnt(41)
    v_mfma_f32_16x16x32_bf16 v[20:23], v[8:11], v[64:67], 0
    s_waitcnt vmcnt(40)
    v_mfma_f32_16x16x32_bf16 v[24:27], v[8:11], v[68:71], 0
    s_waitcnt vmcnt(39)
    v_mfma_f32_16x16x32_bf16 v[28:31], v[8:11], v[72:75], 0
    s_waitcnt vmcnt(38)
    v_mfma_f32_16x16x32_bf16 v[32:35], v[8:11], v[76:79], 0
    s_waitcnt vmcnt(37)
    v_mfma_f32_16x16x32_bf16 v[16:19], v[8:11], v[80:83], v[16:19]
    s_waitcnt vmcnt(36)
    v_mfma_f32_16x16x32_bf16 v[20:23], v[8:11], v[84:87], v[20:23]
    s_waitcnt vmcnt(35)
    v_mfma_f32_16x16x32_bf16 v[24:27], v[8:11], v[88:91], v[24:27]
    s_waitcnt vmcnt(34)
    v_mfma_f32_16x16x32_bf16 v[28:31], v[8:11], v[92:95], v[28:31]
    s_waitcnt vmcnt(33)
    v_mfma_f32_16x16x32_bf16 v[32:35], v[8:11], v[96:99], v[32:35]
    s_waitcnt vmcnt(32)
    v_mfma_f32_16x16x32_bf16 v[16:19], v[8:11], v[100:103], v[16:19]
    s_waitcnt vmcnt(31)
    v_mfma_f32_16x16x32_bf16 v[20:23], v[8:11], v[104:107], v[20:23]
    s_waitcnt vmcnt(30)
    v_mfma_f32_16x16x32_bf16 v[24:27], v[8:11], v[108:111], v[24:27]
    s_waitcnt vmcnt(29)
    v_mfma_f32_16x16x32_bf16 v[28:31], v[8:11], v[112:115], v[28:31]
    s_waitcnt vmcnt(28)
    v_mfma_f32_16x16x32_bf16 v[32:35], v[8:11], v[116:119], v[32:35]
    s_waitcnt vmcnt(27)
    v_mfma_f32_16x16x32_bf16 v[16:19], v[8:11], v[120:123], v[16:19]
    s_waitcnt vmcnt(26)
    v_mfma_f32_16x16x32_bf16 v[20:23], v[8:11], v[124:127], v[20:23]
    s_waitcnt vmcnt(25)
    v_mfma_f32_16x16x32_bf16 v[24:27], v[8:11], v[128:131], v[24:27]
    s_waitcnt vmcnt(24)
    v_mfma_f32_16x16x32_bf16 v[28:31], v[8:11], v[132:135], v[28:31]
    s_waitcnt vmcnt(23)
    v_mfma_f32_16x16x32_bf16 v[32:35], v[8:11], v[136:139], v[32:35]
    v_permlane16_swap_b32 v220, v222
    v_permlane16_swap_b32 v221, v223
    v_permlane16_swap_b32 v224, v226
    v_permlane16_swap_b32 v225, v227
    v_lshlrev_b32 v60, 16, v220
    v_and_b32 v61, 0xffff0000, v220
    v_pk_add_f32 v[16:17], v[16:17], v[60:61]
    v_cvt_pk_bf16_f32 v64, v16, v17
    v_lshlrev_b32 v60, 16, v221
    v_and_b32 v61, 0xffff0000, v221
    v_pk_add_f32 v[18:19], v[18:19], v[60:61]
    v_cvt_pk_bf16_f32 v65, v18, v19
    v_lshlrev_b32 v60, 16, v222
    v_and_b32 v61, 0xffff0000, v222
    v_pk_add_f32 v[20:21], v[20:21], v[60:61]
    v_cvt_pk_bf16_f32 v66, v20, v21
    v_lshlrev_b32 v60, 16, v223
    v_and_b32 v61, 0xffff0000, v223
    v_pk_add_f32 v[22:23], v[22:23], v[60:61]
    v_cvt_pk_bf16_f32 v67, v22, v23
    v_lshlrev_b32 v60, 16, v224
    v_and_b32 v61, 0xffff0000, v224
    v_pk_add_f32 v[24:25], v[24:25], v[60:61]
    v_cvt_pk_bf16_f32 v68, v24, v25
    v_lshlrev_b32 v60, 16, v225
    v_and_b32 v61, 0xffff0000, v225
    v_pk_add_f32 v[26:27], v[26:27], v[60:61]
    v_cvt_pk_bf16_f32 v69, v26, v27
    v_lshlrev_b32 v60, 16, v226
    v_and_b32 v61, 0xffff0000, v226
    v_pk_add_f32 v[28:29], v[28:29], v[60:61]
    v_cvt_pk_bf16_f32 v70, v28, v29
    v_lshlrev_b32 v60, 16, v227
    v_and_b32 v61, 0xffff0000, v227
    v_pk_add_f32 v[30:31], v[30:31], v[60:61]
    v_cvt_pk_bf16_f32 v71, v30, v31
    v_lshlrev_b32 v60, 16, v228
    v_and_b32 v61, 0xffff0000, v228
    v_pk_add_f32 v[32:33], v[32:33], v[60:61]
    v_cvt_pk_bf16_f32 v72, v32, v33
    v_lshlrev_b32 v60, 16, v229
    v_and_b32 v61, 0xffff0000, v229
    v_pk_add_f32 v[34:35], v[34:35], v[60:61]
    v_cvt_pk_bf16_f32 v73, v34, v35
    v_lshlrev_b32 v16, 16, v64
    v_and_b32 v17, 0xffff0000, v64
    v_lshlrev_b32 v18, 16, v65
    v_and_b32 v19, 0xffff0000, v65
    v_lshlrev_b32 v20, 16, v66
    v_and_b32 v21, 0xffff0000, v66
    v_lshlrev_b32 v22, 16, v67
    v_and_b32 v23, 0xffff0000, v67
    v_lshlrev_b32 v24, 16, v68
    v_and_b32 v25, 0xffff0000, v68
    v_lshlrev_b32 v26, 16, v69
    v_and_b32 v27, 0xffff0000, v69
    v_lshlrev_b32 v28, 16, v70
    v_and_b32 v29, 0xffff0000, v70
    v_lshlrev_b32 v30, 16, v71
    v_and_b32 v31, 0xffff0000, v71
    v_lshlrev_b32 v32, 16, v72
    v_and_b32 v33, 0xffff0000, v72
    v_lshlrev_b32 v34, 16, v73
    v_and_b32 v35, 0xffff0000, v73
    v_pk_add_f32 v[132:133], v[16:17], v[18:19]
    v_pk_add_f32 v[134:135], v[20:21], v[22:23]
    v_pk_add_f32 v[132:133], v[132:133], v[24:25]
    v_pk_add_f32 v[134:135], v[134:135], v[26:27]
    v_pk_add_f32 v[132:133], v[132:133], v[28:29]
    v_pk_add_f32 v[134:135], v[134:135], v[30:31]
    v_pk_add_f32 v[132:133], v[132:133], v[32:33]
    v_pk_add_f32 v[134:135], v[134:135], v[34:35]
    v_pk_add_f32 v[132:133], v[132:133], v[134:135]
    v_add_f32 v132, v132, v133
    v_mul_f32 v132, 0xbd4ccccd, v132
    v_mov_b32 v133, v132
    v_mov_b32 v138, v132
    v_pk_add_f32 v[136:137], v[16:17], v[132:133]
    v_pk_mul_f32 v[134:135], v[136:137], v[136:137]
    v_pk_add_f32 v[136:137], v[18:19], v[132:133]
    v_add_f32_dpp v138, v138, v138 row_ror:8 row_mask:0xf bank_mask:0xf
    v_pk_fma_f32 v[134:135], v[136:137], v[136:137], v[134:135]
    v_pk_add_f32 v[136:137], v[20:21], v[132:133]
    v_add_f32_dpp v138, v138, v138 row_ror:4 row_mask:0xf bank_mask:0xf
    v_pk_fma_f32 v[134:135], v[136:137], v[136:137], v[134:135]
    v_pk_add_f32 v[136:137], v[22:23], v[132:133]
    v_add_f32_dpp v138, v138, v138 row_ror:2 row_mask:0xf bank_mask:0xf
    v_pk_fma_f32 v[134:135], v[136:137], v[136:137], v[134:135]
    v_pk_add_f32 v[136:137], v[24:25], v[132:133]
    v_add_f32_dpp v138, v138, v138 row_ror:1 row_mask:0xf bank_mask:0xf
    v_pk_fma_f32 v[134:135], v[136:137], v[136:137], v[134:135]
    v_pk_add_f32 v[136:137], v[26:27], v[132:133]
    v_pk_fma_f32 v[134:135], v[136:137], v[136:137], v[134:135]
    v_pk_add_f32 v[136:137], v[28:29], v[132:133]
    v_mov_b32 v139, v138
    v_pk_fma_f32 v[134:135], v[136:137], v[136:137], v[134:135]
    v_pk_add_f32 v[136:137], v[30:31], v[132:133]
    v_pk_fma_f32 v[134:135], v[136:137], v[136:137], v[134:135]
    v_pk_add_f32 v[136:137], v[32:33], v[132:133]
    v_permlane16_swap_b32 v139, v138
    v_pk_fma_f32 v[134:135], v[136:137], v[136:137], v[134:135]
    v_pk_add_f32 v[136:137], v[34:35], v[132:133]
    v_pk_fma_f32 v[134:135], v[136:137], v[136:137], v[134:135]
    v_add_f32 v138, v138, v139
    v_add_f32 v134, v134, v135
    v_mul_f32 v138, 0x3d000000, v138
    v_sub_f32 v136, v132, v138
    v_mul_f32 v137, 0x41a00000, v136
    v_fmac_f32 v134, v136, v137
    v_cvt_pk_bf16_f32 v132, v138, v138
    v_and_b32 v132, 0xffff0000, v132
    v_mov_b32 v133, v132
    v_add_f32_dpp v134, v134, v134 row_ror:8 row_mask:0xf bank_mask:0xf
    v_pk_add_f32 v[16:17], v[16:17], v[132:133]
    v_pk_add_f32 v[18:19], v[18:19], v[132:133]
    v_add_f32_dpp v134, v134, v134 row_ror:4 row_mask:0xf bank_mask:0xf
    v_pk_add_f32 v[20:21], v[20:21], v[132:133]
    v_pk_add_f32 v[22:23], v[22:23], v[132:133]
    v_add_f32_dpp v134, v134, v134 row_ror:2 row_mask:0xf bank_mask:0xf
    v_pk_add_f32 v[24:25], v[24:25], v[132:133]
    v_pk_add_f32 v[26:27], v[26:27], v[132:133]
    v_add_f32_dpp v134, v134, v134 row_ror:1 row_mask:0xf bank_mask:0xf
    v_pk_add_f32 v[28:29], v[28:29], v[132:133]
    v_pk_add_f32 v[30:31], v[30:31], v[132:133]
    v_mov_b32 v135, v134
    v_pk_add_f32 v[32:33], v[32:33], v[132:133]
    v_pk_add_f32 v[34:35], v[34:35], v[132:133]
    v_permlane16_swap_b32 v135, v134
    v_add_f32 v134, v134, v135
    v_mul_f32 v134, 0x3acccccd, v134
    v_cvt_pk_bf16_f32 v134, v134, v134
    v_and_b32 v134, 0xffff0000, v134
    v_add_f32 v134, 0x3727c5ac, v134
    v_cvt_pk_bf16_f32 v134, v134, v134
    v_and_b32 v134, 0xffff0000, v134
    v_sqrt_f32 v134, v134
    s_nop 0
    v_cvt_pk_bf16_f32 v134, v134, v134
    v_and_b32 v134, 0xffff0000, v134
    v_rcp_f32 v134, v134
    s_nop 0
    v_mov_b32 v135, v134
    v_pk_mul_f32 v[16:17], v[16:17], v[134:135]
    v_pk_mul_f32 v[18:19], v[18:19], v[134:135]
    v_pk_mul_f32 v[20:21], v[20:21], v[134:135]
    v_pk_mul_f32 v[22:23], v[22:23], v[134:135]
    v_pk_mul_f32 v[24:25], v[24:25], v[134:135]
    v_pk_mul_f32 v[26:27], v[26:27], v[134:135]
    v_pk_mul_f32 v[28:29], v[28:29], v[134:135]
    v_pk_mul_f32 v[30:31], v[30:31], v[134:135]
    v_pk_mul_f32 v[32:33], v[32:33], v[134:135]
    v_pk_mul_f32 v[34:35], v[34:35], v[134:135]
    v_cvt_pk_bf16_f32 v76, v16, v17
    v_cvt_pk_bf16_f32 v77, v18, v19
    v_cvt_pk_bf16_f32 v78, v20, v21
    v_cvt_pk_bf16_f32 v79, v22, v23
    v_cvt_pk_bf16_f32 v80, v24, v25
    v_cvt_pk_bf16_f32 v81, v26, v27
    v_cvt_pk_bf16_f32 v82, v28, v29
    v_cvt_pk_bf16_f32 v83, v30, v31
    v_cvt_pk_bf16_f32 v84, v32, v33
    v_cvt_pk_bf16_f32 v85, v34, v35
    v_permlane16_swap_b32 v76, v78
    v_permlane16_swap_b32 v77, v79
    v_permlane16_swap_b32 v80, v82
    v_permlane16_swap_b32 v81, v83
    buffer_store_dwordx4 v[76:79], v2, s[8:11], s61 offen offset:0 sc1
    buffer_store_dwordx4 v[80:83], v2, s[8:11], s61 offen offset:512 sc1
    buffer_store_dwordx2 v[84:85], v1, s[8:11], s61 offen offset:1024 sc1
    v_permlane16_swap_b32 v64, v66
    v_permlane16_swap_b32 v65, v67
    v_permlane16_swap_b32 v68, v70
    v_permlane16_swap_b32 v69, v71
    buffer_store_dwordx4 v[64:67], v2, s[52:55], s62 offen offset:0 sc1
    buffer_store_dwordx4 v[68:71], v2, s[52:55], s62 offen offset:512 sc1
    buffer_store_dwordx2 v[72:73], v1, s[52:55], s62 offen offset:1024 sc1
    s_waitcnt vmcnt(25)
    v_mfma_f32_16x16x32_bf16 v[36:39], v[8:11], v[140:143], 0
    s_waitcnt vmcnt(24)
    v_mfma_f32_16x16x32_bf16 v[40:43], v[8:11], v[144:147], 0
    s_waitcnt vmcnt(23)
    v_mfma_f32_16x16x32_bf16 v[44:47], v[8:11], v[148:151], 0
    s_waitcnt vmcnt(22)
    v_mfma_f32_16x16x32_bf16 v[48:51], v[8:11], v[152:155], 0
    s_waitcnt vmcnt(21)
    v_mfma_f32_16x16x32_bf16 v[52:55], v[8:11], v[156:159], 0
    s_waitcnt vmcnt(20)
    v_mfma_f32_16x16x32_bf16 v[36:39], v[8:11], v[160:163], v[36:39]
    s_waitcnt vmcnt(19)
    v_mfma_f32_16x16x32_bf16 v[40:43], v[8:11], v[164:167], v[40:43]
    s_waitcnt vmcnt(18)
    v_mfma_f32_16x16x32_bf16 v[44:47], v[8:11], v[168:171], v[44:47]
    s_waitcnt vmcnt(17)
    v_mfma_f32_16x16x32_bf16 v[48:51], v[8:11], v[172:175], v[48:51]
    s_waitcnt vmcnt(16)
    v_mfma_f32_16x16x32_bf16 v[52:55], v[8:11], v[176:179], v[52:55]
    s_waitcnt vmcnt(15)
    v_mfma_f32_16x16x32_bf16 v[36:39], v[8:11], v[180:183], v[36:39]
    s_waitcnt vmcnt(14)
    v_mfma_f32_16x16x32_bf16 v[40:43], v[8:11], v[184:187], v[40:43]
    s_waitcnt vmcnt(13)
    v_mfma_f32_16x16x32_bf16 v[44:47], v[8:11], v[188:191], v[44:47]
    s_waitcnt vmcnt(12)
    v_mfma_f32_16x16x32_bf16 v[48:51], v[8:11], v[192:195], v[48:51]
    s_waitcnt vmcnt(11)
    v_mfma_f32_16x16x32_bf16 v[52:55], v[8:11], v[196:199], v[52:55]
    s_waitcnt vmcnt(10)
    v_mfma_f32_16x16x32_bf16 v[36:39], v[8:11], v[200:203], v[36:39]
    s_waitcnt vmcnt(9)
    v_mfma_f32_16x16x32_bf16 v[40:43], v[8:11], v[204:207], v[40:43]
    s_waitcnt vmcnt(8)
    v_mfma_f32_16x16x32_bf16 v[44:47], v[8:11], v[208:211], v[44:47]
    s_waitcnt vmcnt(7)
    v_mfma_f32_16x16x32_bf16 v[48:51], v[8:11], v[212:215], v[48:51]
    s_waitcnt vmcnt(6)
    v_mfma_f32_16x16x32_bf16 v[52:55], v[8:11], v[216:219], v[52:55]
    v_permlane16_swap_b32 v230, v232
    v_permlane16_swap_b32 v231, v233
    v_permlane16_swap_b32 v234, v236
    v_permlane16_swap_b32 v235, v237
    v_lshlrev_b32 v60, 16, v230
    v_and_b32 v61, 0xffff0000, v230
    v_pk_add_f32 v[36:37], v[36:37], v[60:61]
    v_cvt_pk_bf16_f32 v96, v36, v37
    v_lshlrev_b32 v60, 16, v231
    v_and_b32 v61, 0xffff0000, v231
    v_pk_add_f32 v[38:39], v[38:39], v[60:61]
    v_cvt_pk_bf16_f32 v97, v38, v39
    v_lshlrev_b32 v60, 16, v232
    v_and_b32 v61, 0xffff0000, v232
    v_pk_add_f32 v[40:41], v[40:41], v[60:61]
    v_cvt_pk_bf16_f32 v98, v40, v41
    v_lshlrev_b32 v60, 16, v233
    v_and_b32 v61, 0xffff0000, v233
    v_pk_add_f32 v[42:43], v[42:43], v[60:61]
    v_cvt_pk_bf16_f32 v99, v42, v43
    v_lshlrev_b32 v60, 16, v234
    v_and_b32 v61, 0xffff0000, v234
    v_pk_add_f32 v[44:45], v[44:45], v[60:61]
    v_cvt_pk_bf16_f32 v100, v44, v45
    v_lshlrev_b32 v60, 16, v235
    v_and_b32 v61, 0xffff0000, v235
    v_pk_add_f32 v[46:47], v[46:47], v[60:61]
    v_cvt_pk_bf16_f32 v101, v46, v47
    v_lshlrev_b32 v60, 16, v236
    v_and_b32 v61, 0xffff0000, v236
    v_pk_add_f32 v[48:49], v[48:49], v[60:61]
    v_cvt_pk_bf16_f32 v102, v48, v49
    v_lshlrev_b32 v60, 16, v237
    v_and_b32 v61, 0xffff0000, v237
    v_pk_add_f32 v[50:51], v[50:51], v[60:61]
    v_cvt_pk_bf16_f32 v103, v50, v51
    v_lshlrev_b32 v60, 16, v238
    v_and_b32 v61, 0xffff0000, v238
    v_pk_add_f32 v[52:53], v[52:53], v[60:61]
    v_cvt_pk_bf16_f32 v104, v52, v53
    v_lshlrev_b32 v60, 16, v239
    v_and_b32 v61, 0xffff0000, v239
    v_pk_add_f32 v[54:55], v[54:55], v[60:61]
    v_cvt_pk_bf16_f32 v105, v54, v55
    v_lshlrev_b32 v36, 16, v96
    v_and_b32 v37, 0xffff0000, v96
    v_lshlrev_b32 v38, 16, v97
    v_and_b32 v39, 0xffff0000, v97
    v_lshlrev_b32 v40, 16, v98
    v_and_b32 v41, 0xffff0000, v98
    v_lshlrev_b32 v42, 16, v99
    v_and_b32 v43, 0xffff0000, v99
    v_lshlrev_b32 v44, 16, v100
    v_and_b32 v45, 0xffff0000, v100
    v_lshlrev_b32 v46, 16, v101
    v_and_b32 v47, 0xffff0000, v101
    v_lshlrev_b32 v48, 16, v102
    v_and_b32 v49, 0xffff0000, v102
    v_lshlrev_b32 v50, 16, v103
    v_and_b32 v51, 0xffff0000, v103
    v_lshlrev_b32 v52, 16, v104
    v_and_b32 v53, 0xffff0000, v104
    v_lshlrev_b32 v54, 16, v105
    v_and_b32 v55, 0xffff0000, v105
    v_pk_add_f32 v[132:133], v[36:37], v[38:39]
    v_pk_add_f32 v[134:135], v[40:41], v[42:43]
    v_pk_add_f32 v[132:133], v[132:133], v[44:45]
    v_pk_add_f32 v[134:135], v[134:135], v[46:47]
    v_pk_add_f32 v[132:133], v[132:133], v[48:49]
    v_pk_add_f32 v[134:135], v[134:135], v[50:51]
    v_pk_add_f32 v[132:133], v[132:133], v[52:53]
    v_pk_add_f32 v[134:135], v[134:135], v[54:55]
    v_pk_add_f32 v[132:133], v[132:133], v[134:135]
    v_add_f32 v132, v132, v133
    v_mul_f32 v132, 0xbd4ccccd, v132
    v_mov_b32 v133, v132
    v_mov_b32 v138, v132
    v_pk_add_f32 v[136:137], v[36:37], v[132:133]
    v_pk_mul_f32 v[134:135], v[136:137], v[136:137]
    v_pk_add_f32 v[136:137], v[38:39], v[132:133]
    v_add_f32_dpp v138, v138, v138 row_ror:8 row_mask:0xf bank_mask:0xf
    v_pk_fma_f32 v[134:135], v[136:137], v[136:137], v[134:135]
    v_pk_add_f32 v[136:137], v[40:41], v[132:133]
    v_add_f32_dpp v138, v138, v138 row_ror:4 row_mask:0xf bank_mask:0xf
    v_pk_fma_f32 v[134:135], v[136:137], v[136:137], v[134:135]
    v_pk_add_f32 v[136:137], v[42:43], v[132:133]
    v_add_f32_dpp v138, v138, v138 row_ror:2 row_mask:0xf bank_mask:0xf
    v_pk_fma_f32 v[134:135], v[136:137], v[136:137], v[134:135]
    v_pk_add_f32 v[136:137], v[44:45], v[132:133]
    v_add_f32_dpp v138, v138, v138 row_ror:1 row_mask:0xf bank_mask:0xf
    v_pk_fma_f32 v[134:135], v[136:137], v[136:137], v[134:135]
    v_pk_add_f32 v[136:137], v[46:47], v[132:133]
    v_pk_fma_f32 v[134:135], v[136:137], v[136:137], v[134:135]
    v_pk_add_f32 v[136:137], v[48:49], v[132:133]
    v_mov_b32 v139, v138
    v_pk_fma_f32 v[134:135], v[136:137], v[136:137], v[134:135]
    v_pk_add_f32 v[136:137], v[50:51], v[132:133]
    v_pk_fma_f32 v[134:135], v[136:137], v[136:137], v[134:135]
    v_pk_add_f32 v[136:137], v[52:53], v[132:133]
    v_permlane16_swap_b32 v139, v138
    v_pk_fma_f32 v[134:135], v[136:137], v[136:137], v[134:135]
    v_pk_add_f32 v[136:137], v[54:55], v[132:133]
    v_pk_fma_f32 v[134:135], v[136:137], v[136:137], v[134:135]
    v_add_f32 v138, v138, v139
    v_add_f32 v134, v134, v135
    v_mul_f32 v138, 0x3d000000, v138
    v_sub_f32 v136, v132, v138
    v_mul_f32 v137, 0x41a00000, v136
    v_fmac_f32 v134, v136, v137
    v_cvt_pk_bf16_f32 v132, v138, v138
    v_and_b32 v132, 0xffff0000, v132
    v_mov_b32 v133, v132
    v_add_f32_dpp v134, v134, v134 row_ror:8 row_mask:0xf bank_mask:0xf
    v_pk_add_f32 v[36:37], v[36:37], v[132:133]
    v_pk_add_f32 v[38:39], v[38:39], v[132:133]
    v_add_f32_dpp v134, v134, v134 row_ror:4 row_mask:0xf bank_mask:0xf
    v_pk_add_f32 v[40:41], v[40:41], v[132:133]
    v_pk_add_f32 v[42:43], v[42:43], v[132:133]
    v_add_f32_dpp v134, v134, v134 row_ror:2 row_mask:0xf bank_mask:0xf
    v_pk_add_f32 v[44:45], v[44:45], v[132:133]
    v_pk_add_f32 v[46:47], v[46:47], v[132:133]
    v_add_f32_dpp v134, v134, v134 row_ror:1 row_mask:0xf bank_mask:0xf
    v_pk_add_f32 v[48:49], v[48:49], v[132:133]
    v_pk_add_f32 v[50:51], v[50:51], v[132:133]
    v_mov_b32 v135, v134
    v_pk_add_f32 v[52:53], v[52:53], v[132:133]
    v_pk_add_f32 v[54:55], v[54:55], v[132:133]
    v_permlane16_swap_b32 v135, v134
    v_add_f32 v134, v134, v135
    v_mul_f32 v134, 0x3acccccd, v134
    v_cvt_pk_bf16_f32 v134, v134, v134
    v_and_b32 v134, 0xffff0000, v134
    v_add_f32 v134, 0x3727c5ac, v134
    v_cvt_pk_bf16_f32 v134, v134, v134
    v_and_b32 v134, 0xffff0000, v134
    v_sqrt_f32 v134, v134
    s_nop 0
    v_cvt_pk_bf16_f32 v134, v134, v134
    v_and_b32 v134, 0xffff0000, v134
    v_rcp_f32 v134, v134
    s_nop 0
    v_mov_b32 v135, v134
    v_pk_mul_f32 v[36:37], v[36:37], v[134:135]
    v_pk_mul_f32 v[38:39], v[38:39], v[134:135]
    v_pk_mul_f32 v[40:41], v[40:41], v[134:135]
    v_pk_mul_f32 v[42:43], v[42:43], v[134:135]
    v_pk_mul_f32 v[44:45], v[44:45], v[134:135]
    v_pk_mul_f32 v[46:47], v[46:47], v[134:135]
    v_pk_mul_f32 v[48:49], v[48:49], v[134:135]
    v_pk_mul_f32 v[50:51], v[50:51], v[134:135]
    v_pk_mul_f32 v[52:53], v[52:53], v[134:135]
    v_pk_mul_f32 v[54:55], v[54:55], v[134:135]
    v_cvt_pk_bf16_f32 v108, v36, v37
    v_cvt_pk_bf16_f32 v109, v38, v39
    v_cvt_pk_bf16_f32 v110, v40, v41
    v_cvt_pk_bf16_f32 v111, v42, v43
    v_cvt_pk_bf16_f32 v112, v44, v45
    v_cvt_pk_bf16_f32 v113, v46, v47
    v_cvt_pk_bf16_f32 v114, v48, v49
    v_cvt_pk_bf16_f32 v115, v50, v51
    v_cvt_pk_bf16_f32 v116, v52, v53
    v_cvt_pk_bf16_f32 v117, v54, v55
    v_permlane16_swap_b32 v108, v110
    v_permlane16_swap_b32 v109, v111
    v_permlane16_swap_b32 v112, v114
    v_permlane16_swap_b32 v113, v115
    buffer_store_dwordx4 v[108:111], v2, s[8:11], s61 offen offset:2560 sc1
    buffer_store_dwordx4 v[112:115], v2, s[8:11], s61 offen offset:3072 sc1
    buffer_store_dwordx2 v[116:117], v1, s[8:11], s61 offen offset:3584 sc1
    v_permlane16_swap_b32 v96, v98
    v_permlane16_swap_b32 v97, v99
    v_permlane16_swap_b32 v100, v102
    v_permlane16_swap_b32 v101, v103
    buffer_store_dwordx4 v[96:99], v2, s[52:55], s62 offen offset:2560 sc1
    buffer_store_dwordx4 v[100:103], v2, s[52:55], s62 offen offset:3072 sc1
    buffer_store_dwordx2 v[104:105], v1, s[52:55], s62 offen offset:3584 sc1
    s_branch L_r_end
L_r_b:
    s_cmp_eq_u32 s72, 3
    s_cbranch_scc1 L_r_c
    buffer_load_dwordx4 v[220:223], v2, s[48:51], s60 offen offset:0 sc1
    buffer_load_dwordx4 v[224:227], v2, s[48:51], s60 offen offset:512 sc1
    buffer_load_dwordx2 v[228:229], v1, s[48:51], s60 offen offset:1024 sc1
    buffer_load_dwordx4 v[60:63], v3, s[8:11], s86 offen offset:0 sc1 nt
    buffer_load_dwordx4 v[64:67], v3, s[8:11], s86 offen offset:256 sc1 nt
    buffer_load_dwordx4 v[68:71], v3, s[8:11], s86 offen offset:512 sc1 nt
    buffer_load_dwordx4 v[72:75], v3, s[8:11], s86 offen offset:768 sc1 nt
    buffer_load_dwordx4 v[76:79], v3, s[8:11], s86 offen offset:1024 sc1 nt
    buffer_load_dwordx4 v[80:83], v3, s[8:11], s87 offen offset:0 sc1 nt
    buffer_load_dwordx4 v[84:87], v3, s[8:11], s87 offen offset:256 sc1 nt
    buffer_load_dwordx4 v[88:91], v3, s[8:11], s87 offen offset:512 sc1 nt
    buffer_load_dwordx4 v[92:95], v3, s[8:11], s87 offen offset:768 sc1 nt
    buffer_load_dwordx4 v[96:99], v3, s[8:11], s87 offen offset:1024 sc1 nt
    buffer_load_dwordx4 v[230:233], v2, s[48:51], s60 offen offset:2560 sc1
    buffer_load_dwordx4 v[234:237], v2, s[48:51], s60 offen offset:3072 sc1
    buffer_load_dwordx2 v[238:239], v1, s[48:51], s60 offen offset:3584 sc1
    buffer_load_dwordx4 v[140:143], v3, s[8:11], s86 offen offset:2560 sc1 nt
    buffer_load_dwordx4 v[144:147], v3, s[8:11], s86 offen offset:2816 sc1 nt
    buffer_load_dwordx4 v[148:151], v3, s[8:11], s86 offen offset:3072 sc1 nt
    buffer_load_dwordx4 v[152:155], v3, s[8:11], s86 offen offset:3328 sc1 nt
    buffer_load_dwordx4 v[156:159], v3, s[8:11], s86 offen offset:3584 sc1 nt
    buffer_load_dwordx4 v[160:163], v3, s[8:11], s87 offen offset:2560 sc1 nt
    buffer_load_dwordx4 v[164:167], v3, s[8:11], s87 offen offset:2816 sc1 nt
    buffer_load_dwordx4 v[168:171], v3, s[8:11], s87 offen offset:3072 sc1 nt
    buffer_load_dwordx4 v[172:175], v3, s[8:11], s87 offen offset:3328 sc1 nt
    buffer_load_dwordx4 v[176:179], v3, s[8:11], s87 offen offset:3584 sc1 nt
    s_waitcnt vmcnt(22)
    v_mfma_f32_16x16x32_bf16 v[16:19], v[8:11], v[60:63], 0
    s_waitcnt vmcnt(21)
    v_mfma_f32_16x16x32_bf16 v[20:23], v[8:11], v[64:67], 0
    s_waitcnt vmcnt(20)
    v_mfma_f32_16x16x32_bf16 v[24:27], v[8:11], v[68:71], 0
    s_waitcnt vmcnt(19)
    v_mfma_f32_16x16x32_bf16 v[28:31], v[8:11], v[72:75], 0
    s_waitcnt vmcnt(18)
    v_mfma_f32_16x16x32_bf16 v[32:35], v[8:11], v[76:79], 0
    s_waitcnt vmcnt(17)
    v_mfma_f32_16x16x32_bf16 v[16:19], v[8:11], v[80:83], v[16:19]
    s_waitcnt vmcnt(16)
    v_mfma_f32_16x16x32_bf16 v[20:23], v[8:11], v[84:87], v[20:23]
    s_waitcnt vmcnt(15)
    v_mfma_f32_16x16x32_bf16 v[24:27], v[8:11], v[88:91], v[24:27]
    s_waitcnt vmcnt(14)
    v_mfma_f32_16x16x32_bf16 v[28:31], v[8:11], v[92:95], v[28:31]
    s_waitcnt vmcnt(13)
    v_mfma_f32_16x16x32_bf16 v[32:35], v[8:11], v[96:99], v[32:35]
    v_permlane16_swap_b32 v220, v222
    v_permlane16_swap_b32 v221, v223
    v_permlane16_swap_b32 v224, v226
    v_permlane16_swap_b32 v225, v227
    v_lshlrev_b32 v60, 16, v220
    v_and_b32 v61, 0xffff0000, v220
    v_pk_add_f32 v[16:17], v[16:17], v[60:61]
    v_cvt_pk_bf16_f32 v64, v16, v17
    v_lshlrev_b32 v60, 16, v221
    v_and_b32 v61, 0xffff0000, v221
    v_pk_add_f32 v[18:19], v[18:19], v[60:61]
    v_cvt_pk_bf16_f32 v65, v18, v19
    v_lshlrev_b32 v60, 16, v222
    v_and_b32 v61, 0xffff0000, v222
    v_pk_add_f32 v[20:21], v[20:21], v[60:61]
    v_cvt_pk_bf16_f32 v66, v20, v21
    v_lshlrev_b32 v60, 16, v223
    v_and_b32 v61, 0xffff0000, v223
    v_pk_add_f32 v[22:23], v[22:23], v[60:61]
    v_cvt_pk_bf16_f32 v67, v22, v23
    v_lshlrev_b32 v60, 16, v224
    v_and_b32 v61, 0xffff0000, v224
    v_pk_add_f32 v[24:25], v[24:25], v[60:61]
    v_cvt_pk_bf16_f32 v68, v24, v25
    v_lshlrev_b32 v60, 16, v225
    v_and_b32 v61, 0xffff0000, v225
    v_pk_add_f32 v[26:27], v[26:27], v[60:61]
    v_cvt_pk_bf16_f32 v69, v26, v27
    v_lshlrev_b32 v60, 16, v226
    v_and_b32 v61, 0xffff0000, v226
    v_pk_add_f32 v[28:29], v[28:29], v[60:61]
    v_cvt_pk_bf16_f32 v70, v28, v29
    v_lshlrev_b32 v60, 16, v227
    v_and_b32 v61, 0xffff0000, v227
    v_pk_add_f32 v[30:31], v[30:31], v[60:61]
    v_cvt_pk_bf16_f32 v71, v30, v31
    v_lshlrev_b32 v60, 16, v228
    v_and_b32 v61, 0xffff0000, v228
    v_pk_add_f32 v[32:33], v[32:33], v[60:61]
    v_cvt_pk_bf16_f32 v72, v32, v33
    v_lshlrev_b32 v60, 16, v229
    v_and_b32 v61, 0xffff0000, v229
    v_pk_add_f32 v[34:35], v[34:35], v[60:61]
    v_cvt_pk_bf16_f32 v73, v34, v35
    v_lshlrev_b32 v16, 16, v64
    v_and_b32 v17, 0xffff0000, v64
    v_lshlrev_b32 v18, 16, v65
    v_and_b32 v19, 0xffff0000, v65
    v_lshlrev_b32 v20, 16, v66
    v_and_b32 v21, 0xffff0000, v66
    v_lshlrev_b32 v22, 16, v67
    v_and_b32 v23, 0xffff0000, v67
    v_lshlrev_b32 v24, 16, v68
    v_and_b32 v25, 0xffff0000, v68
    v_lshlrev_b32 v26, 16, v69
    v_and_b32 v27, 0xffff0000, v69
    v_lshlrev_b32 v28, 16, v70
    v_and_b32 v29, 0xffff0000, v70
    v_lshlrev_b32 v30, 16, v71
    v_and_b32 v31, 0xffff0000, v71
    v_lshlrev_b32 v32, 16, v72
    v_and_b32 v33, 0xffff0000, v72
    v_lshlrev_b32 v34, 16, v73
    v_and_b32 v35, 0xffff0000, v73
    v_pk_add_f32 v[132:133], v[16:17], v[18:19]
    v_pk_add_f32 v[134:135], v[20:21], v[22:23]
    v_pk_add_f32 v[132:133], v[132:133], v[24:25]
    v_pk_add_f32 v[134:135], v[134:135], v[26:27]
    v_pk_add_f32 v[132:133], v[132:133], v[28:29]
    v_pk_add_f32 v[134:135], v[134:135], v[30:31]
    v_pk_add_f32 v[132:133], v[132:133], v[32:33]
    v_pk_add_f32 v[134:135], v[134:135], v[34:35]
    v_pk_add_f32 v[132:133], v[132:133], v[134:135]
    v_add_f32 v132, v132, v133
    v_mul_f32 v132, 0xbd4ccccd, v132
    v_mov_b32 v133, v132
    v_mov_b32 v138, v132
    v_pk_add_f32 v[136:137], v[16:17], v[132:133]
    v_pk_mul_f32 v[134:135], v[136:137], v[136:137]
    v_pk_add_f32 v[136:137], v[18:19], v[132:133]
    v_add_f32_dpp v138, v138, v138 row_ror:8 row_mask:0xf bank_mask:0xf
    v_pk_fma_f32 v[134:135], v[136:137], v[136:137], v[134:135]
    v_pk_add_f32 v[136:137], v[20:21], v[132:133]
    v_add_f32_dpp v138, v138, v138 row_ror:4 row_mask:0xf bank_mask:0xf
    v_pk_fma_f32 v[134:135], v[136:137], v[136:137], v[134:135]
    v_pk_add_f32 v[136:137], v[22:23], v[132:133]
    v_add_f32_dpp v138, v138, v138 row_ror:2 row_mask:0xf bank_mask:0xf
    v_pk_fma_f32 v[134:135], v[136:137], v[136:137], v[134:135]
    v_pk_add_f32 v[136:137], v[24:25], v[132:133]
    v_add_f32_dpp v138, v138, v138 row_ror:1 row_mask:0xf bank_mask:0xf
    v_pk_fma_f32 v[134:135], v[136:137], v[136:137], v[134:135]
    v_pk_add_f32 v[136:137], v[26:27], v[132:133]
    v_pk_fma_f32 v[134:135], v[136:137], v[136:137], v[134:135]
    v_pk_add_f32 v[136:137], v[28:29], v[132:133]
    v_mov_b32 v139, v138
    v_pk_fma_f32 v[134:135], v[136:137], v[136:137], v[134:135]
    v_pk_add_f32 v[136:137], v[30:31], v[132:133]
    v_pk_fma_f32 v[134:135], v[136:137], v[136:137], v[134:135]
    v_pk_add_f32 v[136:137], v[32:33], v[132:133]
    v_permlane16_swap_b32 v139, v138
    v_pk_fma_f32 v[134:135], v[136:137], v[136:137], v[134:135]
    v_pk_add_f32 v[136:137], v[34:35], v[132:133]
    v_pk_fma_f32 v[134:135], v[136:137], v[136:137], v[134:135]
    v_add_f32 v138, v138, v139
    v_add_f32 v134, v134, v135
    v_mul_f32 v138, 0x3d000000, v138
    v_sub_f32 v136, v132, v138
    v_mul_f32 v137, 0x41a00000, v136
    v_fmac_f32 v134, v136, v137
    v_cvt_pk_bf16_f32 v132, v138, v138
    v_and_b32 v132, 0xffff0000, v132
    v_mov_b32 v133, v132
    v_add_f32_dpp v134, v134, v134 row_ror:8 row_mask:0xf bank_mask:0xf
    v_pk_add_f32 v[16:17], v[16:17], v[132:133]
    v_pk_add_f32 v[18:19], v[18:19], v[132:133]
    v_add_f32_dpp v134, v134, v134 row_ror:4 row_mask:0xf bank_mask:0xf
    v_pk_add_f32 v[20:21], v[20:21], v[132:133]
    v_pk_add_f32 v[22:23], v[22:23], v[132:133]
    v_add_f32_dpp v134, v134, v134 row_ror:2 row_mask:0xf bank_mask:0xf
    v_pk_add_f32 v[24:25], v[24:25], v[132:133]
    v_pk_add_f32 v[26:27], v[26:27], v[132:133]
    v_add_f32_dpp v134, v134, v134 row_ror:1 row_mask:0xf bank_mask:0xf
    v_pk_add_f32 v[28:29], v[28:29], v[132:133]
    v_pk_add_f32 v[30:31], v[30:31], v[132:133]
    v_mov_b32 v135, v134
    v_pk_add_f32 v[32:33], v[32:33], v[132:133]
    v_pk_add_f32 v[34:35], v[34:35], v[132:133]
    v_permlane16_swap_b32 v135, v134
    v_add_f32 v134, v134, v135
    v_mul_f32 v134, 0x3acccccd, v134
    v_cvt_pk_bf16_f32 v134, v134, v134
    v_and_b32 v134, 0xffff0000, v134
    v_add_f32 v134, 0x3727c5ac, v134
    v_cvt_pk_bf16_f32 v134, v134, v134
    v_and_b32 v134, 0xffff0000, v134
    v_sqrt_f32 v134, v134
    s_nop 0
    v_cvt_pk_bf16_f32 v134, v134, v134
    v_and_b32 v134, 0xffff0000, v134
    v_rcp_f32 v134, v134
    s_nop 0
    v_mov_b32 v135, v134
    v_pk_mul_f32 v[16:17], v[16:17], v[134:135]
    v_pk_mul_f32 v[18:19], v[18:19], v[134:135]
    v_pk_mul_f32 v[20:21], v[20:21], v[134:135]
    v_pk_mul_f32 v[22:23], v[22:23], v[134:135]
    v_pk_mul_f32 v[24:25], v[24:25], v[134:135]
    v_pk_mul_f32 v[26:27], v[26:27], v[134:135]
    v_pk_mul_f32 v[28:29], v[28:29], v[134:135]
    v_pk_mul_f32 v[30:31], v[30:31], v[134:135]
    v_pk_mul_f32 v[32:33], v[32:33], v[134:135]
    v_pk_mul_f32 v[34:35], v[34:35], v[134:135]
    v_cvt_pk_bf16_f32 v76, v16, v17
    v_cvt_pk_bf16_f32 v77, v18, v19
    v_cvt_pk_bf16_f32 v78, v20, v21
    v_cvt_pk_bf16_f32 v79, v22, v23
    v_cvt_pk_bf16_f32 v80, v24, v25
    v_cvt_pk_bf16_f32 v81, v26, v27
    v_cvt_pk_bf16_f32 v82, v28, v29
    v_cvt_pk_bf16_f32 v83, v30, v31
    v_cvt_pk_bf16_f32 v84, v32, v33
    v_cvt_pk_bf16_f32 v85, v34, v35
    v_permlane16_swap_b32 v76, v78
    v_permlane16_swap_b32 v77, v79
    v_permlane16_swap_b32 v80, v82
    v_permlane16_swap_b32 v81, v83
    buffer_store_dwordx4 v[76:79], v2, s[8:11], s61 offen offset:0 sc1
    buffer_store_dwordx4 v[80:83], v2, s[8:11], s61 offen offset:512 sc1
    buffer_store_dwordx2 v[84:85], v1, s[8:11], s61 offen offset:1024 sc1
    v_permlane16_swap_b32 v64, v66
    v_permlane16_swap_b32 v65, v67
    v_permlane16_swap_b32 v68, v70
    v_permlane16_swap_b32 v69, v71
    buffer_store_dwordx4 v[64:67], v2, s[52:55], s62 offen offset:0 sc1
    buffer_store_dwordx4 v[68:71], v2, s[52:55], s62 offen offset:512 sc1
    buffer_store_dwordx2 v[72:73], v1, s[52:55], s62 offen offset:1024 sc1
    s_waitcnt vmcnt(15)
    v_mfma_f32_16x16x32_bf16 v[36:39], v[8:11], v[140:143], 0
    s_waitcnt vmcnt(14)
    v_mfma_f32_16x16x32_bf16 v[40:43], v[8:11], v[144:147], 0
    s_waitcnt vmcnt(13)
    v_mfma_f32_16x16x32_bf16 v[44:47], v[8:11], v[148:151], 0
    s_waitcnt vmcnt(12)
    v_mfma_f32_16x16x32_bf16 v[48:51], v[8:11], v[152:155], 0
    s_waitcnt vmcnt(11)
    v_mfma_f32_16x16x32_bf16 v[52:55], v[8:11], v[156:159], 0
    s_waitcnt vmcnt(10)
    v_mfma_f32_16x16x32_bf16 v[36:39], v[8:11], v[160:163], v[36:39]
    s_waitcnt vmcnt(9)
    v_mfma_f32_16x16x32_bf16 v[40:43], v[8:11], v[164:167], v[40:43]
    s_waitcnt vmcnt(8)
    v_mfma_f32_16x16x32_bf16 v[44:47], v[8:11], v[168:171], v[44:47]
    s_waitcnt vmcnt(7)
    v_mfma_f32_16x16x32_bf16 v[48:51], v[8:11], v[172:175], v[48:51]
    s_waitcnt vmcnt(6)
    v_mfma_f32_16x16x32_bf16 v[52:55], v[8:11], v[176:179], v[52:55]
    v_permlane16_swap_b32 v230, v232
    v_permlane16_swap_b32 v231, v233
    v_permlane16_swap_b32 v234, v236
    v_permlane16_swap_b32 v235, v237
    v_lshlrev_b32 v60, 16, v230
    v_and_b32 v61, 0xffff0000, v230
    v_pk_add_f32 v[36:37], v[36:37], v[60:61]
    v_cvt_pk_bf16_f32 v96, v36, v37
    v_lshlrev_b32 v60, 16, v231
    v_and_b32 v61, 0xffff0000, v231
    v_pk_add_f32 v[38:39], v[38:39], v[60:61]
    v_cvt_pk_bf16_f32 v97, v38, v39
    v_lshlrev_b32 v60, 16, v232
    v_and_b32 v61, 0xffff0000, v232
    v_pk_add_f32 v[40:41], v[40:41], v[60:61]
    v_cvt_pk_bf16_f32 v98, v40, v41
    v_lshlrev_b32 v60, 16, v233
    v_and_b32 v61, 0xffff0000, v233
    v_pk_add_f32 v[42:43], v[42:43], v[60:61]
    v_cvt_pk_bf16_f32 v99, v42, v43
    v_lshlrev_b32 v60, 16, v234
    v_and_b32 v61, 0xffff0000, v234
    v_pk_add_f32 v[44:45], v[44:45], v[60:61]
    v_cvt_pk_bf16_f32 v100, v44, v45
    v_lshlrev_b32 v60, 16, v235
    v_and_b32 v61, 0xffff0000, v235
    v_pk_add_f32 v[46:47], v[46:47], v[60:61]
    v_cvt_pk_bf16_f32 v101, v46, v47
    v_lshlrev_b32 v60, 16, v236
    v_and_b32 v61, 0xffff0000, v236
    v_pk_add_f32 v[48:49], v[48:49], v[60:61]
    v_cvt_pk_bf16_f32 v102, v48, v49
    v_lshlrev_b32 v60, 16, v237
    v_and_b32 v61, 0xffff0000, v237
    v_pk_add_f32 v[50:51], v[50:51], v[60:61]
    v_cvt_pk_bf16_f32 v103, v50, v51
    v_lshlrev_b32 v60, 16, v238
    v_and_b32 v61, 0xffff0000, v238
    v_pk_add_f32 v[52:53], v[52:53], v[60:61]
    v_cvt_pk_bf16_f32 v104, v52, v53
    v_lshlrev_b32 v60, 16, v239
    v_and_b32 v61, 0xffff0000, v239
    v_pk_add_f32 v[54:55], v[54:55], v[60:61]
    v_cvt_pk_bf16_f32 v105, v54, v55
    v_lshlrev_b32 v36, 16, v96
    v_and_b32 v37, 0xffff0000, v96
    v_lshlrev_b32 v38, 16, v97
    v_and_b32 v39, 0xffff0000, v97
    v_lshlrev_b32 v40, 16, v98
    v_and_b32 v41, 0xffff0000, v98
    v_lshlrev_b32 v42, 16, v99
    v_and_b32 v43, 0xffff0000, v99
    v_lshlrev_b32 v44, 16, v100
    v_and_b32 v45, 0xffff0000, v100
    v_lshlrev_b32 v46, 16, v101
    v_and_b32 v47, 0xffff0000, v101
    v_lshlrev_b32 v48, 16, v102
    v_and_b32 v49, 0xffff0000, v102
    v_lshlrev_b32 v50, 16, v103
    v_and_b32 v51, 0xffff0000, v103
    v_lshlrev_b32 v52, 16, v104
    v_and_b32 v53, 0xffff0000, v104
    v_lshlrev_b32 v54, 16, v105
    v_and_b32 v55, 0xffff0000, v105
    v_pk_add_f32 v[132:133], v[36:37], v[38:39]
    v_pk_add_f32 v[134:135], v[40:41], v[42:43]
    v_pk_add_f32 v[132:133], v[132:133], v[44:45]
    v_pk_add_f32 v[134:135], v[134:135], v[46:47]
    v_pk_add_f32 v[132:133], v[132:133], v[48:49]
    v_pk_add_f32 v[134:135], v[134:135], v[50:51]
    v_pk_add_f32 v[132:133], v[132:133], v[52:53]
    v_pk_add_f32 v[134:135], v[134:135], v[54:55]
    v_pk_add_f32 v[132:133], v[132:133], v[134:135]
    v_add_f32 v132, v132, v133
    v_mul_f32 v132, 0xbd4ccccd, v132
    v_mov_b32 v133, v132
    v_mov_b32 v138, v132
    v_pk_add_f32 v[136:137], v[36:37], v[132:133]
    v_pk_mul_f32 v[134:135], v[136:137], v[136:137]
    v_pk_add_f32 v[136:137], v[38:39], v[132:133]
    v_add_f32_dpp v138, v138, v138 row_ror:8 row_mask:0xf bank_mask:0xf
    v_pk_fma_f32 v[134:135], v[136:137], v[136:137], v[134:135]
    v_pk_add_f32 v[136:137], v[40:41], v[132:133]
    v_add_f32_dpp v138, v138, v138 row_ror:4 row_mask:0xf bank_mask:0xf
    v_pk_fma_f32 v[134:135], v[136:137], v[136:137], v[134:135]
    v_pk_add_f32 v[136:137], v[42:43], v[132:133]
    v_add_f32_dpp v138, v138, v138 row_ror:2 row_mask:0xf bank_mask:0xf
    v_pk_fma_f32 v[134:135], v[136:137], v[136:137], v[134:135]
    v_pk_add_f32 v[136:137], v[44:45], v[132:133]
    v_add_f32_dpp v138, v138, v138 row_ror:1 row_mask:0xf bank_mask:0xf
    v_pk_fma_f32 v[134:135], v[136:137], v[136:137], v[134:135]
    v_pk_add_f32 v[136:137], v[46:47], v[132:133]
    v_pk_fma_f32 v[134:135], v[136:137], v[136:137], v[134:135]
    v_pk_add_f32 v[136:137], v[48:49], v[132:133]
    v_mov_b32 v139, v138
    v_pk_fma_f32 v[134:135], v[136:137], v[136:137], v[134:135]
    v_pk_add_f32 v[136:137], v[50:51], v[132:133]
    v_pk_fma_f32 v[134:135], v[136:137], v[136:137], v[134:135]
    v_pk_add_f32 v[136:137], v[52:53], v[132:133]
    v_permlane16_swap_b32 v139, v138
    v_pk_fma_f32 v[134:135], v[136:137], v[136:137], v[134:135]
    v_pk_add_f32 v[136:137], v[54:55], v[132:133]
    v_pk_fma_f32 v[134:135], v[136:137], v[136:137], v[134:135]
    v_add_f32 v138, v138, v139
    v_add_f32 v134, v134, v135
    v_mul_f32 v138, 0x3d000000, v138
    v_sub_f32 v136, v132, v138
    v_mul_f32 v137, 0x41a00000, v136
    v_fmac_f32 v134, v136, v137
    v_cvt_pk_bf16_f32 v132, v138, v138
    v_and_b32 v132, 0xffff0000, v132
    v_mov_b32 v133, v132
    v_add_f32_dpp v134, v134, v134 row_ror:8 row_mask:0xf bank_mask:0xf
    v_pk_add_f32 v[36:37], v[36:37], v[132:133]
    v_pk_add_f32 v[38:39], v[38:39], v[132:133]
    v_add_f32_dpp v134, v134, v134 row_ror:4 row_mask:0xf bank_mask:0xf
    v_pk_add_f32 v[40:41], v[40:41], v[132:133]
    v_pk_add_f32 v[42:43], v[42:43], v[132:133]
    v_add_f32_dpp v134, v134, v134 row_ror:2 row_mask:0xf bank_mask:0xf
    v_pk_add_f32 v[44:45], v[44:45], v[132:133]
    v_pk_add_f32 v[46:47], v[46:47], v[132:133]
    v_add_f32_dpp v134, v134, v134 row_ror:1 row_mask:0xf bank_mask:0xf
    v_pk_add_f32 v[48:49], v[48:49], v[132:133]
    v_pk_add_f32 v[50:51], v[50:51], v[132:133]
    v_mov_b32 v135, v134
    v_pk_add_f32 v[52:53], v[52:53], v[132:133]
    v_pk_add_f32 v[54:55], v[54:55], v[132:133]
    v_permlane16_swap_b32 v135, v134
    v_add_f32 v134, v134, v135
    v_mul_f32 v134, 0x3acccccd, v134
    v_cvt_pk_bf16_f32 v134, v134, v134
    v_and_b32 v134, 0xffff0000, v134
    v_add_f32 v134, 0x3727c5ac, v134
    v_cvt_pk_bf16_f32 v134, v134, v134
    v_and_b32 v134, 0xffff0000, v134
    v_sqrt_f32 v134, v134
    s_nop 0
    v_cvt_pk_bf16_f32 v134, v134, v134
    v_and_b32 v134, 0xffff0000, v134
    v_rcp_f32 v134, v134
    s_nop 0
    v_mov_b32 v135, v134
    v_pk_mul_f32 v[36:37], v[36:37], v[134:135]
    v_pk_mul_f32 v[38:39], v[38:39], v[134:135]
    v_pk_mul_f32 v[40:41], v[40:41], v[134:135]
    v_pk_mul_f32 v[42:43], v[42:43], v[134:135]
    v_pk_mul_f32 v[44:45], v[44:45], v[134:135]
    v_pk_mul_f32 v[46:47], v[46:47], v[134:135]
    v_pk_mul_f32 v[48:49], v[48:49], v[134:135]
    v_pk_mul_f32 v[50:51], v[50:51], v[134:135]
    v_pk_mul_f32 v[52:53], v[52:53], v[134:135]
    v_pk_mul_f32 v[54:55], v[54:55], v[134:135]
    v_cvt_pk_bf16_f32 v108, v36, v37
    v_cvt_pk_bf16_f32 v109, v38, v39
    v_cvt_pk_bf16_f32 v110, v40, v41
    v_cvt_pk_bf16_f32 v111, v42, v43
    v_cvt_pk_bf16_f32 v112, v44, v45
    v_cvt_pk_bf16_f32 v113, v46, v47
    v_cvt_pk_bf16_f32 v114, v48, v49
    v_cvt_pk_bf16_f32 v115, v50, v51
    v_cvt_pk_bf16_f32 v116, v52, v53
    v_cvt_pk_bf16_f32 v117, v54, v55
    v_permlane16_swap_b32 v108, v110
    v_permlane16_swap_b32 v109, v111
    v_permlane16_swap_b32 v112, v114
    v_permlane16_swap_b32 v113, v115
    buffer_store_dwordx4 v[108:111], v2, s[8:11], s61 offen offset:2560 sc1
    buffer_store_dwordx4 v[112:115], v2, s[8:11], s61 offen offset:3072 sc1
    buffer_store_dwordx2 v[116:117], v1, s[8:11], s61 offen offset:3584 sc1
    v_permlane16_swap_b32 v96, v98
    v_permlane16_swap_b32 v97, v99
    v_permlane16_swap_b32 v100, v102
    v_permlane16_swap_b32 v101, v103
    buffer_store_dwordx4 v[96:99], v2, s[52:55], s62 offen offset:2560 sc1
    buffer_store_dwordx4 v[100:103], v2, s[52:55], s62 offen offset:3072 sc1
    buffer_store_dwordx2 v[104:105], v1, s[52:55], s62 offen offset:3584 sc1
    s_branch L_r_end
L_r_c:
    buffer_load_dwordx4 v[220:223], v2, s[48:51], s60 offen offset:0 sc1
    buffer_load_dwordx4 v[224:227], v2, s[48:51], s60 offen offset:512 sc1
    buffer_load_dwordx2 v[228:229], v1, s[48:51], s60 offen offset:1024 sc1
    buffer_load_dwordx4 v[60:63], v3, s[8:11], s86 offen offset:0 sc1 nt
    buffer_load_dwordx4 v[64:67], v3, s[8:11], s86 offen offset:256 sc1 nt
    buffer_load_dwordx4 v[68:71], v3, s[8:11], s86 offen offset:512 sc1 nt
    buffer_load_dwordx4 v[72:75], v3, s[8:11], s86 offen offset:768 sc1 nt
    buffer_load_dwordx4 v[76:79], v3, s[8:11], s86 offen offset:1024 sc1 nt
    buffer_load_dwordx4 v[80:83], v3, s[8:11], s87 offen offset:0 sc1 nt
    buffer_load_dwordx4 v[84:87], v3, s[8:11], s87 offen offset:256 sc1 nt
    buffer_load_dwordx4 v[88:91], v3, s[8:11], s87 offen offset:512 sc1 nt
    buffer_load_dwordx4 v[92:95], v3, s[8:11], s87 offen offset:768 sc1 nt
    buffer_load_dwordx4 v[96:99], v3, s[8:11], s87 offen offset:1024 sc1 nt
    buffer_load_dwordx4 v[230:233], v2, s[48:51], s60 offen offset:2560 sc1
    buffer_load_dwordx4 v[234:237], v2, s[48:51], s60 offen offset:3072 sc1
    buffer_load_dwordx2 v[238:239], v1, s[48:51], s60 offen offset:3584 sc1
    buffer_load_dwordx4 v[140:143], v3, s[8:11], s86 offen offset:2560 sc1 nt
    buffer_load_dwordx4 v[144:147], v3, s[8:11], s86 offen offset:2816 sc1 nt
    buffer_load_dwordx4 v[148:151], v3, s[8:11], s86 offen offset:3072 sc1 nt
    buffer_load_dwordx4 v[152:155], v3, s[8:11], s86 offen offset:3328 sc1 nt
    buffer_load_dwordx4 v[156:159], v3, s[8:11], s86 offen offset:3584 sc1 nt
    buffer_load_dwordx4 v[160:163], v3, s[8:11], s87 offen offset:2560 sc1 nt
    buffer_load_dwordx4 v[164:167], v3, s[8:11], s87 offen offset:2816 sc1 nt
    buffer_load_dwordx4 v[168:171], v3, s[8:11], s87 offen offset:3072 sc1 nt
    buffer_load_dwordx4 v[172:175], v3, s[8:11], s87 offen offset:3328 sc1 nt
    buffer_load_dwordx4 v[176:179], v3, s[8:11], s87 offen offset:3584 sc1 nt
    s_waitcnt vmcnt(22)
    v_mfma_f32_16x16x32_bf16 v[16:19], v[8:11], v[60:63], 0
    s_waitcnt vmcnt(21)
    v_mfma_f32_16x16x32_bf16 v[20:23], v[8:11], v[64:67], 0
    s_waitcnt vmcnt(20)
    v_mfma_f32_16x16x32_bf16 v[24:27], v[8:11], v[68:71], 0
    s_waitcnt vmcnt(19)
    v_mfma_f32_16x16x32_bf16 v[28:31], v[8:11], v[72:75], 0
    s_waitcnt vmcnt(18)
    v_mfma_f32_16x16x32_bf16 v[32:35], v[8:11], v[76:79], 0
    s_waitcnt vmcnt(17)
    v_mfma_f32_16x16x32_bf16 v[16:19], v[8:11], v[80:83], v[16:19]
    s_waitcnt vmcnt(16)
    v_mfma_f32_16x16x32_bf16 v[20:23], v[8:11], v[84:87], v[20:23]
    s_waitcnt vmcnt(15)
    v_mfma_f32_16x16x32_bf16 v[24:27], v[8:11], v[88:91], v[24:27]
    s_waitcnt vmcnt(14)
    v_mfma_f32_16x16x32_bf16 v[28:31], v[8:11], v[92:95], v[28:31]
    s_waitcnt vmcnt(13)
    v_mfma_f32_16x16x32_bf16 v[32:35], v[8:11], v[96:99], v[32:35]
    v_permlane16_swap_b32 v220, v222
    v_permlane16_swap_b32 v221, v223
    v_permlane16_swap_b32 v224, v226
    v_permlane16_swap_b32 v225, v227
    v_lshlrev_b32 v60, 16, v220
    v_and_b32 v61, 0xffff0000, v220
    v_pk_add_f32 v[16:17], v[16:17], v[60:61]
    v_cvt_pk_bf16_f32 v64, v16, v17
    v_lshlrev_b32 v60, 16, v221
    v_and_b32 v61, 0xffff0000, v221
    v_pk_add_f32 v[18:19], v[18:19], v[60:61]
    v_cvt_pk_bf16_f32 v65, v18, v19
    v_lshlrev_b32 v60, 16, v222
    v_and_b32 v61, 0xffff0000, v222
    v_pk_add_f32 v[20:21], v[20:21], v[60:61]
    v_cvt_pk_bf16_f32 v66, v20, v21
    v_lshlrev_b32 v60, 16, v223
    v_and_b32 v61, 0xffff0000, v223
    v_pk_add_f32 v[22:23], v[22:23], v[60:61]
    v_cvt_pk_bf16_f32 v67, v22, v23
    v_lshlrev_b32 v60, 16, v224
    v_and_b32 v61, 0xffff0000, v224
    v_pk_add_f32 v[24:25], v[24:25], v[60:61]
    v_cvt_pk_bf16_f32 v68, v24, v25
    v_lshlrev_b32 v60, 16, v225
    v_and_b32 v61, 0xffff0000, v225
    v_pk_add_f32 v[26:27], v[26:27], v[60:61]
    v_cvt_pk_bf16_f32 v69, v26, v27
    v_lshlrev_b32 v60, 16, v226
    v_and_b32 v61, 0xffff0000, v226
    v_pk_add_f32 v[28:29], v[28:29], v[60:61]
    v_cvt_pk_bf16_f32 v70, v28, v29
    v_lshlrev_b32 v60, 16, v227
    v_and_b32 v61, 0xffff0000, v227
    v_pk_add_f32 v[30:31], v[30:31], v[60:61]
    v_cvt_pk_bf16_f32 v71, v30, v31
    v_lshlrev_b32 v60, 16, v228
    v_and_b32 v61, 0xffff0000, v228
    v_pk_add_f32 v[32:33], v[32:33], v[60:61]
    v_cvt_pk_bf16_f32 v72, v32, v33
    v_lshlrev_b32 v60, 16, v229
    v_and_b32 v61, 0xffff0000, v229
    v_pk_add_f32 v[34:35], v[34:35], v[60:61]
    v_cvt_pk_bf16_f32 v73, v34, v35
    v_permlane16_swap_b32 v64, v66
    v_permlane16_swap_b32 v65, v67
    v_permlane16_swap_b32 v68, v70
    v_permlane16_swap_b32 v69, v71
    buffer_store_dwordx4 v[64:67], v2, s[52:55], s62 offen offset:0 sc1
    buffer_store_dwordx4 v[68:71], v2, s[52:55], s62 offen offset:512 sc1
    buffer_store_dwordx2 v[72:73], v1, s[52:55], s62 offen offset:1024 sc1
    s_waitcnt vmcnt(12)
    v_mfma_f32_16x16x32_bf16 v[36:39], v[8:11], v[140:143], 0
    s_waitcnt vmcnt(11)
    v_mfma_f32_16x16x32_bf16 v[40:43], v[8:11], v[144:147], 0
    s_waitcnt vmcnt(10)
    v_mfma_f32_16x16x32_bf16 v[44:47], v[8:11], v[148:151], 0
    s_waitcnt vmcnt(9)
    v_mfma_f32_16x16x32_bf16 v[48:51], v[8:11], v[152:155], 0
    s_waitcnt vmcnt(8)
    v_mfma_f32_16x16x32_bf16 v[52:55], v[8:11], v[156:159], 0
    s_waitcnt vmcnt(7)
    v_mfma_f32_16x16x32_bf16 v[36:39], v[8:11], v[160:163], v[36:39]
    s_waitcnt vmcnt(6)
    v_mfma_f32_16x16x32_bf16 v[40:43], v[8:11], v[164:167], v[40:43]
    s_waitcnt vmcnt(5)
    v_mfma_f32_16x16x32_bf16 v[44:47], v[8:11], v[168:171], v[44:47]
    s_waitcnt vmcnt(4)
    v_mfma_f32_16x16x32_bf16 v[48:51], v[8:11], v[172:175], v[48:51]
    s_waitcnt vmcnt(3)
    v_mfma_f32_16x16x32_bf16 v[52:55], v[8:11], v[176:179], v[52:55]
    v_permlane16_swap_b32 v230, v232
    v_permlane16_swap_b32 v231, v233
    v_permlane16_swap_b32 v234, v236
    v_permlane16_swap_b32 v235, v237
    v_lshlrev_b32 v60, 16, v230
    v_and_b32 v61, 0xffff0000, v230
    v_pk_add_f32 v[36:37], v[36:37], v[60:61]
    v_cvt_pk_bf16_f32 v96, v36, v37
    v_lshlrev_b32 v60, 16, v231
    v_and_b32 v61, 0xffff0000, v231
    v_pk_add_f32 v[38:39], v[38:39], v[60:61]
    v_cvt_pk_bf16_f32 v97, v38, v39
    v_lshlrev_b32 v60, 16, v232
    v_and_b32 v61, 0xffff0000, v232
    v_pk_add_f32 v[40:41], v[40:41], v[60:61]
    v_cvt_pk_bf16_f32 v98, v40, v41
    v_lshlrev_b32 v60, 16, v233
    v_and_b32 v61, 0xffff0000, v233
    v_pk_add_f32 v[42:43], v[42:43], v[60:61]
    v_cvt_pk_bf16_f32 v99, v42, v43
    v_lshlrev_b32 v60, 16, v234
    v_and_b32 v61, 0xffff0000, v234
    v_pk_add_f32 v[44:45], v[44:45], v[60:61]
    v_cvt_pk_bf16_f32 v100, v44, v45
    v_lshlrev_b32 v60, 16, v235
    v_and_b32 v61, 0xffff0000, v235
    v_pk_add_f32 v[46:47], v[46:47], v[60:61]
    v_cvt_pk_bf16_f32 v101, v46, v47
    v_lshlrev_b32 v60, 16, v236
    v_and_b32 v61, 0xffff0000, v236
    v_pk_add_f32 v[48:49], v[48:49], v[60:61]
    v_cvt_pk_bf16_f32 v102, v48, v49
    v_lshlrev_b32 v60, 16, v237
    v_and_b32 v61, 0xffff0000, v237
    v_pk_add_f32 v[50:51], v[50:51], v[60:61]
    v_cvt_pk_bf16_f32 v103, v50, v51
    v_lshlrev_b32 v60, 16, v238
    v_and_b32 v61, 0xffff0000, v238
    v_pk_add_f32 v[52:53], v[52:53], v[60:61]
    v_cvt_pk_bf16_f32 v104, v52, v53
    v_lshlrev_b32 v60, 16, v239
    v_and_b32 v61, 0xffff0000, v239
    v_pk_add_f32 v[54:55], v[54:55], v[60:61]
    v_cvt_pk_bf16_f32 v105, v54, v55
    v_permlane16_swap_b32 v96, v98
    v_permlane16_swap_b32 v97, v99
    v_permlane16_swap_b32 v100, v102
    v_permlane16_swap_b32 v101, v103
    buffer_store_dwordx4 v[96:99], v2, s[52:55], s62 offen offset:2560 sc1
    buffer_store_dwordx4 v[100:103], v2, s[52:55], s62 offen offset:3072 sc1
    buffer_store_dwordx2 v[104:105], v1, s[52:55], s62 offen offset:3584 sc1
L_r_end:
    v_mov_b32 v56, -1
    s_mov_b64 exec, s[84:85]
    v_mov_b32 v56, 0
    buffer_atomic_add v56, v5, s[8:11], s77 offen sc0
    s_mov_b64 exec, -1
    s_add_u32 s73, s73, 1
    s_add_u32 s83, s73, 1
    s_waitcnt vmcnt(0)
    v_mov_b32 v4, s73
    s_mov_b64 exec, 1
    buffer_store_dword v4, off, s[8:11], s71 sc1
    s_mov_b64 exec, -1
    s_cmp_ge_u32 s73, 64
    s_cbranch_scc1 L_end
    v_cmp_gt_u32 vcc, s83, v56
    s_cbranch_vccz L_r_go
    s_branch L_r_poll
L_op:
    s_sub_u32 s70, s5, 21
    s_mul_i32 s60, s3, 5
    s_add_u32 s60, s60, s70
    s_lshl_b32 s60, s60, 7
    s_add_u32 s71, s60, 28672
    s_add_u32 s72, s71, 8192
    v_mov_b32 v4, 0
    s_mov_b64 exec, 1
    buffer_store_dword v4, off, s[8:11], s71 sc1
    s_mov_b64 exec, -1
    v_mov_b32 v4, 0
    s_mov_b64 exec, 1
    buffer_store_dword v4, off, s[8:11], s72 sc1
    s_mov_b64 exec, -1
    s_lshl_b32 s85, s3, 7
    s_lshl_b32 s60, s70, 2
    s_add_u32 s85, s85, s60
    s_add_u32 s85, s85, 18432
    s_add_u32 s86, s85, 32
    v_mov_b32 v4, 0
    s_mov_b64 exec, 1
    buffer_store_dword v4, off, s[8:11], s85 sc1
    s_mov_b64 exec, -1
    v_mov_b32 v4, 0
    s_mov_b64 exec, 1
    buffer_store_dword v4, off, s[8:11], s86 sc1
    s_mov_b64 exec, -1
    s_waitcnt vmcnt(0)
    s_barrier
    s_cmp_lg_u32 s4, 0
    s_cbranch_scc1 L_arr_14
    s_and_b32 s60, s2, 7
    s_lshl_b32 s60, s60, 5
    s_add_u32 s60, s60, 16
    v_mov_b32 v1, 1
    s_mov_b64 exec, 1
    buffer_atomic_add v1, off, s[12:15], s60
    s_mov_b64 exec, -1
L_arr_14:
    s_mul_i32 s66, s3, 5120
    s_mul_i32 s67, s64, 40960
    s_add_u32 s67, s67, s66
    buffer_load_dwordx2 v[16:17], v2, s[44:47], s67 offen offset:0
    buffer_load_dwordx2 v[18:19], v2, s[44:47], s67 offen offset:256
    buffer_load_dwordx2 v[20:21], v2, s[44:47], s67 offen offset:512
    buffer_load_dwordx2 v[22:23], v2, s[44:47], s67 offen offset:768
    buffer_load_dwordx2 v[24:25], v2, s[44:47], s67 offen offset:1024
    buffer_load_dwordx2 v[26:27], v2, s[44:47], s67 offen offset:2560
    buffer_load_dwordx2 v[28:29], v2, s[44:47], s67 offen offset:2816
    buffer_load_dwordx2 v[30:31], v2, s[44:47], s67 offen offset:3072
    buffer_load_dwordx2 v[32:33], v2, s[44:47], s67 offen offset:3328
    buffer_load_dwordx2 v[34:35], v2, s[44:47], s67 offen offset:3584
    s_add_u32 s68, s67, 4194304
    s_waitcnt vmcnt(5)
    v_lshlrev_b32 v40, 16, v16
    v_and_b32 v41, 0xffff0000, v16
    v_lshlrev_b32 v42, 16, v17
    v_and_b32 v43, 0xffff0000, v17
    v_lshlrev_b32 v44, 16, v18
    v_and_b32 v45, 0xffff0000, v18
    v_lshlrev_b32 v46, 16, v19
    v_and_b32 v47, 0xffff0000, v19
    v_lshlrev_b32 v48, 16, v20
    v_and_b32 v49, 0xffff0000, v20
    v_lshlrev_b32 v50, 16, v21
    v_and_b32 v51, 0xffff0000, v21
    v_lshlrev_b32 v52, 16, v22
    v_and_b32 v53, 0xffff0000, v22
    v_lshlrev_b32 v54, 16, v23
    v_and_b32 v55, 0xffff0000, v23
    v_lshlrev_b32 v56, 16, v24
    v_and_b32 v57, 0xffff0000, v24
    v_lshlrev_b32 v58, 16, v25
    v_and_b32 v59, 0xffff0000, v25
    v_pk_add_f32 v[80:81], v[40:41], v[42:43]
    v_pk_add_f32 v[82:83], v[44:45], v[46:47]
    v_pk_add_f32 v[80:81], v[80:81], v[48:49]
    v_pk_add_f32 v[82:83], v[82:83], v[50:51]
    v_pk_add_f32 v[80:81], v[80:81], v[52:53]
    v_pk_add_f32 v[82:83], v[82:83], v[54:55]
    v_pk_add_f32 v[80:81], v[80:81], v[56:57]
    v_pk_add_f32 v[82:83], v[82:83], v[58:59]
    v_pk_add_f32 v[80:81], v[80:81], v[82:83]
    v_add_f32 v80, v80, v81
    v_mul_f32 v80, 0xbd4ccccd, v80
    v_mov_b32 v81, v80
    v_mov_b32 v86, v80
    v_pk_add_f32 v[84:85], v[40:41], v[80:81]
    v_pk_mul_f32 v[82:83], v[84:85], v[84:85]
    v_pk_add_f32 v[84:85], v[42:43], v[80:81]
    v_add_f32_dpp v86, v86, v86 row_ror:8 row_mask:0xf bank_mask:0xf
    v_pk_fma_f32 v[82:83], v[84:85], v[84:85], v[82:83]
    v_pk_add_f32 v[84:85], v[44:45], v[80:81]
    v_add_f32_dpp v86, v86, v86 row_ror:4 row_mask:0xf bank_mask:0xf
    v_pk_fma_f32 v[82:83], v[84:85], v[84:85], v[82:83]
    v_pk_add_f32 v[84:85], v[46:47], v[80:81]
    v_add_f32_dpp v86, v86, v86 row_ror:2 row_mask:0xf bank_mask:0xf
    v_pk_fma_f32 v[82:83], v[84:85], v[84:85], v[82:83]
    v_pk_add_f32 v[84:85], v[48:49], v[80:81]
    v_add_f32_dpp v86, v86, v86 row_ror:1 row_mask:0xf bank_mask:0xf
    v_pk_fma_f32 v[82:83], v[84:85], v[84:85], v[82:83]
    v_pk_add_f32 v[84:85], v[50:51], v[80:81]
    v_pk_fma_f32 v[82:83], v[84:85], v[84:85], v[82:83]
    v_pk_add_f32 v[84:85], v[52:53], v[80:81]
    v_mov_b32 v87, v86
    v_pk_fma_f32 v[82:83], v[84:85], v[84:85], v[82:83]
    v_pk_add_f32 v[84:85], v[54:55], v[80:81]
    v_pk_fma_f32 v[82:83], v[84:85], v[84:85], v[82:83]
    v_pk_add_f32 v[84:85], v[56:57], v[80:81]
    v_permlane16_swap_b32 v87, v86
    v_pk_fma_f32 v[82:83], v[84:85], v[84:85], v[82:83]
    v_pk_add_f32 v[84:85], v[58:59], v[80:81]
    v_pk_fma_f32 v[82:83], v[84:85], v[84:85], v[82:83]
    v_add_f32 v86, v86, v87
    v_add_f32 v82, v82, v83
    v_mul_f32 v86, 0x3d000000, v86
    v_sub_f32 v84, v80, v86
    v_mul_f32 v85, 0x41a00000, v84
    v_fmac_f32 v82, v84, v85
    v_cvt_pk_bf16_f32 v80, v86, v86
    v_and_b32 v80, 0xffff0000, v80
    v_mov_b32 v81, v80
    v_add_f32_dpp v82, v82, v82 row_ror:8 row_mask:0xf bank_mask:0xf
    v_pk_add_f32 v[40:41], v[40:41], v[80:81]
    v_pk_add_f32 v[42:43], v[42:43], v[80:81]
    v_add_f32_dpp v82, v82, v82 row_ror:4 row_mask:0xf bank_mask:0xf
    v_pk_add_f32 v[44:45], v[44:45], v[80:81]
    v_pk_add_f32 v[46:47], v[46:47], v[80:81]
    v_add_f32_dpp v82, v82, v82 row_ror:2 row_mask:0xf bank_mask:0xf
    v_pk_add_f32 v[48:49], v[48:49], v[80:81]
    v_pk_add_f32 v[50:51], v[50:51], v[80:81]
    v_add_f32_dpp v82, v82, v82 row_ror:1 row_mask:0xf bank_mask:0xf
    v_pk_add_f32 v[52:53], v[52:53], v[80:81]
    v_pk_add_f32 v[54:55], v[54:55], v[80:81]
    v_mov_b32 v83, v82
    v_pk_add_f32 v[56:57], v[56:57], v[80:81]
    v_pk_add_f32 v[58:59], v[58:59], v[80:81]
    v_permlane16_swap_b32 v83, v82
    v_add_f32 v82, v82, v83
    v_mul_f32 v82, 0x3acccccd, v82
    v_cvt_pk_bf16_f32 v82, v82, v82
    v_and_b32 v82, 0xffff0000, v82
    v_add_f32 v82, 0x3727c5ac, v82
    v_cvt_pk_bf16_f32 v82, v82, v82
    v_and_b32 v82, 0xffff0000, v82
    v_sqrt_f32 v82, v82
    v_cvt_pk_bf16_f32 v41, v40, v41
    v_cvt_pk_bf16_f32 v43, v42, v43
    v_cvt_pk_bf16_f32 v45, v44, v45
    v_cvt_pk_bf16_f32 v47, v46, v47
    v_cvt_pk_bf16_f32 v49, v48, v49
    v_cvt_pk_bf16_f32 v51, v50, v51
    v_cvt_pk_bf16_f32 v53, v52, v53
    v_cvt_pk_bf16_f32 v55, v54, v55
    v_cvt_pk_bf16_f32 v57, v56, v57
    v_cvt_pk_bf16_f32 v59, v58, v59
    v_cvt_pk_bf16_f32 v82, v82, v82
    v_and_b32 v82, 0xffff0000, v82
    v_rcp_f32 v82, v82
    v_lshlrev_b32 v40, 16, v41
    v_and_b32 v41, 0xffff0000, v41
    v_lshlrev_b32 v42, 16, v43
    v_and_b32 v43, 0xffff0000, v43
    v_lshlrev_b32 v44, 16, v45
    v_and_b32 v45, 0xffff0000, v45
    v_lshlrev_b32 v46, 16, v47
    v_and_b32 v47, 0xffff0000, v47
    v_lshlrev_b32 v48, 16, v49
    v_and_b32 v49, 0xffff0000, v49
    v_lshlrev_b32 v50, 16, v51
    v_and_b32 v51, 0xffff0000, v51
    v_lshlrev_b32 v52, 16, v53
    v_and_b32 v53, 0xffff0000, v53
    v_lshlrev_b32 v54, 16, v55
    v_and_b32 v55, 0xffff0000, v55
    v_lshlrev_b32 v56, 16, v57
    v_and_b32 v57, 0xffff0000, v57
    v_lshlrev_b32 v58, 16, v59
    v_and_b32 v59, 0xffff0000, v59
    v_mov_b32 v83, v82
    v_pk_mul_f32 v[40:41], v[40:41], v[82:83]
    v_pk_mul_f32 v[42:43], v[42:43], v[82:83]
    v_pk_mul_f32 v[44:45], v[44:45], v[82:83]
    v_pk_mul_f32 v[46:47], v[46:47], v[82:83]
    v_pk_mul_f32 v[48:49], v[48:49], v[82:83]
    v_pk_mul_f32 v[50:51], v[50:51], v[82:83]
    v_pk_mul_f32 v[52:53], v[52:53], v[82:83]
    v_pk_mul_f32 v[54:55], v[54:55], v[82:83]
    v_pk_mul_f32 v[56:57], v[56:57], v[82:83]
    v_pk_mul_f32 v[58:59], v[58:59], v[82:83]
    v_cvt_pk_bf16_f32 v60, v40, v41
    v_cvt_pk_bf16_f32 v61, v42, v43
    v_cvt_pk_bf16_f32 v62, v44, v45
    v_cvt_pk_bf16_f32 v63, v46, v47
    v_cvt_pk_bf16_f32 v64, v48, v49
    v_cvt_pk_bf16_f32 v65, v50, v51
    v_cvt_pk_bf16_f32 v66, v52, v53
    v_cvt_pk_bf16_f32 v67, v54, v55
    v_cvt_pk_bf16_f32 v68, v56, v57
    v_cvt_pk_bf16_f32 v69, v58, v59
    buffer_store_dwordx2 v[60:61], v2, s[8:11], s68 offen offset:0 sc1
    buffer_store_dwordx2 v[62:63], v2, s[8:11], s68 offen offset:256 sc1
    buffer_store_dwordx2 v[64:65], v2, s[8:11], s68 offen offset:512 sc1
    buffer_store_dwordx2 v[66:67], v2, s[8:11], s68 offen offset:768 sc1
    buffer_store_dwordx2 v[68:69], v2, s[8:11], s68 offen offset:1024 sc1
    s_waitcnt vmcnt(5)
    v_lshlrev_b32 v40, 16, v26
    v_and_b32 v41, 0xffff0000, v26
    v_lshlrev_b32 v42, 16, v27
    v_and_b32 v43, 0xffff0000, v27
    v_lshlrev_b32 v44, 16, v28
    v_and_b32 v45, 0xffff0000, v28
    v_lshlrev_b32 v46, 16, v29
    v_and_b32 v47, 0xffff0000, v29
    v_lshlrev_b32 v48, 16, v30
    v_and_b32 v49, 0xffff0000, v30
    v_lshlrev_b32 v50, 16, v31
    v_and_b32 v51, 0xffff0000, v31
    v_lshlrev_b32 v52, 16, v32
    v_and_b32 v53, 0xffff0000, v32
    v_lshlrev_b32 v54, 16, v33
    v_and_b32 v55, 0xffff0000, v33
    v_lshlrev_b32 v56, 16, v34
    v_and_b32 v57, 0xffff0000, v34
    v_lshlrev_b32 v58, 16, v35
    v_and_b32 v59, 0xffff0000, v35
    v_pk_add_f32 v[80:81], v[40:41], v[42:43]
    v_pk_add_f32 v[82:83], v[44:45], v[46:47]
    v_pk_add_f32 v[80:81], v[80:81], v[48:49]
    v_pk_add_f32 v[82:83], v[82:83], v[50:51]
    v_pk_add_f32 v[80:81], v[80:81], v[52:53]
    v_pk_add_f32 v[82:83], v[82:83], v[54:55]
    v_pk_add_f32 v[80:81], v[80:81], v[56:57]
    v_pk_add_f32 v[82:83], v[82:83], v[58:59]
    v_pk_add_f32 v[80:81], v[80:81], v[82:83]
    v_add_f32 v80, v80, v81
    v_mul_f32 v80, 0xbd4ccccd, v80
    v_mov_b32 v81, v80
    v_mov_b32 v86, v80
    v_pk_add_f32 v[84:85], v[40:41], v[80:81]
    v_pk_mul_f32 v[82:83], v[84:85], v[84:85]
    v_pk_add_f32 v[84:85], v[42:43], v[80:81]
    v_add_f32_dpp v86, v86, v86 row_ror:8 row_mask:0xf bank_mask:0xf
    v_pk_fma_f32 v[82:83], v[84:85], v[84:85], v[82:83]
    v_pk_add_f32 v[84:85], v[44:45], v[80:81]
    v_add_f32_dpp v86, v86, v86 row_ror:4 row_mask:0xf bank_mask:0xf
    v_pk_fma_f32 v[82:83], v[84:85], v[84:85], v[82:83]
    v_pk_add_f32 v[84:85], v[46:47], v[80:81]
    v_add_f32_dpp v86, v86, v86 row_ror:2 row_mask:0xf bank_mask:0xf
    v_pk_fma_f32 v[82:83], v[84:85], v[84:85], v[82:83]
    v_pk_add_f32 v[84:85], v[48:49], v[80:81]
    v_add_f32_dpp v86, v86, v86 row_ror:1 row_mask:0xf bank_mask:0xf
    v_pk_fma_f32 v[82:83], v[84:85], v[84:85], v[82:83]
    v_pk_add_f32 v[84:85], v[50:51], v[80:81]
    v_pk_fma_f32 v[82:83], v[84:85], v[84:85], v[82:83]
    v_pk_add_f32 v[84:85], v[52:53], v[80:81]
    v_mov_b32 v87, v86
    v_pk_fma_f32 v[82:83], v[84:85], v[84:85], v[82:83]
    v_pk_add_f32 v[84:85], v[54:55], v[80:81]
    v_pk_fma_f32 v[82:83], v[84:85], v[84:85], v[82:83]
    v_pk_add_f32 v[84:85], v[56:57], v[80:81]
    v_permlane16_swap_b32 v87, v86
    v_pk_fma_f32 v[82:83], v[84:85], v[84:85], v[82:83]
    v_pk_add_f32 v[84:85], v[58:59], v[80:81]
    v_pk_fma_f32 v[82:83], v[84:85], v[84:85], v[82:83]
    v_add_f32 v86, v86, v87
    v_add_f32 v82, v82, v83
    v_mul_f32 v86, 0x3d000000, v86
    v_sub_f32 v84, v80, v86
    v_mul_f32 v85, 0x41a00000, v84
    v_fmac_f32 v82, v84, v85
    v_cvt_pk_bf16_f32 v80, v86, v86
    v_and_b32 v80, 0xffff0000, v80
    v_mov_b32 v81, v80
    v_add_f32_dpp v82, v82, v82 row_ror:8 row_mask:0xf bank_mask:0xf
    v_pk_add_f32 v[40:41], v[40:41], v[80:81]
    v_pk_add_f32 v[42:43], v[42:43], v[80:81]
    v_add_f32_dpp v82, v82, v82 row_ror:4 row_mask:0xf bank_mask:0xf
    v_pk_add_f32 v[44:45], v[44:45], v[80:81]
    v_pk_add_f32 v[46:47], v[46:47], v[80:81]
    v_add_f32_dpp v82, v82, v82 row_ror:2 row_mask:0xf bank_mask:0xf
    v_pk_add_f32 v[48:49], v[48:49], v[80:81]
    v_pk_add_f32 v[50:51], v[50:51], v[80:81]
    v_add_f32_dpp v82, v82, v82 row_ror:1 row_mask:0xf bank_mask:0xf
    v_pk_add_f32 v[52:53], v[52:53], v[80:81]
    v_pk_add_f32 v[54:55], v[54:55], v[80:81]
    v_mov_b32 v83, v82
    v_pk_add_f32 v[56:57], v[56:57], v[80:81]
    v_pk_add_f32 v[58:59], v[58:59], v[80:81]
    v_permlane16_swap_b32 v83, v82
    v_add_f32 v82, v82, v83
    v_mul_f32 v82, 0x3acccccd, v82
    v_cvt_pk_bf16_f32 v82, v82, v82
    v_and_b32 v82, 0xffff0000, v82
    v_add_f32 v82, 0x3727c5ac, v82
    v_cvt_pk_bf16_f32 v82, v82, v82
    v_and_b32 v82, 0xffff0000, v82
    v_sqrt_f32 v82, v82
    v_cvt_pk_bf16_f32 v41, v40, v41
    v_cvt_pk_bf16_f32 v43, v42, v43
    v_cvt_pk_bf16_f32 v45, v44, v45
    v_cvt_pk_bf16_f32 v47, v46, v47
    v_cvt_pk_bf16_f32 v49, v48, v49
    v_cvt_pk_bf16_f32 v51, v50, v51
    v_cvt_pk_bf16_f32 v53, v52, v53
    v_cvt_pk_bf16_f32 v55, v54, v55
    v_cvt_pk_bf16_f32 v57, v56, v57
    v_cvt_pk_bf16_f32 v59, v58, v59
    v_cvt_pk_bf16_f32 v82, v82, v82
    v_and_b32 v82, 0xffff0000, v82
    v_rcp_f32 v82, v82
    v_lshlrev_b32 v40, 16, v41
    v_and_b32 v41, 0xffff0000, v41
    v_lshlrev_b32 v42, 16, v43
    v_and_b32 v43, 0xffff0000, v43
    v_lshlrev_b32 v44, 16, v45
    v_and_b32 v45, 0xffff0000, v45
    v_lshlrev_b32 v46, 16, v47
    v_and_b32 v47, 0xffff0000, v47
    v_lshlrev_b32 v48, 16, v49
    v_and_b32 v49, 0xffff0000, v49
    v_lshlrev_b32 v50, 16, v51
    v_and_b32 v51, 0xffff0000, v51
    v_lshlrev_b32 v52, 16, v53
    v_and_b32 v53, 0xffff0000, v53
    v_lshlrev_b32 v54, 16, v55
    v_and_b32 v55, 0xffff0000, v55
    v_lshlrev_b32 v56, 16, v57
    v_and_b32 v57, 0xffff0000, v57
    v_lshlrev_b32 v58, 16, v59
    v_and_b32 v59, 0xffff0000, v59
    v_mov_b32 v83, v82
    v_pk_mul_f32 v[40:41], v[40:41], v[82:83]
    v_pk_mul_f32 v[42:43], v[42:43], v[82:83]
    v_pk_mul_f32 v[44:45], v[44:45], v[82:83]
    v_pk_mul_f32 v[46:47], v[46:47], v[82:83]
    v_pk_mul_f32 v[48:49], v[48:49], v[82:83]
    v_pk_mul_f32 v[50:51], v[50:51], v[82:83]
    v_pk_mul_f32 v[52:53], v[52:53], v[82:83]
    v_pk_mul_f32 v[54:55], v[54:55], v[82:83]
    v_pk_mul_f32 v[56:57], v[56:57], v[82:83]
    v_pk_mul_f32 v[58:59], v[58:59], v[82:83]
    v_cvt_pk_bf16_f32 v70, v40, v41
    v_cvt_pk_bf16_f32 v71, v42, v43
    v_cvt_pk_bf16_f32 v72, v44, v45
    v_cvt_pk_bf16_f32 v73, v46, v47
    v_cvt_pk_bf16_f32 v74, v48, v49
    v_cvt_pk_bf16_f32 v75, v50, v51
    v_cvt_pk_bf16_f32 v76, v52, v53
    v_cvt_pk_bf16_f32 v77, v54, v55
    v_cvt_pk_bf16_f32 v78, v56, v57
    v_cvt_pk_bf16_f32 v79, v58, v59
    buffer_store_dwordx2 v[70:71], v2, s[8:11], s68 offen offset:2560 sc1
    buffer_store_dwordx2 v[72:73], v2, s[8:11], s68 offen offset:2816 sc1
    buffer_store_dwordx2 v[74:75], v2, s[8:11], s68 offen offset:3072 sc1
    buffer_store_dwordx2 v[76:77], v2, s[8:11], s68 offen offset:3328 sc1
    buffer_store_dwordx2 v[78:79], v2, s[8:11], s68 offen offset:3584 sc1
    s_waitcnt vmcnt(0)
    s_add_u32 s68, s65, 0
    v_mov_b32 v4, 1
    s_mov_b64 exec, 1
    buffer_store_dword v4, off, s[8:11], s68 sc1
    s_mov_b64 exec, -1
    s_cmp_ge_u32 s64, 20
    s_cbranch_scc1 L_ln1d_15
    s_add_u32 s64, s64, 44
    s_add_u32 s65, s65, 1408
    s_mul_i32 s67, s64, 40960
    s_add_u32 s67, s67, s66
    buffer_load_dwordx2 v[16:17], v2, s[44:47], s67 offen offset:0
    buffer_load_dwordx2 v[18:19], v2, s[44:47], s67 offen offset:256
    buffer_load_dwordx2 v[20:21], v2, s[44:47], s67 offen offset:512
    buffer_load_dwordx2 v[22:23], v2, s[44:47], s67 offen offset:768
    buffer_load_dwordx2 v[24:25], v2, s[44:47], s67 offen offset:1024
    buffer_load_dwordx2 v[26:27], v2, s[44:47], s67 offen offset:2560
    buffer_load_dwordx2 v[28:29], v2, s[44:47], s67 offen offset:2816
    buffer_load_dwordx2 v[30:31], v2, s[44:47], s67 offen offset:3072
    buffer_load_dwordx2 v[32:33], v2, s[44:47], s67 offen offset:3328
    buffer_load_dwordx2 v[34:35], v2, s[44:47], s67 offen offset:3584
    s_add_u32 s68, s67, 4194304
    s_waitcnt vmcnt(5)
    v_lshlrev_b32 v40, 16, v16
    v_and_b32 v41, 0xffff0000, v16
    v_lshlrev_b32 v42, 16, v17
    v_and_b32 v43, 0xffff0000, v17
    v_lshlrev_b32 v44, 16, v18
    v_and_b32 v45, 0xffff0000, v18
    v_lshlrev_b32 v46, 16, v19
    v_and_b32 v47, 0xffff0000, v19
    v_lshlrev_b32 v48, 16, v20
    v_and_b32 v49, 0xffff0000, v20
    v_lshlrev_b32 v50, 16, v21
    v_and_b32 v51, 0xffff0000, v21
    v_lshlrev_b32 v52, 16, v22
    v_and_b32 v53, 0xffff0000, v22
    v_lshlrev_b32 v54, 16, v23
    v_and_b32 v55, 0xffff0000, v23
    v_lshlrev_b32 v56, 16, v24
    v_and_b32 v57, 0xffff0000, v24
    v_lshlrev_b32 v58, 16, v25
    v_and_b32 v59, 0xffff0000, v25
    v_pk_add_f32 v[80:81], v[40:41], v[42:43]
    v_pk_add_f32 v[82:83], v[44:45], v[46:47]
    v_pk_add_f32 v[80:81], v[80:81], v[48:49]
    v_pk_add_f32 v[82:83], v[82:83], v[50:51]
    v_pk_add_f32 v[80:81], v[80:81], v[52:53]
    v_pk_add_f32 v[82:83], v[82:83], v[54:55]
    v_pk_add_f32 v[80:81], v[80:81], v[56:57]
    v_pk_add_f32 v[82:83], v[82:83], v[58:59]
    v_pk_add_f32 v[80:81], v[80:81], v[82:83]
    v_add_f32 v80, v80, v81
    v_mul_f32 v80, 0xbd4ccccd, v80
    v_mov_b32 v81, v80
    v_mov_b32 v86, v80
    v_pk_add_f32 v[84:85], v[40:41], v[80:81]
    v_pk_mul_f32 v[82:83], v[84:85], v[84:85]
    v_pk_add_f32 v[84:85], v[42:43], v[80:81]
    v_add_f32_dpp v86, v86, v86 row_ror:8 row_mask:0xf bank_mask:0xf
    v_pk_fma_f32 v[82:83], v[84:85], v[84:85], v[82:83]
    v_pk_add_f32 v[84:85], v[44:45], v[80:81]
    v_add_f32_dpp v86, v86, v86 row_ror:4 row_mask:0xf bank_mask:0xf
    v_pk_fma_f32 v[82:83], v[84:85], v[84:85], v[82:83]
    v_pk_add_f32 v[84:85], v[46:47], v[80:81]
    v_add_f32_dpp v86, v86, v86 row_ror:2 row_mask:0xf bank_mask:0xf
    v_pk_fma_f32 v[82:83], v[84:85], v[84:85], v[82:83]
    v_pk_add_f32 v[84:85], v[48:49], v[80:81]
    v_add_f32_dpp v86, v86, v86 row_ror:1 row_mask:0xf bank_mask:0xf
    v_pk_fma_f32 v[82:83], v[84:85], v[84:85], v[82:83]
    v_pk_add_f32 v[84:85], v[50:51], v[80:81]
    v_pk_fma_f32 v[82:83], v[84:85], v[84:85], v[82:83]
    v_pk_add_f32 v[84:85], v[52:53], v[80:81]
    v_mov_b32 v87, v86
    v_pk_fma_f32 v[82:83], v[84:85], v[84:85], v[82:83]
    v_pk_add_f32 v[84:85], v[54:55], v[80:81]
    v_pk_fma_f32 v[82:83], v[84:85], v[84:85], v[82:83]
    v_pk_add_f32 v[84:85], v[56:57], v[80:81]
    v_permlane16_swap_b32 v87, v86
    v_pk_fma_f32 v[82:83], v[84:85], v[84:85], v[82:83]
    v_pk_add_f32 v[84:85], v[58:59], v[80:81]
    v_pk_fma_f32 v[82:83], v[84:85], v[84:85], v[82:83]
    v_add_f32 v86, v86, v87
    v_add_f32 v82, v82, v83
    v_mul_f32 v86, 0x3d000000, v86
    v_sub_f32 v84, v80, v86
    v_mul_f32 v85, 0x41a00000, v84
    v_fmac_f32 v82, v84, v85
    v_cvt_pk_bf16_f32 v80, v86, v86
    v_and_b32 v80, 0xffff0000, v80
    v_mov_b32 v81, v80
    v_add_f32_dpp v82, v82, v82 row_ror:8 row_mask:0xf bank_mask:0xf
    v_pk_add_f32 v[40:41], v[40:41], v[80:81]
    v_pk_add_f32 v[42:43], v[42:43], v[80:81]
    v_add_f32_dpp v82, v82, v82 row_ror:4 row_mask:0xf bank_mask:0xf
    v_pk_add_f32 v[44:45], v[44:45], v[80:81]
    v_pk_add_f32 v[46:47], v[46:47], v[80:81]
    v_add_f32_dpp v82, v82, v82 row_ror:2 row_mask:0xf bank_mask:0xf
    v_pk_add_f32 v[48:49], v[48:49], v[80:81]
    v_pk_add_f32 v[50:51], v[50:51], v[80:81]
    v_add_f32_dpp v82, v82, v82 row_ror:1 row_mask:0xf bank_mask:0xf
    v_pk_add_f32 v[52:53], v[52:53], v[80:81]
    v_pk_add_f32 v[54:55], v[54:55], v[80:81]
    v_mov_b32 v83, v82
    v_pk_add_f32 v[56:57], v[56:57], v[80:81]
    v_pk_add_f32 v[58:59], v[58:59], v[80:81]
    v_permlane16_swap_b32 v83, v82
    v_add_f32 v82, v82, v83
    v_mul_f32 v82, 0x3acccccd, v82
    v_cvt_pk_bf16_f32 v82, v82, v82
    v_and_b32 v82, 0xffff0000, v82
    v_add_f32 v82, 0x3727c5ac, v82
    v_cvt_pk_bf16_f32 v82, v82, v82
    v_and_b32 v82, 0xffff0000, v82
    v_sqrt_f32 v82, v82
    v_cvt_pk_bf16_f32 v41, v40, v41
    v_cvt_pk_bf16_f32 v43, v42, v43
    v_cvt_pk_bf16_f32 v45, v44, v45
    v_cvt_pk_bf16_f32 v47, v46, v47
    v_cvt_pk_bf16_f32 v49, v48, v49
    v_cvt_pk_bf16_f32 v51, v50, v51
    v_cvt_pk_bf16_f32 v53, v52, v53
    v_cvt_pk_bf16_f32 v55, v54, v55
    v_cvt_pk_bf16_f32 v57, v56, v57
    v_cvt_pk_bf16_f32 v59, v58, v59
    v_cvt_pk_bf16_f32 v82, v82, v82
    v_and_b32 v82, 0xffff0000, v82
    v_rcp_f32 v82, v82
    v_lshlrev_b32 v40, 16, v41
    v_and_b32 v41, 0xffff0000, v41
    v_lshlrev_b32 v42, 16, v43
    v_and_b32 v43, 0xffff0000, v43
    v_lshlrev_b32 v44, 16, v45
    v_and_b32 v45, 0xffff0000, v45
    v_lshlrev_b32 v46, 16, v47
    v_and_b32 v47, 0xffff0000, v47
    v_lshlrev_b32 v48, 16, v49
    v_and_b32 v49, 0xffff0000, v49
    v_lshlrev_b32 v50, 16, v51
    v_and_b32 v51, 0xffff0000, v51
    v_lshlrev_b32 v52, 16, v53
    v_and_b32 v53, 0xffff0000, v53
    v_lshlrev_b32 v54, 16, v55
    v_and_b32 v55, 0xffff0000, v55
    v_lshlrev_b32 v56, 16, v57
    v_and_b32 v57, 0xffff0000, v57
    v_lshlrev_b32 v58, 16, v59
    v_and_b32 v59, 0xffff0000, v59
    v_mov_b32 v83, v82
    v_pk_mul_f32 v[40:41], v[40:41], v[82:83]
    v_pk_mul_f32 v[42:43], v[42:43], v[82:83]
    v_pk_mul_f32 v[44:45], v[44:45], v[82:83]
    v_pk_mul_f32 v[46:47], v[46:47], v[82:83]
    v_pk_mul_f32 v[48:49], v[48:49], v[82:83]
    v_pk_mul_f32 v[50:51], v[50:51], v[82:83]
    v_pk_mul_f32 v[52:53], v[52:53], v[82:83]
    v_pk_mul_f32 v[54:55], v[54:55], v[82:83]
    v_pk_mul_f32 v[56:57], v[56:57], v[82:83]
    v_pk_mul_f32 v[58:59], v[58:59], v[82:83]
    v_cvt_pk_bf16_f32 v60, v40, v41
    v_cvt_pk_bf16_f32 v61, v42, v43
    v_cvt_pk_bf16_f32 v62, v44, v45
    v_cvt_pk_bf16_f32 v63, v46, v47
    v_cvt_pk_bf16_f32 v64, v48, v49
    v_cvt_pk_bf16_f32 v65, v50, v51
    v_cvt_pk_bf16_f32 v66, v52, v53
    v_cvt_pk_bf16_f32 v67, v54, v55
    v_cvt_pk_bf16_f32 v68, v56, v57
    v_cvt_pk_bf16_f32 v69, v58, v59
    buffer_store_dwordx2 v[60:61], v2, s[8:11], s68 offen offset:0 sc1
    buffer_store_dwordx2 v[62:63], v2, s[8:11], s68 offen offset:256 sc1
    buffer_store_dwordx2 v[64:65], v2, s[8:11], s68 offen offset:512 sc1
    buffer_store_dwordx2 v[66:67], v2, s[8:11], s68 offen offset:768 sc1
    buffer_store_dwordx2 v[68:69], v2, s[8:11], s68 offen offset:1024 sc1
    s_waitcnt vmcnt(5)
    v_lshlrev_b32 v40, 16, v26
    v_and_b32 v41, 0xffff0000, v26
    v_lshlrev_b32 v42, 16, v27
    v_and_b32 v43, 0xffff0000, v27
    v_lshlrev_b32 v44, 16, v28
    v_and_b32 v45, 0xffff0000, v28
    v_lshlrev_b32 v46, 16, v29
    v_and_b32 v47, 0xffff0000, v29
    v_lshlrev_b32 v48, 16, v30
    v_and_b32 v49, 0xffff0000, v30
    v_lshlrev_b32 v50, 16, v31
    v_and_b32 v51, 0xffff0000, v31
    v_lshlrev_b32 v52, 16, v32
    v_and_b32 v53, 0xffff0000, v32
    v_lshlrev_b32 v54, 16, v33
    v_and_b32 v55, 0xffff0000, v33
    v_lshlrev_b32 v56, 16, v34
    v_and_b32 v57, 0xffff0000, v34
    v_lshlrev_b32 v58, 16, v35
    v_and_b32 v59, 0xffff0000, v35
    v_pk_add_f32 v[80:81], v[40:41], v[42:43]
    v_pk_add_f32 v[82:83], v[44:45], v[46:47]
    v_pk_add_f32 v[80:81], v[80:81], v[48:49]
    v_pk_add_f32 v[82:83], v[82:83], v[50:51]
    v_pk_add_f32 v[80:81], v[80:81], v[52:53]
    v_pk_add_f32 v[82:83], v[82:83], v[54:55]
    v_pk_add_f32 v[80:81], v[80:81], v[56:57]
    v_pk_add_f32 v[82:83], v[82:83], v[58:59]
    v_pk_add_f32 v[80:81], v[80:81], v[82:83]
    v_add_f32 v80, v80, v81
    v_mul_f32 v80, 0xbd4ccccd, v80
    v_mov_b32 v81, v80
    v_mov_b32 v86, v80
    v_pk_add_f32 v[84:85], v[40:41], v[80:81]
    v_pk_mul_f32 v[82:83], v[84:85], v[84:85]
    v_pk_add_f32 v[84:85], v[42:43], v[80:81]
    v_add_f32_dpp v86, v86, v86 row_ror:8 row_mask:0xf bank_mask:0xf
    v_pk_fma_f32 v[82:83], v[84:85], v[84:85], v[82:83]
    v_pk_add_f32 v[84:85], v[44:45], v[80:81]
    v_add_f32_dpp v86, v86, v86 row_ror:4 row_mask:0xf bank_mask:0xf
    v_pk_fma_f32 v[82:83], v[84:85], v[84:85], v[82:83]
    v_pk_add_f32 v[84:85], v[46:47], v[80:81]
    v_add_f32_dpp v86, v86, v86 row_ror:2 row_mask:0xf bank_mask:0xf
    v_pk_fma_f32 v[82:83], v[84:85], v[84:85], v[82:83]
    v_pk_add_f32 v[84:85], v[48:49], v[80:81]
    v_add_f32_dpp v86, v86, v86 row_ror:1 row_mask:0xf bank_mask:0xf
    v_pk_fma_f32 v[82:83], v[84:85], v[84:85], v[82:83]
    v_pk_add_f32 v[84:85], v[50:51], v[80:81]
    v_pk_fma_f32 v[82:83], v[84:85], v[84:85], v[82:83]
    v_pk_add_f32 v[84:85], v[52:53], v[80:81]
    v_mov_b32 v87, v86
    v_pk_fma_f32 v[82:83], v[84:85], v[84:85], v[82:83]
    v_pk_add_f32 v[84:85], v[54:55], v[80:81]
    v_pk_fma_f32 v[82:83], v[84:85], v[84:85], v[82:83]
    v_pk_add_f32 v[84:85], v[56:57], v[80:81]
    v_permlane16_swap_b32 v87, v86
    v_pk_fma_f32 v[82:83], v[84:85], v[84:85], v[82:83]
    v_pk_add_f32 v[84:85], v[58:59], v[80:81]
    v_pk_fma_f32 v[82:83], v[84:85], v[84:85], v[82:83]
    v_add_f32 v86, v86, v87
    v_add_f32 v82, v82, v83
    v_mul_f32 v86, 0x3d000000, v86
    v_sub_f32 v84, v80, v86
    v_mul_f32 v85, 0x41a00000, v84
    v_fmac_f32 v82, v84, v85
    v_cvt_pk_bf16_f32 v80, v86, v86
    v_and_b32 v80, 0xffff0000, v80
    v_mov_b32 v81, v80
    v_add_f32_dpp v82, v82, v82 row_ror:8 row_mask:0xf bank_mask:0xf
    v_pk_add_f32 v[40:41], v[40:41], v[80:81]
    v_pk_add_f32 v[42:43], v[42:43], v[80:81]
    v_add_f32_dpp v82, v82, v82 row_ror:4 row_mask:0xf bank_mask:0xf
    v_pk_add_f32 v[44:45], v[44:45], v[80:81]
    v_pk_add_f32 v[46:47], v[46:47], v[80:81]
    v_add_f32_dpp v82, v82, v82 row_ror:2 row_mask:0xf bank_mask:0xf
    v_pk_add_f32 v[48:49], v[48:49], v[80:81]
    v_pk_add_f32 v[50:51], v[50:51], v[80:81]
    v_add_f32_dpp v82, v82, v82 row_ror:1 row_mask:0xf bank_mask:0xf
    v_pk_add_f32 v[52:53], v[52:53], v[80:81]
    v_pk_add_f32 v[54:55], v[54:55], v[80:81]
    v_mov_b32 v83, v82
    v_pk_add_f32 v[56:57], v[56:57], v[80:81]
    v_pk_add_f32 v[58:59], v[58:59], v[80:81]
    v_permlane16_swap_b32 v83, v82
    v_add_f32 v82, v82, v83
    v_mul_f32 v82, 0x3acccccd, v82
    v_cvt_pk_bf16_f32 v82, v82, v82
    v_and_b32 v82, 0xffff0000, v82
    v_add_f32 v82, 0x3727c5ac, v82
    v_cvt_pk_bf16_f32 v82, v82, v82
    v_and_b32 v82, 0xffff0000, v82
    v_sqrt_f32 v82, v82
    v_cvt_pk_bf16_f32 v41, v40, v41
    v_cvt_pk_bf16_f32 v43, v42, v43
    v_cvt_pk_bf16_f32 v45, v44, v45
    v_cvt_pk_bf16_f32 v47, v46, v47
    v_cvt_pk_bf16_f32 v49, v48, v49
    v_cvt_pk_bf16_f32 v51, v50, v51
    v_cvt_pk_bf16_f32 v53, v52, v53
    v_cvt_pk_bf16_f32 v55, v54, v55
    v_cvt_pk_bf16_f32 v57, v56, v57
    v_cvt_pk_bf16_f32 v59, v58, v59
    v_cvt_pk_bf16_f32 v82, v82, v82
    v_and_b32 v82, 0xffff0000, v82
    v_rcp_f32 v82, v82
    v_lshlrev_b32 v40, 16, v41
    v_and_b32 v41, 0xffff0000, v41
    v_lshlrev_b32 v42, 16, v43
    v_and_b32 v43, 0xffff0000, v43
    v_lshlrev_b32 v44, 16, v45
    v_and_b32 v45, 0xffff0000, v45
    v_lshlrev_b32 v46, 16, v47
    v_and_b32 v47, 0xffff0000, v47
    v_lshlrev_b32 v48, 16, v49
    v_and_b32 v49, 0xffff0000, v49
    v_lshlrev_b32 v50, 16, v51
    v_and_b32 v51, 0xffff0000, v51
    v_lshlrev_b32 v52, 16, v53
    v_and_b32 v53, 0xffff0000, v53
    v_lshlrev_b32 v54, 16, v55
    v_and_b32 v55, 0xffff0000, v55
    v_lshlrev_b32 v56, 16, v57
    v_and_b32 v57, 0xffff0000, v57
    v_lshlrev_b32 v58, 16, v59
    v_and_b32 v59, 0xffff0000, v59
    v_mov_b32 v83, v82
    v_pk_mul_f32 v[40:41], v[40:41], v[82:83]
    v_pk_mul_f32 v[42:43], v[42:43], v[82:83]
    v_pk_mul_f32 v[44:45], v[44:45], v[82:83]
    v_pk_mul_f32 v[46:47], v[46:47], v[82:83]
    v_pk_mul_f32 v[48:49], v[48:49], v[82:83]
    v_pk_mul_f32 v[50:51], v[50:51], v[82:83]
    v_pk_mul_f32 v[52:53], v[52:53], v[82:83]
    v_pk_mul_f32 v[54:55], v[54:55], v[82:83]
    v_pk_mul_f32 v[56:57], v[56:57], v[82:83]
    v_pk_mul_f32 v[58:59], v[58:59], v[82:83]
    v_cvt_pk_bf16_f32 v70, v40, v41
    v_cvt_pk_bf16_f32 v71, v42, v43
    v_cvt_pk_bf16_f32 v72, v44, v45
    v_cvt_pk_bf16_f32 v73, v46, v47
    v_cvt_pk_bf16_f32 v74, v48, v49
    v_cvt_pk_bf16_f32 v75, v50, v51
    v_cvt_pk_bf16_f32 v76, v52, v53
    v_cvt_pk_bf16_f32 v77, v54, v55
    v_cvt_pk_bf16_f32 v78, v56, v57
    v_cvt_pk_bf16_f32 v79, v58, v59
    buffer_store_dwordx2 v[70:71], v2, s[8:11], s68 offen offset:2560 sc1
    buffer_store_dwordx2 v[72:73], v2, s[8:11], s68 offen offset:2816 sc1
    buffer_store_dwordx2 v[74:75], v2, s[8:11], s68 offen offset:3072 sc1
    buffer_store_dwordx2 v[76:77], v2, s[8:11], s68 offen offset:3328 sc1
    buffer_store_dwordx2 v[78:79], v2, s[8:11], s68 offen offset:3584 sc1
    s_waitcnt vmcnt(0)
    s_add_u32 s68, s65, 0
    v_mov_b32 v4, 1
    s_mov_b64 exec, 1
    buffer_store_dword v4, off, s[8:11], s68 sc1
    s_mov_b64 exec, -1
L_ln1d_15:
    v_lshlrev_b32 v7, 2, v0
L_wi_16:
    buffer_load_dword v6, v7, s[12:15], 0 offen sc1
    s_waitcnt vmcnt(0)
    v_cmp_ne_u32 vcc, 32, v6
    s_mov_b32 s60, 0x10101010
    s_mov_b32 s61, 0x10101010
    s_and_b64 s[62:63], vcc, s[60:61]
    s_cbranch_scc0 L_wid_17
    s_sleep 2
    s_sub_u32 s6, s6, 1
    s_cbranch_scc0 L_wi_16
    s_branch L_fail
L_wid_17:
    s_mov_b32 s60, 0x01010101
    s_mov_b32 s61, 0x01010101
    s_and_b64 s[62:63], vcc, s[60:61]
    s_cselect_b32 s7, 0, 1
    s_lshl_b32 s60, s3, 8
    s_add_u32 s60, s60, 12288
    v_mov_b32 v6, 12
L_poll_18:
    buffer_load_dword v4, v6, s[8:11], s60 offen offset:0 sc1
    s_waitcnt vmcnt(0)
    v_cmp_gt_u32 vcc, 1, v4
    s_cbranch_vccz L_pok_19
    s_sleep 8
    s_sub_u32 s6, s6, 1
    s_cbranch_scc0 L_poll_18
    s_branch L_fail
L_pok_19:
    s_mov_b32 s44, s26
    s_and_b32 s45, s27, 0xffff
    s_mov_b32 s46, 7864320
    s_mov_b32 s47, 0x20000
    v_lshrrev_b32 v1, 4, v0
    s_lshl_b32 s60, s4, 6
    v_add_u32 v1, s60, v1
    v_mul_u32_u24 v1, 1280, v1
    v_and_b32 v2, 15, v0
    v_lshl_add_u32 v5, v2, 4, v1
    s_mul_i32 s60, s3, 983040
    s_lshl_b32 s61, s70, 8
    s_add_u32 s60, s60, s61
    v_add_u32 v5, s60, v5
    s_lshl_b32 s62, s4, 6
    v_lshrrev_b32 v1, 5, v0
    v_lshlrev_b32 v1, 4, v1
    v_bfe_u32 v2, v0, 4, 1
    v_lshl_add_u32 v1, v2, 2, v1
    v_bfe_u32 v2, v0, 2, 2
    v_add_u32 v1, v1, v2
    v_mul_u32_u24 v1, 256, v1
    v_and_b32 v2, 3, v0
    v_lshl_add_u32 v6, v2, 3, v1
    v_add_u32 v6, s62, v6
    s_lshl_b32 s60, s4, 14
    s_add_u32 m0, s60, 0
    s_mov_b32 s61, 0
    buffer_load_dwordx4 v5, s[44:47], s61 offen nt lds
    s_add_u32 m0, m0, 1024
    s_add_u32 s61, s61, 5120
    buffer_load_dwordx4 v5, s[44:47], s61 offen nt lds
    s_add_u32 m0, m0, 1024
    s_add_u32 s61, s61, 5120
    buffer_load_dwordx4 v5, s[44:47], s61 offen nt lds
    s_add_u32 m0, m0, 1024
    s_add_u32 s61, s61, 5120
    buffer_load_dwordx4 v5, s[44:47], s61 offen nt lds
    s_add_u32 m0, m0, 1024
    s_add_u32 s61, s61, 5120
    buffer_load_dwordx4 v5, s[44:47], s61 offen nt lds
    s_add_u32 m0, m0, 1024
    s_add_u32 s61, s61, 5120
    buffer_load_dwordx4 v5, s[44:47], s61 offen nt lds
    s_add_u32 m0, m0, 1024
    s_add_u32 s61, s61, 5120
    buffer_load_dwordx4 v5, s[44:47], s61 offen nt lds
    s_add_u32 m0, m0, 1024
    s_add_u32 s61, s61, 5120
    buffer_load_dwordx4 v5, s[44:47], s61 offen nt lds
    s_add_u32 m0, m0, 1024
    s_add_u32 s61, s61, 5120
    buffer_load_dwordx4 v5, s[44:47], s61 offen nt lds
    s_add_u32 m0, m0, 1024
    s_add_u32 s61, s61, 5120
    buffer_load_dwordx4 v5, s[44:47], s61 offen nt lds
    s_add_u32 m0, m0, 1024
    s_add_u32 s61, s61, 5120
    buffer_load_dwordx4 v5, s[44:47], s61 offen nt lds
    s_add_u32 m0, m0, 1024
    s_add_u32 s61, s61, 5120
    buffer_load_dwordx4 v5, s[44:47], s61 offen nt lds
    s_add_u32 m0, m0, 1024
    s_add_u32 s61, s61, 5120
    buffer_load_dwordx4 v5, s[44:47], s61 offen nt lds
    s_add_u32 m0, m0, 1024
    s_add_u32 s61, s61, 5120
    buffer_load_dwordx4 v5, s[44:47], s61 offen nt lds
    s_add_u32 m0, m0, 1024
    s_add_u32 s61, s61, 5120
    buffer_load_dwordx4 v5, s[44:47], s61 offen nt lds
    s_add_u32 m0, m0, 1024
    s_add_u32 s61, s61, 5120
    buffer_load_dwordx4 v5, s[44:47], s61 offen nt lds
    s_lshl_b32 s60, s4, 14
    s_add_u32 m0, s60, 65536
    s_mov_b32 s61, 327680
    buffer_load_dwordx4 v5, s[44:47], s61 offen nt lds
    s_add_u32 m0, m0, 1024
    s_add_u32 s61, s61, 5120
    buffer_load_dwordx4 v5, s[44:47], s61 offen nt lds
    s_add_u32 m0, m0, 1024
    s_add_u32 s61, s61, 5120
    buffer_load_dwordx4 v5, s[44:47], s61 offen nt lds
    s_add_u32 m0, m0, 1024
    s_add_u32 s61, s61, 5120
    buffer_load_dwordx4 v5, s[44:47], s61 offen nt lds
    s_add_u32 m0, m0, 1024
    s_add_u32 s61, s61, 5120
    buffer_load_dwordx4 v5, s[44:47], s61 offen nt lds
    s_add_u32 m0, m0, 1024
    s_add_u32 s61, s61, 5120
    buffer_load_dwordx4 v5, s[44:47], s61 offen nt lds
    s_add_u32 m0, m0, 1024
    s_add_u32 s61, s61, 5120
    buffer_load_dwordx4 v5, s[44:47], s61 offen nt lds
    s_add_u32 m0, m0, 1024
    s_add_u32 s61, s61, 5120
    buffer_load_dwordx4 v5, s[44:47], s61 offen nt lds
    s_add_u32 m0, m0, 1024
    s_add_u32 s61, s61, 5120
    buffer_load_dwordx4 v5, s[44:47], s61 offen nt lds
    s_add_u32 m0, m0, 1024
    s_add_u32 s61, s61, 5120
    buffer_load_dwordx4 v5, s[44:47], s61 offen nt lds
    s_add_u32 m0, m0, 1024
    s_add_u32 s61, s61, 5120
    buffer_load_dwordx4 v5, s[44:47], s61 offen nt lds
    s_add_u32 m0, m0, 1024
    s_add_u32 s61, s61, 5120
    buffer_load_dwordx4 v5, s[44:47], s61 offen nt lds
    s_add_u32 m0, m0, 1024
    s_add_u32 s61, s61, 5120
    buffer_load_dwordx4 v5, s[44:47], s61 offen nt lds
    s_add_u32 m0, m0, 1024
    s_add_u32 s61, s61, 5120
    buffer_load_dwordx4 v5, s[44:47], s61 offen nt lds
    s_add_u32 m0, m0, 1024
    s_add_u32 s61, s61, 5120
    buffer_load_dwordx4 v5, s[44:47], s61 offen nt lds
    s_add_u32 m0, m0, 1024
    s_add_u32 s61, s61, 5120
    buffer_load_dwordx4 v5, s[44:47], s61 offen nt lds
    s_waitcnt vmcnt(16)
    s_barrier
    ds_read_b64_tr_b16 a[0:1], v6 offset:0
    ds_read_b64_tr_b16 a[96:97], v6 offset:32
    ds_read_b64_tr_b16 a[2:3], v6 offset:2048
    ds_read_b64_tr_b16 a[98:99], v6 offset:2080
    ds_read_b64_tr_b16 a[4:5], v6 offset:8192
    ds_read_b64_tr_b16 a[100:101], v6 offset:8224
    ds_read_b64_tr_b16 a[6:7], v6 offset:10240
    ds_read_b64_tr_b16 a[102:103], v6 offset:10272
    ds_read_b64_tr_b16 a[8:9], v6 offset:16384
    ds_read_b64_tr_b16 a[104:105], v6 offset:16416
    ds_read_b64_tr_b16 a[10:11], v6 offset:18432
    ds_read_b64_tr_b16 a[106:107], v6 offset:18464
    ds_read_b64_tr_b16 a[12:13], v6 offset:24576
    ds_read_b64_tr_b16 a[108:109], v6 offset:24608
    ds_read_b64_tr_b16 a[14:15], v6 offset:26624
    ds_read_b64_tr_b16 a[110:111], v6 offset:26656
    ds_read_b64_tr_b16 a[16:17], v6 offset:32768
    ds_read_b64_tr_b16 a[112:113], v6 offset:32800
    ds_read_b64_tr_b16 a[18:19], v6 offset:34816
    ds_read_b64_tr_b16 a[114:115], v6 offset:34848
    ds_read_b64_tr_b16 a[20:21], v6 offset:40960
    ds_read_b64_tr_b16 a[116:117], v6 offset:40992
    ds_read_b64_tr_b16 a[22:23], v6 offset:43008
    ds_read_b64_tr_b16 a[118:119], v6 offset:43040
    ds_read_b64_tr_b16 a[24:25], v6 offset:49152
    ds_read_b64_tr_b16 a[120:121], v6 offset:49184
    ds_read_b64_tr_b16 a[26:27], v6 offset:51200
    ds_read_b64_tr_b16 a[122:123], v6 offset:51232
    ds_read_b64_tr_b16 a[28:29], v6 offset:57344
    ds_read_b64_tr_b16 a[124:125], v6 offset:57376
    ds_read_b64_tr_b16 a[30:31], v6 offset:59392
    ds_read_b64_tr_b16 a[126:127], v6 offset:59424
    s_waitcnt lgkmcnt(0)
    s_barrier
    s_lshl_b32 s60, s4, 14
    s_add_u32 m0, s60, 0
    s_mov_b32 s61, 655360
    buffer_load_dwordx4 v5, s[44:47], s61 offen nt lds
    s_add_u32 m0, m0, 1024
    s_add_u32 s61, s61, 5120
    buffer_load_dwordx4 v5, s[44:47], s61 offen nt lds
    s_add_u32 m0, m0, 1024
    s_add_u32 s61, s61, 5120
    buffer_load_dwordx4 v5, s[44:47], s61 offen nt lds
    s_add_u32 m0, m0, 1024
    s_add_u32 s61, s61, 5120
    buffer_load_dwordx4 v5, s[44:47], s61 offen nt lds
    s_add_u32 m0, m0, 1024
    s_add_u32 s61, s61, 5120
    buffer_load_dwordx4 v5, s[44:47], s61 offen nt lds
    s_add_u32 m0, m0, 1024
    s_add_u32 s61, s61, 5120
    buffer_load_dwordx4 v5, s[44:47], s61 offen nt lds
    s_add_u32 m0, m0, 1024
    s_add_u32 s61, s61, 5120
    buffer_load_dwordx4 v5, s[44:47], s61 offen nt lds
    s_add_u32 m0, m0, 1024
    s_add_u32 s61, s61, 5120
    buffer_load_dwordx4 v5, s[44:47], s61 offen nt lds
    s_add_u32 m0, m0, 1024
    s_add_u32 s61, s61, 5120
    buffer_load_dwordx4 v5, s[44:47], s61 offen nt lds
    s_add_u32 m0, m0, 1024
    s_add_u32 s61, s61, 5120
    buffer_load_dwordx4 v5, s[44:47], s61 offen nt lds
    s_add_u32 m0, m0, 1024
    s_add_u32 s61, s61, 5120
    buffer_load_dwordx4 v5, s[44:47], s61 offen nt lds
    s_add_u32 m0, m0, 1024
    s_add_u32 s61, s61, 5120
    buffer_load_dwordx4 v5, s[44:47], s61 offen nt lds
    s_add_u32 m0, m0, 1024
    s_add_u32 s61, s61, 5120
    buffer_load_dwordx4 v5, s[44:47], s61 offen nt lds
    s_add_u32 m0, m0, 1024
    s_add_u32 s61, s61, 5120
    buffer_load_dwordx4 v5, s[44:47], s61 offen nt lds
    s_add_u32 m0, m0, 1024
    s_add_u32 s61, s61, 5120
    buffer_load_dwordx4 v5, s[44:47], s61 offen nt lds
    s_add_u32 m0, m0, 1024
    s_add_u32 s61, s61, 5120
    buffer_load_dwordx4 v5, s[44:47], s61 offen nt lds
    s_waitcnt vmcnt(16)
    s_barrier
    v_add_u32 v7, 65536, v6
    ds_read_b64_tr_b16 a[32:33], v7 offset:0
    ds_read_b64_tr_b16 a[128:129], v7 offset:32
    ds_read_b64_tr_b16 a[34:35], v7 offset:2048
    ds_read_b64_tr_b16 a[130:131], v7 offset:2080
    ds_read_b64_tr_b16 a[36:37], v7 offset:8192
    ds_read_b64_tr_b16 a[132:133], v7 offset:8224
    ds_read_b64_tr_b16 a[38:39], v7 offset:10240
    ds_read_b64_tr_b16 a[134:135], v7 offset:10272
    ds_read_b64_tr_b16 a[40:41], v7 offset:16384
    ds_read_b64_tr_b16 a[136:137], v7 offset:16416
    ds_read_b64_tr_b16 a[42:43], v7 offset:18432
    ds_read_b64_tr_b16 a[138:139], v7 offset:18464
    ds_read_b64_tr_b16 a[44:45], v7 offset:24576
    ds_read_b64_tr_b16 a[140:141], v7 offset:24608
    ds_read_b64_tr_b16 a[46:47], v7 offset:26624
    ds_read_b64_tr_b16 a[142:143], v7 offset:26656
    ds_read_b64_tr_b16 a[48:49], v7 offset:32768
    ds_read_b64_tr_b16 a[144:145], v7 offset:32800
    ds_read_b64_tr_b16 a[50:51], v7 offset:34816
    ds_read_b64_tr_b16 a[146:147], v7 offset:34848
    ds_read_b64_tr_b16 a[52:53], v7 offset:40960
    ds_read_b64_tr_b16 a[148:149], v7 offset:40992
    ds_read_b64_tr_b16 a[54:55], v7 offset:43008
    ds_read_b64_tr_b16 a[150:151], v7 offset:43040
    ds_read_b64_tr_b16 a[56:57], v7 offset:49152
    ds_read_b64_tr_b16 a[152:153], v7 offset:49184
    ds_read_b64_tr_b16 a[58:59], v7 offset:51200
    ds_read_b64_tr_b16 a[154:155], v7 offset:51232
    ds_read_b64_tr_b16 a[60:61], v7 offset:57344
    ds_read_b64_tr_b16 a[156:157], v7 offset:57376
    ds_read_b64_tr_b16 a[62:63], v7 offset:59392
    ds_read_b64_tr_b16 a[158:159], v7 offset:59424
    s_waitcnt lgkmcnt(0)
    s_barrier
    s_waitcnt vmcnt(0)
    s_barrier
    ds_read_b64_tr_b16 a[64:65], v6 offset:0
    ds_read_b64_tr_b16 a[160:161], v6 offset:32
    ds_read_b64_tr_b16 a[66:67], v6 offset:2048
    ds_read_b64_tr_b16 a[162:163], v6 offset:2080
    ds_read_b64_tr_b16 a[68:69], v6 offset:8192
    ds_read_b64_tr_b16 a[164:165], v6 offset:8224
    ds_read_b64_tr_b16 a[70:71], v6 offset:10240
    ds_read_b64_tr_b16 a[166:167], v6 offset:10272
    ds_read_b64_tr_b16 a[72:73], v6 offset:16384
    ds_read_b64_tr_b16 a[168:169], v6 offset:16416
    ds_read_b64_tr_b16 a[74:75], v6 offset:18432
    ds_read_b64_tr_b16 a[170:171], v6 offset:18464
    ds_read_b64_tr_b16 a[76:77], v6 offset:24576
    ds_read_b64_tr_b16 a[172:173], v6 offset:24608
    ds_read_b64_tr_b16 a[78:79], v6 offset:26624
    ds_read_b64_tr_b16 a[174:175], v6 offset:26656
    ds_read_b64_tr_b16 a[80:81], v6 offset:32768
    ds_read_b64_tr_b16 a[176:177], v6 offset:32800
    ds_read_b64_tr_b16 a[82:83], v6 offset:34816
    ds_read_b64_tr_b16 a[178:179], v6 offset:34848
    ds_read_b64_tr_b16 a[84:85], v6 offset:40960
    ds_read_b64_tr_b16 a[180:181], v6 offset:40992
    ds_read_b64_tr_b16 a[86:87], v6 offset:43008
    ds_read_b64_tr_b16 a[182:183], v6 offset:43040
    ds_read_b64_tr_b16 a[88:89], v6 offset:49152
    ds_read_b64_tr_b16 a[184:185], v6 offset:49184
    ds_read_b64_tr_b16 a[90:91], v6 offset:51200
    ds_read_b64_tr_b16 a[186:187], v6 offset:51232
    ds_read_b64_tr_b16 a[92:93], v6 offset:57344
    ds_read_b64_tr_b16 a[188:189], v6 offset:57376
    ds_read_b64_tr_b16 a[94:95], v6 offset:59392
    ds_read_b64_tr_b16 a[190:191], v6 offset:59424
    s_waitcnt lgkmcnt(0)
    s_barrier
    v_mov_b32 v1, 0
    v_mov_b32 v2, 110592
    ds_write_b32 v2, v1
    v_mov_b32 v2, 110596
    ds_write_b32 v2, v1
    s_waitcnt lgkmcnt(0)
    s_barrier
    v_lshlrev_b32 v8, 4, v0
    s_mul_i32 s60, s4, 2560
    s_add_u32 s60, s60, 98304
    v_and_b32 v1, 31, v0
    v_mul_u32_u24 v1, 80, v1
    v_lshrrev_b32 v2, 5, v0
    v_lshl_add_u32 v1, v2, 3, v1
    v_add_u32 v9, s60, v1
    v_lshrrev_b32 v1, 2, v0
    v_and_b32 v2, 3, v0
    v_mul_u32_u24 v3, 80, v1
    v_lshl_add_u32 v3, v2, 4, v3
    v_add_u32 v10, s60, v3
    v_mul_u32_u24 v3, 1280, v1
    v_lshl_add_u32 v12, v2, 4, v3
    v_add_u32 v13, 20480, v12
    v_and_b32 v1, 15, v0
    v_mul_u32_u24 v1, 80, v1
    v_lshrrev_b32 v2, 4, v0
    v_lshl_add_u32 v1, v2, 3, v1
    v_add_u32 v9, s60, v1
    v_lshrrev_b32 v1, 5, v0
    v_lshlrev_b32 v1, 10, v1
    v_bfe_u32 v2, v0, 4, 1
    v_lshl_add_u32 v1, v2, 9, v1
    v_and_b32 v2, 15, v0
    v_lshl_add_u32 v3, v2, 4, v1
    v_and_b32 v1, 3, v0
    v_lshlrev_b32 v5, 2, v1
    s_lshl_b32 s60, s3, 7
    s_add_u32 s76, s60, 8192
    s_lshl_b32 s60, s3, 2
    s_add_u32 s60, s60, s4
    s_mul_i32 s77, s60, 36864
    s_mul_i32 s61, s3, 1032192
    s_add_u32 s77, s77, s61
    s_add_u32 s77, s77, 116391936
    s_mul_i32 s78, s3, 40960
    s_lshl_b32 s60, s70, 8
    s_add_u32 s78, s78, s60
    s_lshl_b32 s60, s4, 6
    s_add_u32 s78, s78, s60
    v_lshlrev_b32 v7, 2, v0
L_wi_20:
    buffer_load_dword v6, v7, s[12:15], 0 offen sc1
    s_waitcnt vmcnt(0)
    v_cmp_ne_u32 vcc, 32, v6
    s_mov_b32 s60, 0x10101010
    s_mov_b32 s61, 0x10101010
    s_and_b64 s[62:63], vcc, s[60:61]
    s_cbranch_scc0 L_wid_21
    s_sleep 2
    s_sub_u32 s6, s6, 1
    s_cbranch_scc0 L_wi_20
    s_branch L_fail
L_wid_21:
    s_mov_b32 s60, 0x01010101
    s_mov_b32 s61, 0x01010101
    s_and_b64 s[62:63], vcc, s[60:61]
    s_cselect_b32 s7, 0, 1
    v_add_u32 v7, 32768, v3
    s_mul_i32 s81, s4, 12288
    s_mov_b32 s79, 0
L_op_a:
    s_add_u32 s73, s79, 1
L_poll_22:
    buffer_load_dword v4, v5, s[8:11], s76 offen offset:0 sc1
    s_waitcnt vmcnt(0)
    v_cmp_gt_u32 vcc, s73, v4
    s_cbranch_vccz L_pok_23
    s_sleep 1
    s_sub_u32 s6, s6, 1
    s_cbranch_scc0 L_poll_22
    s_branch L_fail
L_pok_23:
    s_and_b32 s74, s79, 3
    s_mul_i32 s74, s74, 147456
    s_add_u32 s74, s74, s77
    s_add_u32 m0, s81, 0
    s_nop 0
    buffer_load_dwordx4 v8, s[8:11], s74 offen offset:0 sc1 lds
    buffer_load_dwordx4 v8, s[8:11], s74 offen offset:1024 sc1 lds
    buffer_load_dwordx4 v8, s[8:11], s74 offen offset:2048 sc1 lds
    buffer_load_dwordx4 v8, s[8:11], s74 offen offset:3072 sc1 lds
    s_add_u32 m0, s81, 4096
    s_add_u32 s74, s74, 4096
    buffer_load_dwordx4 v8, s[8:11], s74 offen offset:0 sc1 lds
    buffer_load_dwordx4 v8, s[8:11], s74 offen offset:1024 sc1 lds
    buffer_load_dwordx4 v8, s[8:11], s74 offen offset:2048 sc1 lds
    buffer_load_dwordx4 v8, s[8:11], s74 offen offset:3072 sc1 lds
    s_add_u32 m0, s81, 8192
    s_add_u32 s74, s74, 4096
    buffer_load_dwordx4 v8, s[8:11], s74 offen offset:0 sc1 lds
    buffer_load_dwordx4 v8, s[8:11], s74 offen offset:1024 sc1 lds
    buffer_load_dwordx4 v8, s[8:11], s74 offen offset:2048 sc1 lds
    buffer_load_dwordx4 v8, s[8:11], s74 offen offset:3072 sc1 lds
    s_and_b32 s75, s79, 63
    s_mul_i32 s75, s75, 327680
    s_add_u32 s75, s75, 23068672
    s_add_u32 s75, s75, s78
    s_waitcnt vmcnt(0)
    s_barrier
    ds_read_b128 v[64:67], v3 offset:0
    ds_read_b128 v[68:71], v3 offset:256
    ds_read_b128 v[72:75], v3 offset:2048
    ds_read_b128 v[76:79], v3 offset:2304
    ds_read_b128 v[80:83], v3 offset:4096
    ds_read_b128 v[84:87], v3 offset:4352
    s_waitcnt lgkmcnt(5)
    v_mfma_f32_16x16x32_bf16 v[16:19], a[0:3], v[64:67], 0
    ds_read_b128 v[88:91], v3 offset:6144
    v_mfma_f32_16x16x32_bf16 v[24:27], a[96:99], v[64:67], 0
    s_waitcnt lgkmcnt(5)
    v_mfma_f32_16x16x32_bf16 v[20:23], a[0:3], v[68:71], 0
    ds_read_b128 v[92:95], v3 offset:6400
    v_mfma_f32_16x16x32_bf16 v[28:31], a[96:99], v[68:71], 0
    s_cmp_lg_u32 s4, 0
    s_cbranch_scc1 L_rel_24
    v_mov_b32 v6, s73
    s_mov_b64 exec, 1
    s_cmp_eq_u32 s7, 0
    s_cbranch_scc1 L_sl_25
    buffer_store_dword v6, off, s[8:11], s85
    s_branch L_sd_26
L_sl_25:
    buffer_store_dword v6, off, s[8:11], s85 sc1
L_sd_26:
    s_mov_b64 exec, -1
L_rel_24:
    s_waitcnt lgkmcnt(5)
    v_mfma_f32_16x16x32_bf16 v[16:19], a[4:7], v[72:75], v[16:19]
    ds_read_b128 v[64:67], v3 offset:8192
    v_mfma_f32_16x16x32_bf16 v[24:27], a[100:103], v[72:75], v[24:27]
    s_waitcnt lgkmcnt(5)
    v_mfma_f32_16x16x32_bf16 v[20:23], a[4:7], v[76:79], v[20:23]
    ds_read_b128 v[68:71], v3 offset:8448
    v_mfma_f32_16x16x32_bf16 v[28:31], a[100:103], v[76:79], v[28:31]
    s_waitcnt lgkmcnt(5)
    v_mfma_f32_16x16x32_bf16 v[16:19], a[8:11], v[80:83], v[16:19]
    ds_read_b128 v[72:75], v3 offset:10240
    v_mfma_f32_16x16x32_bf16 v[24:27], a[104:107], v[80:83], v[24:27]
    s_waitcnt lgkmcnt(5)
    v_mfma_f32_16x16x32_bf16 v[20:23], a[8:11], v[84:87], v[20:23]
    ds_read_b128 v[76:79], v3 offset:10496
    v_mfma_f32_16x16x32_bf16 v[28:31], a[104:107], v[84:87], v[28:31]
    s_waitcnt lgkmcnt(5)
    v_mfma_f32_16x16x32_bf16 v[16:19], a[12:15], v[88:91], v[16:19]
    ds_read_b128 v[80:83], v3 offset:12288
    v_mfma_f32_16x16x32_bf16 v[24:27], a[108:111], v[88:91], v[24:27]
    s_waitcnt lgkmcnt(5)
    v_mfma_f32_16x16x32_bf16 v[20:23], a[12:15], v[92:95], v[20:23]
    ds_read_b128 v[84:87], v3 offset:12544
    v_mfma_f32_16x16x32_bf16 v[28:31], a[108:111], v[92:95], v[28:31]
    s_waitcnt lgkmcnt(5)
    v_mfma_f32_16x16x32_bf16 v[16:19], a[16:19], v[64:67], v[16:19]
    ds_read_b128 v[88:91], v3 offset:14336
    v_mfma_f32_16x16x32_bf16 v[24:27], a[112:115], v[64:67], v[24:27]
    s_waitcnt lgkmcnt(5)
    v_mfma_f32_16x16x32_bf16 v[20:23], a[16:19], v[68:71], v[20:23]
    ds_read_b128 v[92:95], v3 offset:14592
    v_mfma_f32_16x16x32_bf16 v[28:31], a[112:115], v[68:71], v[28:31]
    s_waitcnt lgkmcnt(5)
    v_mfma_f32_16x16x32_bf16 v[16:19], a[20:23], v[72:75], v[16:19]
    ds_read_b128 v[64:67], v3 offset:16384
    v_mfma_f32_16x16x32_bf16 v[24:27], a[116:119], v[72:75], v[24:27]
    s_waitcnt lgkmcnt(5)
    v_mfma_f32_16x16x32_bf16 v[20:23], a[20:23], v[76:79], v[20:23]
    ds_read_b128 v[68:71], v3 offset:16640
    v_mfma_f32_16x16x32_bf16 v[28:31], a[116:119], v[76:79], v[28:31]
    s_waitcnt lgkmcnt(5)
    v_mfma_f32_16x16x32_bf16 v[16:19], a[24:27], v[80:83], v[16:19]
    ds_read_b128 v[72:75], v3 offset:18432
    v_mfma_f32_16x16x32_bf16 v[24:27], a[120:123], v[80:83], v[24:27]
    s_waitcnt lgkmcnt(5)
    v_mfma_f32_16x16x32_bf16 v[20:23], a[24:27], v[84:87], v[20:23]
    ds_read_b128 v[76:79], v3 offset:18688
    v_mfma_f32_16x16x32_bf16 v[28:31], a[120:123], v[84:87], v[28:31]
    s_waitcnt lgkmcnt(5)
    v_mfma_f32_16x16x32_bf16 v[16:19], a[28:31], v[88:91], v[16:19]
    ds_read_b128 v[80:83], v3 offset:20480
    v_mfma_f32_16x16x32_bf16 v[24:27], a[124:127], v[88:91], v[24:27]
    s_waitcnt lgkmcnt(5)
    v_mfma_f32_16x16x32_bf16 v[20:23], a[28:31], v[92:95], v[20:23]
    ds_read_b128 v[84:87], v3 offset:20736
    v_mfma_f32_16x16x32_bf16 v[28:31], a[124:127], v[92:95], v[28:31]
    s_waitcnt lgkmcnt(5)
    v_mfma_f32_16x16x32_bf16 v[16:19], a[32:35], v[64:67], v[16:19]
    ds_read_b128 v[88:91], v3 offset:22528
    v_mfma_f32_16x16x32_bf16 v[24:27], a[128:131], v[64:67], v[24:27]
    s_waitcnt lgkmcnt(5)
    v_mfma_f32_16x16x32_bf16 v[20:23], a[32:35], v[68:71], v[20:23]
    ds_read_b128 v[92:95], v3 offset:22784
    v_mfma_f32_16x16x32_bf16 v[28:31], a[128:131], v[68:71], v[28:31]
    s_waitcnt lgkmcnt(5)
    v_mfma_f32_16x16x32_bf16 v[16:19], a[36:39], v[72:75], v[16:19]
    ds_read_b128 v[64:67], v3 offset:24576
    v_mfma_f32_16x16x32_bf16 v[24:27], a[132:135], v[72:75], v[24:27]
    s_waitcnt lgkmcnt(5)
    v_mfma_f32_16x16x32_bf16 v[20:23], a[36:39], v[76:79], v[20:23]
    ds_read_b128 v[68:71], v3 offset:24832
    v_mfma_f32_16x16x32_bf16 v[28:31], a[132:135], v[76:79], v[28:31]
    s_waitcnt lgkmcnt(5)
    v_mfma_f32_16x16x32_bf16 v[16:19], a[40:43], v[80:83], v[16:19]
    ds_read_b128 v[72:75], v3 offset:26624
    v_mfma_f32_16x16x32_bf16 v[24:27], a[136:139], v[80:83], v[24:27]
    s_waitcnt lgkmcnt(5)
    v_mfma_f32_16x16x32_bf16 v[20:23], a[40:43], v[84:87], v[20:23]
    ds_read_b128 v[76:79], v3 offset:26880
    v_mfma_f32_16x16x32_bf16 v[28:31], a[136:139], v[84:87], v[28:31]
    s_waitcnt lgkmcnt(5)
    v_mfma_f32_16x16x32_bf16 v[16:19], a[44:47], v[88:91], v[16:19]
    ds_read_b128 v[80:83], v3 offset:28672
    v_mfma_f32_16x16x32_bf16 v[24:27], a[140:143], v[88:91], v[24:27]
    s_waitcnt lgkmcnt(5)
    v_mfma_f32_16x16x32_bf16 v[20:23], a[44:47], v[92:95], v[20:23]
    ds_read_b128 v[84:87], v3 offset:28928
    v_mfma_f32_16x16x32_bf16 v[28:31], a[140:143], v[92:95], v[28:31]
    s_waitcnt lgkmcnt(5)
    v_mfma_f32_16x16x32_bf16 v[16:19], a[48:51], v[64:67], v[16:19]
    ds_read_b128 v[88:91], v3 offset:30720
    v_mfma_f32_16x16x32_bf16 v[24:27], a[144:147], v[64:67], v[24:27]
    s_waitcnt lgkmcnt(5)
    v_mfma_f32_16x16x32_bf16 v[20:23], a[48:51], v[68:71], v[20:23]
    ds_read_b128 v[92:95], v3 offset:30976
    v_mfma_f32_16x16x32_bf16 v[28:31], a[144:147], v[68:71], v[28:31]
    s_waitcnt lgkmcnt(5)
    v_mfma_f32_16x16x32_bf16 v[16:19], a[52:55], v[72:75], v[16:19]
    ds_read_b128 v[64:67], v3 offset:32768
    v_mfma_f32_16x16x32_bf16 v[24:27], a[148:151], v[72:75], v[24:27]
    s_waitcnt lgkmcnt(5)
    v_mfma_f32_16x16x32_bf16 v[20:23], a[52:55], v[76:79], v[20:23]
    ds_read_b128 v[68:71], v3 offset:33024
    v_mfma_f32_16x16x32_bf16 v[28:31], a[148:151], v[76:79], v[28:31]
    s_waitcnt lgkmcnt(5)
    v_mfma_f32_16x16x32_bf16 v[16:19], a[56:59], v[80:83], v[16:19]
    ds_read_b128 v[72:75], v3 offset:34816
    v_mfma_f32_16x16x32_bf16 v[24:27], a[152:155], v[80:83], v[24:27]
    s_waitcnt lgkmcnt(5)
    v_mfma_f32_16x16x32_bf16 v[20:23], a[56:59], v[84:87], v[20:23]
    ds_read_b128 v[76:79], v3 offset:35072
    v_mfma_f32_16x16x32_bf16 v[28:31], a[152:155], v[84:87], v[28:31]
    s_waitcnt lgkmcnt(5)
    v_mfma_f32_16x16x32_bf16 v[16:19], a[60:63], v[88:91], v[16:19]
    ds_read_b128 v[80:83], v3 offset:36864
    v_mfma_f32_16x16x32_bf16 v[24:27], a[156:159], v[88:91], v[24:27]
    s_waitcnt lgkmcnt(5)
    v_mfma_f32_16x16x32_bf16 v[20:23], a[60:63], v[92:95], v[20:23]
    ds_read_b128 v[84:87], v3 offset:37120
    v_mfma_f32_16x16x32_bf16 v[28:31], a[156:159], v[92:95], v[28:31]
    s_waitcnt lgkmcnt(5)
    v_mfma_f32_16x16x32_bf16 v[16:19], a[64:67], v[64:67], v[16:19]
    ds_read_b128 v[88:91], v3 offset:38912
    v_mfma_f32_16x16x32_bf16 v[24:27], a[160:163], v[64:67], v[24:27]
    s_waitcnt lgkmcnt(5)
    v_mfma_f32_16x16x32_bf16 v[20:23], a[64:67], v[68:71], v[20:23]
    ds_read_b128 v[92:95], v3 offset:39168
    v_mfma_f32_16x16x32_bf16 v[28:31], a[160:163], v[68:71], v[28:31]
    s_waitcnt lgkmcnt(5)
    v_mfma_f32_16x16x32_bf16 v[16:19], a[68:71], v[72:75], v[16:19]
    ds_read_b128 v[64:67], v3 offset:40960
    v_mfma_f32_16x16x32_bf16 v[24:27], a[164:167], v[72:75], v[24:27]
    s_waitcnt lgkmcnt(5)
    v_mfma_f32_16x16x32_bf16 v[20:23], a[68:71], v[76:79], v[20:23]
    ds_read_b128 v[68:71], v3 offset:41216
    v_mfma_f32_16x16x32_bf16 v[28:31], a[164:167], v[76:79], v[28:31]
    s_waitcnt lgkmcnt(5)
    v_mfma_f32_16x16x32_bf16 v[16:19], a[72:75], v[80:83], v[16:19]
    ds_read_b128 v[72:75], v3 offset:43008
    v_mfma_f32_16x16x32_bf16 v[24:27], a[168:171], v[80:83], v[24:27]
    s_waitcnt lgkmcnt(5)
    v_mfma_f32_16x16x32_bf16 v[20:23], a[72:75], v[84:87], v[20:23]
    ds_read_b128 v[76:79], v3 offset:43264
    v_mfma_f32_16x16x32_bf16 v[28:31], a[168:171], v[84:87], v[28:31]
    s_waitcnt lgkmcnt(5)
    v_mfma_f32_16x16x32_bf16 v[16:19], a[76:79], v[88:91], v[16:19]
    ds_read_b128 v[80:83], v3 offset:45056
    v_mfma_f32_16x16x32_bf16 v[24:27], a[172:175], v[88:91], v[24:27]
    s_waitcnt lgkmcnt(5)
    v_mfma_f32_16x16x32_bf16 v[20:23], a[76:79], v[92:95], v[20:23]
    ds_read_b128 v[84:87], v3 offset:45312
    v_mfma_f32_16x16x32_bf16 v[28:31], a[172:175], v[92:95], v[28:31]
    s_waitcnt lgkmcnt(5)
    v_mfma_f32_16x16x32_bf16 v[16:19], a[80:83], v[64:67], v[16:19]
    ds_read_b128 v[88:91], v3 offset:47104
    v_mfma_f32_16x16x32_bf16 v[24:27], a[176:179], v[64:67], v[24:27]
    s_waitcnt lgkmcnt(5)
    v_mfma_f32_16x16x32_bf16 v[20:23], a[80:83], v[68:71], v[20:23]
    ds_read_b128 v[92:95], v3 offset:47360
    v_mfma_f32_16x16x32_bf16 v[28:31], a[176:179], v[68:71], v[28:31]
    s_waitcnt lgkmcnt(5)
    v_mfma_f32_16x16x32_bf16 v[16:19], a[84:87], v[72:75], v[16:19]
    v_mfma_f32_16x16x32_bf16 v[24:27], a[180:183], v[72:75], v[24:27]
    s_waitcnt lgkmcnt(4)
    v_mfma_f32_16x16x32_bf16 v[20:23], a[84:87], v[76:79], v[20:23]
    v_mfma_f32_16x16x32_bf16 v[28:31], a[180:183], v[76:79], v[28:31]
    s_waitcnt lgkmcnt(3)
    v_mfma_f32_16x16x32_bf16 v[16:19], a[88:91], v[80:83], v[16:19]
    v_mfma_f32_16x16x32_bf16 v[24:27], a[184:187], v[80:83], v[24:27]
    s_waitcnt lgkmcnt(2)
    v_mfma_f32_16x16x32_bf16 v[20:23], a[88:91], v[84:87], v[20:23]
    v_mfma_f32_16x16x32_bf16 v[28:31], a[184:187], v[84:87], v[28:31]
    s_waitcnt lgkmcnt(1)
    v_mfma_f32_16x16x32_bf16 v[16:19], a[92:95], v[88:91], v[16:19]
    v_mfma_f32_16x16x32_bf16 v[24:27], a[188:191], v[88:91], v[24:27]
    s_waitcnt lgkmcnt(0)
    v_mfma_f32_16x16x32_bf16 v[20:23], a[92:95], v[92:95], v[20:23]
    v_mfma_f32_16x16x32_bf16 v[28:31], a[188:191], v[92:95], v[28:31]
    s_nop 3
    v_cvt_pk_bf16_f32 v32, v16, v17
    v_cvt_pk_bf16_f32 v33, v18, v19
    s_nop 0
    v_cvt_pk_bf16_f32 v34, v20, v21
    v_cvt_pk_bf16_f32 v35, v22, v23
    v_cvt_pk_bf16_f32 v36, v24, v25
    v_cvt_pk_bf16_f32 v37, v26, v27
    v_cvt_pk_bf16_f32 v38, v28, v29
    v_cvt_pk_bf16_f32 v39, v30, v31
    ds_write_b64 v9, v[32:33] offset:0
    ds_write_b64 v9, v[34:35] offset:1280
    ds_write_b64 v9, v[36:37] offset:32
    ds_write_b64 v9, v[38:39] offset:1312
    s_waitcnt lgkmcnt(0)
    ds_read_b128 v[40:43], v10
    ds_read_b128 v[44:47], v10 offset:1280
    s_waitcnt lgkmcnt(1)
    buffer_store_dwordx4 v[40:43], v12, s[8:11], s75 offen offset:0 sc1
    s_waitcnt lgkmcnt(0)
    buffer_store_dwordx4 v[44:47], v13, s[8:11], s75 offen offset:0 sc1
    s_waitcnt vmcnt(0)
    v_mov_b32 v4, 1
    v_mov_b32 v6, 110592
    s_mov_b64 exec, 1
    ds_add_rtn_u32 v4, v6, v4
    s_waitcnt lgkmcnt(0)
    v_readfirstlane_b32 s60, v4
    v_mov_b32 v4, s73
    s_and_b32 s60, s60, 3
    s_cmp_lg_u32 s60, 3
    s_cbranch_scc1 L_nl_27
    buffer_store_dword v4, off, s[8:11], s71 sc1
L_nl_27:
    s_mov_b64 exec, -1
    s_barrier
    s_mov_b32 s79, s73
    s_cmp_lt_u32 s79, 7
    s_cbranch_scc1 L_op_a
    s_mov_b32 s80, 0
    s_mov_b32 s87, 0
    s_mov_b32 s88, 0
L_op_b:
    s_add_u32 s73, s79, 1
    s_add_u32 s82, s80, 1
L_op_bp:
    s_cmp_lg_u32 s88, 0
    s_cbranch_scc1 L_op_pf
    buffer_load_dword v4, v5, s[8:11], s76 offen sc1
    buffer_load_dword v6, v5, s[8:11], s76 offen sc1
    buffer_load_dword v11, v5, s[8:11], s76 offen sc1
    s_waitcnt vmcnt(2)
    v_cmp_gt_u32 vcc, s73, v4
    s_cbranch_vccz L_op_b1
    s_waitcnt vmcnt(0)
    s_cmp_eq_u32 s87, 0
    s_cbranch_scc1 L_op_b0
    v_mov_b32 v6, 1
    v_mov_b32 v11, 110596
    s_mov_b64 exec, 1
    ds_add_rtn_u32 v6, v11, v6
    s_waitcnt lgkmcnt(0)
    v_readfirstlane_b32 s60, v6
    v_mov_b32 v6, s80
    s_and_b32 s60, s60, 3
    s_cmp_lg_u32 s60, 3
    s_cbranch_scc1 L_nl_28
    buffer_store_dword v6, off, s[8:11], s72 sc1
L_nl_28:
    s_mov_b64 exec, -1
    s_mov_b32 s87, 0
L_op_b0:
L_poll_29:
    buffer_load_dword v4, v5, s[8:11], s76 offen offset:0 sc1
    s_waitcnt vmcnt(0)
    v_cmp_gt_u32 vcc, s73, v4
    s_cbranch_vccz L_pok_30
    s_sleep 1
    s_sub_u32 s6, s6, 1
    s_cbranch_scc0 L_poll_29
    s_branch L_fail
L_pok_30:
L_op_b1:
    s_and_b32 s74, s79, 3
    s_mul_i32 s74, s74, 147456
    s_add_u32 s74, s74, s77
    s_add_u32 m0, s81, 0
    s_nop 0
    buffer_load_dwordx4 v8, s[8:11], s74 offen offset:0 sc1 lds
    buffer_load_dwordx4 v8, s[8:11], s74 offen offset:1024 sc1 lds
    buffer_load_dwordx4 v8, s[8:11], s74 offen offset:2048 sc1 lds
    buffer_load_dwordx4 v8, s[8:11], s74 offen offset:3072 sc1 lds
    s_add_u32 m0, s81, 4096
    s_add_u32 s74, s74, 4096
    buffer_load_dwordx4 v8, s[8:11], s74 offen offset:0 sc1 lds
    buffer_load_dwordx4 v8, s[8:11], s74 offen offset:1024 sc1 lds
    buffer_load_dwordx4 v8, s[8:11], s74 offen offset:2048 sc1 lds
    buffer_load_dwordx4 v8, s[8:11], s74 offen offset:3072 sc1 lds
    s_add_u32 m0, s81, 8192
    s_add_u32 s74, s74, 4096
    buffer_load_dwordx4 v8, s[8:11], s74 offen offset:0 sc1 lds
    buffer_load_dwordx4 v8, s[8:11], s74 offen offset:1024 sc1 lds
    buffer_load_dwordx4 v8, s[8:11], s74 offen offset:2048 sc1 lds
    buffer_load_dwordx4 v8, s[8:11], s74 offen offset:3072 sc1 lds
    buffer_load_dword v4, v5, s[8:11], s76 offen offset:1024 sc1
    s_and_b32 s75, s79, 63
    s_mul_i32 s75, s75, 327680
    s_add_u32 s75, s75, 23068672
    s_add_u32 s75, s75, s78
    s_and_b32 s83, s80, 3
    s_mul_i32 s83, s83, 147456
    s_add_u32 s83, s83, s77
    s_add_u32 s83, s83, 589824
    s_waitcnt vmcnt(0)
    s_cmp_eq_u32 s87, 0
    s_cbranch_scc1 L_op_b5
    v_mov_b32 v6, 1
    v_mov_b32 v11, 110596
    s_mov_b64 exec, 1
    ds_add_rtn_u32 v6, v11, v6
    s_waitcnt lgkmcnt(0)
    v_readfirstlane_b32 s60, v6
    v_mov_b32 v6, s80
    s_and_b32 s60, s60, 3
    s_cmp_lg_u32 s60, 3
    s_cbranch_scc1 L_nl_31
    buffer_store_dword v6, off, s[8:11], s72 sc1
L_nl_31:
    s_mov_b64 exec, -1
    s_mov_b32 s87, 0
L_op_b5:
    v_cmp_gt_u32 vcc, s82, v4
    s_cmp_eq_u64 vcc, 0
    s_cselect_b32 s84, 1, 0
    s_branch L_op_b6
L_op_pf:
    s_and_b32 s75, s79, 63
    s_mul_i32 s75, s75, 327680
    s_add_u32 s75, s75, 23068672
    s_add_u32 s75, s75, s78
    s_and_b32 s83, s80, 3
    s_mul_i32 s83, s83, 147456
    s_add_u32 s83, s83, s77
    s_add_u32 s83, s83, 589824
    s_mov_b32 s84, 0
    s_waitcnt vmcnt(2)
L_op_b6:
    s_barrier
    s_cmp_eq_u32 s84, 0
    s_cbranch_scc1 L_op_x1
    ds_read_b128 v[64:67], v3 offset:0
    ds_read_b128 v[68:71], v3 offset:256
    ds_read_b128 v[72:75], v3 offset:2048
    ds_read_b128 v[76:79], v3 offset:2304
    ds_read_b128 v[80:83], v3 offset:4096
    ds_read_b128 v[84:87], v3 offset:4352
    s_waitcnt lgkmcnt(5)
    v_mfma_f32_16x16x32_bf16 v[16:19], a[0:3], v[64:67], 0
    ds_read_b128 v[88:91], v3 offset:6144
    v_mfma_f32_16x16x32_bf16 v[24:27], a[96:99], v[64:67], 0
    s_waitcnt lgkmcnt(5)
    v_mfma_f32_16x16x32_bf16 v[20:23], a[0:3], v[68:71], 0
    ds_read_b128 v[92:95], v3 offset:6400
    v_mfma_f32_16x16x32_bf16 v[28:31], a[96:99], v[68:71], 0
    s_cmp_lg_u32 s4, 0
    s_cbranch_scc1 L_rel_32
    v_mov_b32 v6, s73
    s_mov_b64 exec, 1
    s_cmp_eq_u32 s7, 0
    s_cbranch_scc1 L_sl_33
    buffer_store_dword v6, off, s[8:11], s85
    s_branch L_sd_34
L_sl_33:
    buffer_store_dword v6, off, s[8:11], s85 sc1
L_sd_34:
    s_mov_b64 exec, -1
L_rel_32:
    s_waitcnt lgkmcnt(5)
    v_mfma_f32_16x16x32_bf16 v[16:19], a[4:7], v[72:75], v[16:19]
    ds_read_b128 v[64:67], v3 offset:8192
    v_mfma_f32_16x16x32_bf16 v[24:27], a[100:103], v[72:75], v[24:27]
    s_add_u32 m0, s81, 49152
    s_nop 0
    buffer_load_dwordx4 v8, s[8:11], s83 offen offset:0 sc1 lds
    s_waitcnt lgkmcnt(5)
    v_mfma_f32_16x16x32_bf16 v[20:23], a[4:7], v[76:79], v[20:23]
    ds_read_b128 v[68:71], v3 offset:8448
    v_mfma_f32_16x16x32_bf16 v[28:31], a[100:103], v[76:79], v[28:31]
    s_waitcnt lgkmcnt(5)
    v_mfma_f32_16x16x32_bf16 v[16:19], a[8:11], v[80:83], v[16:19]
    ds_read_b128 v[72:75], v3 offset:10240
    v_mfma_f32_16x16x32_bf16 v[24:27], a[104:107], v[80:83], v[24:27]
    buffer_load_dwordx4 v8, s[8:11], s83 offen offset:1024 sc1 lds
    s_waitcnt lgkmcnt(5)
    v_mfma_f32_16x16x32_bf16 v[20:23], a[8:11], v[84:87], v[20:23]
    ds_read_b128 v[76:79], v3 offset:10496
    v_mfma_f32_16x16x32_bf16 v[28:31], a[104:107], v[84:87], v[28:31]
    s_waitcnt lgkmcnt(5)
    v_mfma_f32_16x16x32_bf16 v[16:19], a[12:15], v[88:91], v[16:19]
    ds_read_b128 v[80:83], v3 offset:12288
    v_mfma_f32_16x16x32_bf16 v[24:27], a[108:111], v[88:91], v[24:27]
    buffer_load_dwordx4 v8, s[8:11], s83 offen offset:2048 sc1 lds
    s_waitcnt lgkmcnt(5)
    v_mfma_f32_16x16x32_bf16 v[20:23], a[12:15], v[92:95], v[20:23]
    ds_read_b128 v[84:87], v3 offset:12544
    v_mfma_f32_16x16x32_bf16 v[28:31], a[108:111], v[92:95], v[28:31]
    s_waitcnt lgkmcnt(5)
    v_mfma_f32_16x16x32_bf16 v[16:19], a[16:19], v[64:67], v[16:19]
    ds_read_b128 v[88:91], v3 offset:14336
    v_mfma_f32_16x16x32_bf16 v[24:27], a[112:115], v[64:67], v[24:27]
    buffer_load_dwordx4 v8, s[8:11], s83 offen offset:3072 sc1 lds
    s_waitcnt lgkmcnt(5)
    v_mfma_f32_16x16x32_bf16 v[20:23], a[16:19], v[68:71], v[20:23]
    ds_read_b128 v[92:95], v3 offset:14592
    v_mfma_f32_16x16x32_bf16 v[28:31], a[112:115], v[68:71], v[28:31]
    s_waitcnt lgkmcnt(5)
    v_mfma_f32_16x16x32_bf16 v[16:19], a[20:23], v[72:75], v[16:19]
    ds_read_b128 v[64:67], v3 offset:16384
    v_mfma_f32_16x16x32_bf16 v[24:27], a[116:119], v[72:75], v[24:27]
    s_add_u32 m0, s81, 53248
    s_add_u32 s83, s83, 4096
    buffer_load_dwordx4 v8, s[8:11], s83 offen offset:0 sc1 lds
    s_waitcnt lgkmcnt(5)
    v_mfma_f32_16x16x32_bf16 v[20:23], a[20:23], v[76:79], v[20:23]
    ds_read_b128 v[68:71], v3 offset:16640
    v_mfma_f32_16x16x32_bf16 v[28:31], a[116:119], v[76:79], v[28:31]
    s_waitcnt lgkmcnt(5)
    v_mfma_f32_16x16x32_bf16 v[16:19], a[24:27], v[80:83], v[16:19]
    ds_read_b128 v[72:75], v3 offset:18432
    v_mfma_f32_16x16x32_bf16 v[24:27], a[120:123], v[80:83], v[24:27]
    buffer_load_dwordx4 v8, s[8:11], s83 offen offset:1024 sc1 lds
    s_waitcnt lgkmcnt(5)
    v_mfma_f32_16x16x32_bf16 v[20:23], a[24:27], v[84:87], v[20:23]
    ds_read_b128 v[76:79], v3 offset:18688
    v_mfma_f32_16x16x32_bf16 v[28:31], a[120:123], v[84:87], v[28:31]
    s_waitcnt lgkmcnt(5)
    v_mfma_f32_16x16x32_bf16 v[16:19], a[28:31], v[88:91], v[16:19]
    ds_read_b128 v[80:83], v3 offset:20480
    v_mfma_f32_16x16x32_bf16 v[24:27], a[124:127], v[88:91], v[24:27]
    buffer_load_dwordx4 v8, s[8:11], s83 offen offset:2048 sc1 lds
    s_waitcnt lgkmcnt(5)
    v_mfma_f32_16x16x32_bf16 v[20:23], a[28:31], v[92:95], v[20:23]
    ds_read_b128 v[84:87], v3 offset:20736
    v_mfma_f32_16x16x32_bf16 v[28:31], a[124:127], v[92:95], v[28:31]
    s_waitcnt lgkmcnt(5)
    v_mfma_f32_16x16x32_bf16 v[16:19], a[32:35], v[64:67], v[16:19]
    ds_read_b128 v[88:91], v3 offset:22528
    v_mfma_f32_16x16x32_bf16 v[24:27], a[128:131], v[64:67], v[24:27]
    buffer_load_dwordx4 v8, s[8:11], s83 offen offset:3072 sc1 lds
    s_waitcnt lgkmcnt(5)
    v_mfma_f32_16x16x32_bf16 v[20:23], a[32:35], v[68:71], v[20:23]
    ds_read_b128 v[92:95], v3 offset:22784
    v_mfma_f32_16x16x32_bf16 v[28:31], a[128:131], v[68:71], v[28:31]
    s_waitcnt lgkmcnt(5)
    v_mfma_f32_16x16x32_bf16 v[16:19], a[36:39], v[72:75], v[16:19]
    ds_read_b128 v[64:67], v3 offset:24576
    v_mfma_f32_16x16x32_bf16 v[24:27], a[132:135], v[72:75], v[24:27]
    s_add_u32 m0, s81, 57344
    s_add_u32 s83, s83, 4096
    buffer_load_dwordx4 v8, s[8:11], s83 offen offset:0 sc1 lds
    s_waitcnt lgkmcnt(5)
    v_mfma_f32_16x16x32_bf16 v[20:23], a[36:39], v[76:79], v[20:23]
    ds_read_b128 v[68:71], v3 offset:24832
    v_mfma_f32_16x16x32_bf16 v[28:31], a[132:135], v[76:79], v[28:31]
    s_waitcnt lgkmcnt(5)
    v_mfma_f32_16x16x32_bf16 v[16:19], a[40:43], v[80:83], v[16:19]
    ds_read_b128 v[72:75], v3 offset:26624
    v_mfma_f32_16x16x32_bf16 v[24:27], a[136:139], v[80:83], v[24:27]
    buffer_load_dwordx4 v8, s[8:11], s83 offen offset:1024 sc1 lds
    s_waitcnt lgkmcnt(5)
    v_mfma_f32_16x16x32_bf16 v[20:23], a[40:43], v[84:87], v[20:23]
    ds_read_b128 v[76:79], v3 offset:26880
    v_mfma_f32_16x16x32_bf16 v[28:31], a[136:139], v[84:87], v[28:31]
    s_waitcnt lgkmcnt(5)
    v_mfma_f32_16x16x32_bf16 v[16:19], a[44:47], v[88:91], v[16:19]
    ds_read_b128 v[80:83], v3 offset:28672
    v_mfma_f32_16x16x32_bf16 v[24:27], a[140:143], v[88:91], v[24:27]
    buffer_load_dwordx4 v8, s[8:11], s83 offen offset:2048 sc1 lds
    s_waitcnt lgkmcnt(5)
    v_mfma_f32_16x16x32_bf16 v[20:23], a[44:47], v[92:95], v[20:23]
    ds_read_b128 v[84:87], v3 offset:28928
    v_mfma_f32_16x16x32_bf16 v[28:31], a[140:143], v[92:95], v[28:31]
    s_waitcnt lgkmcnt(5)
    v_mfma_f32_16x16x32_bf16 v[16:19], a[48:51], v[64:67], v[16:19]
    ds_read_b128 v[88:91], v3 offset:30720
    v_mfma_f32_16x16x32_bf16 v[24:27], a[144:147], v[64:67], v[24:27]
    buffer_load_dwordx4 v8, s[8:11], s83 offen offset:3072 sc1 lds
    s_waitcnt lgkmcnt(5)
    v_mfma_f32_16x16x32_bf16 v[20:23], a[48:51], v[68:71], v[20:23]
    ds_read_b128 v[92:95], v3 offset:30976
    v_mfma_f32_16x16x32_bf16 v[28:31], a[144:147], v[68:71], v[28:31]
    s_waitcnt lgkmcnt(5)
    v_mfma_f32_16x16x32_bf16 v[16:19], a[52:55], v[72:75], v[16:19]
    ds_read_b128 v[64:67], v3 offset:32768
    v_mfma_f32_16x16x32_bf16 v[24:27], a[148:151], v[72:75], v[24:27]
    s_waitcnt lgkmcnt(5)
    v_mfma_f32_16x16x32_bf16 v[20:23], a[52:55], v[76:79], v[20:23]
    ds_read_b128 v[68:71], v3 offset:33024
    v_mfma_f32_16x16x32_bf16 v[28:31], a[148:151], v[76:79], v[28:31]
    s_waitcnt lgkmcnt(5)
    v_mfma_f32_16x16x32_bf16 v[16:19], a[56:59], v[80:83], v[16:19]
    ds_read_b128 v[72:75], v3 offset:34816
    v_mfma_f32_16x16x32_bf16 v[24:27], a[152:155], v[80:83], v[24:27]
    s_waitcnt lgkmcnt(5)
    v_mfma_f32_16x16x32_bf16 v[20:23], a[56:59], v[84:87], v[20:23]
    ds_read_b128 v[76:79], v3 offset:35072
    v_mfma_f32_16x16x32_bf16 v[28:31], a[152:155], v[84:87], v[28:31]
    s_waitcnt lgkmcnt(5)
    v_mfma_f32_16x16x32_bf16 v[16:19], a[60:63], v[88:91], v[16:19]
    ds_read_b128 v[80:83], v3 offset:36864
    v_mfma_f32_16x16x32_bf16 v[24:27], a[156:159], v[88:91], v[24:27]
    s_waitcnt lgkmcnt(5)
    v_mfma_f32_16x16x32_bf16 v[20:23], a[60:63], v[92:95], v[20:23]
    ds_read_b128 v[84:87], v3 offset:37120
    v_mfma_f32_16x16x32_bf16 v[28:31], a[156:159], v[92:95], v[28:31]
    s_waitcnt lgkmcnt(5)
    v_mfma_f32_16x16x32_bf16 v[16:19], a[64:67], v[64:67], v[16:19]
    ds_read_b128 v[88:91], v3 offset:38912
    v_mfma_f32_16x16x32_bf16 v[24:27], a[160:163], v[64:67], v[24:27]
    s_waitcnt lgkmcnt(5)
    v_mfma_f32_16x16x32_bf16 v[20:23], a[64:67], v[68:71], v[20:23]
    ds_read_b128 v[92:95], v3 offset:39168
    v_mfma_f32_16x16x32_bf16 v[28:31], a[160:163], v[68:71], v[28:31]
    s_waitcnt lgkmcnt(5)
    v_mfma_f32_16x16x32_bf16 v[16:19], a[68:71], v[72:75], v[16:19]
    ds_read_b128 v[64:67], v3 offset:40960
    v_mfma_f32_16x16x32_bf16 v[24:27], a[164:167], v[72:75], v[24:27]
    s_waitcnt lgkmcnt(5)
    v_mfma_f32_16x16x32_bf16 v[20:23], a[68:71], v[76:79], v[20:23]
    ds_read_b128 v[68:71], v3 offset:41216
    v_mfma_f32_16x16x32_bf16 v[28:31], a[164:167], v[76:79], v[28:31]
    s_waitcnt lgkmcnt(5)
    v_mfma_f32_16x16x32_bf16 v[16:19], a[72:75], v[80:83], v[16:19]
    ds_read_b128 v[72:75], v3 offset:43008
    v_mfma_f32_16x16x32_bf16 v[24:27], a[168:171], v[80:83], v[24:27]
    s_waitcnt lgkmcnt(5)
    v_mfma_f32_16x16x32_bf16 v[20:23], a[72:75], v[84:87], v[20:23]
    ds_read_b128 v[76:79], v3 offset:43264
    v_mfma_f32_16x16x32_bf16 v[28:31], a[168:171], v[84:87], v[28:31]
    s_waitcnt lgkmcnt(5)
    v_mfma_f32_16x16x32_bf16 v[16:19], a[76:79], v[88:91], v[16:19]
    ds_read_b128 v[80:83], v3 offset:45056
    v_mfma_f32_16x16x32_bf16 v[24:27], a[172:175], v[88:91], v[24:27]
    s_waitcnt lgkmcnt(5)
    v_mfma_f32_16x16x32_bf16 v[20:23], a[76:79], v[92:95], v[20:23]
    ds_read_b128 v[84:87], v3 offset:45312
    v_mfma_f32_16x16x32_bf16 v[28:31], a[172:175], v[92:95], v[28:31]
    s_waitcnt lgkmcnt(5)
    v_mfma_f32_16x16x32_bf16 v[16:19], a[80:83], v[64:67], v[16:19]
    ds_read_b128 v[88:91], v3 offset:47104
    v_mfma_f32_16x16x32_bf16 v[24:27], a[176:179], v[64:67], v[24:27]
    s_waitcnt lgkmcnt(5)
    v_mfma_f32_16x16x32_bf16 v[20:23], a[80:83], v[68:71], v[20:23]
    ds_read_b128 v[92:95], v3 offset:47360
    v_mfma_f32_16x16x32_bf16 v[28:31], a[176:179], v[68:71], v[28:31]
    s_waitcnt lgkmcnt(5)
    v_mfma_f32_16x16x32_bf16 v[16:19], a[84:87], v[72:75], v[16:19]
    v_mfma_f32_16x16x32_bf16 v[24:27], a[180:183], v[72:75], v[24:27]
    s_waitcnt lgkmcnt(4)
    v_mfma_f32_16x16x32_bf16 v[20:23], a[84:87], v[76:79], v[20:23]
    v_mfma_f32_16x16x32_bf16 v[28:31], a[180:183], v[76:79], v[28:31]
    s_waitcnt lgkmcnt(3)
    v_mfma_f32_16x16x32_bf16 v[16:19], a[88:91], v[80:83], v[16:19]
    v_mfma_f32_16x16x32_bf16 v[24:27], a[184:187], v[80:83], v[24:27]
    s_waitcnt lgkmcnt(2)
    v_mfma_f32_16x16x32_bf16 v[20:23], a[88:91], v[84:87], v[20:23]
    v_mfma_f32_16x16x32_bf16 v[28:31], a[184:187], v[84:87], v[28:31]
    s_waitcnt lgkmcnt(1)
    v_mfma_f32_16x16x32_bf16 v[16:19], a[92:95], v[88:91], v[16:19]
    v_mfma_f32_16x16x32_bf16 v[24:27], a[188:191], v[88:91], v[24:27]
    s_waitcnt lgkmcnt(0)
    v_mfma_f32_16x16x32_bf16 v[20:23], a[92:95], v[92:95], v[20:23]
    v_mfma_f32_16x16x32_bf16 v[28:31], a[188:191], v[92:95], v[28:31]
    s_nop 3
    v_cvt_pk_bf16_f32 v32, v16, v17
    v_cvt_pk_bf16_f32 v33, v18, v19
    s_nop 0
    v_cvt_pk_bf16_f32 v34, v20, v21
    v_cvt_pk_bf16_f32 v35, v22, v23
    v_cvt_pk_bf16_f32 v36, v24, v25
    v_cvt_pk_bf16_f32 v37, v26, v27
    v_cvt_pk_bf16_f32 v38, v28, v29
    v_cvt_pk_bf16_f32 v39, v30, v31
    ds_write_b64 v9, v[32:33] offset:0
    ds_write_b64 v9, v[34:35] offset:1280
    ds_write_b64 v9, v[36:37] offset:32
    ds_write_b64 v9, v[38:39] offset:1312
    s_waitcnt lgkmcnt(0)
    ds_read_b128 v[40:43], v10
    ds_read_b128 v[44:47], v10 offset:1280
    s_waitcnt lgkmcnt(1)
    buffer_store_dwordx4 v[40:43], v12, s[8:11], s75 offen offset:0 sc1
    s_waitcnt lgkmcnt(0)
    buffer_store_dwordx4 v[44:47], v13, s[8:11], s75 offen offset:0 sc1
    s_branch L_op_x3
L_op_x1:
    ds_read_b128 v[64:67], v3 offset:0
    ds_read_b128 v[68:71], v3 offset:256
    ds_read_b128 v[72:75], v3 offset:2048
    ds_read_b128 v[76:79], v3 offset:2304
    ds_read_b128 v[80:83], v3 offset:4096
    ds_read_b128 v[84:87], v3 offset:4352
    s_waitcnt lgkmcnt(5)
    v_mfma_f32_16x16x32_bf16 v[16:19], a[0:3], v[64:67], 0
    ds_read_b128 v[88:91], v3 offset:6144
    v_mfma_f32_16x16x32_bf16 v[24:27], a[96:99], v[64:67], 0
    s_waitcnt lgkmcnt(5)
    v_mfma_f32_16x16x32_bf16 v[20:23], a[0:3], v[68:71], 0
    ds_read_b128 v[92:95], v3 offset:6400
    v_mfma_f32_16x16x32_bf16 v[28:31], a[96:99], v[68:71], 0
    s_cmp_lg_u32 s4, 0
    s_cbranch_scc1 L_rel_35
    v_mov_b32 v6, s73
    s_mov_b64 exec, 1
    s_cmp_eq_u32 s7, 0
    s_cbranch_scc1 L_sl_36
    buffer_store_dword v6, off, s[8:11], s85
    s_branch L_sd_37
L_sl_36:
    buffer_store_dword v6, off, s[8:11], s85 sc1
L_sd_37:
    s_mov_b64 exec, -1
L_rel_35:
    s_waitcnt lgkmcnt(5)
    v_mfma_f32_16x16x32_bf16 v[16:19], a[4:7], v[72:75], v[16:19]
    ds_read_b128 v[64:67], v3 offset:8192
    v_mfma_f32_16x16x32_bf16 v[24:27], a[100:103], v[72:75], v[24:27]
    s_waitcnt lgkmcnt(5)
    v_mfma_f32_16x16x32_bf16 v[20:23], a[4:7], v[76:79], v[20:23]
    ds_read_b128 v[68:71], v3 offset:8448
    v_mfma_f32_16x16x32_bf16 v[28:31], a[100:103], v[76:79], v[28:31]
    s_waitcnt lgkmcnt(5)
    v_mfma_f32_16x16x32_bf16 v[16:19], a[8:11], v[80:83], v[16:19]
    ds_read_b128 v[72:75], v3 offset:10240
    v_mfma_f32_16x16x32_bf16 v[24:27], a[104:107], v[80:83], v[24:27]
    s_waitcnt lgkmcnt(5)
    v_mfma_f32_16x16x32_bf16 v[20:23], a[8:11], v[84:87], v[20:23]
    ds_read_b128 v[76:79], v3 offset:10496
    v_mfma_f32_16x16x32_bf16 v[28:31], a[104:107], v[84:87], v[28:31]
    s_waitcnt lgkmcnt(5)
    v_mfma_f32_16x16x32_bf16 v[16:19], a[12:15], v[88:91], v[16:19]
    ds_read_b128 v[80:83], v3 offset:12288
    v_mfma_f32_16x16x32_bf16 v[24:27], a[108:111], v[88:91], v[24:27]
    s_waitcnt lgkmcnt(5)
    v_mfma_f32_16x16x32_bf16 v[20:23], a[12:15], v[92:95], v[20:23]
    ds_read_b128 v[84:87], v3 offset:12544
    v_mfma_f32_16x16x32_bf16 v[28:31], a[108:111], v[92:95], v[28:31]
    s_waitcnt lgkmcnt(5)
    v_mfma_f32_16x16x32_bf16 v[16:19], a[16:19], v[64:67], v[16:19]
    ds_read_b128 v[88:91], v3 offset:14336
    v_mfma_f32_16x16x32_bf16 v[24:27], a[112:115], v[64:67], v[24:27]
    s_waitcnt lgkmcnt(5)
    v_mfma_f32_16x16x32_bf16 v[20:23], a[16:19], v[68:71], v[20:23]
    ds_read_b128 v[92:95], v3 offset:14592
    v_mfma_f32_16x16x32_bf16 v[28:31], a[112:115], v[68:71], v[28:31]
    s_waitcnt lgkmcnt(5)
    v_mfma_f32_16x16x32_bf16 v[16:19], a[20:23], v[72:75], v[16:19]
    ds_read_b128 v[64:67], v3 offset:16384
    v_mfma_f32_16x16x32_bf16 v[24:27], a[116:119], v[72:75], v[24:27]
    s_cmp_lg_u32 s84, 0
    s_cbranch_scc1 L_rl_38
    buffer_load_dword v4, v5, s[8:11], s76 offen offset:1024 sc1
L_rl_38:
    s_waitcnt lgkmcnt(5)
    v_mfma_f32_16x16x32_bf16 v[20:23], a[20:23], v[76:79], v[20:23]
    ds_read_b128 v[68:71], v3 offset:16640
    v_mfma_f32_16x16x32_bf16 v[28:31], a[116:119], v[76:79], v[28:31]
    s_waitcnt lgkmcnt(5)
    v_mfma_f32_16x16x32_bf16 v[16:19], a[24:27], v[80:83], v[16:19]
    ds_read_b128 v[72:75], v3 offset:18432
    v_mfma_f32_16x16x32_bf16 v[24:27], a[120:123], v[80:83], v[24:27]
    s_waitcnt lgkmcnt(5)
    v_mfma_f32_16x16x32_bf16 v[20:23], a[24:27], v[84:87], v[20:23]
    ds_read_b128 v[76:79], v3 offset:18688
    v_mfma_f32_16x16x32_bf16 v[28:31], a[120:123], v[84:87], v[28:31]
    s_waitcnt lgkmcnt(5)
    v_mfma_f32_16x16x32_bf16 v[16:19], a[28:31], v[88:91], v[16:19]
    ds_read_b128 v[80:83], v3 offset:20480
    v_mfma_f32_16x16x32_bf16 v[24:27], a[124:127], v[88:91], v[24:27]
    s_waitcnt lgkmcnt(5)
    v_mfma_f32_16x16x32_bf16 v[20:23], a[28:31], v[92:95], v[20:23]
    ds_read_b128 v[84:87], v3 offset:20736
    v_mfma_f32_16x16x32_bf16 v[28:31], a[124:127], v[92:95], v[28:31]
    s_waitcnt lgkmcnt(5)
    v_mfma_f32_16x16x32_bf16 v[16:19], a[32:35], v[64:67], v[16:19]
    ds_read_b128 v[88:91], v3 offset:22528
    v_mfma_f32_16x16x32_bf16 v[24:27], a[128:131], v[64:67], v[24:27]
    s_waitcnt lgkmcnt(5)
    v_mfma_f32_16x16x32_bf16 v[20:23], a[32:35], v[68:71], v[20:23]
    ds_read_b128 v[92:95], v3 offset:22784
    v_mfma_f32_16x16x32_bf16 v[28:31], a[128:131], v[68:71], v[28:31]
    s_waitcnt lgkmcnt(5)
    v_mfma_f32_16x16x32_bf16 v[16:19], a[36:39], v[72:75], v[16:19]
    ds_read_b128 v[64:67], v3 offset:24576
    v_mfma_f32_16x16x32_bf16 v[24:27], a[132:135], v[72:75], v[24:27]
    s_waitcnt lgkmcnt(5)
    v_mfma_f32_16x16x32_bf16 v[20:23], a[36:39], v[76:79], v[20:23]
    ds_read_b128 v[68:71], v3 offset:24832
    v_mfma_f32_16x16x32_bf16 v[28:31], a[132:135], v[76:79], v[28:31]
    s_waitcnt lgkmcnt(5)
    v_mfma_f32_16x16x32_bf16 v[16:19], a[40:43], v[80:83], v[16:19]
    ds_read_b128 v[72:75], v3 offset:26624
    v_mfma_f32_16x16x32_bf16 v[24:27], a[136:139], v[80:83], v[24:27]
    s_waitcnt lgkmcnt(5)
    v_mfma_f32_16x16x32_bf16 v[20:23], a[40:43], v[84:87], v[20:23]
    ds_read_b128 v[76:79], v3 offset:26880
    v_mfma_f32_16x16x32_bf16 v[28:31], a[136:139], v[84:87], v[28:31]
    s_waitcnt lgkmcnt(5)
    v_mfma_f32_16x16x32_bf16 v[16:19], a[44:47], v[88:91], v[16:19]
    ds_read_b128 v[80:83], v3 offset:28672
    v_mfma_f32_16x16x32_bf16 v[24:27], a[140:143], v[88:91], v[24:27]
    s_cmp_lg_u32 s84, 0
    s_cbranch_scc1 L_ck_39
    s_waitcnt vmcnt(0)
    s_cmp_eq_u32 s87, 0
    s_cbranch_scc1 L_ck_40
    v_mov_b32 v6, 1
    v_mov_b32 v11, 110596
    s_mov_b64 exec, 1
    ds_add_rtn_u32 v6, v11, v6
    s_waitcnt lgkmcnt(0)
    v_readfirstlane_b32 s60, v6
    v_mov_b32 v6, s80
    s_and_b32 s60, s60, 3
    s_cmp_lg_u32 s60, 3
    s_cbranch_scc1 L_nl_41
    buffer_store_dword v6, off, s[8:11], s72 sc1
L_nl_41:
    s_mov_b64 exec, -1
    s_mov_b32 s87, 0
L_ck_40:
    v_cmp_gt_u32 vcc, s82, v4
    s_cbranch_vccnz L_ck_39
    s_mov_b32 s84, 2
L_ck_39:
    s_cmp_eq_u32 s84, 0
    s_cbranch_scc1 L_op_x2
    s_waitcnt lgkmcnt(5)
    v_mfma_f32_16x16x32_bf16 v[20:23], a[44:47], v[92:95], v[20:23]
    ds_read_b128 v[84:87], v3 offset:28928
    v_mfma_f32_16x16x32_bf16 v[28:31], a[140:143], v[92:95], v[28:31]
    s_add_u32 m0, s81, 49152
    s_nop 0
    buffer_load_dwordx4 v8, s[8:11], s83 offen offset:0 sc1 lds
    s_waitcnt lgkmcnt(5)
    v_mfma_f32_16x16x32_bf16 v[16:19], a[48:51], v[64:67], v[16:19]
    ds_read_b128 v[88:91], v3 offset:30720
    v_mfma_f32_16x16x32_bf16 v[24:27], a[144:147], v[64:67], v[24:27]
    s_waitcnt lgkmcnt(5)
    v_mfma_f32_16x16x32_bf16 v[20:23], a[48:51], v[68:71], v[20:23]
    ds_read_b128 v[92:95], v3 offset:30976
    v_mfma_f32_16x16x32_bf16 v[28:31], a[144:147], v[68:71], v[28:31]
    buffer_load_dwordx4 v8, s[8:11], s83 offen offset:1024 sc1 lds
    s_waitcnt lgkmcnt(5)
    v_mfma_f32_16x16x32_bf16 v[16:19], a[52:55], v[72:75], v[16:19]
    ds_read_b128 v[64:67], v3 offset:32768
    v_mfma_f32_16x16x32_bf16 v[24:27], a[148:151], v[72:75], v[24:27]
    s_waitcnt lgkmcnt(5)
    v_mfma_f32_16x16x32_bf16 v[20:23], a[52:55], v[76:79], v[20:23]
    ds_read_b128 v[68:71], v3 offset:33024
    v_mfma_f32_16x16x32_bf16 v[28:31], a[148:151], v[76:79], v[28:31]
    buffer_load_dwordx4 v8, s[8:11], s83 offen offset:2048 sc1 lds
    s_waitcnt lgkmcnt(5)
    v_mfma_f32_16x16x32_bf16 v[16:19], a[56:59], v[80:83], v[16:19]
    ds_read_b128 v[72:75], v3 offset:34816
    v_mfma_f32_16x16x32_bf16 v[24:27], a[152:155], v[80:83], v[24:27]
    s_waitcnt lgkmcnt(5)
    v_mfma_f32_16x16x32_bf16 v[20:23], a[56:59], v[84:87], v[20:23]
    ds_read_b128 v[76:79], v3 offset:35072
    v_mfma_f32_16x16x32_bf16 v[28:31], a[152:155], v[84:87], v[28:31]
    buffer_load_dwordx4 v8, s[8:11], s83 offen offset:3072 sc1 lds
    s_waitcnt lgkmcnt(5)
    v_mfma_f32_16x16x32_bf16 v[16:19], a[60:63], v[88:91], v[16:19]
    ds_read_b128 v[80:83], v3 offset:36864
    v_mfma_f32_16x16x32_bf16 v[24:27], a[156:159], v[88:91], v[24:27]
    s_waitcnt lgkmcnt(5)
    v_mfma_f32_16x16x32_bf16 v[20:23], a[60:63], v[92:95], v[20:23]
    ds_read_b128 v[84:87], v3 offset:37120
    v_mfma_f32_16x16x32_bf16 v[28:31], a[156:159], v[92:95], v[28:31]
    s_add_u32 m0, s81, 53248
    s_add_u32 s83, s83, 4096
    buffer_load_dwordx4 v8, s[8:11], s83 offen offset:0 sc1 lds
    s_waitcnt lgkmcnt(5)
    v_mfma_f32_16x16x32_bf16 v[16:19], a[64:67], v[64:67], v[16:19]
    ds_read_b128 v[88:91], v3 offset:38912
    v_mfma_f32_16x16x32_bf16 v[24:27], a[160:163], v[64:67], v[24:27]
    s_waitcnt lgkmcnt(5)
    v_mfma_f32_16x16x32_bf16 v[20:23], a[64:67], v[68:71], v[20:23]
    ds_read_b128 v[92:95], v3 offset:39168
    v_mfma_f32_16x16x32_bf16 v[28:31], a[160:163], v[68:71], v[28:31]
    buffer_load_dwordx4 v8, s[8:11], s83 offen offset:1024 sc1 lds
    s_waitcnt lgkmcnt(5)
    v_mfma_f32_16x16x32_bf16 v[16:19], a[68:71], v[72:75], v[16:19]
    ds_read_b128 v[64:67], v3 offset:40960
    v_mfma_f32_16x16x32_bf16 v[24:27], a[164:167], v[72:75], v[24:27]
    s_waitcnt lgkmcnt(5)
    v_mfma_f32_16x16x32_bf16 v[20:23], a[68:71], v[76:79], v[20:23]
    ds_read_b128 v[68:71], v3 offset:41216
    v_mfma_f32_16x16x32_bf16 v[28:31], a[164:167], v[76:79], v[28:31]
    buffer_load_dwordx4 v8, s[8:11], s83 offen offset:2048 sc1 lds
    s_waitcnt lgkmcnt(5)
    v_mfma_f32_16x16x32_bf16 v[16:19], a[72:75], v[80:83], v[16:19]
    ds_read_b128 v[72:75], v3 offset:43008
    v_mfma_f32_16x16x32_bf16 v[24:27], a[168:171], v[80:83], v[24:27]
    s_waitcnt lgkmcnt(5)
    v_mfma_f32_16x16x32_bf16 v[20:23], a[72:75], v[84:87], v[20:23]
    ds_read_b128 v[76:79], v3 offset:43264
    v_mfma_f32_16x16x32_bf16 v[28:31], a[168:171], v[84:87], v[28:31]
    buffer_load_dwordx4 v8, s[8:11], s83 offen offset:3072 sc1 lds
    s_waitcnt lgkmcnt(5)
    v_mfma_f32_16x16x32_bf16 v[16:19], a[76:79], v[88:91], v[16:19]
    ds_read_b128 v[80:83], v3 offset:45056
    v_mfma_f32_16x16x32_bf16 v[24:27], a[172:175], v[88:91], v[24:27]
    s_waitcnt lgkmcnt(5)
    v_mfma_f32_16x16x32_bf16 v[20:23], a[76:79], v[92:95], v[20:23]
    ds_read_b128 v[84:87], v3 offset:45312
    v_mfma_f32_16x16x32_bf16 v[28:31], a[172:175], v[92:95], v[28:31]
    s_add_u32 m0, s81, 57344
    s_add_u32 s83, s83, 4096
    buffer_load_dwordx4 v8, s[8:11], s83 offen offset:0 sc1 lds
    s_waitcnt lgkmcnt(5)
    v_mfma_f32_16x16x32_bf16 v[16:19], a[80:83], v[64:67], v[16:19]
    ds_read_b128 v[88:91], v3 offset:47104
    v_mfma_f32_16x16x32_bf16 v[24:27], a[176:179], v[64:67], v[24:27]
    s_waitcnt lgkmcnt(5)
    v_mfma_f32_16x16x32_bf16 v[20:23], a[80:83], v[68:71], v[20:23]
    ds_read_b128 v[92:95], v3 offset:47360
    v_mfma_f32_16x16x32_bf16 v[28:31], a[176:179], v[68:71], v[28:31]
    buffer_load_dwordx4 v8, s[8:11], s83 offen offset:1024 sc1 lds
    s_waitcnt lgkmcnt(5)
    v_mfma_f32_16x16x32_bf16 v[16:19], a[84:87], v[72:75], v[16:19]
    v_mfma_f32_16x16x32_bf16 v[24:27], a[180:183], v[72:75], v[24:27]
    s_waitcnt lgkmcnt(4)
    v_mfma_f32_16x16x32_bf16 v[20:23], a[84:87], v[76:79], v[20:23]
    v_mfma_f32_16x16x32_bf16 v[28:31], a[180:183], v[76:79], v[28:31]
    buffer_load_dwordx4 v8, s[8:11], s83 offen offset:2048 sc1 lds
    s_waitcnt lgkmcnt(3)
    v_mfma_f32_16x16x32_bf16 v[16:19], a[88:91], v[80:83], v[16:19]
    v_mfma_f32_16x16x32_bf16 v[24:27], a[184:187], v[80:83], v[24:27]
    s_waitcnt lgkmcnt(2)
    v_mfma_f32_16x16x32_bf16 v[20:23], a[88:91], v[84:87], v[20:23]
    v_mfma_f32_16x16x32_bf16 v[28:31], a[184:187], v[84:87], v[28:31]
    buffer_load_dwordx4 v8, s[8:11], s83 offen offset:3072 sc1 lds
    s_waitcnt lgkmcnt(1)
    v_mfma_f32_16x16x32_bf16 v[16:19], a[92:95], v[88:91], v[16:19]
    v_mfma_f32_16x16x32_bf16 v[24:27], a[188:191], v[88:91], v[24:27]
    s_waitcnt lgkmcnt(0)
    v_mfma_f32_16x16x32_bf16 v[20:23], a[92:95], v[92:95], v[20:23]
    v_mfma_f32_16x16x32_bf16 v[28:31], a[188:191], v[92:95], v[28:31]
    s_nop 3
    v_cvt_pk_bf16_f32 v32, v16, v17
    v_cvt_pk_bf16_f32 v33, v18, v19
    s_nop 0
    v_cvt_pk_bf16_f32 v34, v20, v21
    v_cvt_pk_bf16_f32 v35, v22, v23
    v_cvt_pk_bf16_f32 v36, v24, v25
    v_cvt_pk_bf16_f32 v37, v26, v27
    v_cvt_pk_bf16_f32 v38, v28, v29
    v_cvt_pk_bf16_f32 v39, v30, v31
    ds_write_b64 v9, v[32:33] offset:0
    ds_write_b64 v9, v[34:35] offset:1280
    ds_write_b64 v9, v[36:37] offset:32
    ds_write_b64 v9, v[38:39] offset:1312
    s_waitcnt lgkmcnt(0)
    ds_read_b128 v[40:43], v10
    ds_read_b128 v[44:47], v10 offset:1280
    s_waitcnt lgkmcnt(1)
    buffer_store_dwordx4 v[40:43], v12, s[8:11], s75 offen offset:0 sc1
    s_waitcnt lgkmcnt(0)
    buffer_store_dwordx4 v[44:47], v13, s[8:11], s75 offen offset:0 sc1
L_op_x3:
    s_waitcnt vmcnt(2)
    s_branch L_op_b3
L_op_x2:
    s_waitcnt lgkmcnt(5)
    v_mfma_f32_16x16x32_bf16 v[20:23], a[44:47], v[92:95], v[20:23]
    ds_read_b128 v[84:87], v3 offset:28928
    v_mfma_f32_16x16x32_bf16 v[28:31], a[140:143], v[92:95], v[28:31]
    s_waitcnt lgkmcnt(5)
    v_mfma_f32_16x16x32_bf16 v[16:19], a[48:51], v[64:67], v[16:19]
    ds_read_b128 v[88:91], v3 offset:30720
    v_mfma_f32_16x16x32_bf16 v[24:27], a[144:147], v[64:67], v[24:27]
    s_waitcnt lgkmcnt(5)
    v_mfma_f32_16x16x32_bf16 v[20:23], a[48:51], v[68:71], v[20:23]
    ds_read_b128 v[92:95], v3 offset:30976
    v_mfma_f32_16x16x32_bf16 v[28:31], a[144:147], v[68:71], v[28:31]
    s_waitcnt lgkmcnt(5)
    v_mfma_f32_16x16x32_bf16 v[16:19], a[52:55], v[72:75], v[16:19]
    ds_read_b128 v[64:67], v3 offset:32768
    v_mfma_f32_16x16x32_bf16 v[24:27], a[148:151], v[72:75], v[24:27]
    s_waitcnt lgkmcnt(5)
    v_mfma_f32_16x16x32_bf16 v[20:23], a[52:55], v[76:79], v[20:23]
    ds_read_b128 v[68:71], v3 offset:33024
    v_mfma_f32_16x16x32_bf16 v[28:31], a[148:151], v[76:79], v[28:31]
    s_waitcnt lgkmcnt(5)
    v_mfma_f32_16x16x32_bf16 v[16:19], a[56:59], v[80:83], v[16:19]
    ds_read_b128 v[72:75], v3 offset:34816
    v_mfma_f32_16x16x32_bf16 v[24:27], a[152:155], v[80:83], v[24:27]
    s_waitcnt lgkmcnt(5)
    v_mfma_f32_16x16x32_bf16 v[20:23], a[56:59], v[84:87], v[20:23]
    ds_read_b128 v[76:79], v3 offset:35072
    v_mfma_f32_16x16x32_bf16 v[28:31], a[152:155], v[84:87], v[28:31]
    s_waitcnt lgkmcnt(5)
    v_mfma_f32_16x16x32_bf16 v[16:19], a[60:63], v[88:91], v[16:19]
    ds_read_b128 v[80:83], v3 offset:36864
    v_mfma_f32_16x16x32_bf16 v[24:27], a[156:159], v[88:91], v[24:27]
    s_waitcnt lgkmcnt(5)
    v_mfma_f32_16x16x32_bf16 v[20:23], a[60:63], v[92:95], v[20:23]
    ds_read_b128 v[84:87], v3 offset:37120
    v_mfma_f32_16x16x32_bf16 v[28:31], a[156:159], v[92:95], v[28:31]
    s_waitcnt lgkmcnt(5)
    v_mfma_f32_16x16x32_bf16 v[16:19], a[64:67], v[64:67], v[16:19]
    ds_read_b128 v[88:91], v3 offset:38912
    v_mfma_f32_16x16x32_bf16 v[24:27], a[160:163], v[64:67], v[24:27]
    s_waitcnt lgkmcnt(5)
    v_mfma_f32_16x16x32_bf16 v[20:23], a[64:67], v[68:71], v[20:23]
    ds_read_b128 v[92:95], v3 offset:39168
    v_mfma_f32_16x16x32_bf16 v[28:31], a[160:163], v[68:71], v[28:31]
    s_waitcnt lgkmcnt(5)
    v_mfma_f32_16x16x32_bf16 v[16:19], a[68:71], v[72:75], v[16:19]
    ds_read_b128 v[64:67], v3 offset:40960
    v_mfma_f32_16x16x32_bf16 v[24:27], a[164:167], v[72:75], v[24:27]
    s_waitcnt lgkmcnt(5)
    v_mfma_f32_16x16x32_bf16 v[20:23], a[68:71], v[76:79], v[20:23]
    ds_read_b128 v[68:71], v3 offset:41216
    v_mfma_f32_16x16x32_bf16 v[28:31], a[164:167], v[76:79], v[28:31]
    s_waitcnt lgkmcnt(5)
    v_mfma_f32_16x16x32_bf16 v[16:19], a[72:75], v[80:83], v[16:19]
    ds_read_b128 v[72:75], v3 offset:43008
    v_mfma_f32_16x16x32_bf16 v[24:27], a[168:171], v[80:83], v[24:27]
    s_waitcnt lgkmcnt(5)
    v_mfma_f32_16x16x32_bf16 v[20:23], a[72:75], v[84:87], v[20:23]
    ds_read_b128 v[76:79], v3 offset:43264
    v_mfma_f32_16x16x32_bf16 v[28:31], a[168:171], v[84:87], v[28:31]
    s_waitcnt lgkmcnt(5)
    v_mfma_f32_16x16x32_bf16 v[16:19], a[76:79], v[88:91], v[16:19]
    ds_read_b128 v[80:83], v3 offset:45056
    v_mfma_f32_16x16x32_bf16 v[24:27], a[172:175], v[88:91], v[24:27]
    s_waitcnt lgkmcnt(5)
    v_mfma_f32_16x16x32_bf16 v[20:23], a[76:79], v[92:95], v[20:23]
    ds_read_b128 v[84:87], v3 offset:45312
    v_mfma_f32_16x16x32_bf16 v[28:31], a[172:175], v[92:95], v[28:31]
    s_waitcnt lgkmcnt(5)
    v_mfma_f32_16x16x32_bf16 v[16:19], a[80:83], v[64:67], v[16:19]
    ds_read_b128 v[88:91], v3 offset:47104
    v_mfma_f32_16x16x32_bf16 v[24:27], a[176:179], v[64:67], v[24:27]
    s_waitcnt lgkmcnt(5)
    v_mfma_f32_16x16x32_bf16 v[20:23], a[80:83], v[68:71], v[20:23]
    ds_read_b128 v[92:95], v3 offset:47360
    v_mfma_f32_16x16x32_bf16 v[28:31], a[176:179], v[68:71], v[28:31]
    s_waitcnt lgkmcnt(5)
    v_mfma_f32_16x16x32_bf16 v[16:19], a[84:87], v[72:75], v[16:19]
    v_mfma_f32_16x16x32_bf16 v[24:27], a[180:183], v[72:75], v[24:27]
    s_waitcnt lgkmcnt(4)
    v_mfma_f32_16x16x32_bf16 v[20:23], a[84:87], v[76:79], v[20:23]
    v_mfma_f32_16x16x32_bf16 v[28:31], a[180:183], v[76:79], v[28:31]
    s_waitcnt lgkmcnt(3)
    v_mfma_f32_16x16x32_bf16 v[16:19], a[88:91], v[80:83], v[16:19]
    v_mfma_f32_16x16x32_bf16 v[24:27], a[184:187], v[80:83], v[24:27]
    s_waitcnt lgkmcnt(2)
    v_mfma_f32_16x16x32_bf16 v[20:23], a[88:91], v[84:87], v[20:23]
    v_mfma_f32_16x16x32_bf16 v[28:31], a[184:187], v[84:87], v[28:31]
    s_waitcnt lgkmcnt(1)
    v_mfma_f32_16x16x32_bf16 v[16:19], a[92:95], v[88:91], v[16:19]
    v_mfma_f32_16x16x32_bf16 v[24:27], a[188:191], v[88:91], v[24:27]
    s_waitcnt lgkmcnt(0)
    v_mfma_f32_16x16x32_bf16 v[20:23], a[92:95], v[92:95], v[20:23]
    v_mfma_f32_16x16x32_bf16 v[28:31], a[188:191], v[92:95], v[28:31]
    s_nop 3
    v_cvt_pk_bf16_f32 v32, v16, v17
    v_cvt_pk_bf16_f32 v33, v18, v19
    s_nop 0
    v_cvt_pk_bf16_f32 v34, v20, v21
    v_cvt_pk_bf16_f32 v35, v22, v23
    v_cvt_pk_bf16_f32 v36, v24, v25
    v_cvt_pk_bf16_f32 v37, v26, v27
    v_cvt_pk_bf16_f32 v38, v28, v29
    v_cvt_pk_bf16_f32 v39, v30, v31
    ds_write_b64 v9, v[32:33] offset:0
    ds_write_b64 v9, v[34:35] offset:1280
    ds_write_b64 v9, v[36:37] offset:32
    ds_write_b64 v9, v[38:39] offset:1312
    s_waitcnt lgkmcnt(0)
    ds_read_b128 v[40:43], v10
    ds_read_b128 v[44:47], v10 offset:1280
    s_waitcnt lgkmcnt(1)
    buffer_store_dwordx4 v[40:43], v12, s[8:11], s75 offen offset:0 sc1
    s_waitcnt lgkmcnt(0)
    buffer_store_dwordx4 v[44:47], v13, s[8:11], s75 offen offset:0 sc1
L_op_b2:
    s_waitcnt vmcnt(0)
    v_mov_b32 v6, 1
    v_mov_b32 v11, 110592
    s_mov_b64 exec, 1
    ds_add_rtn_u32 v6, v11, v6
    s_waitcnt lgkmcnt(0)
    v_readfirstlane_b32 s60, v6
    v_mov_b32 v6, s73
    s_and_b32 s60, s60, 3
    s_cmp_lg_u32 s60, 3
    s_cbranch_scc1 L_nl_42
    buffer_store_dword v6, off, s[8:11], s71 sc1
L_nl_42:
    s_mov_b64 exec, -1
L_poll_43:
    buffer_load_dword v4, v5, s[8:11], s76 offen offset:1024 sc1
    s_waitcnt vmcnt(0)
    v_cmp_gt_u32 vcc, s82, v4
    s_cbranch_vccz L_pok_44
    s_sleep 1
    s_sub_u32 s6, s6, 1
    s_cbranch_scc0 L_poll_43
    s_branch L_fail
L_pok_44:
    s_add_u32 m0, s81, 49152
    s_nop 0
    buffer_load_dwordx4 v8, s[8:11], s83 offen offset:0 sc1 lds
    buffer_load_dwordx4 v8, s[8:11], s83 offen offset:1024 sc1 lds
    buffer_load_dwordx4 v8, s[8:11], s83 offen offset:2048 sc1 lds
    buffer_load_dwordx4 v8, s[8:11], s83 offen offset:3072 sc1 lds
    s_add_u32 m0, s81, 53248
    s_add_u32 s83, s83, 4096
    buffer_load_dwordx4 v8, s[8:11], s83 offen offset:0 sc1 lds
    buffer_load_dwordx4 v8, s[8:11], s83 offen offset:1024 sc1 lds
    buffer_load_dwordx4 v8, s[8:11], s83 offen offset:2048 sc1 lds
    buffer_load_dwordx4 v8, s[8:11], s83 offen offset:3072 sc1 lds
    s_add_u32 m0, s81, 57344
    s_add_u32 s83, s83, 4096
    buffer_load_dwordx4 v8, s[8:11], s83 offen offset:0 sc1 lds
    buffer_load_dwordx4 v8, s[8:11], s83 offen offset:1024 sc1 lds
    buffer_load_dwordx4 v8, s[8:11], s83 offen offset:2048 sc1 lds
    buffer_load_dwordx4 v8, s[8:11], s83 offen offset:3072 sc1 lds
    s_waitcnt vmcnt(0)
L_op_b3:
    s_mul_i32 s75, s80, 327680
    s_add_u32 s75, s75, 44040192
    s_add_u32 s75, s75, s78
    s_barrier
    ds_read_b128 v[64:67], v7 offset:16384
    ds_read_b128 v[68:71], v7 offset:16640
    ds_read_b128 v[72:75], v7 offset:18432
    ds_read_b128 v[76:79], v7 offset:18688
    ds_read_b128 v[80:83], v7 offset:20480
    ds_read_b128 v[84:87], v7 offset:20736
    s_waitcnt lgkmcnt(5)
    v_mfma_f32_16x16x32_bf16 v[16:19], a[0:3], v[64:67], 0
    ds_read_b128 v[88:91], v7 offset:22528
    v_mfma_f32_16x16x32_bf16 v[24:27], a[96:99], v[64:67], 0
    s_waitcnt lgkmcnt(5)
    v_mfma_f32_16x16x32_bf16 v[20:23], a[0:3], v[68:71], 0
    ds_read_b128 v[92:95], v7 offset:22784
    v_mfma_f32_16x16x32_bf16 v[28:31], a[96:99], v[68:71], 0
    s_cmp_lg_u32 s4, 0
    s_cbranch_scc1 L_rel_45
    v_mov_b32 v6, s82
    s_mov_b64 exec, 1
    s_cmp_eq_u32 s7, 0
    s_cbranch_scc1 L_sl_46
    buffer_store_dword v6, off, s[8:11], s86
    s_branch L_sd_47
L_sl_46:
    buffer_store_dword v6, off, s[8:11], s86 sc1
L_sd_47:
    s_mov_b64 exec, -1
L_rel_45:
    s_waitcnt lgkmcnt(5)
    v_mfma_f32_16x16x32_bf16 v[16:19], a[4:7], v[72:75], v[16:19]
    ds_read_b128 v[64:67], v7 offset:24576
    v_mfma_f32_16x16x32_bf16 v[24:27], a[100:103], v[72:75], v[24:27]
    s_waitcnt lgkmcnt(5)
    v_mfma_f32_16x16x32_bf16 v[20:23], a[4:7], v[76:79], v[20:23]
    ds_read_b128 v[68:71], v7 offset:24832
    v_mfma_f32_16x16x32_bf16 v[28:31], a[100:103], v[76:79], v[28:31]
    s_waitcnt lgkmcnt(5)
    v_mfma_f32_16x16x32_bf16 v[16:19], a[8:11], v[80:83], v[16:19]
    ds_read_b128 v[72:75], v7 offset:26624
    v_mfma_f32_16x16x32_bf16 v[24:27], a[104:107], v[80:83], v[24:27]
    s_waitcnt lgkmcnt(5)
    v_mfma_f32_16x16x32_bf16 v[20:23], a[8:11], v[84:87], v[20:23]
    ds_read_b128 v[76:79], v7 offset:26880
    v_mfma_f32_16x16x32_bf16 v[28:31], a[104:107], v[84:87], v[28:31]
    s_waitcnt lgkmcnt(5)
    v_mfma_f32_16x16x32_bf16 v[16:19], a[12:15], v[88:91], v[16:19]
    ds_read_b128 v[80:83], v7 offset:28672
    v_mfma_f32_16x16x32_bf16 v[24:27], a[108:111], v[88:91], v[24:27]
    buffer_load_dword v4, v5, s[8:11], s76 offen sc1
    s_waitcnt lgkmcnt(5)
    v_mfma_f32_16x16x32_bf16 v[20:23], a[12:15], v[92:95], v[20:23]
    ds_read_b128 v[84:87], v7 offset:28928
    v_mfma_f32_16x16x32_bf16 v[28:31], a[108:111], v[92:95], v[28:31]
    s_waitcnt lgkmcnt(5)
    v_mfma_f32_16x16x32_bf16 v[16:19], a[16:19], v[64:67], v[16:19]
    ds_read_b128 v[88:91], v7 offset:30720
    v_mfma_f32_16x16x32_bf16 v[24:27], a[112:115], v[64:67], v[24:27]
    s_waitcnt lgkmcnt(5)
    v_mfma_f32_16x16x32_bf16 v[20:23], a[16:19], v[68:71], v[20:23]
    ds_read_b128 v[92:95], v7 offset:30976
    v_mfma_f32_16x16x32_bf16 v[28:31], a[112:115], v[68:71], v[28:31]
    s_waitcnt lgkmcnt(5)
    v_mfma_f32_16x16x32_bf16 v[16:19], a[20:23], v[72:75], v[16:19]
    ds_read_b128 v[64:67], v7 offset:32768
    v_mfma_f32_16x16x32_bf16 v[24:27], a[116:119], v[72:75], v[24:27]
    s_waitcnt lgkmcnt(5)
    v_mfma_f32_16x16x32_bf16 v[20:23], a[20:23], v[76:79], v[20:23]
    ds_read_b128 v[68:71], v7 offset:33024
    v_mfma_f32_16x16x32_bf16 v[28:31], a[116:119], v[76:79], v[28:31]
    s_waitcnt lgkmcnt(5)
    v_mfma_f32_16x16x32_bf16 v[16:19], a[24:27], v[80:83], v[16:19]
    ds_read_b128 v[72:75], v7 offset:34816
    v_mfma_f32_16x16x32_bf16 v[24:27], a[120:123], v[80:83], v[24:27]
    s_waitcnt lgkmcnt(5)
    v_mfma_f32_16x16x32_bf16 v[20:23], a[24:27], v[84:87], v[20:23]
    ds_read_b128 v[76:79], v7 offset:35072
    v_mfma_f32_16x16x32_bf16 v[28:31], a[120:123], v[84:87], v[28:31]
    s_waitcnt lgkmcnt(5)
    v_mfma_f32_16x16x32_bf16 v[16:19], a[28:31], v[88:91], v[16:19]
    ds_read_b128 v[80:83], v7 offset:36864
    v_mfma_f32_16x16x32_bf16 v[24:27], a[124:127], v[88:91], v[24:27]
    s_waitcnt vmcnt(0)
    s_add_u32 s89, s73, 1
    v_cmp_gt_u32 vcc, s89, v4
    s_cmp_eq_u64 vcc, 0
    s_cselect_b32 s88, 1, 0
    s_and_b32 s74, s73, 3
    s_mul_i32 s74, s74, 147456
    s_add_u32 s74, s74, s77
    s_cmp_eq_u32 s84, 0
    s_cbranch_scc1 L_op_b4
    v_mov_b32 v6, 1
    v_mov_b32 v11, 110592
    s_mov_b64 exec, 1
    ds_add_rtn_u32 v6, v11, v6
    s_waitcnt lgkmcnt(0)
    v_readfirstlane_b32 s60, v6
    v_mov_b32 v6, s73
    s_and_b32 s60, s60, 3
    s_cmp_lg_u32 s60, 3
    s_cbranch_scc1 L_nl_48
    buffer_store_dword v6, off, s[8:11], s71 sc1
L_nl_48:
    s_mov_b64 exec, -1
L_op_b4:
    s_cmp_eq_u32 s88, 0
    s_cbranch_scc1 L_op_y1
    s_waitcnt lgkmcnt(5)
    v_mfma_f32_16x16x32_bf16 v[20:23], a[28:31], v[92:95], v[20:23]
    ds_read_b128 v[84:87], v7 offset:37120
    v_mfma_f32_16x16x32_bf16 v[28:31], a[124:127], v[92:95], v[28:31]
    s_add_u32 m0, s81, 0
    s_nop 0
    buffer_load_dwordx4 v8, s[8:11], s74 offen offset:0 sc1 lds
    s_waitcnt lgkmcnt(5)
    v_mfma_f32_16x16x32_bf16 v[16:19], a[32:35], v[64:67], v[16:19]
    ds_read_b128 v[88:91], v7 offset:38912
    v_mfma_f32_16x16x32_bf16 v[24:27], a[128:131], v[64:67], v[24:27]
    s_waitcnt lgkmcnt(5)
    v_mfma_f32_16x16x32_bf16 v[20:23], a[32:35], v[68:71], v[20:23]
    ds_read_b128 v[92:95], v7 offset:39168
    v_mfma_f32_16x16x32_bf16 v[28:31], a[128:131], v[68:71], v[28:31]
    buffer_load_dwordx4 v8, s[8:11], s74 offen offset:1024 sc1 lds
    s_waitcnt lgkmcnt(5)
    v_mfma_f32_16x16x32_bf16 v[16:19], a[36:39], v[72:75], v[16:19]
    ds_read_b128 v[64:67], v7 offset:40960
    v_mfma_f32_16x16x32_bf16 v[24:27], a[132:135], v[72:75], v[24:27]
    s_waitcnt lgkmcnt(5)
    v_mfma_f32_16x16x32_bf16 v[20:23], a[36:39], v[76:79], v[20:23]
    ds_read_b128 v[68:71], v7 offset:41216
    v_mfma_f32_16x16x32_bf16 v[28:31], a[132:135], v[76:79], v[28:31]
    buffer_load_dwordx4 v8, s[8:11], s74 offen offset:2048 sc1 lds
    s_waitcnt lgkmcnt(5)
    v_mfma_f32_16x16x32_bf16 v[16:19], a[40:43], v[80:83], v[16:19]
    ds_read_b128 v[72:75], v7 offset:43008
    v_mfma_f32_16x16x32_bf16 v[24:27], a[136:139], v[80:83], v[24:27]
    s_waitcnt lgkmcnt(5)
    v_mfma_f32_16x16x32_bf16 v[20:23], a[40:43], v[84:87], v[20:23]
    ds_read_b128 v[76:79], v7 offset:43264
    v_mfma_f32_16x16x32_bf16 v[28:31], a[136:139], v[84:87], v[28:31]
    buffer_load_dwordx4 v8, s[8:11], s74 offen offset:3072 sc1 lds
    s_waitcnt lgkmcnt(5)
    v_mfma_f32_16x16x32_bf16 v[16:19], a[44:47], v[88:91], v[16:19]
    ds_read_b128 v[80:83], v7 offset:45056
    v_mfma_f32_16x16x32_bf16 v[24:27], a[140:143], v[88:91], v[24:27]
    s_waitcnt lgkmcnt(5)
    v_mfma_f32_16x16x32_bf16 v[20:23], a[44:47], v[92:95], v[20:23]
    ds_read_b128 v[84:87], v7 offset:45312
    v_mfma_f32_16x16x32_bf16 v[28:31], a[140:143], v[92:95], v[28:31]
    s_add_u32 m0, s81, 4096
    s_add_u32 s74, s74, 4096
    buffer_load_dwordx4 v8, s[8:11], s74 offen offset:0 sc1 lds
    s_waitcnt lgkmcnt(5)
    v_mfma_f32_16x16x32_bf16 v[16:19], a[48:51], v[64:67], v[16:19]
    ds_read_b128 v[88:91], v7 offset:47104
    v_mfma_f32_16x16x32_bf16 v[24:27], a[144:147], v[64:67], v[24:27]
    s_waitcnt lgkmcnt(5)
    v_mfma_f32_16x16x32_bf16 v[20:23], a[48:51], v[68:71], v[20:23]
    ds_read_b128 v[92:95], v7 offset:47360
    v_mfma_f32_16x16x32_bf16 v[28:31], a[144:147], v[68:71], v[28:31]
    buffer_load_dwordx4 v8, s[8:11], s74 offen offset:1024 sc1 lds
    s_waitcnt lgkmcnt(5)
    v_mfma_f32_16x16x32_bf16 v[16:19], a[52:55], v[72:75], v[16:19]
    ds_read_b128 v[64:67], v7 offset:49152
    v_mfma_f32_16x16x32_bf16 v[24:27], a[148:151], v[72:75], v[24:27]
    s_waitcnt lgkmcnt(5)
    v_mfma_f32_16x16x32_bf16 v[20:23], a[52:55], v[76:79], v[20:23]
    ds_read_b128 v[68:71], v7 offset:49408
    v_mfma_f32_16x16x32_bf16 v[28:31], a[148:151], v[76:79], v[28:31]
    buffer_load_dwordx4 v8, s[8:11], s74 offen offset:2048 sc1 lds
    s_waitcnt lgkmcnt(5)
    v_mfma_f32_16x16x32_bf16 v[16:19], a[56:59], v[80:83], v[16:19]
    ds_read_b128 v[72:75], v7 offset:51200
    v_mfma_f32_16x16x32_bf16 v[24:27], a[152:155], v[80:83], v[24:27]
    s_waitcnt lgkmcnt(5)
    v_mfma_f32_16x16x32_bf16 v[20:23], a[56:59], v[84:87], v[20:23]
    ds_read_b128 v[76:79], v7 offset:51456
    v_mfma_f32_16x16x32_bf16 v[28:31], a[152:155], v[84:87], v[28:31]
    buffer_load_dwordx4 v8, s[8:11], s74 offen offset:3072 sc1 lds
    s_waitcnt lgkmcnt(5)
    v_mfma_f32_16x16x32_bf16 v[16:19], a[60:63], v[88:91], v[16:19]
    ds_read_b128 v[80:83], v7 offset:53248
    v_mfma_f32_16x16x32_bf16 v[24:27], a[156:159], v[88:91], v[24:27]
    s_waitcnt lgkmcnt(5)
    v_mfma_f32_16x16x32_bf16 v[20:23], a[60:63], v[92:95], v[20:23]
    ds_read_b128 v[84:87], v7 offset:53504
    v_mfma_f32_16x16x32_bf16 v[28:31], a[156:159], v[92:95], v[28:31]
    s_add_u32 m0, s81, 8192
    s_add_u32 s74, s74, 4096
    buffer_load_dwordx4 v8, s[8:11], s74 offen offset:0 sc1 lds
    s_waitcnt lgkmcnt(5)
    v_mfma_f32_16x16x32_bf16 v[16:19], a[64:67], v[64:67], v[16:19]
    ds_read_b128 v[88:91], v7 offset:55296
    v_mfma_f32_16x16x32_bf16 v[24:27], a[160:163], v[64:67], v[24:27]
    s_waitcnt lgkmcnt(5)
    v_mfma_f32_16x16x32_bf16 v[20:23], a[64:67], v[68:71], v[20:23]
    ds_read_b128 v[92:95], v7 offset:55552
    v_mfma_f32_16x16x32_bf16 v[28:31], a[160:163], v[68:71], v[28:31]
    buffer_load_dwordx4 v8, s[8:11], s74 offen offset:1024 sc1 lds
    s_waitcnt lgkmcnt(5)
    v_mfma_f32_16x16x32_bf16 v[16:19], a[68:71], v[72:75], v[16:19]
    ds_read_b128 v[64:67], v7 offset:57344
    v_mfma_f32_16x16x32_bf16 v[24:27], a[164:167], v[72:75], v[24:27]
    s_waitcnt lgkmcnt(5)
    v_mfma_f32_16x16x32_bf16 v[20:23], a[68:71], v[76:79], v[20:23]
    ds_read_b128 v[68:71], v7 offset:57600
    v_mfma_f32_16x16x32_bf16 v[28:31], a[164:167], v[76:79], v[28:31]
    buffer_load_dwordx4 v8, s[8:11], s74 offen offset:2048 sc1 lds
    s_waitcnt lgkmcnt(5)
    v_mfma_f32_16x16x32_bf16 v[16:19], a[72:75], v[80:83], v[16:19]
    ds_read_b128 v[72:75], v7 offset:59392
    v_mfma_f32_16x16x32_bf16 v[24:27], a[168:171], v[80:83], v[24:27]
    s_waitcnt lgkmcnt(5)
    v_mfma_f32_16x16x32_bf16 v[20:23], a[72:75], v[84:87], v[20:23]
    ds_read_b128 v[76:79], v7 offset:59648
    v_mfma_f32_16x16x32_bf16 v[28:31], a[168:171], v[84:87], v[28:31]
    buffer_load_dwordx4 v8, s[8:11], s74 offen offset:3072 sc1 lds
    s_waitcnt lgkmcnt(5)
    v_mfma_f32_16x16x32_bf16 v[16:19], a[76:79], v[88:91], v[16:19]
    ds_read_b128 v[80:83], v7 offset:61440
    v_mfma_f32_16x16x32_bf16 v[24:27], a[172:175], v[88:91], v[24:27]
    s_waitcnt lgkmcnt(5)
    v_mfma_f32_16x16x32_bf16 v[20:23], a[76:79], v[92:95], v[20:23]
    ds_read_b128 v[84:87], v7 offset:61696
    v_mfma_f32_16x16x32_bf16 v[28:31], a[172:175], v[92:95], v[28:31]
    s_waitcnt lgkmcnt(5)
    v_mfma_f32_16x16x32_bf16 v[16:19], a[80:83], v[64:67], v[16:19]
    ds_read_b128 v[88:91], v7 offset:63488
    v_mfma_f32_16x16x32_bf16 v[24:27], a[176:179], v[64:67], v[24:27]
    s_waitcnt lgkmcnt(5)
    v_mfma_f32_16x16x32_bf16 v[20:23], a[80:83], v[68:71], v[20:23]
    ds_read_b128 v[92:95], v7 offset:63744
    v_mfma_f32_16x16x32_bf16 v[28:31], a[176:179], v[68:71], v[28:31]
    s_waitcnt lgkmcnt(5)
    v_mfma_f32_16x16x32_bf16 v[16:19], a[84:87], v[72:75], v[16:19]
    v_mfma_f32_16x16x32_bf16 v[24:27], a[180:183], v[72:75], v[24:27]
    s_waitcnt lgkmcnt(4)
    v_mfma_f32_16x16x32_bf16 v[20:23], a[84:87], v[76:79], v[20:23]
    v_mfma_f32_16x16x32_bf16 v[28:31], a[180:183], v[76:79], v[28:31]
    s_waitcnt lgkmcnt(3)
    v_mfma_f32_16x16x32_bf16 v[16:19], a[88:91], v[80:83], v[16:19]
    v_mfma_f32_16x16x32_bf16 v[24:27], a[184:187], v[80:83], v[24:27]
    s_waitcnt lgkmcnt(2)
    v_mfma_f32_16x16x32_bf16 v[20:23], a[88:91], v[84:87], v[20:23]
    v_mfma_f32_16x16x32_bf16 v[28:31], a[184:187], v[84:87], v[28:31]
    s_waitcnt lgkmcnt(1)
    v_mfma_f32_16x16x32_bf16 v[16:19], a[92:95], v[88:91], v[16:19]
    v_mfma_f32_16x16x32_bf16 v[24:27], a[188:191], v[88:91], v[24:27]
    s_waitcnt lgkmcnt(0)
    v_mfma_f32_16x16x32_bf16 v[20:23], a[92:95], v[92:95], v[20:23]
    v_mfma_f32_16x16x32_bf16 v[28:31], a[188:191], v[92:95], v[28:31]
    s_nop 3
    v_cvt_pk_bf16_f32 v32, v16, v17
    v_cvt_pk_bf16_f32 v33, v18, v19
    s_nop 0
    v_cvt_pk_bf16_f32 v34, v20, v21
    v_cvt_pk_bf16_f32 v35, v22, v23
    v_cvt_pk_bf16_f32 v36, v24, v25
    v_cvt_pk_bf16_f32 v37, v26, v27
    v_cvt_pk_bf16_f32 v38, v28, v29
    v_cvt_pk_bf16_f32 v39, v30, v31
    ds_write_b64 v9, v[32:33] offset:0
    ds_write_b64 v9, v[34:35] offset:1280
    ds_write_b64 v9, v[36:37] offset:32
    ds_write_b64 v9, v[38:39] offset:1312
    s_waitcnt lgkmcnt(0)
    ds_read_b128 v[40:43], v10
    ds_read_b128 v[44:47], v10 offset:1280
    s_waitcnt lgkmcnt(1)
    buffer_store_dwordx4 v[40:43], v12, s[8:11], s75 offen offset:0 sc1
    s_waitcnt lgkmcnt(0)
    buffer_store_dwordx4 v[44:47], v13, s[8:11], s75 offen offset:0 sc1
    s_branch L_op_y2
L_op_y1:
    s_waitcnt lgkmcnt(5)
    v_mfma_f32_16x16x32_bf16 v[20:23], a[28:31], v[92:95], v[20:23]
    ds_read_b128 v[84:87], v7 offset:37120
    v_mfma_f32_16x16x32_bf16 v[28:31], a[124:127], v[92:95], v[28:31]
    s_waitcnt lgkmcnt(5)
    v_mfma_f32_16x16x32_bf16 v[16:19], a[32:35], v[64:67], v[16:19]
    ds_read_b128 v[88:91], v7 offset:38912
    v_mfma_f32_16x16x32_bf16 v[24:27], a[128:131], v[64:67], v[24:27]
    s_waitcnt lgkmcnt(5)
    v_mfma_f32_16x16x32_bf16 v[20:23], a[32:35], v[68:71], v[20:23]
    ds_read_b128 v[92:95], v7 offset:39168
    v_mfma_f32_16x16x32_bf16 v[28:31], a[128:131], v[68:71], v[28:31]
    s_waitcnt lgkmcnt(5)
    v_mfma_f32_16x16x32_bf16 v[16:19], a[36:39], v[72:75], v[16:19]
    ds_read_b128 v[64:67], v7 offset:40960
    v_mfma_f32_16x16x32_bf16 v[24:27], a[132:135], v[72:75], v[24:27]
    s_waitcnt lgkmcnt(5)
    v_mfma_f32_16x16x32_bf16 v[20:23], a[36:39], v[76:79], v[20:23]
    ds_read_b128 v[68:71], v7 offset:41216
    v_mfma_f32_16x16x32_bf16 v[28:31], a[132:135], v[76:79], v[28:31]
    s_waitcnt lgkmcnt(5)
    v_mfma_f32_16x16x32_bf16 v[16:19], a[40:43], v[80:83], v[16:19]
    ds_read_b128 v[72:75], v7 offset:43008
    v_mfma_f32_16x16x32_bf16 v[24:27], a[136:139], v[80:83], v[24:27]
    s_waitcnt lgkmcnt(5)
    v_mfma_f32_16x16x32_bf16 v[20:23], a[40:43], v[84:87], v[20:23]
    ds_read_b128 v[76:79], v7 offset:43264
    v_mfma_f32_16x16x32_bf16 v[28:31], a[136:139], v[84:87], v[28:31]
    s_waitcnt lgkmcnt(5)
    v_mfma_f32_16x16x32_bf16 v[16:19], a[44:47], v[88:91], v[16:19]
    ds_read_b128 v[80:83], v7 offset:45056
    v_mfma_f32_16x16x32_bf16 v[24:27], a[140:143], v[88:91], v[24:27]
    s_waitcnt lgkmcnt(5)
    v_mfma_f32_16x16x32_bf16 v[20:23], a[44:47], v[92:95], v[20:23]
    ds_read_b128 v[84:87], v7 offset:45312
    v_mfma_f32_16x16x32_bf16 v[28:31], a[140:143], v[92:95], v[28:31]
    s_waitcnt lgkmcnt(5)
    v_mfma_f32_16x16x32_bf16 v[16:19], a[48:51], v[64:67], v[16:19]
    ds_read_b128 v[88:91], v7 offset:47104
    v_mfma_f32_16x16x32_bf16 v[24:27], a[144:147], v[64:67], v[24:27]
    s_waitcnt lgkmcnt(5)
    v_mfma_f32_16x16x32_bf16 v[20:23], a[48:51], v[68:71], v[20:23]
    ds_read_b128 v[92:95], v7 offset:47360
    v_mfma_f32_16x16x32_bf16 v[28:31], a[144:147], v[68:71], v[28:31]
    s_waitcnt lgkmcnt(5)
    v_mfma_f32_16x16x32_bf16 v[16:19], a[52:55], v[72:75], v[16:19]
    ds_read_b128 v[64:67], v7 offset:49152
    v_mfma_f32_16x16x32_bf16 v[24:27], a[148:151], v[72:75], v[24:27]
    s_waitcnt lgkmcnt(5)
    v_mfma_f32_16x16x32_bf16 v[20:23], a[52:55], v[76:79], v[20:23]
    ds_read_b128 v[68:71], v7 offset:49408
    v_mfma_f32_16x16x32_bf16 v[28:31], a[148:151], v[76:79], v[28:31]
    s_waitcnt lgkmcnt(5)
    v_mfma_f32_16x16x32_bf16 v[16:19], a[56:59], v[80:83], v[16:19]
    ds_read_b128 v[72:75], v7 offset:51200
    v_mfma_f32_16x16x32_bf16 v[24:27], a[152:155], v[80:83], v[24:27]
    s_waitcnt lgkmcnt(5)
    v_mfma_f32_16x16x32_bf16 v[20:23], a[56:59], v[84:87], v[20:23]
    ds_read_b128 v[76:79], v7 offset:51456
    v_mfma_f32_16x16x32_bf16 v[28:31], a[152:155], v[84:87], v[28:31]
    s_waitcnt lgkmcnt(5)
    v_mfma_f32_16x16x32_bf16 v[16:19], a[60:63], v[88:91], v[16:19]
    ds_read_b128 v[80:83], v7 offset:53248
    v_mfma_f32_16x16x32_bf16 v[24:27], a[156:159], v[88:91], v[24:27]
    s_waitcnt lgkmcnt(5)
    v_mfma_f32_16x16x32_bf16 v[20:23], a[60:63], v[92:95], v[20:23]
    ds_read_b128 v[84:87], v7 offset:53504
    v_mfma_f32_16x16x32_bf16 v[28:31], a[156:159], v[92:95], v[28:31]
    s_waitcnt lgkmcnt(5)
    v_mfma_f32_16x16x32_bf16 v[16:19], a[64:67], v[64:67], v[16:19]
    ds_read_b128 v[88:91], v7 offset:55296
    v_mfma_f32_16x16x32_bf16 v[24:27], a[160:163], v[64:67], v[24:27]
    s_waitcnt lgkmcnt(5)
    v_mfma_f32_16x16x32_bf16 v[20:23], a[64:67], v[68:71], v[20:23]
    ds_read_b128 v[92:95], v7 offset:55552
    v_mfma_f32_16x16x32_bf16 v[28:31], a[160:163], v[68:71], v[28:31]
    s_waitcnt lgkmcnt(5)
    v_mfma_f32_16x16x32_bf16 v[16:19], a[68:71], v[72:75], v[16:19]
    ds_read_b128 v[64:67], v7 offset:57344
    v_mfma_f32_16x16x32_bf16 v[24:27], a[164:167], v[72:75], v[24:27]
    s_waitcnt lgkmcnt(5)
    v_mfma_f32_16x16x32_bf16 v[20:23], a[68:71], v[76:79], v[20:23]
    ds_read_b128 v[68:71], v7 offset:57600
    v_mfma_f32_16x16x32_bf16 v[28:31], a[164:167], v[76:79], v[28:31]
    s_waitcnt lgkmcnt(5)
    v_mfma_f32_16x16x32_bf16 v[16:19], a[72:75], v[80:83], v[16:19]
    ds_read_b128 v[72:75], v7 offset:59392
    v_mfma_f32_16x16x32_bf16 v[24:27], a[168:171], v[80:83], v[24:27]
    s_waitcnt lgkmcnt(5)
    v_mfma_f32_16x16x32_bf16 v[20:23], a[72:75], v[84:87], v[20:23]
    ds_read_b128 v[76:79], v7 offset:59648
    v_mfma_f32_16x16x32_bf16 v[28:31], a[168:171], v[84:87], v[28:31]
    s_waitcnt lgkmcnt(5)
    v_mfma_f32_16x16x32_bf16 v[16:19], a[76:79], v[88:91], v[16:19]
    ds_read_b128 v[80:83], v7 offset:61440
    v_mfma_f32_16x16x32_bf16 v[24:27], a[172:175], v[88:91], v[24:27]
    s_waitcnt lgkmcnt(5)
    v_mfma_f32_16x16x32_bf16 v[20:23], a[76:79], v[92:95], v[20:23]
    ds_read_b128 v[84:87], v7 offset:61696
    v_mfma_f32_16x16x32_bf16 v[28:31], a[172:175], v[92:95], v[28:31]
    s_waitcnt lgkmcnt(5)
    v_mfma_f32_16x16x32_bf16 v[16:19], a[80:83], v[64:67], v[16:19]
    ds_read_b128 v[88:91], v7 offset:63488
    v_mfma_f32_16x16x32_bf16 v[24:27], a[176:179], v[64:67], v[24:27]
    s_waitcnt lgkmcnt(5)
    v_mfma_f32_16x16x32_bf16 v[20:23], a[80:83], v[68:71], v[20:23]
    ds_read_b128 v[92:95], v7 offset:63744
    v_mfma_f32_16x16x32_bf16 v[28:31], a[176:179], v[68:71], v[28:31]
    s_waitcnt lgkmcnt(5)
    v_mfma_f32_16x16x32_bf16 v[16:19], a[84:87], v[72:75], v[16:19]
    v_mfma_f32_16x16x32_bf16 v[24:27], a[180:183], v[72:75], v[24:27]
    s_waitcnt lgkmcnt(4)
    v_mfma_f32_16x16x32_bf16 v[20:23], a[84:87], v[76:79], v[20:23]
    v_mfma_f32_16x16x32_bf16 v[28:31], a[180:183], v[76:79], v[28:31]
    s_waitcnt lgkmcnt(3)
    v_mfma_f32_16x16x32_bf16 v[16:19], a[88:91], v[80:83], v[16:19]
    v_mfma_f32_16x16x32_bf16 v[24:27], a[184:187], v[80:83], v[24:27]
    s_waitcnt lgkmcnt(2)
    v_mfma_f32_16x16x32_bf16 v[20:23], a[88:91], v[84:87], v[20:23]
    v_mfma_f32_16x16x32_bf16 v[28:31], a[184:187], v[84:87], v[28:31]
    s_waitcnt lgkmcnt(1)
    v_mfma_f32_16x16x32_bf16 v[16:19], a[92:95], v[88:91], v[16:19]
    v_mfma_f32_16x16x32_bf16 v[24:27], a[188:191], v[88:91], v[24:27]
    s_waitcnt lgkmcnt(0)
    v_mfma_f32_16x16x32_bf16 v[20:23], a[92:95], v[92:95], v[20:23]
    v_mfma_f32_16x16x32_bf16 v[28:31], a[188:191], v[92:95], v[28:31]
    s_nop 3
    v_cvt_pk_bf16_f32 v32, v16, v17
    v_cvt_pk_bf16_f32 v33, v18, v19
    s_nop 0
    v_cvt_pk_bf16_f32 v34, v20, v21
    v_cvt_pk_bf16_f32 v35, v22, v23
    v_cvt_pk_bf16_f32 v36, v24, v25
    v_cvt_pk_bf16_f32 v37, v26, v27
    v_cvt_pk_bf16_f32 v38, v28, v29
    v_cvt_pk_bf16_f32 v39, v30, v31
    ds_write_b64 v9, v[32:33] offset:0
    ds_write_b64 v9, v[34:35] offset:1280
    ds_write_b64 v9, v[36:37] offset:32
    ds_write_b64 v9, v[38:39] offset:1312
    s_waitcnt lgkmcnt(0)
    ds_read_b128 v[40:43], v10
    ds_read_b128 v[44:47], v10 offset:1280
    s_waitcnt lgkmcnt(1)
    buffer_store_dwordx4 v[40:43], v12, s[8:11], s75 offen offset:0 sc1
    s_waitcnt lgkmcnt(0)
    buffer_store_dwordx4 v[44:47], v13, s[8:11], s75 offen offset:0 sc1
L_op_y2:
    s_mov_b32 s87, 1
    s_mov_b32 s79, s73
    s_mov_b32 s80, s82
    s_cmp_lt_u32 s79, 64
    s_cbranch_scc1 L_op_b
    s_waitcnt vmcnt(0)
    v_mov_b32 v6, 1
    v_mov_b32 v11, 110596
    s_mov_b64 exec, 1
    ds_add_rtn_u32 v6, v11, v6
    s_waitcnt lgkmcnt(0)
    v_readfirstlane_b32 s60, v6
    v_mov_b32 v6, s80
    s_and_b32 s60, s60, 3
    s_cmp_lg_u32 s60, 3
    s_cbranch_scc1 L_nl_49
    buffer_store_dword v6, off, s[8:11], s72 sc1
L_nl_49:
    s_mov_b64 exec, -1
    s_barrier
    s_mov_b32 s79, 57
L_op_c:
    s_add_u32 s73, s79, 1
L_poll_50:
    buffer_load_dword v4, v5, s[8:11], s76 offen offset:1024 sc1
    s_waitcnt vmcnt(0)
    v_cmp_gt_u32 vcc, s73, v4
    s_cbranch_vccz L_pok_51
    s_sleep 1
    s_sub_u32 s6, s6, 1
    s_cbranch_scc0 L_poll_50
    s_branch L_fail
L_pok_51:
    s_and_b32 s74, s79, 3
    s_mul_i32 s74, s74, 147456
    s_add_u32 s74, s74, s77
    s_add_u32 s74, s74, 589824
    s_add_u32 m0, s81, 49152
    s_nop 0
    buffer_load_dwordx4 v8, s[8:11], s74 offen offset:0 sc1 lds
    buffer_load_dwordx4 v8, s[8:11], s74 offen offset:1024 sc1 lds
    buffer_load_dwordx4 v8, s[8:11], s74 offen offset:2048 sc1 lds
    buffer_load_dwordx4 v8, s[8:11], s74 offen offset:3072 sc1 lds
    s_add_u32 m0, s81, 53248
    s_add_u32 s74, s74, 4096
    buffer_load_dwordx4 v8, s[8:11], s74 offen offset:0 sc1 lds
    buffer_load_dwordx4 v8, s[8:11], s74 offen offset:1024 sc1 lds
    buffer_load_dwordx4 v8, s[8:11], s74 offen offset:2048 sc1 lds
    buffer_load_dwordx4 v8, s[8:11], s74 offen offset:3072 sc1 lds
    s_add_u32 m0, s81, 57344
    s_add_u32 s74, s74, 4096
    buffer_load_dwordx4 v8, s[8:11], s74 offen offset:0 sc1 lds
    buffer_load_dwordx4 v8, s[8:11], s74 offen offset:1024 sc1 lds
    buffer_load_dwordx4 v8, s[8:11], s74 offen offset:2048 sc1 lds
    buffer_load_dwordx4 v8, s[8:11], s74 offen offset:3072 sc1 lds
    s_mul_i32 s75, s79, 327680
    s_add_u32 s75, s75, 44040192
    s_add_u32 s75, s75, s78
    s_waitcnt vmcnt(0)
    s_barrier
    ds_read_b128 v[64:67], v7 offset:16384
    ds_read_b128 v[68:71], v7 offset:16640
    ds_read_b128 v[72:75], v7 offset:18432
    ds_read_b128 v[76:79], v7 offset:18688
    ds_read_b128 v[80:83], v7 offset:20480
    ds_read_b128 v[84:87], v7 offset:20736
    s_waitcnt lgkmcnt(5)
    v_mfma_f32_16x16x32_bf16 v[16:19], a[0:3], v[64:67], 0
    ds_read_b128 v[88:91], v7 offset:22528
    v_mfma_f32_16x16x32_bf16 v[24:27], a[96:99], v[64:67], 0
    s_waitcnt lgkmcnt(5)
    v_mfma_f32_16x16x32_bf16 v[20:23], a[0:3], v[68:71], 0
    ds_read_b128 v[92:95], v7 offset:22784
    v_mfma_f32_16x16x32_bf16 v[28:31], a[96:99], v[68:71], 0
    s_cmp_lg_u32 s4, 0
    s_cbranch_scc1 L_rel_52
    v_mov_b32 v6, s73
    s_mov_b64 exec, 1
    s_cmp_eq_u32 s7, 0
    s_cbranch_scc1 L_sl_53
    buffer_store_dword v6, off, s[8:11], s86
    s_branch L_sd_54
L_sl_53:
    buffer_store_dword v6, off, s[8:11], s86 sc1
L_sd_54:
    s_mov_b64 exec, -1
L_rel_52:
    s_waitcnt lgkmcnt(5)
    v_mfma_f32_16x16x32_bf16 v[16:19], a[4:7], v[72:75], v[16:19]
    ds_read_b128 v[64:67], v7 offset:24576
    v_mfma_f32_16x16x32_bf16 v[24:27], a[100:103], v[72:75], v[24:27]
    s_waitcnt lgkmcnt(5)
    v_mfma_f32_16x16x32_bf16 v[20:23], a[4:7], v[76:79], v[20:23]
    ds_read_b128 v[68:71], v7 offset:24832
    v_mfma_f32_16x16x32_bf16 v[28:31], a[100:103], v[76:79], v[28:31]
    s_waitcnt lgkmcnt(5)
    v_mfma_f32_16x16x32_bf16 v[16:19], a[8:11], v[80:83], v[16:19]
    ds_read_b128 v[72:75], v7 offset:26624
    v_mfma_f32_16x16x32_bf16 v[24:27], a[104:107], v[80:83], v[24:27]
    s_waitcnt lgkmcnt(5)
    v_mfma_f32_16x16x32_bf16 v[20:23], a[8:11], v[84:87], v[20:23]
    ds_read_b128 v[76:79], v7 offset:26880
    v_mfma_f32_16x16x32_bf16 v[28:31], a[104:107], v[84:87], v[28:31]
    s_waitcnt lgkmcnt(5)
    v_mfma_f32_16x16x32_bf16 v[16:19], a[12:15], v[88:91], v[16:19]
    ds_read_b128 v[80:83], v7 offset:28672
    v_mfma_f32_16x16x32_bf16 v[24:27], a[108:111], v[88:91], v[24:27]
    s_waitcnt lgkmcnt(5)
    v_mfma_f32_16x16x32_bf16 v[20:23], a[12:15], v[92:95], v[20:23]
    ds_read_b128 v[84:87], v7 offset:28928
    v_mfma_f32_16x16x32_bf16 v[28:31], a[108:111], v[92:95], v[28:31]
    s_waitcnt lgkmcnt(5)
    v_mfma_f32_16x16x32_bf16 v[16:19], a[16:19], v[64:67], v[16:19]
    ds_read_b128 v[88:91], v7 offset:30720
    v_mfma_f32_16x16x32_bf16 v[24:27], a[112:115], v[64:67], v[24:27]
    s_waitcnt lgkmcnt(5)
    v_mfma_f32_16x16x32_bf16 v[20:23], a[16:19], v[68:71], v[20:23]
    ds_read_b128 v[92:95], v7 offset:30976
    v_mfma_f32_16x16x32_bf16 v[28:31], a[112:115], v[68:71], v[28:31]
    s_waitcnt lgkmcnt(5)
    v_mfma_f32_16x16x32_bf16 v[16:19], a[20:23], v[72:75], v[16:19]
    ds_read_b128 v[64:67], v7 offset:32768
    v_mfma_f32_16x16x32_bf16 v[24:27], a[116:119], v[72:75], v[24:27]
    s_waitcnt lgkmcnt(5)
    v_mfma_f32_16x16x32_bf16 v[20:23], a[20:23], v[76:79], v[20:23]
    ds_read_b128 v[68:71], v7 offset:33024
    v_mfma_f32_16x16x32_bf16 v[28:31], a[116:119], v[76:79], v[28:31]
    s_waitcnt lgkmcnt(5)
    v_mfma_f32_16x16x32_bf16 v[16:19], a[24:27], v[80:83], v[16:19]
    ds_read_b128 v[72:75], v7 offset:34816
    v_mfma_f32_16x16x32_bf16 v[24:27], a[120:123], v[80:83], v[24:27]
    s_waitcnt lgkmcnt(5)
    v_mfma_f32_16x16x32_bf16 v[20:23], a[24:27], v[84:87], v[20:23]
    ds_read_b128 v[76:79], v7 offset:35072
    v_mfma_f32_16x16x32_bf16 v[28:31], a[120:123], v[84:87], v[28:31]
    s_waitcnt lgkmcnt(5)
    v_mfma_f32_16x16x32_bf16 v[16:19], a[28:31], v[88:91], v[16:19]
    ds_read_b128 v[80:83], v7 offset:36864
    v_mfma_f32_16x16x32_bf16 v[24:27], a[124:127], v[88:91], v[24:27]
    s_waitcnt lgkmcnt(5)
    v_mfma_f32_16x16x32_bf16 v[20:23], a[28:31], v[92:95], v[20:23]
    ds_read_b128 v[84:87], v7 offset:37120
    v_mfma_f32_16x16x32_bf16 v[28:31], a[124:127], v[92:95], v[28:31]
    s_waitcnt lgkmcnt(5)
    v_mfma_f32_16x16x32_bf16 v[16:19], a[32:35], v[64:67], v[16:19]
    ds_read_b128 v[88:91], v7 offset:38912
    v_mfma_f32_16x16x32_bf16 v[24:27], a[128:131], v[64:67], v[24:27]
    s_waitcnt lgkmcnt(5)
    v_mfma_f32_16x16x32_bf16 v[20:23], a[32:35], v[68:71], v[20:23]
    ds_read_b128 v[92:95], v7 offset:39168
    v_mfma_f32_16x16x32_bf16 v[28:31], a[128:131], v[68:71], v[28:31]
    s_waitcnt lgkmcnt(5)
    v_mfma_f32_16x16x32_bf16 v[16:19], a[36:39], v[72:75], v[16:19]
    ds_read_b128 v[64:67], v7 offset:40960
    v_mfma_f32_16x16x32_bf16 v[24:27], a[132:135], v[72:75], v[24:27]
    s_waitcnt lgkmcnt(5)
    v_mfma_f32_16x16x32_bf16 v[20:23], a[36:39], v[76:79], v[20:23]
    ds_read_b128 v[68:71], v7 offset:41216
    v_mfma_f32_16x16x32_bf16 v[28:31], a[132:135], v[76:79], v[28:31]
    s_waitcnt lgkmcnt(5)
    v_mfma_f32_16x16x32_bf16 v[16:19], a[40:43], v[80:83], v[16:19]
    ds_read_b128 v[72:75], v7 offset:43008
    v_mfma_f32_16x16x32_bf16 v[24:27], a[136:139], v[80:83], v[24:27]
    s_waitcnt lgkmcnt(5)
    v_mfma_f32_16x16x32_bf16 v[20:23], a[40:43], v[84:87], v[20:23]
    ds_read_b128 v[76:79], v7 offset:43264
    v_mfma_f32_16x16x32_bf16 v[28:31], a[136:139], v[84:87], v[28:31]
    s_waitcnt lgkmcnt(5)
    v_mfma_f32_16x16x32_bf16 v[16:19], a[44:47], v[88:91], v[16:19]
    ds_read_b128 v[80:83], v7 offset:45056
    v_mfma_f32_16x16x32_bf16 v[24:27], a[140:143], v[88:91], v[24:27]
    s_waitcnt lgkmcnt(5)
    v_mfma_f32_16x16x32_bf16 v[20:23], a[44:47], v[92:95], v[20:23]
    ds_read_b128 v[84:87], v7 offset:45312
    v_mfma_f32_16x16x32_bf16 v[28:31], a[140:143], v[92:95], v[28:31]
    s_waitcnt lgkmcnt(5)
    v_mfma_f32_16x16x32_bf16 v[16:19], a[48:51], v[64:67], v[16:19]
    ds_read_b128 v[88:91], v7 offset:47104
    v_mfma_f32_16x16x32_bf16 v[24:27], a[144:147], v[64:67], v[24:27]
    s_waitcnt lgkmcnt(5)
    v_mfma_f32_16x16x32_bf16 v[20:23], a[48:51], v[68:71], v[20:23]
    ds_read_b128 v[92:95], v7 offset:47360
    v_mfma_f32_16x16x32_bf16 v[28:31], a[144:147], v[68:71], v[28:31]
    s_waitcnt lgkmcnt(5)
    v_mfma_f32_16x16x32_bf16 v[16:19], a[52:55], v[72:75], v[16:19]
    ds_read_b128 v[64:67], v7 offset:49152
    v_mfma_f32_16x16x32_bf16 v[24:27], a[148:151], v[72:75], v[24:27]
    s_waitcnt lgkmcnt(5)
    v_mfma_f32_16x16x32_bf16 v[20:23], a[52:55], v[76:79], v[20:23]
    ds_read_b128 v[68:71], v7 offset:49408
    v_mfma_f32_16x16x32_bf16 v[28:31], a[148:151], v[76:79], v[28:31]
    s_waitcnt lgkmcnt(5)
    v_mfma_f32_16x16x32_bf16 v[16:19], a[56:59], v[80:83], v[16:19]
    ds_read_b128 v[72:75], v7 offset:51200
    v_mfma_f32_16x16x32_bf16 v[24:27], a[152:155], v[80:83], v[24:27]
    s_waitcnt lgkmcnt(5)
    v_mfma_f32_16x16x32_bf16 v[20:23], a[56:59], v[84:87], v[20:23]
    ds_read_b128 v[76:79], v7 offset:51456
    v_mfma_f32_16x16x32_bf16 v[28:31], a[152:155], v[84:87], v[28:31]
    s_waitcnt lgkmcnt(5)
    v_mfma_f32_16x16x32_bf16 v[16:19], a[60:63], v[88:91], v[16:19]
    ds_read_b128 v[80:83], v7 offset:53248
    v_mfma_f32_16x16x32_bf16 v[24:27], a[156:159], v[88:91], v[24:27]
    s_waitcnt lgkmcnt(5)
    v_mfma_f32_16x16x32_bf16 v[20:23], a[60:63], v[92:95], v[20:23]
    ds_read_b128 v[84:87], v7 offset:53504
    v_mfma_f32_16x16x32_bf16 v[28:31], a[156:159], v[92:95], v[28:31]
    s_waitcnt lgkmcnt(5)
    v_mfma_f32_16x16x32_bf16 v[16:19], a[64:67], v[64:67], v[16:19]
    ds_read_b128 v[88:91], v7 offset:55296
    v_mfma_f32_16x16x32_bf16 v[24:27], a[160:163], v[64:67], v[24:27]
    s_waitcnt lgkmcnt(5)
    v_mfma_f32_16x16x32_bf16 v[20:23], a[64:67], v[68:71], v[20:23]
    ds_read_b128 v[92:95], v7 offset:55552
    v_mfma_f32_16x16x32_bf16 v[28:31], a[160:163], v[68:71], v[28:31]
    s_waitcnt lgkmcnt(5)
    v_mfma_f32_16x16x32_bf16 v[16:19], a[68:71], v[72:75], v[16:19]
    ds_read_b128 v[64:67], v7 offset:57344
    v_mfma_f32_16x16x32_bf16 v[24:27], a[164:167], v[72:75], v[24:27]
    s_waitcnt lgkmcnt(5)
    v_mfma_f32_16x16x32_bf16 v[20:23], a[68:71], v[76:79], v[20:23]
    ds_read_b128 v[68:71], v7 offset:57600
    v_mfma_f32_16x16x32_bf16 v[28:31], a[164:167], v[76:79], v[28:31]
    s_waitcnt lgkmcnt(5)
    v_mfma_f32_16x16x32_bf16 v[16:19], a[72:75], v[80:83], v[16:19]
    ds_read_b128 v[72:75], v7 offset:59392
    v_mfma_f32_16x16x32_bf16 v[24:27], a[168:171], v[80:83], v[24:27]
    s_waitcnt lgkmcnt(5)
    v_mfma_f32_16x16x32_bf16 v[20:23], a[72:75], v[84:87], v[20:23]
    ds_read_b128 v[76:79], v7 offset:59648
    v_mfma_f32_16x16x32_bf16 v[28:31], a[168:171], v[84:87], v[28:31]
    s_waitcnt lgkmcnt(5)
    v_mfma_f32_16x16x32_bf16 v[16:19], a[76:79], v[88:91], v[16:19]
    ds_read_b128 v[80:83], v7 offset:61440
    v_mfma_f32_16x16x32_bf16 v[24:27], a[172:175], v[88:91], v[24:27]
    s_waitcnt lgkmcnt(5)
    v_mfma_f32_16x16x32_bf16 v[20:23], a[76:79], v[92:95], v[20:23]
    ds_read_b128 v[84:87], v7 offset:61696
    v_mfma_f32_16x16x32_bf16 v[28:31], a[172:175], v[92:95], v[28:31]
    s_waitcnt lgkmcnt(5)
    v_mfma_f32_16x16x32_bf16 v[16:19], a[80:83], v[64:67], v[16:19]
    ds_read_b128 v[88:91], v7 offset:63488
    v_mfma_f32_16x16x32_bf16 v[24:27], a[176:179], v[64:67], v[24:27]
    s_waitcnt lgkmcnt(5)
    v_mfma_f32_16x16x32_bf16 v[20:23], a[80:83], v[68:71], v[20:23]
    ds_read_b128 v[92:95], v7 offset:63744
    v_mfma_f32_16x16x32_bf16 v[28:31], a[176:179], v[68:71], v[28:31]
    s_waitcnt lgkmcnt(5)
    v_mfma_f32_16x16x32_bf16 v[16:19], a[84:87], v[72:75], v[16:19]
    v_mfma_f32_16x16x32_bf16 v[24:27], a[180:183], v[72:75], v[24:27]
    s_waitcnt lgkmcnt(4)
    v_mfma_f32_16x16x32_bf16 v[20:23], a[84:87], v[76:79], v[20:23]
    v_mfma_f32_16x16x32_bf16 v[28:31], a[180:183], v[76:79], v[28:31]
    s_waitcnt lgkmcnt(3)
    v_mfma_f32_16x16x32_bf16 v[16:19], a[88:91], v[80:83], v[16:19]
    v_mfma_f32_16x16x32_bf16 v[24:27], a[184:187], v[80:83], v[24:27]
    s_waitcnt lgkmcnt(2)
    v_mfma_f32_16x16x32_bf16 v[20:23], a[88:91], v[84:87], v[20:23]
    v_mfma_f32_16x16x32_bf16 v[28:31], a[184:187], v[84:87], v[28:31]
    s_waitcnt lgkmcnt(1)
    v_mfma_f32_16x16x32_bf16 v[16:19], a[92:95], v[88:91], v[16:19]
    v_mfma_f32_16x16x32_bf16 v[24:27], a[188:191], v[88:91], v[24:27]
    s_waitcnt lgkmcnt(0)
    v_mfma_f32_16x16x32_bf16 v[20:23], a[92:95], v[92:95], v[20:23]
    v_mfma_f32_16x16x32_bf16 v[28:31], a[188:191], v[92:95], v[28:31]
    s_nop 3
    v_cvt_pk_bf16_f32 v32, v16, v17
    v_cvt_pk_bf16_f32 v33, v18, v19
    s_nop 0
    v_cvt_pk_bf16_f32 v34, v20, v21
    v_cvt_pk_bf16_f32 v35, v22, v23
    v_cvt_pk_bf16_f32 v36, v24, v25
    v_cvt_pk_bf16_f32 v37, v26, v27
    v_cvt_pk_bf16_f32 v38, v28, v29
    v_cvt_pk_bf16_f32 v39, v30, v31
    ds_write_b64 v9, v[32:33] offset:0
    ds_write_b64 v9, v[34:35] offset:1280
    ds_write_b64 v9, v[36:37] offset:32
    ds_write_b64 v9, v[38:39] offset:1312
    s_waitcnt lgkmcnt(0)
    ds_read_b128 v[40:43], v10
    ds_read_b128 v[44:47], v10 offset:1280
    s_waitcnt lgkmcnt(1)
    buffer_store_dwordx4 v[40:43], v12, s[8:11], s75 offen offset:0 sc1
    s_waitcnt lgkmcnt(0)
    buffer_store_dwordx4 v[44:47], v13, s[8:11], s75 offen offset:0 sc1
    s_waitcnt vmcnt(0)
    v_mov_b32 v4, 1
    v_mov_b32 v6, 110596
    s_mov_b64 exec, 1
    ds_add_rtn_u32 v4, v6, v4
    s_waitcnt lgkmcnt(0)
    v_readfirstlane_b32 s60, v4
    v_mov_b32 v4, s73
    s_and_b32 s60, s60, 3
    s_cmp_lg_u32 s60, 3
    s_cbranch_scc1 L_nl_55
    buffer_store_dword v4, off, s[8:11], s72 sc1
L_nl_55:
    s_mov_b64 exec, -1
    s_barrier
    s_mov_b32 s79, s73
    s_cmp_lt_u32 s79, 64
    s_cbranch_scc1 L_op_c
    s_endpgm
L_f:
    s_lshr_b32 s70, s3, 2
    s_sub_u32 s71, s5, 26
    s_lshl_b32 s78, s71, 2
    s_add_u32 s78, s78, s4
    s_and_b32 s83, s3, 3
    s_mul_i32 s60, s83, 384
    s_lshl_b32 s61, s71, 7
    s_add_u32 s60, s60, s61
    s_lshl_b32 s61, s70, 11
    s_add_u32 s60, s60, s61
    s_add_u32 s72, s60, 24576
    v_mov_b32 v4, 0
    s_mov_b64 exec, 1
    buffer_store_dword v4, off, s[8:11], s72 sc1
    s_mov_b64 exec, -1
    s_mul_i32 s60, s3, 98304
    s_add_u32 s60, s60, 3407872
    s_lshl_b32 s61, s78, 11
    s_add_u32 s79, s60, s61
    s_lshl_b32 s62, s4, 11
    s_add_u32 s60, s60, s62
    s_add_u32 s61, s71, 1
    s_cmp_ge_u32 s61, 3
    s_cselect_b32 s62, 3, 0
    s_sub_u32 s61, s61, s62
    s_lshl_b32 s61, s61, 13
    s_add_u32 s80, s60, s61
    s_add_u32 s61, s71, 2
    s_cmp_ge_u32 s61, 3
    s_cselect_b32 s62, 3, 0
    s_sub_u32 s61, s61, s62
    s_lshl_b32 s61, s61, 13
    s_add_u32 s81, s60, s61
    v_lshlrev_b32 v5, 4, v0
    v_mov_b32 v16, -1
    v_mov_b32 v17, -1
    v_mov_b32 v18, -1
    v_mov_b32 v19, -1
    s_add_u32 s60, s79, 0
    buffer_store_dwordx4 v[16:19], v5, s[8:11], s60 offen offset:0 sc1
    buffer_store_dwordx4 v[16:19], v5, s[8:11], s60 offen offset:1024 sc1
    s_add_u32 s60, s79, 24576
    buffer_store_dwordx4 v[16:19], v5, s[8:11], s60 offen offset:0 sc1
    buffer_store_dwordx4 v[16:19], v5, s[8:11], s60 offen offset:1024 sc1
    s_waitcnt vmcnt(0)
    s_barrier
    s_cmp_lg_u32 s4, 0
    s_cbranch_scc1 L_arr_56
    s_and_b32 s60, s2, 7
    s_lshl_b32 s60, s60, 5
    s_add_u32 s60, s60, 16
    v_mov_b32 v1, 1
    s_mov_b64 exec, 1
    buffer_atomic_add v1, off, s[12:15], s60
    s_mov_b64 exec, -1
L_arr_56:
    s_mul_i32 s66, s3, 5120
    s_mul_i32 s67, s64, 40960
    s_add_u32 s67, s67, s66
    buffer_load_dwordx2 v[16:17], v2, s[44:47], s67 offen offset:0
    buffer_load_dwordx2 v[18:19], v2, s[44:47], s67 offen offset:256
    buffer_load_dwordx2 v[20:21], v2, s[44:47], s67 offen offset:512
    buffer_load_dwordx2 v[22:23], v2, s[44:47], s67 offen offset:768
    buffer_load_dwordx2 v[24:25], v2, s[44:47], s67 offen offset:1024
    buffer_load_dwordx2 v[26:27], v2, s[44:47], s67 offen offset:2560
    buffer_load_dwordx2 v[28:29], v2, s[44:47], s67 offen offset:2816
    buffer_load_dwordx2 v[30:31], v2, s[44:47], s67 offen offset:3072
    buffer_load_dwordx2 v[32:33], v2, s[44:47], s67 offen offset:3328
    buffer_load_dwordx2 v[34:35], v2, s[44:47], s67 offen offset:3584
    s_add_u32 s68, s67, 4194304
    s_waitcnt vmcnt(5)
    v_lshlrev_b32 v40, 16, v16
    v_and_b32 v41, 0xffff0000, v16
    v_lshlrev_b32 v42, 16, v17
    v_and_b32 v43, 0xffff0000, v17
    v_lshlrev_b32 v44, 16, v18
    v_and_b32 v45, 0xffff0000, v18
    v_lshlrev_b32 v46, 16, v19
    v_and_b32 v47, 0xffff0000, v19
    v_lshlrev_b32 v48, 16, v20
    v_and_b32 v49, 0xffff0000, v20
    v_lshlrev_b32 v50, 16, v21
    v_and_b32 v51, 0xffff0000, v21
    v_lshlrev_b32 v52, 16, v22
    v_and_b32 v53, 0xffff0000, v22
    v_lshlrev_b32 v54, 16, v23
    v_and_b32 v55, 0xffff0000, v23
    v_lshlrev_b32 v56, 16, v24
    v_and_b32 v57, 0xffff0000, v24
    v_lshlrev_b32 v58, 16, v25
    v_and_b32 v59, 0xffff0000, v25
    v_pk_add_f32 v[80:81], v[40:41], v[42:43]
    v_pk_add_f32 v[82:83], v[44:45], v[46:47]
    v_pk_add_f32 v[80:81], v[80:81], v[48:49]
    v_pk_add_f32 v[82:83], v[82:83], v[50:51]
    v_pk_add_f32 v[80:81], v[80:81], v[52:53]
    v_pk_add_f32 v[82:83], v[82:83], v[54:55]
    v_pk_add_f32 v[80:81], v[80:81], v[56:57]
    v_pk_add_f32 v[82:83], v[82:83], v[58:59]
    v_pk_add_f32 v[80:81], v[80:81], v[82:83]
    v_add_f32 v80, v80, v81
    v_mul_f32 v80, 0xbd4ccccd, v80
    v_mov_b32 v81, v80
    v_mov_b32 v86, v80
    v_pk_add_f32 v[84:85], v[40:41], v[80:81]
    v_pk_mul_f32 v[82:83], v[84:85], v[84:85]
    v_pk_add_f32 v[84:85], v[42:43], v[80:81]
    v_add_f32_dpp v86, v86, v86 row_ror:8 row_mask:0xf bank_mask:0xf
    v_pk_fma_f32 v[82:83], v[84:85], v[84:85], v[82:83]
    v_pk_add_f32 v[84:85], v[44:45], v[80:81]
    v_add_f32_dpp v86, v86, v86 row_ror:4 row_mask:0xf bank_mask:0xf
    v_pk_fma_f32 v[82:83], v[84:85], v[84:85], v[82:83]
    v_pk_add_f32 v[84:85], v[46:47], v[80:81]
    v_add_f32_dpp v86, v86, v86 row_ror:2 row_mask:0xf bank_mask:0xf
    v_pk_fma_f32 v[82:83], v[84:85], v[84:85], v[82:83]
    v_pk_add_f32 v[84:85], v[48:49], v[80:81]
    v_add_f32_dpp v86, v86, v86 row_ror:1 row_mask:0xf bank_mask:0xf
    v_pk_fma_f32 v[82:83], v[84:85], v[84:85], v[82:83]
    v_pk_add_f32 v[84:85], v[50:51], v[80:81]
    v_pk_fma_f32 v[82:83], v[84:85], v[84:85], v[82:83]
    v_pk_add_f32 v[84:85], v[52:53], v[80:81]
    v_mov_b32 v87, v86
    v_pk_fma_f32 v[82:83], v[84:85], v[84:85], v[82:83]
    v_pk_add_f32 v[84:85], v[54:55], v[80:81]
    v_pk_fma_f32 v[82:83], v[84:85], v[84:85], v[82:83]
    v_pk_add_f32 v[84:85], v[56:57], v[80:81]
    v_permlane16_swap_b32 v87, v86
    v_pk_fma_f32 v[82:83], v[84:85], v[84:85], v[82:83]
    v_pk_add_f32 v[84:85], v[58:59], v[80:81]
    v_pk_fma_f32 v[82:83], v[84:85], v[84:85], v[82:83]
    v_add_f32 v86, v86, v87
    v_add_f32 v82, v82, v83
    v_mul_f32 v86, 0x3d000000, v86
    v_sub_f32 v84, v80, v86
    v_mul_f32 v85, 0x41a00000, v84
    v_fmac_f32 v82, v84, v85
    v_cvt_pk_bf16_f32 v80, v86, v86
    v_and_b32 v80, 0xffff0000, v80
    v_mov_b32 v81, v80
    v_add_f32_dpp v82, v82, v82 row_ror:8 row_mask:0xf bank_mask:0xf
    v_pk_add_f32 v[40:41], v[40:41], v[80:81]
    v_pk_add_f32 v[42:43], v[42:43], v[80:81]
    v_add_f32_dpp v82, v82, v82 row_ror:4 row_mask:0xf bank_mask:0xf
    v_pk_add_f32 v[44:45], v[44:45], v[80:81]
    v_pk_add_f32 v[46:47], v[46:47], v[80:81]
    v_add_f32_dpp v82, v82, v82 row_ror:2 row_mask:0xf bank_mask:0xf
    v_pk_add_f32 v[48:49], v[48:49], v[80:81]
    v_pk_add_f32 v[50:51], v[50:51], v[80:81]
    v_add_f32_dpp v82, v82, v82 row_ror:1 row_mask:0xf bank_mask:0xf
    v_pk_add_f32 v[52:53], v[52:53], v[80:81]
    v_pk_add_f32 v[54:55], v[54:55], v[80:81]
    v_mov_b32 v83, v82
    v_pk_add_f32 v[56:57], v[56:57], v[80:81]
    v_pk_add_f32 v[58:59], v[58:59], v[80:81]
    v_permlane16_swap_b32 v83, v82
    v_add_f32 v82, v82, v83
    v_mul_f32 v82, 0x3acccccd, v82
    v_cvt_pk_bf16_f32 v82, v82, v82
    v_and_b32 v82, 0xffff0000, v82
    v_add_f32 v82, 0x3727c5ac, v82
    v_cvt_pk_bf16_f32 v82, v82, v82
    v_and_b32 v82, 0xffff0000, v82
    v_sqrt_f32 v82, v82
    v_cvt_pk_bf16_f32 v41, v40, v41
    v_cvt_pk_bf16_f32 v43, v42, v43
    v_cvt_pk_bf16_f32 v45, v44, v45
    v_cvt_pk_bf16_f32 v47, v46, v47
    v_cvt_pk_bf16_f32 v49, v48, v49
    v_cvt_pk_bf16_f32 v51, v50, v51
    v_cvt_pk_bf16_f32 v53, v52, v53
    v_cvt_pk_bf16_f32 v55, v54, v55
    v_cvt_pk_bf16_f32 v57, v56, v57
    v_cvt_pk_bf16_f32 v59, v58, v59
    v_cvt_pk_bf16_f32 v82, v82, v82
    v_and_b32 v82, 0xffff0000, v82
    v_rcp_f32 v82, v82
    v_lshlrev_b32 v40, 16, v41
    v_and_b32 v41, 0xffff0000, v41
    v_lshlrev_b32 v42, 16, v43
    v_and_b32 v43, 0xffff0000, v43
    v_lshlrev_b32 v44, 16, v45
    v_and_b32 v45, 0xffff0000, v45
    v_lshlrev_b32 v46, 16, v47
    v_and_b32 v47, 0xffff0000, v47
    v_lshlrev_b32 v48, 16, v49
    v_and_b32 v49, 0xffff0000, v49
    v_lshlrev_b32 v50, 16, v51
    v_and_b32 v51, 0xffff0000, v51
    v_lshlrev_b32 v52, 16, v53
    v_and_b32 v53, 0xffff0000, v53
    v_lshlrev_b32 v54, 16, v55
    v_and_b32 v55, 0xffff0000, v55
    v_lshlrev_b32 v56, 16, v57
    v_and_b32 v57, 0xffff0000, v57
    v_lshlrev_b32 v58, 16, v59
    v_and_b32 v59, 0xffff0000, v59
    v_mov_b32 v83, v82
    v_pk_mul_f32 v[40:41], v[40:41], v[82:83]
    v_pk_mul_f32 v[42:43], v[42:43], v[82:83]
    v_pk_mul_f32 v[44:45], v[44:45], v[82:83]
    v_pk_mul_f32 v[46:47], v[46:47], v[82:83]
    v_pk_mul_f32 v[48:49], v[48:49], v[82:83]
    v_pk_mul_f32 v[50:51], v[50:51], v[82:83]
    v_pk_mul_f32 v[52:53], v[52:53], v[82:83]
    v_pk_mul_f32 v[54:55], v[54:55], v[82:83]
    v_pk_mul_f32 v[56:57], v[56:57], v[82:83]
    v_pk_mul_f32 v[58:59], v[58:59], v[82:83]
    v_cvt_pk_bf16_f32 v60, v40, v41
    v_cvt_pk_bf16_f32 v61, v42, v43
    v_cvt_pk_bf16_f32 v62, v44, v45
    v_cvt_pk_bf16_f32 v63, v46, v47
    v_cvt_pk_bf16_f32 v64, v48, v49
    v_cvt_pk_bf16_f32 v65, v50, v51
    v_cvt_pk_bf16_f32 v66, v52, v53
    v_cvt_pk_bf16_f32 v67, v54, v55
    v_cvt_pk_bf16_f32 v68, v56, v57
    v_cvt_pk_bf16_f32 v69, v58, v59
    buffer_store_dwordx2 v[60:61], v2, s[8:11], s68 offen offset:0 sc1
    buffer_store_dwordx2 v[62:63], v2, s[8:11], s68 offen offset:256 sc1
    buffer_store_dwordx2 v[64:65], v2, s[8:11], s68 offen offset:512 sc1
    buffer_store_dwordx2 v[66:67], v2, s[8:11], s68 offen offset:768 sc1
    buffer_store_dwordx2 v[68:69], v2, s[8:11], s68 offen offset:1024 sc1
    s_waitcnt vmcnt(5)
    v_lshlrev_b32 v40, 16, v26
    v_and_b32 v41, 0xffff0000, v26
    v_lshlrev_b32 v42, 16, v27
    v_and_b32 v43, 0xffff0000, v27
    v_lshlrev_b32 v44, 16, v28
    v_and_b32 v45, 0xffff0000, v28
    v_lshlrev_b32 v46, 16, v29
    v_and_b32 v47, 0xffff0000, v29
    v_lshlrev_b32 v48, 16, v30
    v_and_b32 v49, 0xffff0000, v30
    v_lshlrev_b32 v50, 16, v31
    v_and_b32 v51, 0xffff0000, v31
    v_lshlrev_b32 v52, 16, v32
    v_and_b32 v53, 0xffff0000, v32
    v_lshlrev_b32 v54, 16, v33
    v_and_b32 v55, 0xffff0000, v33
    v_lshlrev_b32 v56, 16, v34
    v_and_b32 v57, 0xffff0000, v34
    v_lshlrev_b32 v58, 16, v35
    v_and_b32 v59, 0xffff0000, v35
    v_pk_add_f32 v[80:81], v[40:41], v[42:43]
    v_pk_add_f32 v[82:83], v[44:45], v[46:47]
    v_pk_add_f32 v[80:81], v[80:81], v[48:49]
    v_pk_add_f32 v[82:83], v[82:83], v[50:51]
    v_pk_add_f32 v[80:81], v[80:81], v[52:53]
    v_pk_add_f32 v[82:83], v[82:83], v[54:55]
    v_pk_add_f32 v[80:81], v[80:81], v[56:57]
    v_pk_add_f32 v[82:83], v[82:83], v[58:59]
    v_pk_add_f32 v[80:81], v[80:81], v[82:83]
    v_add_f32 v80, v80, v81
    v_mul_f32 v80, 0xbd4ccccd, v80
    v_mov_b32 v81, v80
    v_mov_b32 v86, v80
    v_pk_add_f32 v[84:85], v[40:41], v[80:81]
    v_pk_mul_f32 v[82:83], v[84:85], v[84:85]
    v_pk_add_f32 v[84:85], v[42:43], v[80:81]
    v_add_f32_dpp v86, v86, v86 row_ror:8 row_mask:0xf bank_mask:0xf
    v_pk_fma_f32 v[82:83], v[84:85], v[84:85], v[82:83]
    v_pk_add_f32 v[84:85], v[44:45], v[80:81]
    v_add_f32_dpp v86, v86, v86 row_ror:4 row_mask:0xf bank_mask:0xf
    v_pk_fma_f32 v[82:83], v[84:85], v[84:85], v[82:83]
    v_pk_add_f32 v[84:85], v[46:47], v[80:81]
    v_add_f32_dpp v86, v86, v86 row_ror:2 row_mask:0xf bank_mask:0xf
    v_pk_fma_f32 v[82:83], v[84:85], v[84:85], v[82:83]
    v_pk_add_f32 v[84:85], v[48:49], v[80:81]
    v_add_f32_dpp v86, v86, v86 row_ror:1 row_mask:0xf bank_mask:0xf
    v_pk_fma_f32 v[82:83], v[84:85], v[84:85], v[82:83]
    v_pk_add_f32 v[84:85], v[50:51], v[80:81]
    v_pk_fma_f32 v[82:83], v[84:85], v[84:85], v[82:83]
    v_pk_add_f32 v[84:85], v[52:53], v[80:81]
    v_mov_b32 v87, v86
    v_pk_fma_f32 v[82:83], v[84:85], v[84:85], v[82:83]
    v_pk_add_f32 v[84:85], v[54:55], v[80:81]
    v_pk_fma_f32 v[82:83], v[84:85], v[84:85], v[82:83]
    v_pk_add_f32 v[84:85], v[56:57], v[80:81]
    v_permlane16_swap_b32 v87, v86
    v_pk_fma_f32 v[82:83], v[84:85], v[84:85], v[82:83]
    v_pk_add_f32 v[84:85], v[58:59], v[80:81]
    v_pk_fma_f32 v[82:83], v[84:85], v[84:85], v[82:83]
    v_add_f32 v86, v86, v87
    v_add_f32 v82, v82, v83
    v_mul_f32 v86, 0x3d000000, v86
    v_sub_f32 v84, v80, v86
    v_mul_f32 v85, 0x41a00000, v84
    v_fmac_f32 v82, v84, v85
    v_cvt_pk_bf16_f32 v80, v86, v86
    v_and_b32 v80, 0xffff0000, v80
    v_mov_b32 v81, v80
    v_add_f32_dpp v82, v82, v82 row_ror:8 row_mask:0xf bank_mask:0xf
    v_pk_add_f32 v[40:41], v[40:41], v[80:81]
    v_pk_add_f32 v[42:43], v[42:43], v[80:81]
    v_add_f32_dpp v82, v82, v82 row_ror:4 row_mask:0xf bank_mask:0xf
    v_pk_add_f32 v[44:45], v[44:45], v[80:81]
    v_pk_add_f32 v[46:47], v[46:47], v[80:81]
    v_add_f32_dpp v82, v82, v82 row_ror:2 row_mask:0xf bank_mask:0xf
    v_pk_add_f32 v[48:49], v[48:49], v[80:81]
    v_pk_add_f32 v[50:51], v[50:51], v[80:81]
    v_add_f32_dpp v82, v82, v82 row_ror:1 row_mask:0xf bank_mask:0xf
    v_pk_add_f32 v[52:53], v[52:53], v[80:81]
    v_pk_add_f32 v[54:55], v[54:55], v[80:81]
    v_mov_b32 v83, v82
    v_pk_add_f32 v[56:57], v[56:57], v[80:81]
    v_pk_add_f32 v[58:59], v[58:59], v[80:81]
    v_permlane16_swap_b32 v83, v82
    v_add_f32 v82, v82, v83
    v_mul_f32 v82, 0x3acccccd, v82
    v_cvt_pk_bf16_f32 v82, v82, v82
    v_and_b32 v82, 0xffff0000, v82
    v_add_f32 v82, 0x3727c5ac, v82
    v_cvt_pk_bf16_f32 v82, v82, v82
    v_and_b32 v82, 0xffff0000, v82
    v_sqrt_f32 v82, v82
    v_cvt_pk_bf16_f32 v41, v40, v41
    v_cvt_pk_bf16_f32 v43, v42, v43
    v_cvt_pk_bf16_f32 v45, v44, v45
    v_cvt_pk_bf16_f32 v47, v46, v47
    v_cvt_pk_bf16_f32 v49, v48, v49
    v_cvt_pk_bf16_f32 v51, v50, v51
    v_cvt_pk_bf16_f32 v53, v52, v53
    v_cvt_pk_bf16_f32 v55, v54, v55
    v_cvt_pk_bf16_f32 v57, v56, v57
    v_cvt_pk_bf16_f32 v59, v58, v59
    v_cvt_pk_bf16_f32 v82, v82, v82
    v_and_b32 v82, 0xffff0000, v82
    v_rcp_f32 v82, v82
    v_lshlrev_b32 v40, 16, v41
    v_and_b32 v41, 0xffff0000, v41
    v_lshlrev_b32 v42, 16, v43
    v_and_b32 v43, 0xffff0000, v43
    v_lshlrev_b32 v44, 16, v45
    v_and_b32 v45, 0xffff0000, v45
    v_lshlrev_b32 v46, 16, v47
    v_and_b32 v47, 0xffff0000, v47
    v_lshlrev_b32 v48, 16, v49
    v_and_b32 v49, 0xffff0000, v49
    v_lshlrev_b32 v50, 16, v51
    v_and_b32 v51, 0xffff0000, v51
    v_lshlrev_b32 v52, 16, v53
    v_and_b32 v53, 0xffff0000, v53
    v_lshlrev_b32 v54, 16, v55
    v_and_b32 v55, 0xffff0000, v55
    v_lshlrev_b32 v56, 16, v57
    v_and_b32 v57, 0xffff0000, v57
    v_lshlrev_b32 v58, 16, v59
    v_and_b32 v59, 0xffff0000, v59
    v_mov_b32 v83, v82
    v_pk_mul_f32 v[40:41], v[40:41], v[82:83]
    v_pk_mul_f32 v[42:43], v[42:43], v[82:83]
    v_pk_mul_f32 v[44:45], v[44:45], v[82:83]
    v_pk_mul_f32 v[46:47], v[46:47], v[82:83]
    v_pk_mul_f32 v[48:49], v[48:49], v[82:83]
    v_pk_mul_f32 v[50:51], v[50:51], v[82:83]
    v_pk_mul_f32 v[52:53], v[52:53], v[82:83]
    v_pk_mul_f32 v[54:55], v[54:55], v[82:83]
    v_pk_mul_f32 v[56:57], v[56:57], v[82:83]
    v_pk_mul_f32 v[58:59], v[58:59], v[82:83]
    v_cvt_pk_bf16_f32 v70, v40, v41
    v_cvt_pk_bf16_f32 v71, v42, v43
    v_cvt_pk_bf16_f32 v72, v44, v45
    v_cvt_pk_bf16_f32 v73, v46, v47
    v_cvt_pk_bf16_f32 v74, v48, v49
    v_cvt_pk_bf16_f32 v75, v50, v51
    v_cvt_pk_bf16_f32 v76, v52, v53
    v_cvt_pk_bf16_f32 v77, v54, v55
    v_cvt_pk_bf16_f32 v78, v56, v57
    v_cvt_pk_bf16_f32 v79, v58, v59
    buffer_store_dwordx2 v[70:71], v2, s[8:11], s68 offen offset:2560 sc1
    buffer_store_dwordx2 v[72:73], v2, s[8:11], s68 offen offset:2816 sc1
    buffer_store_dwordx2 v[74:75], v2, s[8:11], s68 offen offset:3072 sc1
    buffer_store_dwordx2 v[76:77], v2, s[8:11], s68 offen offset:3328 sc1
    buffer_store_dwordx2 v[78:79], v2, s[8:11], s68 offen offset:3584 sc1
    s_waitcnt vmcnt(0)
    s_add_u32 s68, s65, 0
    v_mov_b32 v4, 1
    s_mov_b64 exec, 1
    buffer_store_dword v4, off, s[8:11], s68 sc1
    s_mov_b64 exec, -1
    s_cmp_ge_u32 s64, 20
    s_cbranch_scc1 L_ln1d_57
    s_add_u32 s64, s64, 44
    s_add_u32 s65, s65, 1408
    s_mul_i32 s67, s64, 40960
    s_add_u32 s67, s67, s66
    buffer_load_dwordx2 v[16:17], v2, s[44:47], s67 offen offset:0
    buffer_load_dwordx2 v[18:19], v2, s[44:47], s67 offen offset:256
    buffer_load_dwordx2 v[20:21], v2, s[44:47], s67 offen offset:512
    buffer_load_dwordx2 v[22:23], v2, s[44:47], s67 offen offset:768
    buffer_load_dwordx2 v[24:25], v2, s[44:47], s67 offen offset:1024
    buffer_load_dwordx2 v[26:27], v2, s[44:47], s67 offen offset:2560
    buffer_load_dwordx2 v[28:29], v2, s[44:47], s67 offen offset:2816
    buffer_load_dwordx2 v[30:31], v2, s[44:47], s67 offen offset:3072
    buffer_load_dwordx2 v[32:33], v2, s[44:47], s67 offen offset:3328
    buffer_load_dwordx2 v[34:35], v2, s[44:47], s67 offen offset:3584
    s_add_u32 s68, s67, 4194304
    s_waitcnt vmcnt(5)
    v_lshlrev_b32 v40, 16, v16
    v_and_b32 v41, 0xffff0000, v16
    v_lshlrev_b32 v42, 16, v17
    v_and_b32 v43, 0xffff0000, v17
    v_lshlrev_b32 v44, 16, v18
    v_and_b32 v45, 0xffff0000, v18
    v_lshlrev_b32 v46, 16, v19
    v_and_b32 v47, 0xffff0000, v19
    v_lshlrev_b32 v48, 16, v20
    v_and_b32 v49, 0xffff0000, v20
    v_lshlrev_b32 v50, 16, v21
    v_and_b32 v51, 0xffff0000, v21
    v_lshlrev_b32 v52, 16, v22
    v_and_b32 v53, 0xffff0000, v22
    v_lshlrev_b32 v54, 16, v23
    v_and_b32 v55, 0xffff0000, v23
    v_lshlrev_b32 v56, 16, v24
    v_and_b32 v57, 0xffff0000, v24
    v_lshlrev_b32 v58, 16, v25
    v_and_b32 v59, 0xffff0000, v25
    v_pk_add_f32 v[80:81], v[40:41], v[42:43]
    v_pk_add_f32 v[82:83], v[44:45], v[46:47]
    v_pk_add_f32 v[80:81], v[80:81], v[48:49]
    v_pk_add_f32 v[82:83], v[82:83], v[50:51]
    v_pk_add_f32 v[80:81], v[80:81], v[52:53]
    v_pk_add_f32 v[82:83], v[82:83], v[54:55]
    v_pk_add_f32 v[80:81], v[80:81], v[56:57]
    v_pk_add_f32 v[82:83], v[82:83], v[58:59]
    v_pk_add_f32 v[80:81], v[80:81], v[82:83]
    v_add_f32 v80, v80, v81
    v_mul_f32 v80, 0xbd4ccccd, v80
    v_mov_b32 v81, v80
    v_mov_b32 v86, v80
    v_pk_add_f32 v[84:85], v[40:41], v[80:81]
    v_pk_mul_f32 v[82:83], v[84:85], v[84:85]
    v_pk_add_f32 v[84:85], v[42:43], v[80:81]
    v_add_f32_dpp v86, v86, v86 row_ror:8 row_mask:0xf bank_mask:0xf
    v_pk_fma_f32 v[82:83], v[84:85], v[84:85], v[82:83]
    v_pk_add_f32 v[84:85], v[44:45], v[80:81]
    v_add_f32_dpp v86, v86, v86 row_ror:4 row_mask:0xf bank_mask:0xf
    v_pk_fma_f32 v[82:83], v[84:85], v[84:85], v[82:83]
    v_pk_add_f32 v[84:85], v[46:47], v[80:81]
    v_add_f32_dpp v86, v86, v86 row_ror:2 row_mask:0xf bank_mask:0xf
    v_pk_fma_f32 v[82:83], v[84:85], v[84:85], v[82:83]
    v_pk_add_f32 v[84:85], v[48:49], v[80:81]
    v_add_f32_dpp v86, v86, v86 row_ror:1 row_mask:0xf bank_mask:0xf
    v_pk_fma_f32 v[82:83], v[84:85], v[84:85], v[82:83]
    v_pk_add_f32 v[84:85], v[50:51], v[80:81]
    v_pk_fma_f32 v[82:83], v[84:85], v[84:85], v[82:83]
    v_pk_add_f32 v[84:85], v[52:53], v[80:81]
    v_mov_b32 v87, v86
    v_pk_fma_f32 v[82:83], v[84:85], v[84:85], v[82:83]
    v_pk_add_f32 v[84:85], v[54:55], v[80:81]
    v_pk_fma_f32 v[82:83], v[84:85], v[84:85], v[82:83]
    v_pk_add_f32 v[84:85], v[56:57], v[80:81]
    v_permlane16_swap_b32 v87, v86
    v_pk_fma_f32 v[82:83], v[84:85], v[84:85], v[82:83]
    v_pk_add_f32 v[84:85], v[58:59], v[80:81]
    v_pk_fma_f32 v[82:83], v[84:85], v[84:85], v[82:83]
    v_add_f32 v86, v86, v87
    v_add_f32 v82, v82, v83
    v_mul_f32 v86, 0x3d000000, v86
    v_sub_f32 v84, v80, v86
    v_mul_f32 v85, 0x41a00000, v84
    v_fmac_f32 v82, v84, v85
    v_cvt_pk_bf16_f32 v80, v86, v86
    v_and_b32 v80, 0xffff0000, v80
    v_mov_b32 v81, v80
    v_add_f32_dpp v82, v82, v82 row_ror:8 row_mask:0xf bank_mask:0xf
    v_pk_add_f32 v[40:41], v[40:41], v[80:81]
    v_pk_add_f32 v[42:43], v[42:43], v[80:81]
    v_add_f32_dpp v82, v82, v82 row_ror:4 row_mask:0xf bank_mask:0xf
    v_pk_add_f32 v[44:45], v[44:45], v[80:81]
    v_pk_add_f32 v[46:47], v[46:47], v[80:81]
    v_add_f32_dpp v82, v82, v82 row_ror:2 row_mask:0xf bank_mask:0xf
    v_pk_add_f32 v[48:49], v[48:49], v[80:81]
    v_pk_add_f32 v[50:51], v[50:51], v[80:81]
    v_add_f32_dpp v82, v82, v82 row_ror:1 row_mask:0xf bank_mask:0xf
    v_pk_add_f32 v[52:53], v[52:53], v[80:81]
    v_pk_add_f32 v[54:55], v[54:55], v[80:81]
    v_mov_b32 v83, v82
    v_pk_add_f32 v[56:57], v[56:57], v[80:81]
    v_pk_add_f32 v[58:59], v[58:59], v[80:81]
    v_permlane16_swap_b32 v83, v82
    v_add_f32 v82, v82, v83
    v_mul_f32 v82, 0x3acccccd, v82
    v_cvt_pk_bf16_f32 v82, v82, v82
    v_and_b32 v82, 0xffff0000, v82
    v_add_f32 v82, 0x3727c5ac, v82
    v_cvt_pk_bf16_f32 v82, v82, v82
    v_and_b32 v82, 0xffff0000, v82
    v_sqrt_f32 v82, v82
    v_cvt_pk_bf16_f32 v41, v40, v41
    v_cvt_pk_bf16_f32 v43, v42, v43
    v_cvt_pk_bf16_f32 v45, v44, v45
    v_cvt_pk_bf16_f32 v47, v46, v47
    v_cvt_pk_bf16_f32 v49, v48, v49
    v_cvt_pk_bf16_f32 v51, v50, v51
    v_cvt_pk_bf16_f32 v53, v52, v53
    v_cvt_pk_bf16_f32 v55, v54, v55
    v_cvt_pk_bf16_f32 v57, v56, v57
    v_cvt_pk_bf16_f32 v59, v58, v59
    v_cvt_pk_bf16_f32 v82, v82, v82
    v_and_b32 v82, 0xffff0000, v82
    v_rcp_f32 v82, v82
    v_lshlrev_b32 v40, 16, v41
    v_and_b32 v41, 0xffff0000, v41
    v_lshlrev_b32 v42, 16, v43
    v_and_b32 v43, 0xffff0000, v43
    v_lshlrev_b32 v44, 16, v45
    v_and_b32 v45, 0xffff0000, v45
    v_lshlrev_b32 v46, 16, v47
    v_and_b32 v47, 0xffff0000, v47
    v_lshlrev_b32 v48, 16, v49
    v_and_b32 v49, 0xffff0000, v49
    v_lshlrev_b32 v50, 16, v51
    v_and_b32 v51, 0xffff0000, v51
    v_lshlrev_b32 v52, 16, v53
    v_and_b32 v53, 0xffff0000, v53
    v_lshlrev_b32 v54, 16, v55
    v_and_b32 v55, 0xffff0000, v55
    v_lshlrev_b32 v56, 16, v57
    v_and_b32 v57, 0xffff0000, v57
    v_lshlrev_b32 v58, 16, v59
    v_and_b32 v59, 0xffff0000, v59
    v_mov_b32 v83, v82
    v_pk_mul_f32 v[40:41], v[40:41], v[82:83]
    v_pk_mul_f32 v[42:43], v[42:43], v[82:83]
    v_pk_mul_f32 v[44:45], v[44:45], v[82:83]
    v_pk_mul_f32 v[46:47], v[46:47], v[82:83]
    v_pk_mul_f32 v[48:49], v[48:49], v[82:83]
    v_pk_mul_f32 v[50:51], v[50:51], v[82:83]
    v_pk_mul_f32 v[52:53], v[52:53], v[82:83]
    v_pk_mul_f32 v[54:55], v[54:55], v[82:83]
    v_pk_mul_f32 v[56:57], v[56:57], v[82:83]
    v_pk_mul_f32 v[58:59], v[58:59], v[82:83]
    v_cvt_pk_bf16_f32 v60, v40, v41
    v_cvt_pk_bf16_f32 v61, v42, v43
    v_cvt_pk_bf16_f32 v62, v44, v45
    v_cvt_pk_bf16_f32 v63, v46, v47
    v_cvt_pk_bf16_f32 v64, v48, v49
    v_cvt_pk_bf16_f32 v65, v50, v51
    v_cvt_pk_bf16_f32 v66, v52, v53
    v_cvt_pk_bf16_f32 v67, v54, v55
    v_cvt_pk_bf16_f32 v68, v56, v57
    v_cvt_pk_bf16_f32 v69, v58, v59
    buffer_store_dwordx2 v[60:61], v2, s[8:11], s68 offen offset:0 sc1
    buffer_store_dwordx2 v[62:63], v2, s[8:11], s68 offen offset:256 sc1
    buffer_store_dwordx2 v[64:65], v2, s[8:11], s68 offen offset:512 sc1
    buffer_store_dwordx2 v[66:67], v2, s[8:11], s68 offen offset:768 sc1
    buffer_store_dwordx2 v[68:69], v2, s[8:11], s68 offen offset:1024 sc1
    s_waitcnt vmcnt(5)
    v_lshlrev_b32 v40, 16, v26
    v_and_b32 v41, 0xffff0000, v26
    v_lshlrev_b32 v42, 16, v27
    v_and_b32 v43, 0xffff0000, v27
    v_lshlrev_b32 v44, 16, v28
    v_and_b32 v45, 0xffff0000, v28
    v_lshlrev_b32 v46, 16, v29
    v_and_b32 v47, 0xffff0000, v29
    v_lshlrev_b32 v48, 16, v30
    v_and_b32 v49, 0xffff0000, v30
    v_lshlrev_b32 v50, 16, v31
    v_and_b32 v51, 0xffff0000, v31
    v_lshlrev_b32 v52, 16, v32
    v_and_b32 v53, 0xffff0000, v32
    v_lshlrev_b32 v54, 16, v33
    v_and_b32 v55, 0xffff0000, v33
    v_lshlrev_b32 v56, 16, v34
    v_and_b32 v57, 0xffff0000, v34
    v_lshlrev_b32 v58, 16, v35
    v_and_b32 v59, 0xffff0000, v35
    v_pk_add_f32 v[80:81], v[40:41], v[42:43]
    v_pk_add_f32 v[82:83], v[44:45], v[46:47]
    v_pk_add_f32 v[80:81], v[80:81], v[48:49]
    v_pk_add_f32 v[82:83], v[82:83], v[50:51]
    v_pk_add_f32 v[80:81], v[80:81], v[52:53]
    v_pk_add_f32 v[82:83], v[82:83], v[54:55]
    v_pk_add_f32 v[80:81], v[80:81], v[56:57]
    v_pk_add_f32 v[82:83], v[82:83], v[58:59]
    v_pk_add_f32 v[80:81], v[80:81], v[82:83]
    v_add_f32 v80, v80, v81
    v_mul_f32 v80, 0xbd4ccccd, v80
    v_mov_b32 v81, v80
    v_mov_b32 v86, v80
    v_pk_add_f32 v[84:85], v[40:41], v[80:81]
    v_pk_mul_f32 v[82:83], v[84:85], v[84:85]
    v_pk_add_f32 v[84:85], v[42:43], v[80:81]
    v_add_f32_dpp v86, v86, v86 row_ror:8 row_mask:0xf bank_mask:0xf
    v_pk_fma_f32 v[82:83], v[84:85], v[84:85], v[82:83]
    v_pk_add_f32 v[84:85], v[44:45], v[80:81]
    v_add_f32_dpp v86, v86, v86 row_ror:4 row_mask:0xf bank_mask:0xf
    v_pk_fma_f32 v[82:83], v[84:85], v[84:85], v[82:83]
    v_pk_add_f32 v[84:85], v[46:47], v[80:81]
    v_add_f32_dpp v86, v86, v86 row_ror:2 row_mask:0xf bank_mask:0xf
    v_pk_fma_f32 v[82:83], v[84:85], v[84:85], v[82:83]
    v_pk_add_f32 v[84:85], v[48:49], v[80:81]
    v_add_f32_dpp v86, v86, v86 row_ror:1 row_mask:0xf bank_mask:0xf
    v_pk_fma_f32 v[82:83], v[84:85], v[84:85], v[82:83]
    v_pk_add_f32 v[84:85], v[50:51], v[80:81]
    v_pk_fma_f32 v[82:83], v[84:85], v[84:85], v[82:83]
    v_pk_add_f32 v[84:85], v[52:53], v[80:81]
    v_mov_b32 v87, v86
    v_pk_fma_f32 v[82:83], v[84:85], v[84:85], v[82:83]
    v_pk_add_f32 v[84:85], v[54:55], v[80:81]
    v_pk_fma_f32 v[82:83], v[84:85], v[84:85], v[82:83]
    v_pk_add_f32 v[84:85], v[56:57], v[80:81]
    v_permlane16_swap_b32 v87, v86
    v_pk_fma_f32 v[82:83], v[84:85], v[84:85], v[82:83]
    v_pk_add_f32 v[84:85], v[58:59], v[80:81]
    v_pk_fma_f32 v[82:83], v[84:85], v[84:85], v[82:83]
    v_add_f32 v86, v86, v87
    v_add_f32 v82, v82, v83
    v_mul_f32 v86, 0x3d000000, v86
    v_sub_f32 v84, v80, v86
    v_mul_f32 v85, 0x41a00000, v84
    v_fmac_f32 v82, v84, v85
    v_cvt_pk_bf16_f32 v80, v86, v86
    v_and_b32 v80, 0xffff0000, v80
    v_mov_b32 v81, v80
    v_add_f32_dpp v82, v82, v82 row_ror:8 row_mask:0xf bank_mask:0xf
    v_pk_add_f32 v[40:41], v[40:41], v[80:81]
    v_pk_add_f32 v[42:43], v[42:43], v[80:81]
    v_add_f32_dpp v82, v82, v82 row_ror:4 row_mask:0xf bank_mask:0xf
    v_pk_add_f32 v[44:45], v[44:45], v[80:81]
    v_pk_add_f32 v[46:47], v[46:47], v[80:81]
    v_add_f32_dpp v82, v82, v82 row_ror:2 row_mask:0xf bank_mask:0xf
    v_pk_add_f32 v[48:49], v[48:49], v[80:81]
    v_pk_add_f32 v[50:51], v[50:51], v[80:81]
    v_add_f32_dpp v82, v82, v82 row_ror:1 row_mask:0xf bank_mask:0xf
    v_pk_add_f32 v[52:53], v[52:53], v[80:81]
    v_pk_add_f32 v[54:55], v[54:55], v[80:81]
    v_mov_b32 v83, v82
    v_pk_add_f32 v[56:57], v[56:57], v[80:81]
    v_pk_add_f32 v[58:59], v[58:59], v[80:81]
    v_permlane16_swap_b32 v83, v82
    v_add_f32 v82, v82, v83
    v_mul_f32 v82, 0x3acccccd, v82
    v_cvt_pk_bf16_f32 v82, v82, v82
    v_and_b32 v82, 0xffff0000, v82
    v_add_f32 v82, 0x3727c5ac, v82
    v_cvt_pk_bf16_f32 v82, v82, v82
    v_and_b32 v82, 0xffff0000, v82
    v_sqrt_f32 v82, v82
    v_cvt_pk_bf16_f32 v41, v40, v41
    v_cvt_pk_bf16_f32 v43, v42, v43
    v_cvt_pk_bf16_f32 v45, v44, v45
    v_cvt_pk_bf16_f32 v47, v46, v47
    v_cvt_pk_bf16_f32 v49, v48, v49
    v_cvt_pk_bf16_f32 v51, v50, v51
    v_cvt_pk_bf16_f32 v53, v52, v53
    v_cvt_pk_bf16_f32 v55, v54, v55
    v_cvt_pk_bf16_f32 v57, v56, v57
    v_cvt_pk_bf16_f32 v59, v58, v59
    v_cvt_pk_bf16_f32 v82, v82, v82
    v_and_b32 v82, 0xffff0000, v82
    v_rcp_f32 v82, v82
    v_lshlrev_b32 v40, 16, v41
    v_and_b32 v41, 0xffff0000, v41
    v_lshlrev_b32 v42, 16, v43
    v_and_b32 v43, 0xffff0000, v43
    v_lshlrev_b32 v44, 16, v45
    v_and_b32 v45, 0xffff0000, v45
    v_lshlrev_b32 v46, 16, v47
    v_and_b32 v47, 0xffff0000, v47
    v_lshlrev_b32 v48, 16, v49
    v_and_b32 v49, 0xffff0000, v49
    v_lshlrev_b32 v50, 16, v51
    v_and_b32 v51, 0xffff0000, v51
    v_lshlrev_b32 v52, 16, v53
    v_and_b32 v53, 0xffff0000, v53
    v_lshlrev_b32 v54, 16, v55
    v_and_b32 v55, 0xffff0000, v55
    v_lshlrev_b32 v56, 16, v57
    v_and_b32 v57, 0xffff0000, v57
    v_lshlrev_b32 v58, 16, v59
    v_and_b32 v59, 0xffff0000, v59
    v_mov_b32 v83, v82
    v_pk_mul_f32 v[40:41], v[40:41], v[82:83]
    v_pk_mul_f32 v[42:43], v[42:43], v[82:83]
    v_pk_mul_f32 v[44:45], v[44:45], v[82:83]
    v_pk_mul_f32 v[46:47], v[46:47], v[82:83]
    v_pk_mul_f32 v[48:49], v[48:49], v[82:83]
    v_pk_mul_f32 v[50:51], v[50:51], v[82:83]
    v_pk_mul_f32 v[52:53], v[52:53], v[82:83]
    v_pk_mul_f32 v[54:55], v[54:55], v[82:83]
    v_pk_mul_f32 v[56:57], v[56:57], v[82:83]
    v_pk_mul_f32 v[58:59], v[58:59], v[82:83]
    v_cvt_pk_bf16_f32 v70, v40, v41
    v_cvt_pk_bf16_f32 v71, v42, v43
    v_cvt_pk_bf16_f32 v72, v44, v45
    v_cvt_pk_bf16_f32 v73, v46, v47
    v_cvt_pk_bf16_f32 v74, v48, v49
    v_cvt_pk_bf16_f32 v75, v50, v51
    v_cvt_pk_bf16_f32 v76, v52, v53
    v_cvt_pk_bf16_f32 v77, v54, v55
    v_cvt_pk_bf16_f32 v78, v56, v57
    v_cvt_pk_bf16_f32 v79, v58, v59
    buffer_store_dwordx2 v[70:71], v2, s[8:11], s68 offen offset:2560 sc1
    buffer_store_dwordx2 v[72:73], v2, s[8:11], s68 offen offset:2816 sc1
    buffer_store_dwordx2 v[74:75], v2, s[8:11], s68 offen offset:3072 sc1
    buffer_store_dwordx2 v[76:77], v2, s[8:11], s68 offen offset:3328 sc1
    buffer_store_dwordx2 v[78:79], v2, s[8:11], s68 offen offset:3584 sc1
    s_waitcnt vmcnt(0)
    s_add_u32 s68, s65, 0
    v_mov_b32 v4, 1
    s_mov_b64 exec, 1
    buffer_store_dword v4, off, s[8:11], s68 sc1
    s_mov_b64 exec, -1
L_ln1d_57:
    v_lshlrev_b32 v7, 2, v0
L_wi_58:
    buffer_load_dword v6, v7, s[12:15], 0 offen sc1
    s_waitcnt vmcnt(0)
    v_cmp_ne_u32 vcc, 32, v6
    s_mov_b32 s60, 0x10101010
    s_mov_b32 s61, 0x10101010
    s_and_b64 s[62:63], vcc, s[60:61]
    s_cbranch_scc0 L_wid_59
    s_sleep 2
    s_sub_u32 s6, s6, 1
    s_cbranch_scc0 L_wi_58
    s_branch L_fail
L_wid_59:
    s_mov_b32 s60, 0x01010101
    s_mov_b32 s61, 0x01010101
    s_and_b64 s[62:63], vcc, s[60:61]
    s_cselect_b32 s7, 0, 1
    s_lshl_b32 s60, s3, 8
    s_add_u32 s60, s60, 12288
    v_mov_b32 v6, 12
L_poll_60:
    buffer_load_dword v4, v6, s[8:11], s60 offen offset:0 sc1
    s_waitcnt vmcnt(0)
    v_cmp_gt_u32 vcc, 1, v4
    s_cbranch_vccz L_pok_61
    s_sleep 8
    s_sub_u32 s6, s6, 1
    s_cbranch_scc0 L_poll_60
    s_branch L_fail
L_pok_61:
    s_mov_b32 s44, s32
    s_and_b32 s45, s33, 0xffff
    s_mov_b32 s46, 1966080
    s_mov_b32 s47, 0x20000
    s_mov_b32 s48, s34
    s_and_b32 s49, s35, 0xffff
    s_mov_b32 s50, 1966080
    s_mov_b32 s51, 0x20000
    s_mul_i32 s84, s83, 3
    s_add_u32 s84, s84, s71
    v_lshrrev_b32 v1, 4, v0
    s_mul_i32 s60, s4, 80
    v_add_u32 v1, s60, v1
    v_mul_u32_u24 v1, 3072, v1
    v_and_b32 v2, 15, v0
    v_lshl_add_u32 v5, v2, 4, v1
    s_lshl_b32 s60, s84, 8
    v_add_u32 v5, s60, v5
    s_lshl_b32 s62, s4, 6
    v_lshrrev_b32 v1, 4, v0
    v_lshlrev_b32 v1, 3, v1
    v_bfe_u32 v2, v0, 2, 2
    v_add_u32 v1, v1, v2
    v_mul_u32_u24 v1, 256, v1
    v_and_b32 v2, 3, v0
    v_lshl_add_u32 v6, v2, 3, v1
    v_add_u32 v6, s62, v6
    s_lshl_b32 s85, s78, 7
    s_lshl_b32 s60, s78, 6
    s_add_u32 s60, s60, 512
    s_cmp_ge_u32 s78, 8
    s_cselect_b32 s85, s60, s85
    s_min_u32 s86, s85, 1152
    v_lshrrev_b32 v1, 3, v0
    v_mul_u32_u24 v1, 1280, v1
    v_and_b32 v2, 7, v0
    v_lshl_add_u32 v8, v2, 4, v1
    v_add_u32 v8, s86, v8
    s_mul_i32 s87, s4, 16384
    s_sub_u32 s60, s85, s86
    s_add_u32 s60, s60, s87
    v_lshrrev_b32 v1, 5, v0
    v_lshlrev_b32 v1, 4, v1
    v_bfe_u32 v2, v0, 4, 1
    v_lshl_add_u32 v1, v2, 2, v1
    v_bfe_u32 v2, v0, 2, 2
    v_add_u32 v1, v1, v2
    v_mul_u32_u24 v1, 128, v1
    v_and_b32 v2, 3, v0
    v_lshl_add_u32 v9, v2, 3, v1
    v_add_u32 v9, s60, v9
    s_mul_i32 s60, s4, 20480
    s_add_u32 m0, s60, 0
    s_mov_b32 s61, 0
    buffer_load_dwordx4 v5, s[44:47], s61 offen nt lds
    s_add_u32 m0, m0, 1024
    s_add_u32 s61, s61, 12288
    buffer_load_dwordx4 v5, s[44:47], s61 offen nt lds
    s_add_u32 m0, m0, 1024
    s_add_u32 s61, s61, 12288
    buffer_load_dwordx4 v5, s[44:47], s61 offen nt lds
    s_add_u32 m0, m0, 1024
    s_add_u32 s61, s61, 12288
    buffer_load_dwordx4 v5, s[44:47], s61 offen nt lds
    s_add_u32 m0, m0, 1024
    s_add_u32 s61, s61, 12288
    buffer_load_dwordx4 v5, s[44:47], s61 offen nt lds
    s_add_u32 m0, m0, 1024
    s_add_u32 s61, s61, 12288
    buffer_load_dwordx4 v5, s[44:47], s61 offen nt lds
    s_add_u32 m0, m0, 1024
    s_add_u32 s61, s61, 12288
    buffer_load_dwordx4 v5, s[44:47], s61 offen nt lds
    s_add_u32 m0, m0, 1024
    s_add_u32 s61, s61, 12288
    buffer_load_dwordx4 v5, s[44:47], s61 offen nt lds
    s_add_u32 m0, m0, 1024
    s_add_u32 s61, s61, 12288
    buffer_load_dwordx4 v5, s[44:47], s61 offen nt lds
    s_add_u32 m0, m0, 1024
    s_add_u32 s61, s61, 12288
    buffer_load_dwordx4 v5, s[44:47], s61 offen nt lds
    s_add_u32 m0, m0, 1024
    s_add_u32 s61, s61, 12288
    buffer_load_dwordx4 v5, s[44:47], s61 offen nt lds
    s_add_u32 m0, m0, 1024
    s_add_u32 s61, s61, 12288
    buffer_load_dwordx4 v5, s[44:47], s61 offen nt lds
    s_add_u32 m0, m0, 1024
    s_add_u32 s61, s61, 12288
    buffer_load_dwordx4 v5, s[44:47], s61 offen nt lds
    s_add_u32 m0, m0, 1024
    s_add_u32 s61, s61, 12288
    buffer_load_dwordx4 v5, s[44:47], s61 offen nt lds
    s_add_u32 m0, m0, 1024
    s_add_u32 s61, s61, 12288
    buffer_load_dwordx4 v5, s[44:47], s61 offen nt lds
    s_add_u32 m0, m0, 1024
    s_add_u32 s61, s61, 12288
    buffer_load_dwordx4 v5, s[44:47], s61 offen nt lds
    s_add_u32 m0, m0, 1024
    s_add_u32 s61, s61, 12288
    buffer_load_dwordx4 v5, s[44:47], s61 offen nt lds
    s_add_u32 m0, m0, 1024
    s_add_u32 s61, s61, 12288
    buffer_load_dwordx4 v5, s[44:47], s61 offen nt lds
    s_add_u32 m0, m0, 1024
    s_add_u32 s61, s61, 12288
    buffer_load_dwordx4 v5, s[44:47], s61 offen nt lds
    s_add_u32 m0, m0, 1024
    s_add_u32 s61, s61, 12288
    buffer_load_dwordx4 v5, s[44:47], s61 offen nt lds
    s_mul_i32 s60, s4, 20480
    s_add_u32 m0, s60, 81920
    s_mov_b32 s61, 983040
    buffer_load_dwordx4 v5, s[44:47], s61 offen nt lds
    s_add_u32 m0, m0, 1024
    s_add_u32 s61, s61, 12288
    buffer_load_dwordx4 v5, s[44:47], s61 offen nt lds
    s_add_u32 m0, m0, 1024
    s_add_u32 s61, s61, 12288
    buffer_load_dwordx4 v5, s[44:47], s61 offen nt lds
    s_add_u32 m0, m0, 1024
    s_add_u32 s61, s61, 12288
    buffer_load_dwordx4 v5, s[44:47], s61 offen nt lds
    s_add_u32 m0, m0, 1024
    s_add_u32 s61, s61, 12288
    buffer_load_dwordx4 v5, s[44:47], s61 offen nt lds
    s_add_u32 m0, m0, 1024
    s_add_u32 s61, s61, 12288
    buffer_load_dwordx4 v5, s[44:47], s61 offen nt lds
    s_add_u32 m0, m0, 1024
    s_add_u32 s61, s61, 12288
    buffer_load_dwordx4 v5, s[44:47], s61 offen nt lds
    s_add_u32 m0, m0, 1024
    s_add_u32 s61, s61, 12288
    buffer_load_dwordx4 v5, s[44:47], s61 offen nt lds
    s_add_u32 m0, m0, 1024
    s_add_u32 s61, s61, 12288
    buffer_load_dwordx4 v5, s[44:47], s61 offen nt lds
    s_add_u32 m0, m0, 1024
    s_add_u32 s61, s61, 12288
    buffer_load_dwordx4 v5, s[44:47], s61 offen nt lds
    s_add_u32 m0, m0, 1024
    s_add_u32 s61, s61, 12288
    buffer_load_dwordx4 v5, s[44:47], s61 offen nt lds
    s_add_u32 m0, m0, 1024
    s_add_u32 s61, s61, 12288
    buffer_load_dwordx4 v5, s[44:47], s61 offen nt lds
    s_add_u32 m0, m0, 1024
    s_add_u32 s61, s61, 12288
    buffer_load_dwordx4 v5, s[44:47], s61 offen nt lds
    s_add_u32 m0, m0, 1024
    s_add_u32 s61, s61, 12288
    buffer_load_dwordx4 v5, s[44:47], s61 offen nt lds
    s_add_u32 m0, m0, 1024
    s_add_u32 s61, s61, 12288
    buffer_load_dwordx4 v5, s[44:47], s61 offen nt lds
    s_add_u32 m0, m0, 1024
    s_add_u32 s61, s61, 12288
    buffer_load_dwordx4 v5, s[44:47], s61 offen nt lds
    s_add_u32 m0, m0, 1024
    s_add_u32 s61, s61, 12288
    buffer_load_dwordx4 v5, s[44:47], s61 offen nt lds
    s_add_u32 m0, m0, 1024
    s_add_u32 s61, s61, 12288
    buffer_load_dwordx4 v5, s[44:47], s61 offen nt lds
    s_add_u32 m0, m0, 1024
    s_add_u32 s61, s61, 12288
    buffer_load_dwordx4 v5, s[44:47], s61 offen nt lds
    s_add_u32 m0, m0, 1024
    s_add_u32 s61, s61, 12288
    buffer_load_dwordx4 v5, s[44:47], s61 offen nt lds
    s_waitcnt vmcnt(20)
    s_barrier
    ds_read_b64_tr_b16 a[0:1], v6 offset:0
    ds_read_b64_tr_b16 a[80:81], v6 offset:32
    ds_read_b64_tr_b16 a[2:3], v6 offset:1024
    ds_read_b64_tr_b16 a[82:83], v6 offset:1056
    ds_read_b64_tr_b16 a[4:5], v6 offset:8192
    ds_read_b64_tr_b16 a[84:85], v6 offset:8224
    ds_read_b64_tr_b16 a[6:7], v6 offset:9216
    ds_read_b64_tr_b16 a[86:87], v6 offset:9248
    ds_read_b64_tr_b16 a[8:9], v6 offset:16384
    ds_read_b64_tr_b16 a[88:89], v6 offset:16416
    ds_read_b64_tr_b16 a[10:11], v6 offset:17408
    ds_read_b64_tr_b16 a[90:91], v6 offset:17440
    ds_read_b64_tr_b16 a[12:13], v6 offset:24576
    ds_read_b64_tr_b16 a[92:93], v6 offset:24608
    ds_read_b64_tr_b16 a[14:15], v6 offset:25600
    ds_read_b64_tr_b16 a[94:95], v6 offset:25632
    ds_read_b64_tr_b16 a[16:17], v6 offset:32768
    ds_read_b64_tr_b16 a[96:97], v6 offset:32800
    ds_read_b64_tr_b16 a[18:19], v6 offset:33792
    ds_read_b64_tr_b16 a[98:99], v6 offset:33824
    ds_read_b64_tr_b16 a[20:21], v6 offset:40960
    ds_read_b64_tr_b16 a[100:101], v6 offset:40992
    ds_read_b64_tr_b16 a[22:23], v6 offset:41984
    ds_read_b64_tr_b16 a[102:103], v6 offset:42016
    ds_read_b64_tr_b16 a[24:25], v6 offset:49152
    ds_read_b64_tr_b16 a[104:105], v6 offset:49184
    ds_read_b64_tr_b16 a[26:27], v6 offset:50176
    ds_read_b64_tr_b16 a[106:107], v6 offset:50208
    ds_read_b64_tr_b16 a[28:29], v6 offset:57344
    ds_read_b64_tr_b16 a[108:109], v6 offset:57376
    ds_read_b64_tr_b16 a[30:31], v6 offset:58368
    ds_read_b64_tr_b16 a[110:111], v6 offset:58400
    v_add_u32 v7, 65536, v6
    ds_read_b64_tr_b16 a[32:33], v7 offset:0
    ds_read_b64_tr_b16 a[112:113], v7 offset:32
    ds_read_b64_tr_b16 a[34:35], v7 offset:1024
    ds_read_b64_tr_b16 a[114:115], v7 offset:1056
    ds_read_b64_tr_b16 a[36:37], v7 offset:8192
    ds_read_b64_tr_b16 a[116:117], v7 offset:8224
    ds_read_b64_tr_b16 a[38:39], v7 offset:9216
    ds_read_b64_tr_b16 a[118:119], v7 offset:9248
    s_waitcnt lgkmcnt(0)
    s_barrier
    s_waitcnt vmcnt(0)
    s_barrier
    v_add_u32 v7, 65536, v6
    ds_read_b64_tr_b16 a[40:41], v7 offset:16384
    ds_read_b64_tr_b16 a[120:121], v7 offset:16416
    ds_read_b64_tr_b16 a[42:43], v7 offset:17408
    ds_read_b64_tr_b16 a[122:123], v7 offset:17440
    ds_read_b64_tr_b16 a[44:45], v7 offset:24576
    ds_read_b64_tr_b16 a[124:125], v7 offset:24608
    ds_read_b64_tr_b16 a[46:47], v7 offset:25600
    ds_read_b64_tr_b16 a[126:127], v7 offset:25632
    ds_read_b64_tr_b16 a[48:49], v7 offset:32768
    ds_read_b64_tr_b16 a[128:129], v7 offset:32800
    ds_read_b64_tr_b16 a[50:51], v7 offset:33792
    ds_read_b64_tr_b16 a[130:131], v7 offset:33824
    ds_read_b64_tr_b16 a[52:53], v7 offset:40960
    ds_read_b64_tr_b16 a[132:133], v7 offset:40992
    ds_read_b64_tr_b16 a[54:55], v7 offset:41984
    ds_read_b64_tr_b16 a[134:135], v7 offset:42016
    ds_read_b64_tr_b16 a[56:57], v7 offset:49152
    ds_read_b64_tr_b16 a[136:137], v7 offset:49184
    ds_read_b64_tr_b16 a[58:59], v7 offset:50176
    ds_read_b64_tr_b16 a[138:139], v7 offset:50208
    ds_read_b64_tr_b16 a[60:61], v7 offset:57344
    ds_read_b64_tr_b16 a[140:141], v7 offset:57376
    ds_read_b64_tr_b16 a[62:63], v7 offset:58368
    ds_read_b64_tr_b16 a[142:143], v7 offset:58400
    v_add_u32 v7, 131072, v6
    ds_read_b64_tr_b16 a[64:65], v7 offset:0
    ds_read_b64_tr_b16 a[144:145], v7 offset:32
    ds_read_b64_tr_b16 a[66:67], v7 offset:1024
    ds_read_b64_tr_b16 a[146:147], v7 offset:1056
    ds_read_b64_tr_b16 a[68:69], v7 offset:8192
    ds_read_b64_tr_b16 a[148:149], v7 offset:8224
    ds_read_b64_tr_b16 a[70:71], v7 offset:9216
    ds_read_b64_tr_b16 a[150:151], v7 offset:9248
    ds_read_b64_tr_b16 a[72:73], v7 offset:16384
    ds_read_b64_tr_b16 a[152:153], v7 offset:16416
    ds_read_b64_tr_b16 a[74:75], v7 offset:17408
    ds_read_b64_tr_b16 a[154:155], v7 offset:17440
    ds_read_b64_tr_b16 a[76:77], v7 offset:24576
    ds_read_b64_tr_b16 a[156:157], v7 offset:24608
    ds_read_b64_tr_b16 a[78:79], v7 offset:25600
    ds_read_b64_tr_b16 a[158:159], v7 offset:25632
    s_waitcnt lgkmcnt(0)
    s_barrier
    s_add_u32 s61, s71, 0
    s_cmp_ge_u32 s61, 3
    s_cselect_b32 s62, 3, 0
    s_sub_u32 s61, s61, s62
    s_mul_i32 s62, s83, 3
    s_add_u32 s61, s61, s62
    s_mul_i32 s61, s61, 163840
    s_add_u32 m0, s87, 0
    s_nop 0
    buffer_load_dwordx4 v8, s[48:51], s61 offen nt lds
    s_add_u32 m0, m0, 1024
    s_add_u32 s61, s61, 10240
    buffer_load_dwordx4 v8, s[48:51], s61 offen nt lds
    s_add_u32 m0, m0, 1024
    s_add_u32 s61, s61, 10240
    buffer_load_dwordx4 v8, s[48:51], s61 offen nt lds
    s_add_u32 m0, m0, 1024
    s_add_u32 s61, s61, 10240
    buffer_load_dwordx4 v8, s[48:51], s61 offen nt lds
    s_add_u32 m0, m0, 1024
    s_add_u32 s61, s61, 10240
    buffer_load_dwordx4 v8, s[48:51], s61 offen nt lds
    s_add_u32 m0, m0, 1024
    s_add_u32 s61, s61, 10240
    buffer_load_dwordx4 v8, s[48:51], s61 offen nt lds
    s_add_u32 m0, m0, 1024
    s_add_u32 s61, s61, 10240
    buffer_load_dwordx4 v8, s[48:51], s61 offen nt lds
    s_add_u32 m0, m0, 1024
    s_add_u32 s61, s61, 10240
    buffer_load_dwordx4 v8, s[48:51], s61 offen nt lds
    s_add_u32 m0, m0, 1024
    s_add_u32 s61, s61, 10240
    buffer_load_dwordx4 v8, s[48:51], s61 offen nt lds
    s_add_u32 m0, m0, 1024
    s_add_u32 s61, s61, 10240
    buffer_load_dwordx4 v8, s[48:51], s61 offen nt lds
    s_add_u32 m0, m0, 1024
    s_add_u32 s61, s61, 10240
    buffer_load_dwordx4 v8, s[48:51], s61 offen nt lds
    s_add_u32 m0, m0, 1024
    s_add_u32 s61, s61, 10240
    buffer_load_dwordx4 v8, s[48:51], s61 offen nt lds
    s_add_u32 m0, m0, 1024
    s_add_u32 s61, s61, 10240
    buffer_load_dwordx4 v8, s[48:51], s61 offen nt lds
    s_add_u32 m0, m0, 1024
    s_add_u32 s61, s61, 10240
    buffer_load_dwordx4 v8, s[48:51], s61 offen nt lds
    s_add_u32 m0, m0, 1024
    s_add_u32 s61, s61, 10240
    buffer_load_dwordx4 v8, s[48:51], s61 offen nt lds
    s_add_u32 m0, m0, 1024
    s_add_u32 s61, s61, 10240
    buffer_load_dwordx4 v8, s[48:51], s61 offen nt lds
    s_add_u32 s61, s71, 1
    s_cmp_ge_u32 s61, 3
    s_cselect_b32 s62, 3, 0
    s_sub_u32 s61, s61, s62
    s_mul_i32 s62, s83, 3
    s_add_u32 s61, s61, s62
    s_mul_i32 s61, s61, 163840
    s_add_u32 m0, s87, 65536
    s_nop 0
    buffer_load_dwordx4 v8, s[48:51], s61 offen nt lds
    s_add_u32 m0, m0, 1024
    s_add_u32 s61, s61, 10240
    buffer_load_dwordx4 v8, s[48:51], s61 offen nt lds
    s_add_u32 m0, m0, 1024
    s_add_u32 s61, s61, 10240
    buffer_load_dwordx4 v8, s[48:51], s61 offen nt lds
    s_add_u32 m0, m0, 1024
    s_add_u32 s61, s61, 10240
    buffer_load_dwordx4 v8, s[48:51], s61 offen nt lds
    s_add_u32 m0, m0, 1024
    s_add_u32 s61, s61, 10240
    buffer_load_dwordx4 v8, s[48:51], s61 offen nt lds
    s_add_u32 m0, m0, 1024
    s_add_u32 s61, s61, 10240
    buffer_load_dwordx4 v8, s[48:51], s61 offen nt lds
    s_add_u32 m0, m0, 1024
    s_add_u32 s61, s61, 10240
    buffer_load_dwordx4 v8, s[48:51], s61 offen nt lds
    s_add_u32 m0, m0, 1024
    s_add_u32 s61, s61, 10240
    buffer_load_dwordx4 v8, s[48:51], s61 offen nt lds
    s_add_u32 m0, m0, 1024
    s_add_u32 s61, s61, 10240
    buffer_load_dwordx4 v8, s[48:51], s61 offen nt lds
    s_add_u32 m0, m0, 1024
    s_add_u32 s61, s61, 10240
    buffer_load_dwordx4 v8, s[48:51], s61 offen nt lds
    s_add_u32 m0, m0, 1024
    s_add_u32 s61, s61, 10240
    buffer_load_dwordx4 v8, s[48:51], s61 offen nt lds
    s_add_u32 m0, m0, 1024
    s_add_u32 s61, s61, 10240
    buffer_load_dwordx4 v8, s[48:51], s61 offen nt lds
    s_add_u32 m0, m0, 1024
    s_add_u32 s61, s61, 10240
    buffer_load_dwordx4 v8, s[48:51], s61 offen nt lds
    s_add_u32 m0, m0, 1024
    s_add_u32 s61, s61, 10240
    buffer_load_dwordx4 v8, s[48:51], s61 offen nt lds
    s_add_u32 m0, m0, 1024
    s_add_u32 s61, s61, 10240
    buffer_load_dwordx4 v8, s[48:51], s61 offen nt lds
    s_add_u32 m0, m0, 1024
    s_add_u32 s61, s61, 10240
    buffer_load_dwordx4 v8, s[48:51], s61 offen nt lds
    s_waitcnt vmcnt(16)
    ds_read_b64_tr_b16 a[160:161], v9 offset:0
    ds_read_b64_tr_b16 a[162:163], v9 offset:1024
    ds_read_b64_tr_b16 a[164:165], v9 offset:4096
    ds_read_b64_tr_b16 a[166:167], v9 offset:5120
    ds_read_b64_tr_b16 a[168:169], v9 offset:8192
    ds_read_b64_tr_b16 a[170:171], v9 offset:9216
    ds_read_b64_tr_b16 a[172:173], v9 offset:12288
    ds_read_b64_tr_b16 a[174:175], v9 offset:13312
    ds_read_b64_tr_b16 a[208:209], v9 offset:32
    ds_read_b64_tr_b16 a[210:211], v9 offset:1056
    ds_read_b64_tr_b16 a[212:213], v9 offset:4128
    ds_read_b64_tr_b16 a[214:215], v9 offset:5152
    ds_read_b64_tr_b16 a[216:217], v9 offset:8224
    ds_read_b64_tr_b16 a[218:219], v9 offset:9248
    ds_read_b64_tr_b16 a[220:221], v9 offset:12320
    ds_read_b64_tr_b16 a[222:223], v9 offset:13344
    ds_read_b64_tr_b16 v[160:161], v9 offset:64
    ds_read_b64_tr_b16 v[162:163], v9 offset:1088
    ds_read_b64_tr_b16 v[164:165], v9 offset:4160
    ds_read_b64_tr_b16 v[166:167], v9 offset:5184
    ds_read_b64_tr_b16 v[168:169], v9 offset:8256
    ds_read_b64_tr_b16 v[170:171], v9 offset:9280
    ds_read_b64_tr_b16 v[172:173], v9 offset:12352
    ds_read_b64_tr_b16 v[174:175], v9 offset:13376
    ds_read_b64_tr_b16 v[208:209], v9 offset:96
    ds_read_b64_tr_b16 v[210:211], v9 offset:1120
    ds_read_b64_tr_b16 v[212:213], v9 offset:4192
    ds_read_b64_tr_b16 v[214:215], v9 offset:5216
    ds_read_b64_tr_b16 v[216:217], v9 offset:8288
    ds_read_b64_tr_b16 v[218:219], v9 offset:9312
    ds_read_b64_tr_b16 v[220:221], v9 offset:12384
    ds_read_b64_tr_b16 v[222:223], v9 offset:13408
    s_waitcnt lgkmcnt(0)
    s_add_u32 s61, s71, 2
    s_cmp_ge_u32 s61, 3
    s_cselect_b32 s62, 3, 0
    s_sub_u32 s61, s61, s62
    s_mul_i32 s62, s83, 3
    s_add_u32 s61, s61, s62
    s_mul_i32 s61, s61, 163840
    s_add_u32 m0, s87, 0
    s_nop 0
    buffer_load_dwordx4 v8, s[48:51], s61 offen nt lds
    s_add_u32 m0, m0, 1024
    s_add_u32 s61, s61, 10240
    buffer_load_dwordx4 v8, s[48:51], s61 offen nt lds
    s_add_u32 m0, m0, 1024
    s_add_u32 s61, s61, 10240
    buffer_load_dwordx4 v8, s[48:51], s61 offen nt lds
    s_add_u32 m0, m0, 1024
    s_add_u32 s61, s61, 10240
    buffer_load_dwordx4 v8, s[48:51], s61 offen nt lds
    s_add_u32 m0, m0, 1024
    s_add_u32 s61, s61, 10240
    buffer_load_dwordx4 v8, s[48:51], s61 offen nt lds
    s_add_u32 m0, m0, 1024
    s_add_u32 s61, s61, 10240
    buffer_load_dwordx4 v8, s[48:51], s61 offen nt lds
    s_add_u32 m0, m0, 1024
    s_add_u32 s61, s61, 10240
    buffer_load_dwordx4 v8, s[48:51], s61 offen nt lds
    s_add_u32 m0, m0, 1024
    s_add_u32 s61, s61, 10240
    buffer_load_dwordx4 v8, s[48:51], s61 offen nt lds
    s_add_u32 m0, m0, 1024
    s_add_u32 s61, s61, 10240
    buffer_load_dwordx4 v8, s[48:51], s61 offen nt lds
    s_add_u32 m0, m0, 1024
    s_add_u32 s61, s61, 10240
    buffer_load_dwordx4 v8, s[48:51], s61 offen nt lds
    s_add_u32 m0, m0, 1024
    s_add_u32 s61, s61, 10240
    buffer_load_dwordx4 v8, s[48:51], s61 offen nt lds
    s_add_u32 m0, m0, 1024
    s_add_u32 s61, s61, 10240
    buffer_load_dwordx4 v8, s[48:51], s61 offen nt lds
    s_add_u32 m0, m0, 1024
    s_add_u32 s61, s61, 10240
    buffer_load_dwordx4 v8, s[48:51], s61 offen nt lds
    s_add_u32 m0, m0, 1024
    s_add_u32 s61, s61, 10240
    buffer_load_dwordx4 v8, s[48:51], s61 offen nt lds
    s_add_u32 m0, m0, 1024
    s_add_u32 s61, s61, 10240
    buffer_load_dwordx4 v8, s[48:51], s61 offen nt lds
    s_add_u32 m0, m0, 1024
    s_add_u32 s61, s61, 10240
    buffer_load_dwordx4 v8, s[48:51], s61 offen nt lds
    s_waitcnt vmcnt(16)
    v_add_u32 v7, 65536, v9
    ds_read_b64_tr_b16 a[176:177], v7 offset:0
    ds_read_b64_tr_b16 a[178:179], v7 offset:1024
    ds_read_b64_tr_b16 a[180:181], v7 offset:4096
    ds_read_b64_tr_b16 a[182:183], v7 offset:5120
    ds_read_b64_tr_b16 a[184:185], v7 offset:8192
    ds_read_b64_tr_b16 a[186:187], v7 offset:9216
    ds_read_b64_tr_b16 a[188:189], v7 offset:12288
    ds_read_b64_tr_b16 a[190:191], v7 offset:13312
    ds_read_b64_tr_b16 a[224:225], v7 offset:32
    ds_read_b64_tr_b16 a[226:227], v7 offset:1056
    ds_read_b64_tr_b16 a[228:229], v7 offset:4128
    ds_read_b64_tr_b16 a[230:231], v7 offset:5152
    ds_read_b64_tr_b16 a[232:233], v7 offset:8224
    ds_read_b64_tr_b16 a[234:235], v7 offset:9248
    ds_read_b64_tr_b16 a[236:237], v7 offset:12320
    ds_read_b64_tr_b16 a[238:239], v7 offset:13344
    ds_read_b64_tr_b16 v[176:177], v7 offset:64
    ds_read_b64_tr_b16 v[178:179], v7 offset:1088
    ds_read_b64_tr_b16 v[180:181], v7 offset:4160
    ds_read_b64_tr_b16 v[182:183], v7 offset:5184
    ds_read_b64_tr_b16 v[184:185], v7 offset:8256
    ds_read_b64_tr_b16 v[186:187], v7 offset:9280
    ds_read_b64_tr_b16 v[188:189], v7 offset:12352
    ds_read_b64_tr_b16 v[190:191], v7 offset:13376
    ds_read_b64_tr_b16 v[224:225], v7 offset:96
    ds_read_b64_tr_b16 v[226:227], v7 offset:1120
    ds_read_b64_tr_b16 v[228:229], v7 offset:4192
    ds_read_b64_tr_b16 v[230:231], v7 offset:5216
    ds_read_b64_tr_b16 v[232:233], v7 offset:8288
    ds_read_b64_tr_b16 v[234:235], v7 offset:9312
    ds_read_b64_tr_b16 v[236:237], v7 offset:12384
    ds_read_b64_tr_b16 v[238:239], v7 offset:13408
    s_waitcnt lgkmcnt(0)
    s_waitcnt vmcnt(0)
    ds_read_b64_tr_b16 a[192:193], v9 offset:0
    ds_read_b64_tr_b16 a[194:195], v9 offset:1024
    ds_read_b64_tr_b16 a[196:197], v9 offset:4096
    ds_read_b64_tr_b16 a[198:199], v9 offset:5120
    ds_read_b64_tr_b16 a[200:201], v9 offset:8192
    ds_read_b64_tr_b16 a[202:203], v9 offset:9216
    ds_read_b64_tr_b16 a[204:205], v9 offset:12288
    ds_read_b64_tr_b16 a[206:207], v9 offset:13312
    ds_read_b64_tr_b16 a[240:241], v9 offset:32
    ds_read_b64_tr_b16 a[242:243], v9 offset:1056
    ds_read_b64_tr_b16 a[244:245], v9 offset:4128
    ds_read_b64_tr_b16 a[246:247], v9 offset:5152
    ds_read_b64_tr_b16 a[248:249], v9 offset:8224
    ds_read_b64_tr_b16 a[250:251], v9 offset:9248
    ds_read_b64_tr_b16 a[252:253], v9 offset:12320
    ds_read_b64_tr_b16 a[254:255], v9 offset:13344
    ds_read_b64_tr_b16 v[192:193], v9 offset:64
    ds_read_b64_tr_b16 v[194:195], v9 offset:1088
    ds_read_b64_tr_b16 v[196:197], v9 offset:4160
    ds_read_b64_tr_b16 v[198:199], v9 offset:5184
    ds_read_b64_tr_b16 v[200:201], v9 offset:8256
    ds_read_b64_tr_b16 v[202:203], v9 offset:9280
    ds_read_b64_tr_b16 v[204:205], v9 offset:12352
    ds_read_b64_tr_b16 v[206:207], v9 offset:13376
    ds_read_b64_tr_b16 v[240:241], v9 offset:96
    ds_read_b64_tr_b16 v[242:243], v9 offset:1120
    ds_read_b64_tr_b16 v[244:245], v9 offset:4192
    ds_read_b64_tr_b16 v[246:247], v9 offset:5216
    ds_read_b64_tr_b16 v[248:249], v9 offset:8288
    ds_read_b64_tr_b16 v[250:251], v9 offset:9312
    ds_read_b64_tr_b16 v[252:253], v9 offset:12384
    ds_read_b64_tr_b16 v[254:255], v9 offset:13408
    s_waitcnt lgkmcnt(0)
    s_barrier
    v_mov_b32 v1, 0
    v_mov_b32 v2, 86016
    ds_write_b32 v2, v1
    s_waitcnt lgkmcnt(0)
    s_barrier
    v_lshrrev_b32 v1, 3, v0
    v_and_b32 v2, 7, v0
    v_xor_b32 v2, v2, v1
    s_lshl_b32 s60, s4, 3
    v_add_u32 v1, s60, v1
    v_mul_u32_u24 v1, 1280, v1
    v_lshl_add_u32 v8, v2, 4, v1
    v_bfe_u32 v1, v0, 3, 1
    v_and_b32 v2, 7, v0
    v_mul_u32_u24 v3, 10240, v1
    v_lshl_add_u32 v3, v2, 7, v3
    v_lshrrev_b32 v1, 4, v0
    v_xor_b32 v2, v2, v1
    v_xor_b32 v1, 0, v2
    v_lshl_add_u32 v10, v1, 4, v3
    v_add_u32 v12, 20480, v10
    v_xor_b32 v1, 4, v2
    v_lshl_add_u32 v11, v1, 4, v3
    v_add_u32 v13, 20480, v11
    s_mul_i32 s60, s4, 4608
    s_add_u32 s60, s60, 65536
    v_and_b32 v1, 31, v0
    v_mul_u32_u24 v1, 144, v1
    v_lshrrev_b32 v2, 5, v0
    v_lshl_add_u32 v1, v2, 3, v1
    v_add_u32 v128, s60, v1
    v_lshrrev_b32 v1, 3, v0
    v_and_b32 v2, 7, v0
    v_mul_u32_u24 v3, 144, v1
    v_lshl_add_u32 v3, v2, 4, v3
    v_add_u32 v129, s60, v3
    v_mul_u32_u24 v3, 1280, v1
    v_lshl_add_u32 v130, v2, 4, v3
    v_add_u32 v131, 10240, v130
    v_add_u32 v132, 20480, v130
    v_add_u32 v133, 30720, v130
    v_and_b32 v1, 15, v0
    v_mul_u32_u24 v1, 144, v1
    v_lshrrev_b32 v2, 4, v0
    v_lshl_add_u32 v1, v2, 3, v1
    v_add_u32 v128, s60, v1
    v_bfe_u32 v1, v0, 4, 1
    v_lshrrev_b32 v2, 5, v0
    v_lshlrev_b32 v1, 5, v1
    v_lshl_add_u32 v1, v2, 4, v1
    v_and_b32 v2, 15, v0
    v_add_u32 v1, v1, v2
    v_lshlrev_b32 v134, 4, v1
    s_lshl_b32 s60, s4, 11
    v_add_u32 v135, s60, v134
    v_lshrrev_b32 v1, 5, v0
    v_lshlrev_b32 v1, 10, v1
    v_bfe_u32 v2, v0, 4, 1
    v_lshl_add_u32 v1, v2, 9, v1
    v_and_b32 v2, 15, v0
    v_lshl_add_u32 v136, v2, 4, v1
    s_cmp_ge_u32 s78, 8
    s_cselect_b32 s88, 0x0f0f0f0f, -1
    s_mov_b32 s89, s88
    v_lshlrev_b32 v9, 4, v0
    s_lshl_b32 s60, s4, 11
    v_add_u32 v6, s60, v9
    v_and_b32 v1, 7, v0
    v_lshlrev_b32 v5, 7, v1
    s_lshl_b32 s77, s70, 10
    s_add_u32 s77, s77, 20480
    s_cmp_eq_u32 s70, 0
    s_mov_b32 s90, 19922944
    s_mov_b32 s91, 65011712
    s_cselect_b32 s90, 9437184, s90
    s_cselect_b32 s91, 234881024, s91
    s_cselect_b32 s92, 63, 63
    s_mul_i32 s60, s83, 40960
    s_add_u32 s91, s91, s60
    s_add_u32 s91, s91, s85
    s_mul_i32 s93, s4, 10240
    v_lshlrev_b32 v7, 2, v0
L_wi_62:
    buffer_load_dword v4, v7, s[12:15], 0 offen sc1
    s_waitcnt vmcnt(0)
    v_cmp_ne_u32 vcc, 32, v4
    s_mov_b32 s60, 0x10101010
    s_mov_b32 s61, 0x10101010
    s_and_b64 s[62:63], vcc, s[60:61]
    s_cbranch_scc0 L_wid_63
    s_sleep 2
    s_sub_u32 s6, s6, 1
    s_cbranch_scc0 L_wi_62
    s_branch L_fail
L_wid_63:
    s_mov_b32 s60, 0x01010101
    s_mov_b32 s61, 0x01010101
    s_and_b64 s[62:63], vcc, s[60:61]
    s_cselect_b32 s7, 0, 1
    s_mov_b32 s76, 0
    s_mov_b32 s73, 1
    s_mov_b32 s74, s90
L_f_poll:
L_poll_64:
    buffer_load_dword v4, v5, s[8:11], s77 offen offset:0 sc1
    s_waitcnt vmcnt(0)
    v_cmp_gt_u32 vcc, s73, v4
    s_cbranch_vccz L_pok_65
    s_sleep 1
    s_sub_u32 s6, s6, 1
    s_cbranch_scc0 L_poll_64
    s_branch L_fail
L_pok_65:
L_f_dma:
    s_mov_b32 m0, s93
    s_nop 0
    buffer_load_dwordx4 v8, s[8:11], s74 offen offset:0 sc1 lds
    s_add_u32 m0, m0, 896
    s_nop 0
    buffer_load_dwordx4 v8, s[8:11], s74 offen offset:128 sc1 lds
    s_add_u32 m0, m0, 896
    s_nop 0
    buffer_load_dwordx4 v8, s[8:11], s74 offen offset:256 sc1 lds
    s_add_u32 m0, m0, 896
    s_nop 0
    buffer_load_dwordx4 v8, s[8:11], s74 offen offset:384 sc1 lds
    s_add_u32 m0, m0, 896
    s_nop 0
    buffer_load_dwordx4 v8, s[8:11], s74 offen offset:512 sc1 lds
    s_add_u32 m0, m0, 896
    s_nop 0
    buffer_load_dwordx4 v8, s[8:11], s74 offen offset:640 sc1 lds
    s_add_u32 m0, m0, 896
    s_nop 0
    buffer_load_dwordx4 v8, s[8:11], s74 offen offset:768 sc1 lds
    s_add_u32 m0, m0, 896
    s_nop 0
    buffer_load_dwordx4 v8, s[8:11], s74 offen offset:896 sc1 lds
    s_add_u32 m0, m0, 896
    s_nop 0
    buffer_load_dwordx4 v8, s[8:11], s74 offen offset:1024 sc1 lds
    s_add_u32 m0, m0, 896
    s_nop 0
    buffer_load_dwordx4 v8, s[8:11], s74 offen offset:1152 sc1 lds
    s_waitcnt vmcnt(0)
L_f_go:
    s_barrier
    s_and_b32 s75, s76, s92
    s_mul_i32 s75, s75, 163840
    s_add_u32 s75, s75, s91
    s_and_b32 s60, s76, 3
    s_mul_i32 s60, s60, 24576
    s_add_u32 s61, s60, s79
    s_add_u32 s62, s60, s80
    s_add_u32 s63, s60, s81
    ds_read_b128 v[96:99], v10 offset:0
    ds_read_b128 v[100:103], v12 offset:0
    ds_read_b128 v[104:107], v11 offset:0
    ds_read_b128 v[108:111], v13 offset:0
    ds_read_b128 v[112:115], v10 offset:1024
    ds_read_b128 v[116:119], v12 offset:1024
    s_waitcnt lgkmcnt(5)
    v_mfma_f32_16x16x32_bf16 v[16:19], a[0:3], v[96:99], 0
    ds_read_b128 v[120:123], v11 offset:1024
    v_mfma_f32_16x16x32_bf16 v[24:27], a[80:83], v[96:99], 0
    s_waitcnt lgkmcnt(5)
    v_mfma_f32_16x16x32_bf16 v[20:23], a[0:3], v[100:103], 0
    ds_read_b128 v[124:127], v13 offset:1024
    v_mfma_f32_16x16x32_bf16 v[28:31], a[80:83], v[100:103], 0
    s_waitcnt lgkmcnt(5)
    v_mfma_f32_16x16x32_bf16 v[16:19], a[4:7], v[104:107], v[16:19]
    ds_read_b128 v[96:99], v10 offset:2048
    v_mfma_f32_16x16x32_bf16 v[24:27], a[84:87], v[104:107], v[24:27]
    s_waitcnt lgkmcnt(5)
    v_mfma_f32_16x16x32_bf16 v[20:23], a[4:7], v[108:111], v[20:23]
    ds_read_b128 v[100:103], v12 offset:2048
    v_mfma_f32_16x16x32_bf16 v[28:31], a[84:87], v[108:111], v[28:31]
    s_waitcnt lgkmcnt(5)
    v_mfma_f32_16x16x32_bf16 v[16:19], a[8:11], v[112:115], v[16:19]
    ds_read_b128 v[104:107], v11 offset:2048
    v_mfma_f32_16x16x32_bf16 v[24:27], a[88:91], v[112:115], v[24:27]
    s_waitcnt lgkmcnt(5)
    v_mfma_f32_16x16x32_bf16 v[20:23], a[8:11], v[116:119], v[20:23]
    ds_read_b128 v[108:111], v13 offset:2048
    v_mfma_f32_16x16x32_bf16 v[28:31], a[88:91], v[116:119], v[28:31]
    s_waitcnt lgkmcnt(5)
    v_mfma_f32_16x16x32_bf16 v[16:19], a[12:15], v[120:123], v[16:19]
    ds_read_b128 v[112:115], v10 offset:3072
    v_mfma_f32_16x16x32_bf16 v[24:27], a[92:95], v[120:123], v[24:27]
    s_waitcnt lgkmcnt(5)
    v_mfma_f32_16x16x32_bf16 v[20:23], a[12:15], v[124:127], v[20:23]
    ds_read_b128 v[116:119], v12 offset:3072
    v_mfma_f32_16x16x32_bf16 v[28:31], a[92:95], v[124:127], v[28:31]
    s_waitcnt lgkmcnt(5)
    v_mfma_f32_16x16x32_bf16 v[16:19], a[16:19], v[96:99], v[16:19]
    ds_read_b128 v[120:123], v11 offset:3072
    v_mfma_f32_16x16x32_bf16 v[24:27], a[96:99], v[96:99], v[24:27]
    s_waitcnt lgkmcnt(5)
    v_mfma_f32_16x16x32_bf16 v[20:23], a[16:19], v[100:103], v[20:23]
    ds_read_b128 v[124:127], v13 offset:3072
    v_mfma_f32_16x16x32_bf16 v[28:31], a[96:99], v[100:103], v[28:31]
    s_waitcnt lgkmcnt(5)
    v_mfma_f32_16x16x32_bf16 v[16:19], a[20:23], v[104:107], v[16:19]
    ds_read_b128 v[96:99], v10 offset:4096
    v_mfma_f32_16x16x32_bf16 v[24:27], a[100:103], v[104:107], v[24:27]
    s_waitcnt lgkmcnt(5)
    v_mfma_f32_16x16x32_bf16 v[20:23], a[20:23], v[108:111], v[20:23]
    ds_read_b128 v[100:103], v12 offset:4096
    v_mfma_f32_16x16x32_bf16 v[28:31], a[100:103], v[108:111], v[28:31]
    s_waitcnt lgkmcnt(5)
    v_mfma_f32_16x16x32_bf16 v[16:19], a[24:27], v[112:115], v[16:19]
    ds_read_b128 v[104:107], v11 offset:4096
    v_mfma_f32_16x16x32_bf16 v[24:27], a[104:107], v[112:115], v[24:27]
    s_waitcnt lgkmcnt(5)
    v_mfma_f32_16x16x32_bf16 v[20:23], a[24:27], v[116:119], v[20:23]
    ds_read_b128 v[108:111], v13 offset:4096
    v_mfma_f32_16x16x32_bf16 v[28:31], a[104:107], v[116:119], v[28:31]
    s_waitcnt lgkmcnt(5)
    v_mfma_f32_16x16x32_bf16 v[16:19], a[28:31], v[120:123], v[16:19]
    ds_read_b128 v[112:115], v10 offset:5120
    v_mfma_f32_16x16x32_bf16 v[24:27], a[108:111], v[120:123], v[24:27]
    s_waitcnt lgkmcnt(5)
    v_mfma_f32_16x16x32_bf16 v[20:23], a[28:31], v[124:127], v[20:23]
    ds_read_b128 v[116:119], v12 offset:5120
    v_mfma_f32_16x16x32_bf16 v[28:31], a[108:111], v[124:127], v[28:31]
    s_waitcnt lgkmcnt(5)
    v_mfma_f32_16x16x32_bf16 v[16:19], a[32:35], v[96:99], v[16:19]
    ds_read_b128 v[120:123], v11 offset:5120
    v_mfma_f32_16x16x32_bf16 v[24:27], a[112:115], v[96:99], v[24:27]
    s_waitcnt lgkmcnt(5)
    v_mfma_f32_16x16x32_bf16 v[20:23], a[32:35], v[100:103], v[20:23]
    ds_read_b128 v[124:127], v13 offset:5120
    v_mfma_f32_16x16x32_bf16 v[28:31], a[112:115], v[100:103], v[28:31]
    s_waitcnt lgkmcnt(5)
    v_mfma_f32_16x16x32_bf16 v[16:19], a[36:39], v[104:107], v[16:19]
    ds_read_b128 v[96:99], v10 offset:6144
    v_mfma_f32_16x16x32_bf16 v[24:27], a[116:119], v[104:107], v[24:27]
    s_waitcnt lgkmcnt(5)
    v_mfma_f32_16x16x32_bf16 v[20:23], a[36:39], v[108:111], v[20:23]
    ds_read_b128 v[100:103], v12 offset:6144
    v_mfma_f32_16x16x32_bf16 v[28:31], a[116:119], v[108:111], v[28:31]
    s_waitcnt lgkmcnt(5)
    v_mfma_f32_16x16x32_bf16 v[16:19], a[40:43], v[112:115], v[16:19]
    ds_read_b128 v[104:107], v11 offset:6144
    v_mfma_f32_16x16x32_bf16 v[24:27], a[120:123], v[112:115], v[24:27]
    s_waitcnt lgkmcnt(5)
    v_mfma_f32_16x16x32_bf16 v[20:23], a[40:43], v[116:119], v[20:23]
    ds_read_b128 v[108:111], v13 offset:6144
    v_mfma_f32_16x16x32_bf16 v[28:31], a[120:123], v[116:119], v[28:31]
    s_waitcnt lgkmcnt(5)
    v_mfma_f32_16x16x32_bf16 v[16:19], a[44:47], v[120:123], v[16:19]
    ds_read_b128 v[112:115], v10 offset:7168
    v_mfma_f32_16x16x32_bf16 v[24:27], a[124:127], v[120:123], v[24:27]
    s_waitcnt lgkmcnt(5)
    v_mfma_f32_16x16x32_bf16 v[20:23], a[44:47], v[124:127], v[20:23]
    ds_read_b128 v[116:119], v12 offset:7168
    v_mfma_f32_16x16x32_bf16 v[28:31], a[124:127], v[124:127], v[28:31]
    s_waitcnt lgkmcnt(5)
    v_mfma_f32_16x16x32_bf16 v[16:19], a[48:51], v[96:99], v[16:19]
    ds_read_b128 v[120:123], v11 offset:7168
    v_mfma_f32_16x16x32_bf16 v[24:27], a[128:131], v[96:99], v[24:27]
    s_waitcnt lgkmcnt(5)
    v_mfma_f32_16x16x32_bf16 v[20:23], a[48:51], v[100:103], v[20:23]
    ds_read_b128 v[124:127], v13 offset:7168
    v_mfma_f32_16x16x32_bf16 v[28:31], a[128:131], v[100:103], v[28:31]
    s_waitcnt lgkmcnt(5)
    v_mfma_f32_16x16x32_bf16 v[16:19], a[52:55], v[104:107], v[16:19]
    ds_read_b128 v[96:99], v10 offset:8192
    v_mfma_f32_16x16x32_bf16 v[24:27], a[132:135], v[104:107], v[24:27]
    s_waitcnt lgkmcnt(5)
    v_mfma_f32_16x16x32_bf16 v[20:23], a[52:55], v[108:111], v[20:23]
    ds_read_b128 v[100:103], v12 offset:8192
    v_mfma_f32_16x16x32_bf16 v[28:31], a[132:135], v[108:111], v[28:31]
    s_waitcnt lgkmcnt(5)
    v_mfma_f32_16x16x32_bf16 v[16:19], a[56:59], v[112:115], v[16:19]
    ds_read_b128 v[104:107], v11 offset:8192
    v_mfma_f32_16x16x32_bf16 v[24:27], a[136:139], v[112:115], v[24:27]
    s_waitcnt lgkmcnt(5)
    v_mfma_f32_16x16x32_bf16 v[20:23], a[56:59], v[116:119], v[20:23]
    ds_read_b128 v[108:111], v13 offset:8192
    v_mfma_f32_16x16x32_bf16 v[28:31], a[136:139], v[116:119], v[28:31]
    s_waitcnt lgkmcnt(5)
    v_mfma_f32_16x16x32_bf16 v[16:19], a[60:63], v[120:123], v[16:19]
    ds_read_b128 v[112:115], v10 offset:9216
    v_mfma_f32_16x16x32_bf16 v[24:27], a[140:143], v[120:123], v[24:27]
    s_waitcnt lgkmcnt(5)
    v_mfma_f32_16x16x32_bf16 v[20:23], a[60:63], v[124:127], v[20:23]
    ds_read_b128 v[116:119], v12 offset:9216
    v_mfma_f32_16x16x32_bf16 v[28:31], a[140:143], v[124:127], v[28:31]
    s_waitcnt lgkmcnt(5)
    v_mfma_f32_16x16x32_bf16 v[16:19], a[64:67], v[96:99], v[16:19]
    ds_read_b128 v[120:123], v11 offset:9216
    v_mfma_f32_16x16x32_bf16 v[24:27], a[144:147], v[96:99], v[24:27]
    s_waitcnt lgkmcnt(5)
    v_mfma_f32_16x16x32_bf16 v[20:23], a[64:67], v[100:103], v[20:23]
    ds_read_b128 v[124:127], v13 offset:9216
    v_mfma_f32_16x16x32_bf16 v[28:31], a[144:147], v[100:103], v[28:31]
    s_waitcnt lgkmcnt(5)
    v_mfma_f32_16x16x32_bf16 v[16:19], a[68:71], v[104:107], v[16:19]
    v_mfma_f32_16x16x32_bf16 v[24:27], a[148:151], v[104:107], v[24:27]
    s_waitcnt lgkmcnt(4)
    v_mfma_f32_16x16x32_bf16 v[20:23], a[68:71], v[108:111], v[20:23]
    v_mfma_f32_16x16x32_bf16 v[28:31], a[148:151], v[108:111], v[28:31]
    s_waitcnt lgkmcnt(3)
    v_mfma_f32_16x16x32_bf16 v[16:19], a[72:75], v[112:115], v[16:19]
    v_mfma_f32_16x16x32_bf16 v[24:27], a[152:155], v[112:115], v[24:27]
    s_waitcnt lgkmcnt(2)
    v_mfma_f32_16x16x32_bf16 v[20:23], a[72:75], v[116:119], v[20:23]
    v_mfma_f32_16x16x32_bf16 v[28:31], a[152:155], v[116:119], v[28:31]
    s_waitcnt lgkmcnt(1)
    v_mfma_f32_16x16x32_bf16 v[16:19], a[76:79], v[120:123], v[16:19]
    v_mfma_f32_16x16x32_bf16 v[24:27], a[156:159], v[120:123], v[24:27]
    s_waitcnt lgkmcnt(0)
    v_mfma_f32_16x16x32_bf16 v[20:23], a[76:79], v[124:127], v[20:23]
    v_mfma_f32_16x16x32_bf16 v[28:31], a[156:159], v[124:127], v[28:31]
    s_nop 3
    v_cvt_pk_bf16_f32 v48, v16, v17
    v_cvt_pk_bf16_f32 v49, v18, v19
    s_nop 0
    v_cvt_pk_bf16_f32 v50, v20, v21
    v_cvt_pk_bf16_f32 v51, v22, v23
    v_cvt_pk_bf16_f32 v52, v24, v25
    v_cvt_pk_bf16_f32 v53, v26, v27
    v_cvt_pk_bf16_f32 v54, v28, v29
    v_cvt_pk_bf16_f32 v55, v30, v31
    v_pk_max_i16 v48, v48, 0
    v_pk_max_i16 v49, v49, 0
    v_pk_max_i16 v50, v50, 0
    v_pk_max_i16 v51, v51, 0
    v_pk_max_i16 v52, v52, 0
    v_pk_max_i16 v53, v53, 0
    v_pk_max_i16 v54, v54, 0
    v_pk_max_i16 v55, v55, 0
    v_permlane32_swap_b32 v48, v50
    v_permlane32_swap_b32 v49, v51
    v_permlane32_swap_b32 v52, v54
    v_permlane32_swap_b32 v53, v55
    ds_write_b128 v135, v[48:51] offset:40960
    ds_write_b128 v135, v[52:55] offset:41984
    s_cmp_eq_u32 s7, 0
    s_cbranch_scc1 L_sl_66
    buffer_store_dwordx4 v[48:51], v134, s[8:11], s61 offen offset:0
    buffer_store_dwordx4 v[52:55], v134, s[8:11], s61 offen offset:1024
    s_branch L_sd_67
L_sl_66:
    buffer_store_dwordx4 v[48:51], v134, s[8:11], s61 offen offset:0 sc1
    buffer_store_dwordx4 v[52:55], v134, s[8:11], s61 offen offset:1024 sc1
L_sd_67:
    s_waitcnt lgkmcnt(0)
    s_barrier
    ds_read_b128 v[96:99], v136 offset:40960
    ds_read_b128 v[100:103], v136 offset:41216
    ds_read_b128 v[104:107], v136 offset:43008
    ds_read_b128 v[108:111], v136 offset:43264
    ds_read_b128 v[112:115], v136 offset:45056
    ds_read_b128 v[116:119], v136 offset:45312
    s_waitcnt lgkmcnt(5)
    v_mfma_f32_16x16x32_bf16 v[16:19], a[160:163], v[96:99], 0
    ds_read_b128 v[120:123], v136 offset:47104
    v_mfma_f32_16x16x32_bf16 v[24:27], a[208:211], v[96:99], 0
    v_mfma_f32_16x16x32_bf16 v[32:35], v[160:163], v[96:99], 0
    v_mfma_f32_16x16x32_bf16 v[40:43], v[208:211], v[96:99], 0
    s_waitcnt lgkmcnt(5)
    v_mfma_f32_16x16x32_bf16 v[20:23], a[160:163], v[100:103], 0
    ds_read_b128 v[124:127], v136 offset:47360
    v_mfma_f32_16x16x32_bf16 v[28:31], a[208:211], v[100:103], 0
    v_mfma_f32_16x16x32_bf16 v[36:39], v[160:163], v[100:103], 0
    v_mfma_f32_16x16x32_bf16 v[44:47], v[208:211], v[100:103], 0
    s_waitcnt lgkmcnt(5)
    v_mfma_f32_16x16x32_bf16 v[16:19], a[164:167], v[104:107], v[16:19]
    v_mfma_f32_16x16x32_bf16 v[24:27], a[212:215], v[104:107], v[24:27]
    v_mfma_f32_16x16x32_bf16 v[32:35], v[164:167], v[104:107], v[32:35]
    v_mfma_f32_16x16x32_bf16 v[40:43], v[212:215], v[104:107], v[40:43]
    s_waitcnt lgkmcnt(4)
    v_mfma_f32_16x16x32_bf16 v[20:23], a[164:167], v[108:111], v[20:23]
    v_mfma_f32_16x16x32_bf16 v[28:31], a[212:215], v[108:111], v[28:31]
    v_mfma_f32_16x16x32_bf16 v[36:39], v[164:167], v[108:111], v[36:39]
    v_mfma_f32_16x16x32_bf16 v[44:47], v[212:215], v[108:111], v[44:47]
    buffer_load_dwordx4 v[64:67], v9, s[8:11], s62 offen offset:0 sc1
    buffer_load_dwordx4 v[68:71], v9, s[8:11], s62 offen offset:1024 sc1
    buffer_load_dwordx4 v[72:75], v9, s[8:11], s63 offen offset:0 sc1
    buffer_load_dwordx4 v[76:79], v9, s[8:11], s63 offen offset:1024 sc1
    s_waitcnt lgkmcnt(3)
    v_mfma_f32_16x16x32_bf16 v[16:19], a[168:171], v[112:115], v[16:19]
    v_mfma_f32_16x16x32_bf16 v[24:27], a[216:219], v[112:115], v[24:27]
    v_mfma_f32_16x16x32_bf16 v[32:35], v[168:171], v[112:115], v[32:35]
    v_mfma_f32_16x16x32_bf16 v[40:43], v[216:219], v[112:115], v[40:43]
    s_waitcnt lgkmcnt(2)
    v_mfma_f32_16x16x32_bf16 v[20:23], a[168:171], v[116:119], v[20:23]
    v_mfma_f32_16x16x32_bf16 v[28:31], a[216:219], v[116:119], v[28:31]
    v_mfma_f32_16x16x32_bf16 v[36:39], v[168:171], v[116:119], v[36:39]
    v_mfma_f32_16x16x32_bf16 v[44:47], v[216:219], v[116:119], v[44:47]
    s_waitcnt lgkmcnt(1)
    v_mfma_f32_16x16x32_bf16 v[16:19], a[172:175], v[120:123], v[16:19]
    v_mfma_f32_16x16x32_bf16 v[24:27], a[220:223], v[120:123], v[24:27]
    v_mfma_f32_16x16x32_bf16 v[32:35], v[172:175], v[120:123], v[32:35]
    v_mfma_f32_16x16x32_bf16 v[40:43], v[220:223], v[120:123], v[40:43]
    s_waitcnt lgkmcnt(0)
    v_mfma_f32_16x16x32_bf16 v[20:23], a[172:175], v[124:127], v[20:23]
    v_mfma_f32_16x16x32_bf16 v[28:31], a[220:223], v[124:127], v[28:31]
    v_mfma_f32_16x16x32_bf16 v[36:39], v[172:175], v[124:127], v[36:39]
    v_mfma_f32_16x16x32_bf16 v[44:47], v[220:223], v[124:127], v[44:47]
L_f_c0:
    s_waitcnt vmcnt(3)
    v_max3_u32 v4, v64, v65, v66
    v_max_u32 v4, v4, v67
    v_cmp_eq_u32 vcc, -1, v4
    s_cbranch_vccnz L_f_r0
    ds_write_b128 v6, v[64:67] offset:49152
L_f_c1:
    s_waitcnt vmcnt(2)
    v_max3_u32 v4, v68, v69, v70
    v_max_u32 v4, v4, v71
    v_cmp_eq_u32 vcc, -1, v4
    s_cbranch_vccnz L_f_r1
    ds_write_b128 v6, v[68:71] offset:50176
L_f_c2:
    s_waitcnt vmcnt(1)
    v_max3_u32 v4, v72, v73, v74
    v_max_u32 v4, v4, v75
    v_cmp_eq_u32 vcc, -1, v4
    s_cbranch_vccnz L_f_r2
    ds_write_b128 v6, v[72:75] offset:57344
L_f_c3:
    s_waitcnt vmcnt(0)
    v_max3_u32 v4, v76, v77, v78
    v_max_u32 v4, v4, v79
    v_cmp_eq_u32 vcc, -1, v4
    s_cbranch_vccnz L_f_r3
    ds_write_b128 v6, v[76:79] offset:58368
    v_mov_b32 v64, -1
    v_mov_b32 v65, -1
    v_mov_b32 v66, -1
    v_mov_b32 v67, -1
    s_add_u32 s60, s76, 2
    s_and_b32 s60, s60, 3
    s_mul_i32 s60, s60, 24576
    s_add_u32 s60, s60, s79
    s_cmp_eq_u32 s7, 0
    s_cbranch_scc1 L_sl_68
    buffer_store_dwordx4 v[64:67], v9, s[8:11], s60 offen offset:0
    buffer_store_dwordx4 v[64:67], v9, s[8:11], s60 offen offset:1024
    s_branch L_sd_69
L_sl_68:
    buffer_store_dwordx4 v[64:67], v9, s[8:11], s60 offen offset:0 sc1
    buffer_store_dwordx4 v[64:67], v9, s[8:11], s60 offen offset:1024 sc1
L_sd_69:
    buffer_load_dword v4, v5, s[8:11], s77 offen sc1
    s_add_u32 s74, s74, 40960
    s_add_u32 s94, s73, 1
    s_waitcnt lgkmcnt(0)
    s_barrier
    ds_read_b128 v[96:99], v136 offset:49152
    ds_read_b128 v[100:103], v136 offset:49408
    ds_read_b128 v[104:107], v136 offset:51200
    ds_read_b128 v[108:111], v136 offset:51456
    ds_read_b128 v[112:115], v136 offset:53248
    ds_read_b128 v[116:119], v136 offset:53504
    s_waitcnt lgkmcnt(5)
    v_mfma_f32_16x16x32_bf16 v[16:19], a[176:179], v[96:99], v[16:19]
    ds_read_b128 v[120:123], v136 offset:55296
    v_mfma_f32_16x16x32_bf16 v[24:27], a[224:227], v[96:99], v[24:27]
    v_mfma_f32_16x16x32_bf16 v[32:35], v[176:179], v[96:99], v[32:35]
    v_mfma_f32_16x16x32_bf16 v[40:43], v[224:227], v[96:99], v[40:43]
    s_waitcnt lgkmcnt(5)
    v_mfma_f32_16x16x32_bf16 v[20:23], a[176:179], v[100:103], v[20:23]
    ds_read_b128 v[124:127], v136 offset:55552
    v_mfma_f32_16x16x32_bf16 v[28:31], a[224:227], v[100:103], v[28:31]
    v_mfma_f32_16x16x32_bf16 v[36:39], v[176:179], v[100:103], v[36:39]
    v_mfma_f32_16x16x32_bf16 v[44:47], v[224:227], v[100:103], v[44:47]
    s_waitcnt lgkmcnt(5)
    v_mfma_f32_16x16x32_bf16 v[16:19], a[180:183], v[104:107], v[16:19]
    ds_read_b128 v[96:99], v136 offset:57344
    v_mfma_f32_16x16x32_bf16 v[24:27], a[228:231], v[104:107], v[24:27]
    v_mfma_f32_16x16x32_bf16 v[32:35], v[180:183], v[104:107], v[32:35]
    v_mfma_f32_16x16x32_bf16 v[40:43], v[228:231], v[104:107], v[40:43]
    s_waitcnt lgkmcnt(5)
    v_mfma_f32_16x16x32_bf16 v[20:23], a[180:183], v[108:111], v[20:23]
    ds_read_b128 v[100:103], v136 offset:57600
    v_mfma_f32_16x16x32_bf16 v[28:31], a[228:231], v[108:111], v[28:31]
    v_mfma_f32_16x16x32_bf16 v[36:39], v[180:183], v[108:111], v[36:39]
    v_mfma_f32_16x16x32_bf16 v[44:47], v[228:231], v[108:111], v[44:47]
    s_waitcnt lgkmcnt(5)
    v_mfma_f32_16x16x32_bf16 v[16:19], a[184:187], v[112:115], v[16:19]
    ds_read_b128 v[104:107], v136 offset:59392
    v_mfma_f32_16x16x32_bf16 v[24:27], a[232:235], v[112:115], v[24:27]
    v_mfma_f32_16x16x32_bf16 v[32:35], v[184:187], v[112:115], v[32:35]
    v_mfma_f32_16x16x32_bf16 v[40:43], v[232:235], v[112:115], v[40:43]
    s_waitcnt lgkmcnt(5)
    v_mfma_f32_16x16x32_bf16 v[20:23], a[184:187], v[116:119], v[20:23]
    ds_read_b128 v[108:111], v136 offset:59648
    v_mfma_f32_16x16x32_bf16 v[28:31], a[232:235], v[116:119], v[28:31]
    v_mfma_f32_16x16x32_bf16 v[36:39], v[184:187], v[116:119], v[36:39]
    v_mfma_f32_16x16x32_bf16 v[44:47], v[232:235], v[116:119], v[44:47]
    s_waitcnt vmcnt(0)
    v_cmp_gt_u32 vcc, s94, v4
    s_cmp_eq_u64 vcc, 0
    s_cselect_b32 s82, 1, 0
    s_cmp_eq_u32 s82, 0
    s_cbranch_scc1 L_f_y1
    s_waitcnt lgkmcnt(5)
    v_mfma_f32_16x16x32_bf16 v[16:19], a[188:191], v[120:123], v[16:19]
    ds_read_b128 v[112:115], v136 offset:61440
    v_mfma_f32_16x16x32_bf16 v[24:27], a[236:239], v[120:123], v[24:27]
    v_mfma_f32_16x16x32_bf16 v[32:35], v[188:191], v[120:123], v[32:35]
    v_mfma_f32_16x16x32_bf16 v[40:43], v[236:239], v[120:123], v[40:43]
    s_mov_b32 m0, s93
    s_nop 0
    buffer_load_dwordx4 v8, s[8:11], s74 offen offset:0 sc1 lds
    s_waitcnt lgkmcnt(5)
    v_mfma_f32_16x16x32_bf16 v[20:23], a[188:191], v[124:127], v[20:23]
    ds_read_b128 v[116:119], v136 offset:61696
    v_mfma_f32_16x16x32_bf16 v[28:31], a[236:239], v[124:127], v[28:31]
    v_mfma_f32_16x16x32_bf16 v[36:39], v[188:191], v[124:127], v[36:39]
    v_mfma_f32_16x16x32_bf16 v[44:47], v[236:239], v[124:127], v[44:47]
    s_add_u32 m0, m0, 896
    s_nop 0
    buffer_load_dwordx4 v8, s[8:11], s74 offen offset:128 sc1 lds
    s_waitcnt lgkmcnt(5)
    v_mfma_f32_16x16x32_bf16 v[16:19], a[192:195], v[96:99], v[16:19]
    ds_read_b128 v[120:123], v136 offset:63488
    v_mfma_f32_16x16x32_bf16 v[24:27], a[240:243], v[96:99], v[24:27]
    v_mfma_f32_16x16x32_bf16 v[32:35], v[192:195], v[96:99], v[32:35]
    v_mfma_f32_16x16x32_bf16 v[40:43], v[240:243], v[96:99], v[40:43]
    s_add_u32 m0, m0, 896
    s_nop 0
    buffer_load_dwordx4 v8, s[8:11], s74 offen offset:256 sc1 lds
    s_waitcnt lgkmcnt(5)
    v_mfma_f32_16x16x32_bf16 v[20:23], a[192:195], v[100:103], v[20:23]
    ds_read_b128 v[124:127], v136 offset:63744
    v_mfma_f32_16x16x32_bf16 v[28:31], a[240:243], v[100:103], v[28:31]
    v_mfma_f32_16x16x32_bf16 v[36:39], v[192:195], v[100:103], v[36:39]
    v_mfma_f32_16x16x32_bf16 v[44:47], v[240:243], v[100:103], v[44:47]
    s_add_u32 m0, m0, 896
    s_nop 0
    buffer_load_dwordx4 v8, s[8:11], s74 offen offset:384 sc1 lds
    s_waitcnt lgkmcnt(5)
    v_mfma_f32_16x16x32_bf16 v[16:19], a[196:199], v[104:107], v[16:19]
    v_mfma_f32_16x16x32_bf16 v[24:27], a[244:247], v[104:107], v[24:27]
    v_mfma_f32_16x16x32_bf16 v[32:35], v[196:199], v[104:107], v[32:35]
    v_mfma_f32_16x16x32_bf16 v[40:43], v[244:247], v[104:107], v[40:43]
    s_add_u32 m0, m0, 896
    s_nop 0
    buffer_load_dwordx4 v8, s[8:11], s74 offen offset:512 sc1 lds
    s_waitcnt lgkmcnt(4)
    v_mfma_f32_16x16x32_bf16 v[20:23], a[196:199], v[108:111], v[20:23]
    v_mfma_f32_16x16x32_bf16 v[28:31], a[244:247], v[108:111], v[28:31]
    v_mfma_f32_16x16x32_bf16 v[36:39], v[196:199], v[108:111], v[36:39]
    v_mfma_f32_16x16x32_bf16 v[44:47], v[244:247], v[108:111], v[44:47]
    s_add_u32 m0, m0, 896
    s_nop 0
    buffer_load_dwordx4 v8, s[8:11], s74 offen offset:640 sc1 lds
    s_waitcnt lgkmcnt(3)
    v_mfma_f32_16x16x32_bf16 v[16:19], a[200:203], v[112:115], v[16:19]
    v_mfma_f32_16x16x32_bf16 v[24:27], a[248:251], v[112:115], v[24:27]
    v_mfma_f32_16x16x32_bf16 v[32:35], v[200:203], v[112:115], v[32:35]
    v_mfma_f32_16x16x32_bf16 v[40:43], v[248:251], v[112:115], v[40:43]
    s_add_u32 m0, m0, 896
    s_nop 0
    buffer_load_dwordx4 v8, s[8:11], s74 offen offset:768 sc1 lds
    s_waitcnt lgkmcnt(2)
    v_mfma_f32_16x16x32_bf16 v[20:23], a[200:203], v[116:119], v[20:23]
    v_mfma_f32_16x16x32_bf16 v[28:31], a[248:251], v[116:119], v[28:31]
    v_mfma_f32_16x16x32_bf16 v[36:39], v[200:203], v[116:119], v[36:39]
    v_mfma_f32_16x16x32_bf16 v[44:47], v[248:251], v[116:119], v[44:47]
    s_add_u32 m0, m0, 896
    s_nop 0
    buffer_load_dwordx4 v8, s[8:11], s74 offen offset:896 sc1 lds
    s_waitcnt lgkmcnt(1)
    v_mfma_f32_16x16x32_bf16 v[16:19], a[204:207], v[120:123], v[16:19]
    v_mfma_f32_16x16x32_bf16 v[24:27], a[252:255], v[120:123], v[24:27]
    v_mfma_f32_16x16x32_bf16 v[32:35], v[204:207], v[120:123], v[32:35]
    v_mfma_f32_16x16x32_bf16 v[40:43], v[252:255], v[120:123], v[40:43]
    s_add_u32 m0, m0, 896
    s_nop 0
    buffer_load_dwordx4 v8, s[8:11], s74 offen offset:1024 sc1 lds
    s_waitcnt lgkmcnt(0)
    v_mfma_f32_16x16x32_bf16 v[20:23], a[204:207], v[124:127], v[20:23]
    v_mfma_f32_16x16x32_bf16 v[28:31], a[252:255], v[124:127], v[28:31]
    v_mfma_f32_16x16x32_bf16 v[36:39], v[204:207], v[124:127], v[36:39]
    v_mfma_f32_16x16x32_bf16 v[44:47], v[252:255], v[124:127], v[44:47]
    s_add_u32 m0, m0, 896
    s_nop 0
    buffer_load_dwordx4 v8, s[8:11], s74 offen offset:1152 sc1 lds
    s_branch L_f_y2
L_f_y1:
    s_waitcnt lgkmcnt(5)
    v_mfma_f32_16x16x32_bf16 v[16:19], a[188:191], v[120:123], v[16:19]
    ds_read_b128 v[112:115], v136 offset:61440
    v_mfma_f32_16x16x32_bf16 v[24:27], a[236:239], v[120:123], v[24:27]
    v_mfma_f32_16x16x32_bf16 v[32:35], v[188:191], v[120:123], v[32:35]
    v_mfma_f32_16x16x32_bf16 v[40:43], v[236:239], v[120:123], v[40:43]
    s_waitcnt lgkmcnt(5)
    v_mfma_f32_16x16x32_bf16 v[20:23], a[188:191], v[124:127], v[20:23]
    ds_read_b128 v[116:119], v136 offset:61696
    v_mfma_f32_16x16x32_bf16 v[28:31], a[236:239], v[124:127], v[28:31]
    v_mfma_f32_16x16x32_bf16 v[36:39], v[188:191], v[124:127], v[36:39]
    v_mfma_f32_16x16x32_bf16 v[44:47], v[236:239], v[124:127], v[44:47]
    s_waitcnt lgkmcnt(5)
    v_mfma_f32_16x16x32_bf16 v[16:19], a[192:195], v[96:99], v[16:19]
    ds_read_b128 v[120:123], v136 offset:63488
    v_mfma_f32_16x16x32_bf16 v[24:27], a[240:243], v[96:99], v[24:27]
    v_mfma_f32_16x16x32_bf16 v[32:35], v[192:195], v[96:99], v[32:35]
    v_mfma_f32_16x16x32_bf16 v[40:43], v[240:243], v[96:99], v[40:43]
    s_waitcnt lgkmcnt(5)
    v_mfma_f32_16x16x32_bf16 v[20:23], a[192:195], v[100:103], v[20:23]
    ds_read_b128 v[124:127], v136 offset:63744
    v_mfma_f32_16x16x32_bf16 v[28:31], a[240:243], v[100:103], v[28:31]
    v_mfma_f32_16x16x32_bf16 v[36:39], v[192:195], v[100:103], v[36:39]
    v_mfma_f32_16x16x32_bf16 v[44:47], v[240:243], v[100:103], v[44:47]
    s_waitcnt lgkmcnt(5)
    v_mfma_f32_16x16x32_bf16 v[16:19], a[196:199], v[104:107], v[16:19]
    v_mfma_f32_16x16x32_bf16 v[24:27], a[244:247], v[104:107], v[24:27]
    v_mfma_f32_16x16x32_bf16 v[32:35], v[196:199], v[104:107], v[32:35]
    v_mfma_f32_16x16x32_bf16 v[40:43], v[244:247], v[104:107], v[40:43]
    s_waitcnt lgkmcnt(4)
    v_mfma_f32_16x16x32_bf16 v[20:23], a[196:199], v[108:111], v[20:23]
    v_mfma_f32_16x16x32_bf16 v[28:31], a[244:247], v[108:111], v[28:31]
    v_mfma_f32_16x16x32_bf16 v[36:39], v[196:199], v[108:111], v[36:39]
    v_mfma_f32_16x16x32_bf16 v[44:47], v[244:247], v[108:111], v[44:47]
    s_waitcnt lgkmcnt(3)
    v_mfma_f32_16x16x32_bf16 v[16:19], a[200:203], v[112:115], v[16:19]
    v_mfma_f32_16x16x32_bf16 v[24:27], a[248:251], v[112:115], v[24:27]
    v_mfma_f32_16x16x32_bf16 v[32:35], v[200:203], v[112:115], v[32:35]
    v_mfma_f32_16x16x32_bf16 v[40:43], v[248:251], v[112:115], v[40:43]
    s_waitcnt lgkmcnt(2)
    v_mfma_f32_16x16x32_bf16 v[20:23], a[200:203], v[116:119], v[20:23]
    v_mfma_f32_16x16x32_bf16 v[28:31], a[248:251], v[116:119], v[28:31]
    v_mfma_f32_16x16x32_bf16 v[36:39], v[200:203], v[116:119], v[36:39]
    v_mfma_f32_16x16x32_bf16 v[44:47], v[248:251], v[116:119], v[44:47]
    s_waitcnt lgkmcnt(1)
    v_mfma_f32_16x16x32_bf16 v[16:19], a[204:207], v[120:123], v[16:19]
    v_mfma_f32_16x16x32_bf16 v[24:27], a[252:255], v[120:123], v[24:27]
    v_mfma_f32_16x16x32_bf16 v[32:35], v[204:207], v[120:123], v[32:35]
    v_mfma_f32_16x16x32_bf16 v[40:43], v[252:255], v[120:123], v[40:43]
    s_waitcnt lgkmcnt(0)
    v_mfma_f32_16x16x32_bf16 v[20:23], a[204:207], v[124:127], v[20:23]
    v_mfma_f32_16x16x32_bf16 v[28:31], a[252:255], v[124:127], v[28:31]
    v_mfma_f32_16x16x32_bf16 v[36:39], v[204:207], v[124:127], v[36:39]
    v_mfma_f32_16x16x32_bf16 v[44:47], v[252:255], v[124:127], v[44:47]
L_f_y2:
    v_cvt_pk_bf16_f32 v48, v16, v17
    v_cvt_pk_bf16_f32 v49, v18, v19
    s_nop 2
    v_cvt_pk_bf16_f32 v50, v20, v21
    v_cvt_pk_bf16_f32 v51, v22, v23
    v_cvt_pk_bf16_f32 v52, v24, v25
    v_cvt_pk_bf16_f32 v53, v26, v27
    v_cvt_pk_bf16_f32 v54, v28, v29
    v_cvt_pk_bf16_f32 v55, v30, v31
    ds_write_b64 v128, v[48:49] offset:0
    ds_write_b64 v128, v[50:51] offset:2304
    ds_write_b64 v128, v[52:53] offset:32
    ds_write_b64 v128, v[54:55] offset:2336
    v_cvt_pk_bf16_f32 v56, v32, v33
    v_cvt_pk_bf16_f32 v57, v34, v35
    v_cvt_pk_bf16_f32 v58, v36, v37
    v_cvt_pk_bf16_f32 v59, v38, v39
    v_cvt_pk_bf16_f32 v60, v40, v41
    v_cvt_pk_bf16_f32 v61, v42, v43
    v_cvt_pk_bf16_f32 v62, v44, v45
    v_cvt_pk_bf16_f32 v63, v46, v47
    ds_write_b64 v128, v[56:57] offset:64
    ds_write_b64 v128, v[58:59] offset:2368
    ds_write_b64 v128, v[60:61] offset:96
    ds_write_b64 v128, v[62:63] offset:2400
    s_waitcnt lgkmcnt(0)
    ds_read_b128 v[64:67], v129 offset:0
    ds_read_b128 v[68:71], v129 offset:1152
    ds_read_b128 v[72:75], v129 offset:2304
    ds_read_b128 v[76:79], v129 offset:3456
    s_mov_b64 exec, s[88:89]
    s_waitcnt lgkmcnt(3)
    buffer_store_dwordx4 v[64:67], v130, s[8:11], s75 offen sc1
    s_waitcnt lgkmcnt(2)
    buffer_store_dwordx4 v[68:71], v131, s[8:11], s75 offen sc1
    s_waitcnt lgkmcnt(1)
    buffer_store_dwordx4 v[72:75], v132, s[8:11], s75 offen sc1
    s_waitcnt lgkmcnt(0)
    buffer_store_dwordx4 v[76:79], v133, s[8:11], s75 offen sc1
    s_mov_b64 exec, -1
    buffer_load_dword v4, v5, s[8:11], s77 offen sc1
    s_waitcnt vmcnt(0)
    v_mov_b32 v7, 1
    v_mov_b32 v3, 86016
    s_mov_b64 exec, 1
    ds_add_rtn_u32 v7, v3, v7
    s_waitcnt lgkmcnt(0)
    v_readfirstlane_b32 s60, v7
    v_mov_b32 v7, s73
    s_and_b32 s60, s60, 3
    s_cmp_lg_u32 s60, 3
    s_cbranch_scc1 L_nl_70
    buffer_store_dword v7, off, s[8:11], s72 sc1
L_nl_70:
    s_mov_b64 exec, -1
    s_mov_b32 s76, s73
    s_mov_b32 s73, s94
    s_cmp_ge_u32 s76, 64
    s_cbranch_scc1 L_end
    s_cmp_eq_u32 s82, 1
    s_cbranch_scc1 L_f_go
    v_cmp_gt_u32 vcc, s73, v4
    s_cbranch_vccz L_f_dma
    s_branch L_f_poll
L_f_r0:
    buffer_load_dwordx4 v[64:67], v9, s[8:11], s62 offen offset:0 sc1
    buffer_load_dwordx4 v[68:71], v9, s[8:11], s62 offen offset:1024 sc1
    buffer_load_dwordx4 v[72:75], v9, s[8:11], s63 offen offset:0 sc1
    buffer_load_dwordx4 v[76:79], v9, s[8:11], s63 offen offset:1024 sc1
    s_sub_u32 s6, s6, 1
    s_cbranch_scc0 L_f_c0
    s_branch L_fail
L_f_r1:
    buffer_load_dwordx4 v[68:71], v9, s[8:11], s62 offen offset:1024 sc1
    buffer_load_dwordx4 v[72:75], v9, s[8:11], s63 offen offset:0 sc1
    buffer_load_dwordx4 v[76:79], v9, s[8:11], s63 offen offset:1024 sc1
    s_sub_u32 s6, s6, 1
    s_cbranch_scc0 L_f_c1
    s_branch L_fail
L_f_r2:
    buffer_load_dwordx4 v[72:75], v9, s[8:11], s63 offen offset:0 sc1
    buffer_load_dwordx4 v[76:79], v9, s[8:11], s63 offen offset:1024 sc1
    s_sub_u32 s6, s6, 1
    s_cbranch_scc0 L_f_c2
    s_branch L_fail
L_f_r3:
    buffer_load_dwordx4 v[76:79], v9, s[8:11], s63 offen offset:1024 sc1
    s_sub_u32 s6, s6, 1
    s_cbranch_scc0 L_f_c3
    s_branch L_fail
L_over:
    s_cmp_lg_u32 s4, 0
    s_cbranch_scc1 L_ov1
    v_mov_b32 v2, 1
    s_mov_b64 exec, 1
    buffer_atomic_add v2, off, s[12:15], 0 offset:44 sc0
    s_waitcnt vmcnt(0)
    ds_write_b32 v3, v2
    s_waitcnt lgkmcnt(0)
    s_mov_b64 exec, -1
L_ov1:
    s_barrier
    ds_read_b32 v2, v3
    s_waitcnt lgkmcnt(0)
    v_readfirstlane_b32 s60, v2
    s_barrier
    v_lshlrev_b32 v4, 2, v0
L_ov2:
    buffer_load_dword v2, v4, s[12:15], 0 offen sc1
    s_waitcnt vmcnt(0)
    s_mov_b32 s61, 0
    v_readlane_b32 s64, v2, 0
    v_readlane_b32 s65, v2, 8
    v_readlane_b32 s66, v2, 16
    v_readlane_b32 s67, v2, 24
    v_readlane_b32 s68, v2, 32
    v_readlane_b32 s69, v2, 40
    v_readlane_b32 s70, v2, 48
    v_readlane_b32 s71, v2, 56
    s_add_u32 s61, s61, s64
    s_add_u32 s61, s61, s65
    s_add_u32 s61, s61, s66
    s_add_u32 s61, s61, s67
    s_add_u32 s61, s61, s68
    s_add_u32 s61, s61, s69
    s_add_u32 s61, s61, s70
    s_add_u32 s61, s61, s71
    s_cmp_gt_u32 s61, 256
    s_cbranch_scc1 L_fail
    s_cmp_eq_u32 s61, 256
    s_cbranch_scc1 L_ov3
    s_sleep 4
    s_sub_u32 s6, s6, 1
    s_cbranch_scc0 L_ov2
    s_branch L_fail
L_ov3:
    s_min_u32 s61, s64, 32
    s_sub_u32 s62, 32, s61
    s_mov_b32 s3, 0
    s_add_u32 s5, s61, s60
    s_cmp_lt_u32 s60, s62
    s_cbranch_scc1 L_placed
    s_sub_u32 s60, s60, s62
    s_min_u32 s61, s65, 32
    s_sub_u32 s62, 32, s61
    s_mov_b32 s3, 1
    s_add_u32 s5, s61, s60
    s_cmp_lt_u32 s60, s62
    s_cbranch_scc1 L_placed
    s_sub_u32 s60, s60, s62
    s_min_u32 s61, s66, 32
    s_sub_u32 s62, 32, s61
    s_mov_b32 s3, 2
    s_add_u32 s5, s61, s60
    s_cmp_lt_u32 s60, s62
    s_cbranch_scc1 L_placed
    s_sub_u32 s60, s60, s62
    s_min_u32 s61, s67, 32
    s_sub_u32 s62, 32, s61
    s_mov_b32 s3, 3
    s_add_u32 s5, s61, s60
    s_cmp_lt_u32 s60, s62
    s_cbranch_scc1 L_placed
    s_sub_u32 s60, s60, s62
    s_min_u32 s61, s68, 32
    s_sub_u32 s62, 32, s61
    s_mov_b32 s3, 4
    s_add_u32 s5, s61, s60
    s_cmp_lt_u32 s60, s62
    s_cbranch_scc1 L_placed
    s_sub_u32 s60, s60, s62
    s_min_u32 s61, s69, 32
    s_sub_u32 s62, 32, s61
    s_mov_b32 s3, 5
    s_add_u32 s5, s61, s60
    s_cmp_lt_u32 s60, s62
    s_cbranch_scc1 L_placed
    s_sub_u32 s60, s60, s62
    s_min_u32 s61, s70, 32
    s_sub_u32 s62, 32, s61
    s_mov_b32 s3, 6
    s_add_u32 s5, s61, s60
    s_cmp_lt_u32 s60, s62
    s_cbranch_scc1 L_placed
    s_sub_u32 s60, s60, s62
    s_min_u32 s61, s71, 32
    s_sub_u32 s62, 32, s61
    s_mov_b32 s3, 7
    s_add_u32 s5, s61, s60
    s_cmp_lt_u32 s60, s62
    s_cbranch_scc1 L_placed
    s_sub_u32 s60, s60, s62
L_fail:
    v_mov_b32 v2, 1
    s_mov_b64 exec, 1
    buffer_atomic_add v2, off, s[12:15], 0 offset:4
    s_waitcnt vmcnt(0)
L_end:
    s_endpgm
L_chain:
    s_mul_i32 s64, s5, 11
    s_lshr_b32 s64, s64, 5
    s_mul_i32 s60, s64, 3
    s_sub_u32 s65, s5, s60
    s_lshl_b32 s66, s5, 2
    s_add_u32 s66, s66, s4
    s_lshl_b32 s96, s3, 2
    s_add_u32 s96, s96, s64
    v_lshlrev_b32 v2, 4, v0
    v_and_b32 v16, 15, v0
    v_lshrrev_b32 v17, 4, v0
    v_lshlrev_b32 v18, 5, v16
    v_lshl_add_u32 v3, v17, 3, v18
    v_lshrrev_b32 v19, 1, v17
    v_and_b32 v20, 1, v17
    v_lshl_add_u32 v18, v19, 9, v18
    v_lshl_add_u32 v18, v20, 4, v18
    s_mul_i32 s60, s4, 5120
    v_add_u32 v4, s60, v18
    s_mul_i32 s60, s4, 6144
    v_add_u32 v5, s60, v18
    s_mul_i32 s60, s3, 81920
    s_add_u32 s68, s60, 65536
    s_lshl_b32 s61, s66, 9
    s_add_u32 s69, s68, s61
    s_mul_i32 s60, s3, 147456
    s_add_u32 s60, s60, 720896
    s_lshl_b32 s61, s4, 10
    s_add_u32 s60, s60, s61
    s_mul_i32 s61, s5, 3072
    s_add_u32 s71, s60, s61
    s_add_u32 s61, s65, 1
    s_cmp_eq_u32 s61, 3
    s_cselect_b32 s61, 0, s61
    s_mul_i32 s62, s64, 3
    s_add_u32 s63, s62, s61
    s_mul_i32 s63, s63, 3072
    s_add_u32 s73, s60, s63
    s_add_u32 s61, s61, 1
    s_cmp_eq_u32 s61, 3
    s_cselect_b32 s61, 0, s61
    s_add_u32 s63, s62, s61
    s_mul_i32 s63, s63, 3072
    s_add_u32 s74, s60, s63
    s_mul_i32 s60, s3, 98304
    s_add_u32 s77, s60, 1900544
    s_lshl_b32 s61, s66, 9
    s_add_u32 s75, s77, s61
    s_lshl_b32 s60, s66, 12
    s_lshl_b32 s61, s3, 9
    s_add_u32 s60, s60, s61
    s_add_u32 s78, s60, 77594624
    s_lshl_b32 s60, s3, 8
    s_lshl_b32 s61, s66, 2
    s_add_u32 s60, s60, s61
    s_add_u32 s87, s60, 16384
    v_mov_b32 v24, -1
    v_mov_b32 v25, -1
    v_mov_b32 v26, -1
    v_mov_b32 v27, -1
    v_mov_b32 v28, 0
    s_mov_b64 exec, 1
    buffer_store_dword v28, off, s[8:11], s87 sc1
    s_mov_b64 exec, -1
    s_add_u32 s60, s75, 0
    buffer_store_dwordx2 v[24:25], v3, s[8:11], s60 offen sc1
    s_add_u32 s60, s75, 24576
    buffer_store_dwordx2 v[24:25], v3, s[8:11], s60 offen sc1
    s_cmp_eq_u32 s4, 3
    s_cbranch_scc1 L_i3_71
    s_add_u32 s60, s71, 0
    buffer_store_dwordx4 v[24:27], v2, s[8:11], s60 offen sc1
    s_add_u32 s60, s71, 36864
    buffer_store_dwordx4 v[24:27], v2, s[8:11], s60 offen sc1
L_i3_71:
    s_cmp_ge_u32 s66, 40
    s_cbranch_scc1 L_i4_72
    s_add_u32 s60, s78, 0
    buffer_store_dwordx2 v[24:25], v3, s[8:11], s60 offen sc1
    s_add_u32 s60, s69, 20480
    buffer_store_dwordx2 v[24:25], v3, s[8:11], s60 offen sc1
    s_add_u32 s60, s78, 163840
    buffer_store_dwordx2 v[24:25], v3, s[8:11], s60 offen sc1
    s_add_u32 s60, s69, 40960
    buffer_store_dwordx2 v[24:25], v3, s[8:11], s60 offen sc1
L_i4_72:
    s_waitcnt vmcnt(0)
    s_barrier
    s_cmp_lg_u32 s4, 0
    s_cbranch_scc1 L_arr_73
    s_and_b32 s60, s2, 7
    s_lshl_b32 s60, s60, 5
    s_add_u32 s60, s60, 16
    v_mov_b32 v1, 1
    s_mov_b64 exec, 1
    buffer_atomic_add v1, off, s[12:15], s60
    s_mov_b64 exec, -1
L_arr_73:
    s_mov_b32 s44, s20
    s_and_b32 s45, s21, 0xffff
    s_mov_b32 s46, 7864320
    s_mov_b32 s47, 0x20000
    s_mov_b32 s48, s22
    s_and_b32 s49, s23, 0xffff
    s_mov_b32 s50, 7864320
    s_mov_b32 s51, 0x20000
    s_mov_b32 s52, s24
    s_and_b32 s53, s25, 0xffff
    s_mov_b32 s54, 7864320
    s_mov_b32 s55, 0x20000
    s_mov_b32 s56, s26
    s_and_b32 s57, s27, 0xffff
    s_mov_b32 s58, 7864320
    s_mov_b32 s59, 0x20000
    v_lshrrev_b32 v21, 3, v0
    v_and_b32 v22, 7, v0
    s_mul_i32 s60, s4, 40
    v_add_u32 v23, s60, v21
    s_mov_b32 s61, 12288
    v_mul_lo_u32 v30, s61, v23
    v_lshl_add_u32 v30, v22, 4, v30
    s_mul_i32 s60, s96, 384
    s_lshl_b32 s61, s65, 7
    s_add_u32 s60, s60, s61
    v_add_u32 v30, s60, v30
    s_mul_i32 s60, s4, 5120
    s_add_u32 m0, s60, 102400
    s_mov_b32 s61, 0
    buffer_load_dwordx4 v30, s[44:47], s61 offen nt lds
    s_add_u32 m0, m0, 1024
    s_add_u32 s61, s61, 98304
    buffer_load_dwordx4 v30, s[44:47], s61 offen nt lds
    s_add_u32 m0, m0, 1024
    s_add_u32 s61, s61, 98304
    buffer_load_dwordx4 v30, s[44:47], s61 offen nt lds
    s_add_u32 m0, m0, 1024
    s_add_u32 s61, s61, 98304
    buffer_load_dwordx4 v30, s[44:47], s61 offen nt lds
    s_add_u32 m0, m0, 1024
    s_add_u32 s61, s61, 98304
    buffer_load_dwordx4 v30, s[44:47], s61 offen nt lds
    s_mul_i32 s60, s4, 5120
    s_add_u32 m0, s60, 122880
    s_mov_b32 s61, 0
    buffer_load_dwordx4 v30, s[48:51], s61 offen nt lds
    s_add_u32 m0, m0, 1024
    s_add_u32 s61, s61, 98304
    buffer_load_dwordx4 v30, s[48:51], s61 offen nt lds
    s_add_u32 m0, m0, 1024
    s_add_u32 s61, s61, 98304
    buffer_load_dwordx4 v30, s[48:51], s61 offen nt lds
    s_add_u32 m0, m0, 1024
    s_add_u32 s61, s61, 98304
    buffer_load_dwordx4 v30, s[48:51], s61 offen nt lds
    s_add_u32 m0, m0, 1024
    s_add_u32 s61, s61, 98304
    buffer_load_dwordx4 v30, s[48:51], s61 offen nt lds
    s_mul_i32 s60, s4, 5120
    s_add_u32 m0, s60, 143360
    s_mov_b32 s61, 0
    buffer_load_dwordx4 v30, s[52:55], s61 offen nt lds
    s_add_u32 m0, m0, 1024
    s_add_u32 s61, s61, 98304
    buffer_load_dwordx4 v30, s[52:55], s61 offen nt lds
    s_add_u32 m0, m0, 1024
    s_add_u32 s61, s61, 98304
    buffer_load_dwordx4 v30, s[52:55], s61 offen nt lds
    s_add_u32 m0, m0, 1024
    s_add_u32 s61, s61, 98304
    buffer_load_dwordx4 v30, s[52:55], s61 offen nt lds
    s_add_u32 m0, m0, 1024
    s_add_u32 s61, s61, 98304
    buffer_load_dwordx4 v30, s[52:55], s61 offen nt lds
    s_mul_i32 s60, s4, 5120
    s_add_u32 m0, s60, 0
    s_mov_b32 s61, 1966080
    buffer_load_dwordx4 v30, s[44:47], s61 offen nt lds
    s_add_u32 m0, m0, 1024
    s_add_u32 s61, s61, 98304
    buffer_load_dwordx4 v30, s[44:47], s61 offen nt lds
    s_add_u32 m0, m0, 1024
    s_add_u32 s61, s61, 98304
    buffer_load_dwordx4 v30, s[44:47], s61 offen nt lds
    s_add_u32 m0, m0, 1024
    s_add_u32 s61, s61, 98304
    buffer_load_dwordx4 v30, s[44:47], s61 offen nt lds
    s_add_u32 m0, m0, 1024
    s_add_u32 s61, s61, 98304
    buffer_load_dwordx4 v30, s[44:47], s61 offen nt lds
    s_mul_i32 s60, s4, 5120
    s_add_u32 m0, s60, 20480
    s_mov_b32 s61, 1966080
    buffer_load_dwordx4 v30, s[48:51], s61 offen nt lds
    s_add_u32 m0, m0, 1024
    s_add_u32 s61, s61, 98304
    buffer_load_dwordx4 v30, s[48:51], s61 offen nt lds
    s_add_u32 m0, m0, 1024
    s_add_u32 s61, s61, 98304
    buffer_load_dwordx4 v30, s[48:51], s61 offen nt lds
    s_add_u32 m0, m0, 1024
    s_add_u32 s61, s61, 98304
    buffer_load_dwordx4 v30, s[48:51], s61 offen nt lds
    s_add_u32 m0, m0, 1024
    s_add_u32 s61, s61, 98304
    buffer_load_dwordx4 v30, s[48:51], s61 offen nt lds
    s_mul_i32 s60, s4, 5120
    s_add_u32 m0, s60, 40960
    s_mov_b32 s61, 1966080
    buffer_load_dwordx4 v30, s[52:55], s61 offen nt lds
    s_add_u32 m0, m0, 1024
    s_add_u32 s61, s61, 98304
    buffer_load_dwordx4 v30, s[52:55], s61 offen nt lds
    s_add_u32 m0, m0, 1024
    s_add_u32 s61, s61, 98304
    buffer_load_dwordx4 v30, s[52:55], s61 offen nt lds
    s_add_u32 m0, m0, 1024
    s_add_u32 s61, s61, 98304
    buffer_load_dwordx4 v30, s[52:55], s61 offen nt lds
    s_add_u32 m0, m0, 1024
    s_add_u32 s61, s61, 98304
    buffer_load_dwordx4 v30, s[52:55], s61 offen nt lds
    s_min_u32 s61, s5, 9
    s_lshl_b32 s61, s61, 7
    s_mul_i32 s60, s3, 983040
    s_add_u32 s60, s60, s61
    s_mul_i32 s61, s4, 192
    v_add_u32 v23, s61, v21
    v_mul_u32_u24 v31, 1280, v23
    v_lshl_add_u32 v31, v22, 4, v31
    v_add_u32 v31, s60, v31
    v_bfe_u32 v21, v0, 2, 2
    v_lshl_add_u32 v21, v17, 3, v21
    v_lshlrev_b32 v21, 7, v21
    v_bfe_u32 v22, v0, 1, 1
    v_lshl_add_u32 v33, v22, 5, v21
    v_and_b32 v22, 1, v0
    v_lshl_add_u32 v33, v22, 3, v33
    s_lshr_b32 s60, s4, 1
    s_lshl_b32 s60, s60, 6
    s_and_b32 s61, s4, 1
    s_lshl_b32 s61, s61, 4
    s_add_u32 s60, s60, s61
    v_add_u32 v33, s60, v33
    v_and_b32 v22, 3, v0
    v_lshl_add_u32 v34, v22, 3, v21
    s_lshl_b32 s60, s4, 5
    v_add_u32 v34, s60, v34
    v_add_u32 v32, 102400, v33
    v_add_u32 v35, 102400, v34
    v_lshrrev_b32 v21, 3, v16
    v_lshlrev_b32 v21, 4, v21
    v_bfe_u32 v22, v16, 2, 1
    v_lshl_add_u32 v21, v22, 2, v21
    v_and_b32 v22, 3, v16
    v_add_u32 v21, v21, v22
    s_and_b32 s60, s4, 1
    s_lshl_b32 s60, s60, 3
    v_add_u32 v21, s60, v21
    v_lshl_add_u32 v21, v20, 5, v21
    v_lshlrev_b32 v21, 4, v21
    v_lshl_add_u32 v21, v19, 10, v21
    s_mul_i32 s60, s96, 36864
    s_mul_i32 s61, s3, 1032192
    s_add_u32 s60, s60, s61
    s_lshl_b32 s61, s65, 12
    s_add_u32 s60, s60, s61
    s_add_u32 s61, s60, 12288
    v_add_u32 v7, s61, v21
    s_and_b32 s62, s4, 1
    s_lshl_b32 s62, s62, 4
    v_add_u32 v21, s62, v16
    v_lshl_add_u32 v22, v20, 5, v21
    v_lshlrev_b32 v22, 4, v22
    v_lshl_add_u32 v22, v19, 10, v22
    s_lshr_b32 s63, s4, 1
    s_lshl_b32 s61, s63, 11
    s_add_u32 s61, s61, s60
    s_add_u32 s61, s61, 24576
    v_add_u32 v12, s61, v22
    v_lshlrev_b32 v21, 4, v21
    v_lshl_add_u32 v21, v20, 9, v21
    s_mov_b32 s61, 98304
    v_mul_lo_u32 v22, s61, v19
    v_add_u32 v21, v21, v22
    s_mul_i32 s60, s96, 6144
    s_mul_i32 s62, s3, 172032
    s_add_u32 s60, s60, s62
    s_lshl_b32 s62, s65, 10
    s_add_u32 s60, s60, s62
    s_add_u32 s60, s60, 91226112
    s_lshl_b32 s62, s63, 3
    s_add_u32 s62, s62, s60
    s_add_u32 s62, s62, 3072
    v_add_u32 v1, s62, v21
    v_lshrrev_b32 v21, 3, v16
    v_mul_lo_u32 v21, s61, v21
    v_and_b32 v22, 7, v16
    v_lshl_add_u32 v21, v22, 4, v21
    v_lshl_add_u32 v21, v19, 7, v21
    v_lshl_add_u32 v21, v20, 9, v21
    v_add_u32 v13, s60, v21
    s_mul_i32 s60, s64, 9
    s_add_u32 s60, s60, s65
    s_add_u32 s60, s60, 3
    v_and_b32 v21, 1, v0
    v_mul_u32_u24 v21, 3, v21
    v_add_u32 v21, s60, v21
    v_lshlrev_b32 v6, 2, v21
    s_lshl_b32 s60, s3, 8
    s_add_u32 s86, s60, 12288
    s_mov_b32 s88, 0xff00ff00
    s_mov_b32 s89, 0xff00ff00
    s_mov_b32 s90, 0xff00ff00
    s_mov_b32 s91, 0x00ff00ff
    v_lshrrev_b32 v21, 3, v16
    v_and_b32 v22, 7, v16
    v_cmp_ne_u32 vcc, v21, v20
    s_nop 1
    v_cndmask_b32 v22, v22, 15, vcc
    v_mov_b32 v21, 0x3f80
    v_mov_b32 v23, 0x3f800000
    v_cmp_eq_u32 vcc, 0, v22
    s_nop 1
    v_cndmask_b32 v8, 0, v21, vcc
    v_cmp_eq_u32 vcc, 1, v22
    s_nop 1
    v_cndmask_b32 v8, v8, v23, vcc
    v_cmp_eq_u32 vcc, 2, v22
    s_nop 1
    v_cndmask_b32 v9, 0, v21, vcc
    v_cmp_eq_u32 vcc, 3, v22
    s_nop 1
    v_cndmask_b32 v9, v9, v23, vcc
    v_cmp_eq_u32 vcc, 4, v22
    s_nop 1
    v_cndmask_b32 v10, 0, v21, vcc
    v_cmp_eq_u32 vcc, 5, v22
    s_nop 1
    v_cndmask_b32 v10, v10, v23, vcc
    v_cmp_eq_u32 vcc, 6, v22
    s_nop 1
    v_cndmask_b32 v11, 0, v21, vcc
    v_cmp_eq_u32 vcc, 7, v22
    s_nop 1
    v_cndmask_b32 v11, v11, v23, vcc
    v_lshlrev_b32 v21, 4, v16
    v_lshl_add_u32 v21, v19, 8, v21
    v_lshl_add_u32 v15, v20, 3, v21
    s_waitcnt vmcnt(15)
    s_barrier
    s_cmp_lg_u32 s4, 0
    s_cbranch_scc1 L_tw_75
    ds_read_b64_tr_b16 a[0:1], v32 offset:0
    ds_read_b64_tr_b16 a[2:3], v32 offset:512
    ds_read_b64_tr_b16 a[4:5], v32 offset:4096
    ds_read_b64_tr_b16 a[6:7], v32 offset:4608
    ds_read_b64_tr_b16 a[8:9], v32 offset:8192
    ds_read_b64_tr_b16 a[10:11], v32 offset:8704
    ds_read_b64_tr_b16 a[12:13], v32 offset:12288
    ds_read_b64_tr_b16 a[14:15], v32 offset:12800
    ds_read_b64_tr_b16 a[16:17], v32 offset:16384
    ds_read_b64_tr_b16 a[18:19], v32 offset:16896
    ds_read_b64_tr_b16 a[80:81], v32 offset:20480
    ds_read_b64_tr_b16 a[82:83], v32 offset:20992
    ds_read_b64_tr_b16 a[84:85], v32 offset:24576
    ds_read_b64_tr_b16 a[86:87], v32 offset:25088
    ds_read_b64_tr_b16 a[88:89], v32 offset:28672
    ds_read_b64_tr_b16 a[90:91], v32 offset:29184
    ds_read_b64_tr_b16 a[92:93], v32 offset:32768
    ds_read_b64_tr_b16 a[94:95], v32 offset:33280
    ds_read_b64_tr_b16 a[96:97], v32 offset:36864
    ds_read_b64_tr_b16 a[98:99], v32 offset:37376
    ds_read_b64_tr_b16 a[160:161], v35 offset:40960
    ds_read_b64_tr_b16 a[162:163], v35 offset:41472
    ds_read_b64_tr_b16 a[164:165], v35 offset:45056
    ds_read_b64_tr_b16 a[166:167], v35 offset:45568
    ds_read_b64_tr_b16 a[168:169], v35 offset:49152
    ds_read_b64_tr_b16 a[170:171], v35 offset:49664
    ds_read_b64_tr_b16 a[172:173], v35 offset:53248
    ds_read_b64_tr_b16 a[174:175], v35 offset:53760
    ds_read_b64_tr_b16 a[176:177], v35 offset:57344
    ds_read_b64_tr_b16 a[178:179], v35 offset:57856
    s_branch L_tk_74
L_tw_75:
    s_cmp_lg_u32 s4, 1
    s_cbranch_scc1 L_tw_76
    ds_read_b64_tr_b16 a[60:61], v32 offset:0
    ds_read_b64_tr_b16 a[62:63], v32 offset:512
    ds_read_b64_tr_b16 a[64:65], v32 offset:4096
    ds_read_b64_tr_b16 a[66:67], v32 offset:4608
    ds_read_b64_tr_b16 a[68:69], v32 offset:8192
    ds_read_b64_tr_b16 a[70:71], v32 offset:8704
    ds_read_b64_tr_b16 a[72:73], v32 offset:12288
    ds_read_b64_tr_b16 a[74:75], v32 offset:12800
    ds_read_b64_tr_b16 a[76:77], v32 offset:16384
    ds_read_b64_tr_b16 a[78:79], v32 offset:16896
    ds_read_b64_tr_b16 a[140:141], v32 offset:20480
    ds_read_b64_tr_b16 a[142:143], v32 offset:20992
    ds_read_b64_tr_b16 a[144:145], v32 offset:24576
    ds_read_b64_tr_b16 a[146:147], v32 offset:25088
    ds_read_b64_tr_b16 a[148:149], v32 offset:28672
    ds_read_b64_tr_b16 a[150:151], v32 offset:29184
    ds_read_b64_tr_b16 a[152:153], v32 offset:32768
    ds_read_b64_tr_b16 a[154:155], v32 offset:33280
    ds_read_b64_tr_b16 a[156:157], v32 offset:36864
    ds_read_b64_tr_b16 a[158:159], v32 offset:37376
    ds_read_b64_tr_b16 a[220:221], v35 offset:40960
    ds_read_b64_tr_b16 a[222:223], v35 offset:41472
    ds_read_b64_tr_b16 a[224:225], v35 offset:45056
    ds_read_b64_tr_b16 a[226:227], v35 offset:45568
    ds_read_b64_tr_b16 a[228:229], v35 offset:49152
    ds_read_b64_tr_b16 a[230:231], v35 offset:49664
    ds_read_b64_tr_b16 a[232:233], v35 offset:53248
    ds_read_b64_tr_b16 a[234:235], v35 offset:53760
    ds_read_b64_tr_b16 a[236:237], v35 offset:57344
    ds_read_b64_tr_b16 a[238:239], v35 offset:57856
    s_branch L_tk_74
L_tw_76:
    s_cmp_lg_u32 s4, 2
    s_cbranch_scc1 L_tw_77
    ds_read_b64_tr_b16 a[40:41], v32 offset:0
    ds_read_b64_tr_b16 a[42:43], v32 offset:512
    ds_read_b64_tr_b16 a[44:45], v32 offset:4096
    ds_read_b64_tr_b16 a[46:47], v32 offset:4608
    ds_read_b64_tr_b16 a[48:49], v32 offset:8192
    ds_read_b64_tr_b16 a[50:51], v32 offset:8704
    ds_read_b64_tr_b16 a[52:53], v32 offset:12288
    ds_read_b64_tr_b16 a[54:55], v32 offset:12800
    ds_read_b64_tr_b16 a[56:57], v32 offset:16384
    ds_read_b64_tr_b16 a[58:59], v32 offset:16896
    ds_read_b64_tr_b16 a[120:121], v32 offset:20480
    ds_read_b64_tr_b16 a[122:123], v32 offset:20992
    ds_read_b64_tr_b16 a[124:125], v32 offset:24576
    ds_read_b64_tr_b16 a[126:127], v32 offset:25088
    ds_read_b64_tr_b16 a[128:129], v32 offset:28672
    ds_read_b64_tr_b16 a[130:131], v32 offset:29184
    ds_read_b64_tr_b16 a[132:133], v32 offset:32768
    ds_read_b64_tr_b16 a[134:135], v32 offset:33280
    ds_read_b64_tr_b16 a[136:137], v32 offset:36864
    ds_read_b64_tr_b16 a[138:139], v32 offset:37376
    ds_read_b64_tr_b16 a[200:201], v35 offset:40960
    ds_read_b64_tr_b16 a[202:203], v35 offset:41472
    ds_read_b64_tr_b16 a[204:205], v35 offset:45056
    ds_read_b64_tr_b16 a[206:207], v35 offset:45568
    ds_read_b64_tr_b16 a[208:209], v35 offset:49152
    ds_read_b64_tr_b16 a[210:211], v35 offset:49664
    ds_read_b64_tr_b16 a[212:213], v35 offset:53248
    ds_read_b64_tr_b16 a[214:215], v35 offset:53760
    ds_read_b64_tr_b16 a[216:217], v35 offset:57344
    ds_read_b64_tr_b16 a[218:219], v35 offset:57856
    s_branch L_tk_74
L_tw_77:
    ds_read_b64_tr_b16 a[20:21], v32 offset:0
    ds_read_b64_tr_b16 a[22:23], v32 offset:512
    ds_read_b64_tr_b16 a[24:25], v32 offset:4096
    ds_read_b64_tr_b16 a[26:27], v32 offset:4608
    ds_read_b64_tr_b16 a[28:29], v32 offset:8192
    ds_read_b64_tr_b16 a[30:31], v32 offset:8704
    ds_read_b64_tr_b16 a[32:33], v32 offset:12288
    ds_read_b64_tr_b16 a[34:35], v32 offset:12800
    ds_read_b64_tr_b16 a[36:37], v32 offset:16384
    ds_read_b64_tr_b16 a[38:39], v32 offset:16896
    ds_read_b64_tr_b16 a[100:101], v32 offset:20480
    ds_read_b64_tr_b16 a[102:103], v32 offset:20992
    ds_read_b64_tr_b16 a[104:105], v32 offset:24576
    ds_read_b64_tr_b16 a[106:107], v32 offset:25088
    ds_read_b64_tr_b16 a[108:109], v32 offset:28672
    ds_read_b64_tr_b16 a[110:111], v32 offset:29184
    ds_read_b64_tr_b16 a[112:113], v32 offset:32768
    ds_read_b64_tr_b16 a[114:115], v32 offset:33280
    ds_read_b64_tr_b16 a[116:117], v32 offset:36864
    ds_read_b64_tr_b16 a[118:119], v32 offset:37376
    ds_read_b64_tr_b16 a[180:181], v35 offset:40960
    ds_read_b64_tr_b16 a[182:183], v35 offset:41472
    ds_read_b64_tr_b16 a[184:185], v35 offset:45056
    ds_read_b64_tr_b16 a[186:187], v35 offset:45568
    ds_read_b64_tr_b16 a[188:189], v35 offset:49152
    ds_read_b64_tr_b16 a[190:191], v35 offset:49664
    ds_read_b64_tr_b16 a[192:193], v35 offset:53248
    ds_read_b64_tr_b16 a[194:195], v35 offset:53760
    ds_read_b64_tr_b16 a[196:197], v35 offset:57344
    ds_read_b64_tr_b16 a[198:199], v35 offset:57856
L_tk_74:
    s_waitcnt lgkmcnt(0)
    s_barrier
    s_mul_i32 s60, s4, 5120
    s_add_u32 m0, s60, 102400
    s_mov_b32 s61, 3932160
    buffer_load_dwordx4 v30, s[44:47], s61 offen nt lds
    s_add_u32 m0, m0, 1024
    s_add_u32 s61, s61, 98304
    buffer_load_dwordx4 v30, s[44:47], s61 offen nt lds
    s_add_u32 m0, m0, 1024
    s_add_u32 s61, s61, 98304
    buffer_load_dwordx4 v30, s[44:47], s61 offen nt lds
    s_add_u32 m0, m0, 1024
    s_add_u32 s61, s61, 98304
    buffer_load_dwordx4 v30, s[44:47], s61 offen nt lds
    s_add_u32 m0, m0, 1024
    s_add_u32 s61, s61, 98304
    buffer_load_dwordx4 v30, s[44:47], s61 offen nt lds
    s_mul_i32 s60, s4, 5120
    s_add_u32 m0, s60, 122880
    s_mov_b32 s61, 3932160
    buffer_load_dwordx4 v30, s[48:51], s61 offen nt lds
    s_add_u32 m0, m0, 1024
    s_add_u32 s61, s61, 98304
    buffer_load_dwordx4 v30, s[48:51], s61 offen nt lds
    s_add_u32 m0, m0, 1024
    s_add_u32 s61, s61, 98304
    buffer_load_dwordx4 v30, s[48:51], s61 offen nt lds
    s_add_u32 m0, m0, 1024
    s_add_u32 s61, s61, 98304
    buffer_load_dwordx4 v30, s[48:51], s61 offen nt lds
    s_add_u32 m0, m0, 1024
    s_add_u32 s61, s61, 98304
    buffer_load_dwordx4 v30, s[48:51], s61 offen nt lds
    s_mul_i32 s60, s4, 5120
    s_add_u32 m0, s60, 143360
    s_mov_b32 s61, 3932160
    buffer_load_dwordx4 v30, s[52:55], s61 offen nt lds
    s_add_u32 m0, m0, 1024
    s_add_u32 s61, s61, 98304
    buffer_load_dwordx4 v30, s[52:55], s61 offen nt lds
    s_add_u32 m0, m0, 1024
    s_add_u32 s61, s61, 98304
    buffer_load_dwordx4 v30, s[52:55], s61 offen nt lds
    s_add_u32 m0, m0, 1024
    s_add_u32 s61, s61, 98304
    buffer_load_dwordx4 v30, s[52:55], s61 offen nt lds
    s_add_u32 m0, m0, 1024
    s_add_u32 s61, s61, 98304
    buffer_load_dwordx4 v30, s[52:55], s61 offen nt lds
    s_waitcnt vmcnt(15)
    s_barrier
    s_cmp_lg_u32 s4, 0
    s_cbranch_scc1 L_tw_80
    ds_read_b64_tr_b16 a[20:21], v33 offset:0
    ds_read_b64_tr_b16 a[22:23], v33 offset:512
    ds_read_b64_tr_b16 a[24:25], v33 offset:4096
    ds_read_b64_tr_b16 a[26:27], v33 offset:4608
    ds_read_b64_tr_b16 a[28:29], v33 offset:8192
    ds_read_b64_tr_b16 a[30:31], v33 offset:8704
    ds_read_b64_tr_b16 a[32:33], v33 offset:12288
    ds_read_b64_tr_b16 a[34:35], v33 offset:12800
    ds_read_b64_tr_b16 a[36:37], v33 offset:16384
    ds_read_b64_tr_b16 a[38:39], v33 offset:16896
    ds_read_b64_tr_b16 a[100:101], v33 offset:20480
    ds_read_b64_tr_b16 a[102:103], v33 offset:20992
    ds_read_b64_tr_b16 a[104:105], v33 offset:24576
    ds_read_b64_tr_b16 a[106:107], v33 offset:25088
    ds_read_b64_tr_b16 a[108:109], v33 offset:28672
    ds_read_b64_tr_b16 a[110:111], v33 offset:29184
    ds_read_b64_tr_b16 a[112:113], v33 offset:32768
    ds_read_b64_tr_b16 a[114:115], v33 offset:33280
    ds_read_b64_tr_b16 a[116:117], v33 offset:36864
    ds_read_b64_tr_b16 a[118:119], v33 offset:37376
    ds_read_b64_tr_b16 a[180:181], v34 offset:40960
    ds_read_b64_tr_b16 a[182:183], v34 offset:41472
    ds_read_b64_tr_b16 a[184:185], v34 offset:45056
    ds_read_b64_tr_b16 a[186:187], v34 offset:45568
    ds_read_b64_tr_b16 a[188:189], v34 offset:49152
    ds_read_b64_tr_b16 a[190:191], v34 offset:49664
    ds_read_b64_tr_b16 a[192:193], v34 offset:53248
    ds_read_b64_tr_b16 a[194:195], v34 offset:53760
    ds_read_b64_tr_b16 a[196:197], v34 offset:57344
    ds_read_b64_tr_b16 a[198:199], v34 offset:57856
    s_branch L_tk_79
L_tw_80:
    s_cmp_lg_u32 s4, 1
    s_cbranch_scc1 L_tw_81
    ds_read_b64_tr_b16 a[0:1], v33 offset:0
    ds_read_b64_tr_b16 a[2:3], v33 offset:512
    ds_read_b64_tr_b16 a[4:5], v33 offset:4096
    ds_read_b64_tr_b16 a[6:7], v33 offset:4608
    ds_read_b64_tr_b16 a[8:9], v33 offset:8192
    ds_read_b64_tr_b16 a[10:11], v33 offset:8704
    ds_read_b64_tr_b16 a[12:13], v33 offset:12288
    ds_read_b64_tr_b16 a[14:15], v33 offset:12800
    ds_read_b64_tr_b16 a[16:17], v33 offset:16384
    ds_read_b64_tr_b16 a[18:19], v33 offset:16896
    ds_read_b64_tr_b16 a[80:81], v33 offset:20480
    ds_read_b64_tr_b16 a[82:83], v33 offset:20992
    ds_read_b64_tr_b16 a[84:85], v33 offset:24576
    ds_read_b64_tr_b16 a[86:87], v33 offset:25088
    ds_read_b64_tr_b16 a[88:89], v33 offset:28672
    ds_read_b64_tr_b16 a[90:91], v33 offset:29184
    ds_read_b64_tr_b16 a[92:93], v33 offset:32768
    ds_read_b64_tr_b16 a[94:95], v33 offset:33280
    ds_read_b64_tr_b16 a[96:97], v33 offset:36864
    ds_read_b64_tr_b16 a[98:99], v33 offset:37376
    ds_read_b64_tr_b16 a[160:161], v34 offset:40960
    ds_read_b64_tr_b16 a[162:163], v34 offset:41472
    ds_read_b64_tr_b16 a[164:165], v34 offset:45056
    ds_read_b64_tr_b16 a[166:167], v34 offset:45568
    ds_read_b64_tr_b16 a[168:169], v34 offset:49152
    ds_read_b64_tr_b16 a[170:171], v34 offset:49664
    ds_read_b64_tr_b16 a[172:173], v34 offset:53248
    ds_read_b64_tr_b16 a[174:175], v34 offset:53760
    ds_read_b64_tr_b16 a[176:177], v34 offset:57344
    ds_read_b64_tr_b16 a[178:179], v34 offset:57856
    s_branch L_tk_79
L_tw_81:
    s_cmp_lg_u32 s4, 2
    s_cbranch_scc1 L_tw_82
    ds_read_b64_tr_b16 a[60:61], v33 offset:0
    ds_read_b64_tr_b16 a[62:63], v33 offset:512
    ds_read_b64_tr_b16 a[64:65], v33 offset:4096
    ds_read_b64_tr_b16 a[66:67], v33 offset:4608
    ds_read_b64_tr_b16 a[68:69], v33 offset:8192
    ds_read_b64_tr_b16 a[70:71], v33 offset:8704
    ds_read_b64_tr_b16 a[72:73], v33 offset:12288
    ds_read_b64_tr_b16 a[74:75], v33 offset:12800
    ds_read_b64_tr_b16 a[76:77], v33 offset:16384
    ds_read_b64_tr_b16 a[78:79], v33 offset:16896
    ds_read_b64_tr_b16 a[140:141], v33 offset:20480
    ds_read_b64_tr_b16 a[142:143], v33 offset:20992
    ds_read_b64_tr_b16 a[144:145], v33 offset:24576
    ds_read_b64_tr_b16 a[146:147], v33 offset:25088
    ds_read_b64_tr_b16 a[148:149], v33 offset:28672
    ds_read_b64_tr_b16 a[150:151], v33 offset:29184
    ds_read_b64_tr_b16 a[152:153], v33 offset:32768
    ds_read_b64_tr_b16 a[154:155], v33 offset:33280
    ds_read_b64_tr_b16 a[156:157], v33 offset:36864
    ds_read_b64_tr_b16 a[158:159], v33 offset:37376
    ds_read_b64_tr_b16 a[220:221], v34 offset:40960
    ds_read_b64_tr_b16 a[222:223], v34 offset:41472
    ds_read_b64_tr_b16 a[224:225], v34 offset:45056
    ds_read_b64_tr_b16 a[226:227], v34 offset:45568
    ds_read_b64_tr_b16 a[228:229], v34 offset:49152
    ds_read_b64_tr_b16 a[230:231], v34 offset:49664
    ds_read_b64_tr_b16 a[232:233], v34 offset:53248
    ds_read_b64_tr_b16 a[234:235], v34 offset:53760
    ds_read_b64_tr_b16 a[236:237], v34 offset:57344
    ds_read_b64_tr_b16 a[238:239], v34 offset:57856
    s_branch L_tk_79
L_tw_82:
    ds_read_b64_tr_b16 a[40:41], v33 offset:0
    ds_read_b64_tr_b16 a[42:43], v33 offset:512
    ds_read_b64_tr_b16 a[44:45], v33 offset:4096
    ds_read_b64_tr_b16 a[46:47], v33 offset:4608
    ds_read_b64_tr_b16 a[48:49], v33 offset:8192
    ds_read_b64_tr_b16 a[50:51], v33 offset:8704
    ds_read_b64_tr_b16 a[52:53], v33 offset:12288
    ds_read_b64_tr_b16 a[54:55], v33 offset:12800
    ds_read_b64_tr_b16 a[56:57], v33 offset:16384
    ds_read_b64_tr_b16 a[58:59], v33 offset:16896
    ds_read_b64_tr_b16 a[120:121], v33 offset:20480
    ds_read_b64_tr_b16 a[122:123], v33 offset:20992
    ds_read_b64_tr_b16 a[124:125], v33 offset:24576
    ds_read_b64_tr_b16 a[126:127], v33 offset:25088
    ds_read_b64_tr_b16 a[128:129], v33 offset:28672
    ds_read_b64_tr_b16 a[130:131], v33 offset:29184
    ds_read_b64_tr_b16 a[132:133], v33 offset:32768
    ds_read_b64_tr_b16 a[134:135], v33 offset:33280
    ds_read_b64_tr_b16 a[136:137], v33 offset:36864
    ds_read_b64_tr_b16 a[138:139], v33 offset:37376
    ds_read_b64_tr_b16 a[200:201], v34 offset:40960
    ds_read_b64_tr_b16 a[202:203], v34 offset:41472
    ds_read_b64_tr_b16 a[204:205], v34 offset:45056
    ds_read_b64_tr_b16 a[206:207], v34 offset:45568
    ds_read_b64_tr_b16 a[208:209], v34 offset:49152
    ds_read_b64_tr_b16 a[210:211], v34 offset:49664
    ds_read_b64_tr_b16 a[212:213], v34 offset:53248
    ds_read_b64_tr_b16 a[214:215], v34 offset:53760
    ds_read_b64_tr_b16 a[216:217], v34 offset:57344
    ds_read_b64_tr_b16 a[218:219], v34 offset:57856
L_tk_79:
    s_waitcnt lgkmcnt(0)
    s_barrier
    s_mul_i32 s60, s4, 5120
    s_add_u32 m0, s60, 0
    s_mov_b32 s61, 5898240
    buffer_load_dwordx4 v30, s[44:47], s61 offen nt lds
    s_add_u32 m0, m0, 1024
    s_add_u32 s61, s61, 98304
    buffer_load_dwordx4 v30, s[44:47], s61 offen nt lds
    s_add_u32 m0, m0, 1024
    s_add_u32 s61, s61, 98304
    buffer_load_dwordx4 v30, s[44:47], s61 offen nt lds
    s_add_u32 m0, m0, 1024
    s_add_u32 s61, s61, 98304
    buffer_load_dwordx4 v30, s[44:47], s61 offen nt lds
    s_add_u32 m0, m0, 1024
    s_add_u32 s61, s61, 98304
    buffer_load_dwordx4 v30, s[44:47], s61 offen nt lds
    s_mul_i32 s60, s4, 5120
    s_add_u32 m0, s60, 20480
    s_mov_b32 s61, 5898240
    buffer_load_dwordx4 v30, s[48:51], s61 offen nt lds
    s_add_u32 m0, m0, 1024
    s_add_u32 s61, s61, 98304
    buffer_load_dwordx4 v30, s[48:51], s61 offen nt lds
    s_add_u32 m0, m0, 1024
    s_add_u32 s61, s61, 98304
    buffer_load_dwordx4 v30, s[48:51], s61 offen nt lds
    s_add_u32 m0, m0, 1024
    s_add_u32 s61, s61, 98304
    buffer_load_dwordx4 v30, s[48:51], s61 offen nt lds
    s_add_u32 m0, m0, 1024
    s_add_u32 s61, s61, 98304
    buffer_load_dwordx4 v30, s[48:51], s61 offen nt lds
    s_mul_i32 s60, s4, 5120
    s_add_u32 m0, s60, 40960
    s_mov_b32 s61, 5898240
    buffer_load_dwordx4 v30, s[52:55], s61 offen nt lds
    s_add_u32 m0, m0, 1024
    s_add_u32 s61, s61, 98304
    buffer_load_dwordx4 v30, s[52:55], s61 offen nt lds
    s_add_u32 m0, m0, 1024
    s_add_u32 s61, s61, 98304
    buffer_load_dwordx4 v30, s[52:55], s61 offen nt lds
    s_add_u32 m0, m0, 1024
    s_add_u32 s61, s61, 98304
    buffer_load_dwordx4 v30, s[52:55], s61 offen nt lds
    s_add_u32 m0, m0, 1024
    s_add_u32 s61, s61, 98304
    buffer_load_dwordx4 v30, s[52:55], s61 offen nt lds
    s_waitcnt vmcnt(15)
    s_barrier
    s_cmp_lg_u32 s4, 0
    s_cbranch_scc1 L_tw_85
    ds_read_b64_tr_b16 a[40:41], v32 offset:0
    ds_read_b64_tr_b16 a[42:43], v32 offset:512
    ds_read_b64_tr_b16 a[44:45], v32 offset:4096
    ds_read_b64_tr_b16 a[46:47], v32 offset:4608
    ds_read_b64_tr_b16 a[48:49], v32 offset:8192
    ds_read_b64_tr_b16 a[50:51], v32 offset:8704
    ds_read_b64_tr_b16 a[52:53], v32 offset:12288
    ds_read_b64_tr_b16 a[54:55], v32 offset:12800
    ds_read_b64_tr_b16 a[56:57], v32 offset:16384
    ds_read_b64_tr_b16 a[58:59], v32 offset:16896
    ds_read_b64_tr_b16 a[120:121], v32 offset:20480
    ds_read_b64_tr_b16 a[122:123], v32 offset:20992
    ds_read_b64_tr_b16 a[124:125], v32 offset:24576
    ds_read_b64_tr_b16 a[126:127], v32 offset:25088
    ds_read_b64_tr_b16 a[128:129], v32 offset:28672
    ds_read_b64_tr_b16 a[130:131], v32 offset:29184
    ds_read_b64_tr_b16 a[132:133], v32 offset:32768
    ds_read_b64_tr_b16 a[134:135], v32 offset:33280
    ds_read_b64_tr_b16 a[136:137], v32 offset:36864
    ds_read_b64_tr_b16 a[138:139], v32 offset:37376
    ds_read_b64_tr_b16 a[200:201], v35 offset:40960
    ds_read_b64_tr_b16 a[202:203], v35 offset:41472
    ds_read_b64_tr_b16 a[204:205], v35 offset:45056
    ds_read_b64_tr_b16 a[206:207], v35 offset:45568
    ds_read_b64_tr_b16 a[208:209], v35 offset:49152
    ds_read_b64_tr_b16 a[210:211], v35 offset:49664
    ds_read_b64_tr_b16 a[212:213], v35 offset:53248
    ds_read_b64_tr_b16 a[214:215], v35 offset:53760
    ds_read_b64_tr_b16 a[216:217], v35 offset:57344
    ds_read_b64_tr_b16 a[218:219], v35 offset:57856
    s_branch L_tk_84
L_tw_85:
    s_cmp_lg_u32 s4, 1
    s_cbranch_scc1 L_tw_86
    ds_read_b64_tr_b16 a[20:21], v32 offset:0
    ds_read_b64_tr_b16 a[22:23], v32 offset:512
    ds_read_b64_tr_b16 a[24:25], v32 offset:4096
    ds_read_b64_tr_b16 a[26:27], v32 offset:4608
    ds_read_b64_tr_b16 a[28:29], v32 offset:8192
    ds_read_b64_tr_b16 a[30:31], v32 offset:8704
    ds_read_b64_tr_b16 a[32:33], v32 offset:12288
    ds_read_b64_tr_b16 a[34:35], v32 offset:12800
    ds_read_b64_tr_b16 a[36:37], v32 offset:16384
    ds_read_b64_tr_b16 a[38:39], v32 offset:16896
    ds_read_b64_tr_b16 a[100:101], v32 offset:20480
    ds_read_b64_tr_b16 a[102:103], v32 offset:20992
    ds_read_b64_tr_b16 a[104:105], v32 offset:24576
    ds_read_b64_tr_b16 a[106:107], v32 offset:25088
    ds_read_b64_tr_b16 a[108:109], v32 offset:28672
    ds_read_b64_tr_b16 a[110:111], v32 offset:29184
    ds_read_b64_tr_b16 a[112:113], v32 offset:32768
    ds_read_b64_tr_b16 a[114:115], v32 offset:33280
    ds_read_b64_tr_b16 a[116:117], v32 offset:36864
    ds_read_b64_tr_b16 a[118:119], v32 offset:37376
    ds_read_b64_tr_b16 a[180:181], v35 offset:40960
    ds_read_b64_tr_b16 a[182:183], v35 offset:41472
    ds_read_b64_tr_b16 a[184:185], v35 offset:45056
    ds_read_b64_tr_b16 a[186:187], v35 offset:45568
    ds_read_b64_tr_b16 a[188:189], v35 offset:49152
    ds_read_b64_tr_b16 a[190:191], v35 offset:49664
    ds_read_b64_tr_b16 a[192:193], v35 offset:53248
    ds_read_b64_tr_b16 a[194:195], v35 offset:53760
    ds_read_b64_tr_b16 a[196:197], v35 offset:57344
    ds_read_b64_tr_b16 a[198:199], v35 offset:57856
    s_branch L_tk_84
L_tw_86:
    s_cmp_lg_u32 s4, 2
    s_cbranch_scc1 L_tw_87
    ds_read_b64_tr_b16 a[0:1], v32 offset:0
    ds_read_b64_tr_b16 a[2:3], v32 offset:512
    ds_read_b64_tr_b16 a[4:5], v32 offset:4096
    ds_read_b64_tr_b16 a[6:7], v32 offset:4608
    ds_read_b64_tr_b16 a[8:9], v32 offset:8192
    ds_read_b64_tr_b16 a[10:11], v32 offset:8704
    ds_read_b64_tr_b16 a[12:13], v32 offset:12288
    ds_read_b64_tr_b16 a[14:15], v32 offset:12800
    ds_read_b64_tr_b16 a[16:17], v32 offset:16384
    ds_read_b64_tr_b16 a[18:19], v32 offset:16896
    ds_read_b64_tr_b16 a[80:81], v32 offset:20480
    ds_read_b64_tr_b16 a[82:83], v32 offset:20992
    ds_read_b64_tr_b16 a[84:85], v32 offset:24576
    ds_read_b64_tr_b16 a[86:87], v32 offset:25088
    ds_read_b64_tr_b16 a[88:89], v32 offset:28672
    ds_read_b64_tr_b16 a[90:91], v32 offset:29184
    ds_read_b64_tr_b16 a[92:93], v32 offset:32768
    ds_read_b64_tr_b16 a[94:95], v32 offset:33280
    ds_read_b64_tr_b16 a[96:97], v32 offset:36864
    ds_read_b64_tr_b16 a[98:99], v32 offset:37376
    ds_read_b64_tr_b16 a[160:161], v35 offset:40960
    ds_read_b64_tr_b16 a[162:163], v35 offset:41472
    ds_read_b64_tr_b16 a[164:165], v35 offset:45056
    ds_read_b64_tr_b16 a[166:167], v35 offset:45568
    ds_read_b64_tr_b16 a[168:169], v35 offset:49152
    ds_read_b64_tr_b16 a[170:171], v35 offset:49664
    ds_read_b64_tr_b16 a[172:173], v35 offset:53248
    ds_read_b64_tr_b16 a[174:175], v35 offset:53760
    ds_read_b64_tr_b16 a[176:177], v35 offset:57344
    ds_read_b64_tr_b16 a[178:179], v35 offset:57856
    s_branch L_tk_84
L_tw_87:
    ds_read_b64_tr_b16 a[60:61], v32 offset:0
    ds_read_b64_tr_b16 a[62:63], v32 offset:512
    ds_read_b64_tr_b16 a[64:65], v32 offset:4096
    ds_read_b64_tr_b16 a[66:67], v32 offset:4608
    ds_read_b64_tr_b16 a[68:69], v32 offset:8192
    ds_read_b64_tr_b16 a[70:71], v32 offset:8704
    ds_read_b64_tr_b16 a[72:73], v32 offset:12288
    ds_read_b64_tr_b16 a[74:75], v32 offset:12800
    ds_read_b64_tr_b16 a[76:77], v32 offset:16384
    ds_read_b64_tr_b16 a[78:79], v32 offset:16896
    ds_read_b64_tr_b16 a[140:141], v32 offset:20480
    ds_read_b64_tr_b16 a[142:143], v32 offset:20992
    ds_read_b64_tr_b16 a[144:145], v32 offset:24576
    ds_read_b64_tr_b16 a[146:147], v32 offset:25088
    ds_read_b64_tr_b16 a[148:149], v32 offset:28672
    ds_read_b64_tr_b16 a[150:151], v32 offset:29184
    ds_read_b64_tr_b16 a[152:153], v32 offset:32768
    ds_read_b64_tr_b16 a[154:155], v32 offset:33280
    ds_read_b64_tr_b16 a[156:157], v32 offset:36864
    ds_read_b64_tr_b16 a[158:159], v32 offset:37376
    ds_read_b64_tr_b16 a[220:221], v35 offset:40960
    ds_read_b64_tr_b16 a[222:223], v35 offset:41472
    ds_read_b64_tr_b16 a[224:225], v35 offset:45056
    ds_read_b64_tr_b16 a[226:227], v35 offset:45568
    ds_read_b64_tr_b16 a[228:229], v35 offset:49152
    ds_read_b64_tr_b16 a[230:231], v35 offset:49664
    ds_read_b64_tr_b16 a[232:233], v35 offset:53248
    ds_read_b64_tr_b16 a[234:235], v35 offset:53760
    ds_read_b64_tr_b16 a[236:237], v35 offset:57344
    ds_read_b64_tr_b16 a[238:239], v35 offset:57856
L_tk_84:
    s_waitcnt lgkmcnt(0)
    s_barrier
    s_mul_i32 s60, s4, 24576
    s_add_u32 m0, s60, 61440
    s_mov_b32 s61, 0
    buffer_load_dwordx4 v31, s[56:59], s61 offen nt lds
    s_add_u32 m0, m0, 1024
    s_add_u32 s61, s61, 10240
    buffer_load_dwordx4 v31, s[56:59], s61 offen nt lds
    s_add_u32 m0, m0, 1024
    s_add_u32 s61, s61, 10240
    buffer_load_dwordx4 v31, s[56:59], s61 offen nt lds
    s_add_u32 m0, m0, 1024
    s_add_u32 s61, s61, 10240
    buffer_load_dwordx4 v31, s[56:59], s61 offen nt lds
    s_add_u32 m0, m0, 1024
    s_add_u32 s61, s61, 10240
    buffer_load_dwordx4 v31, s[56:59], s61 offen nt lds
    s_add_u32 m0, m0, 1024
    s_add_u32 s61, s61, 10240
    buffer_load_dwordx4 v31, s[56:59], s61 offen nt lds
    s_add_u32 m0, m0, 1024
    s_add_u32 s61, s61, 10240
    buffer_load_dwordx4 v31, s[56:59], s61 offen nt lds
    s_add_u32 m0, m0, 1024
    s_add_u32 s61, s61, 10240
    buffer_load_dwordx4 v31, s[56:59], s61 offen nt lds
    s_add_u32 m0, m0, 1024
    s_add_u32 s61, s61, 10240
    buffer_load_dwordx4 v31, s[56:59], s61 offen nt lds
    s_add_u32 m0, m0, 1024
    s_add_u32 s61, s61, 10240
    buffer_load_dwordx4 v31, s[56:59], s61 offen nt lds
    s_add_u32 m0, m0, 1024
    s_add_u32 s61, s61, 10240
    buffer_load_dwordx4 v31, s[56:59], s61 offen nt lds
    s_add_u32 m0, m0, 1024
    s_add_u32 s61, s61, 10240
    buffer_load_dwordx4 v31, s[56:59], s61 offen nt lds
    s_add_u32 m0, m0, 1024
    s_add_u32 s61, s61, 10240
    buffer_load_dwordx4 v31, s[56:59], s61 offen nt lds
    s_add_u32 m0, m0, 1024
    s_add_u32 s61, s61, 10240
    buffer_load_dwordx4 v31, s[56:59], s61 offen nt lds
    s_add_u32 m0, m0, 1024
    s_add_u32 s61, s61, 10240
    buffer_load_dwordx4 v31, s[56:59], s61 offen nt lds
    s_add_u32 m0, m0, 1024
    s_add_u32 s61, s61, 10240
    buffer_load_dwordx4 v31, s[56:59], s61 offen nt lds
    s_add_u32 m0, m0, 1024
    s_add_u32 s61, s61, 10240
    buffer_load_dwordx4 v31, s[56:59], s61 offen nt lds
    s_add_u32 m0, m0, 1024
    s_add_u32 s61, s61, 10240
    buffer_load_dwordx4 v31, s[56:59], s61 offen nt lds
    s_add_u32 m0, m0, 1024
    s_add_u32 s61, s61, 10240
    buffer_load_dwordx4 v31, s[56:59], s61 offen nt lds
    s_add_u32 m0, m0, 1024
    s_add_u32 s61, s61, 10240
    buffer_load_dwordx4 v31, s[56:59], s61 offen nt lds
    s_add_u32 m0, m0, 1024
    s_add_u32 s61, s61, 10240
    buffer_load_dwordx4 v31, s[56:59], s61 offen nt lds
    s_add_u32 m0, m0, 1024
    s_add_u32 s61, s61, 10240
    buffer_load_dwordx4 v31, s[56:59], s61 offen nt lds
    s_add_u32 m0, m0, 1024
    s_add_u32 s61, s61, 10240
    buffer_load_dwordx4 v31, s[56:59], s61 offen nt lds
    s_add_u32 m0, m0, 1024
    s_add_u32 s61, s61, 10240
    buffer_load_dwordx4 v31, s[56:59], s61 offen nt lds
    s_waitcnt vmcnt(24)
    s_barrier
    s_cmp_lg_u32 s4, 0
    s_cbranch_scc1 L_tw_90
    ds_read_b64_tr_b16 a[60:61], v33 offset:0
    ds_read_b64_tr_b16 a[62:63], v33 offset:512
    ds_read_b64_tr_b16 a[64:65], v33 offset:4096
    ds_read_b64_tr_b16 a[66:67], v33 offset:4608
    ds_read_b64_tr_b16 a[68:69], v33 offset:8192
    ds_read_b64_tr_b16 a[70:71], v33 offset:8704
    ds_read_b64_tr_b16 a[72:73], v33 offset:12288
    ds_read_b64_tr_b16 a[74:75], v33 offset:12800
    ds_read_b64_tr_b16 a[76:77], v33 offset:16384
    ds_read_b64_tr_b16 a[78:79], v33 offset:16896
    ds_read_b64_tr_b16 a[140:141], v33 offset:20480
    ds_read_b64_tr_b16 a[142:143], v33 offset:20992
    ds_read_b64_tr_b16 a[144:145], v33 offset:24576
    ds_read_b64_tr_b16 a[146:147], v33 offset:25088
    ds_read_b64_tr_b16 a[148:149], v33 offset:28672
    ds_read_b64_tr_b16 a[150:151], v33 offset:29184
    ds_read_b64_tr_b16 a[152:153], v33 offset:32768
    ds_read_b64_tr_b16 a[154:155], v33 offset:33280
    ds_read_b64_tr_b16 a[156:157], v33 offset:36864
    ds_read_b64_tr_b16 a[158:159], v33 offset:37376
    ds_read_b64_tr_b16 a[220:221], v34 offset:40960
    ds_read_b64_tr_b16 a[222:223], v34 offset:41472
    ds_read_b64_tr_b16 a[224:225], v34 offset:45056
    ds_read_b64_tr_b16 a[226:227], v34 offset:45568
    ds_read_b64_tr_b16 a[228:229], v34 offset:49152
    ds_read_b64_tr_b16 a[230:231], v34 offset:49664
    ds_read_b64_tr_b16 a[232:233], v34 offset:53248
    ds_read_b64_tr_b16 a[234:235], v34 offset:53760
    ds_read_b64_tr_b16 a[236:237], v34 offset:57344
    ds_read_b64_tr_b16 a[238:239], v34 offset:57856
    s_branch L_tk_89
L_tw_90:
    s_cmp_lg_u32 s4, 1
    s_cbranch_scc1 L_tw_91
    ds_read_b64_tr_b16 a[40:41], v33 offset:0
    ds_read_b64_tr_b16 a[42:43], v33 offset:512
    ds_read_b64_tr_b16 a[44:45], v33 offset:4096
    ds_read_b64_tr_b16 a[46:47], v33 offset:4608
    ds_read_b64_tr_b16 a[48:49], v33 offset:8192
    ds_read_b64_tr_b16 a[50:51], v33 offset:8704
    ds_read_b64_tr_b16 a[52:53], v33 offset:12288
    ds_read_b64_tr_b16 a[54:55], v33 offset:12800
    ds_read_b64_tr_b16 a[56:57], v33 offset:16384
    ds_read_b64_tr_b16 a[58:59], v33 offset:16896
    ds_read_b64_tr_b16 a[120:121], v33 offset:20480
    ds_read_b64_tr_b16 a[122:123], v33 offset:20992
    ds_read_b64_tr_b16 a[124:125], v33 offset:24576
    ds_read_b64_tr_b16 a[126:127], v33 offset:25088
    ds_read_b64_tr_b16 a[128:129], v33 offset:28672
    ds_read_b64_tr_b16 a[130:131], v33 offset:29184
    ds_read_b64_tr_b16 a[132:133], v33 offset:32768
    ds_read_b64_tr_b16 a[134:135], v33 offset:33280
    ds_read_b64_tr_b16 a[136:137], v33 offset:36864
    ds_read_b64_tr_b16 a[138:139], v33 offset:37376
    ds_read_b64_tr_b16 a[200:201], v34 offset:40960
    ds_read_b64_tr_b16 a[202:203], v34 offset:41472
    ds_read_b64_tr_b16 a[204:205], v34 offset:45056
    ds_read_b64_tr_b16 a[206:207], v34 offset:45568
    ds_read_b64_tr_b16 a[208:209], v34 offset:49152
    ds_read_b64_tr_b16 a[210:211], v34 offset:49664
    ds_read_b64_tr_b16 a[212:213], v34 offset:53248
    ds_read_b64_tr_b16 a[214:215], v34 offset:53760
    ds_read_b64_tr_b16 a[216:217], v34 offset:57344
    ds_read_b64_tr_b16 a[218:219], v34 offset:57856
    s_branch L_tk_89
L_tw_91:
    s_cmp_lg_u32 s4, 2
    s_cbranch_scc1 L_tw_92
    ds_read_b64_tr_b16 a[20:21], v33 offset:0
    ds_read_b64_tr_b16 a[22:23], v33 offset:512
    ds_read_b64_tr_b16 a[24:25], v33 offset:4096
    ds_read_b64_tr_b16 a[26:27], v33 offset:4608
    ds_read_b64_tr_b16 a[28:29], v33 offset:8192
    ds_read_b64_tr_b16 a[30:31], v33 offset:8704
    ds_read_b64_tr_b16 a[32:33], v33 offset:12288
    ds_read_b64_tr_b16 a[34:35], v33 offset:12800
    ds_read_b64_tr_b16 a[36:37], v33 offset:16384
    ds_read_b64_tr_b16 a[38:39], v33 offset:16896
    ds_read_b64_tr_b16 a[100:101], v33 offset:20480
    ds_read_b64_tr_b16 a[102:103], v33 offset:20992
    ds_read_b64_tr_b16 a[104:105], v33 offset:24576
    ds_read_b64_tr_b16 a[106:107], v33 offset:25088
    ds_read_b64_tr_b16 a[108:109], v33 offset:28672
    ds_read_b64_tr_b16 a[110:111], v33 offset:29184
    ds_read_b64_tr_b16 a[112:113], v33 offset:32768
    ds_read_b64_tr_b16 a[114:115], v33 offset:33280
    ds_read_b64_tr_b16 a[116:117], v33 offset:36864
    ds_read_b64_tr_b16 a[118:119], v33 offset:37376
    ds_read_b64_tr_b16 a[180:181], v34 offset:40960
    ds_read_b64_tr_b16 a[182:183], v34 offset:41472
    ds_read_b64_tr_b16 a[184:185], v34 offset:45056
    ds_read_b64_tr_b16 a[186:187], v34 offset:45568
    ds_read_b64_tr_b16 a[188:189], v34 offset:49152
    ds_read_b64_tr_b16 a[190:191], v34 offset:49664
    ds_read_b64_tr_b16 a[192:193], v34 offset:53248
    ds_read_b64_tr_b16 a[194:195], v34 offset:53760
    ds_read_b64_tr_b16 a[196:197], v34 offset:57344
    ds_read_b64_tr_b16 a[198:199], v34 offset:57856
    s_branch L_tk_89
L_tw_92:
    ds_read_b64_tr_b16 a[0:1], v33 offset:0
    ds_read_b64_tr_b16 a[2:3], v33 offset:512
    ds_read_b64_tr_b16 a[4:5], v33 offset:4096
    ds_read_b64_tr_b16 a[6:7], v33 offset:4608
    ds_read_b64_tr_b16 a[8:9], v33 offset:8192
    ds_read_b64_tr_b16 a[10:11], v33 offset:8704
    ds_read_b64_tr_b16 a[12:13], v33 offset:12288
    ds_read_b64_tr_b16 a[14:15], v33 offset:12800
    ds_read_b64_tr_b16 a[16:17], v33 offset:16384
    ds_read_b64_tr_b16 a[18:19], v33 offset:16896
    ds_read_b64_tr_b16 a[80:81], v33 offset:20480
    ds_read_b64_tr_b16 a[82:83], v33 offset:20992
    ds_read_b64_tr_b16 a[84:85], v33 offset:24576
    ds_read_b64_tr_b16 a[86:87], v33 offset:25088
    ds_read_b64_tr_b16 a[88:89], v33 offset:28672
    ds_read_b64_tr_b16 a[90:91], v33 offset:29184
    ds_read_b64_tr_b16 a[92:93], v33 offset:32768
    ds_read_b64_tr_b16 a[94:95], v33 offset:33280
    ds_read_b64_tr_b16 a[96:97], v33 offset:36864
    ds_read_b64_tr_b16 a[98:99], v33 offset:37376
    ds_read_b64_tr_b16 a[160:161], v34 offset:40960
    ds_read_b64_tr_b16 a[162:163], v34 offset:41472
    ds_read_b64_tr_b16 a[164:165], v34 offset:45056
    ds_read_b64_tr_b16 a[166:167], v34 offset:45568
    ds_read_b64_tr_b16 a[168:169], v34 offset:49152
    ds_read_b64_tr_b16 a[170:171], v34 offset:49664
    ds_read_b64_tr_b16 a[172:173], v34 offset:53248
    ds_read_b64_tr_b16 a[174:175], v34 offset:53760
    ds_read_b64_tr_b16 a[176:177], v34 offset:57344
    ds_read_b64_tr_b16 a[178:179], v34 offset:57856
L_tk_89:
    s_waitcnt lgkmcnt(0)
    s_barrier
    v_mov_b32 v58, 0
    v_mov_b32 v59, 0
    s_mov_b32 s44, s18
    s_and_b32 s45, s19, 0xffff
    s_mov_b32 s46, 10240
    s_mov_b32 s47, 0x20000
    s_add_u32 s60, s3, 1
    s_and_b32 s60, s60, 7
    s_lshl_b32 s60, s60, 9
    s_lshl_b32 s48, s66, 12
    s_lshr_b32 s60, s3, 1
    s_add_u32 s60, s60, 0
    s_and_b32 s60, s60, 3
    s_lshl_b32 s60, s60, 10
    s_add_u32 s48, s48, s60
    s_add_u32 s48, s48, 77594624
    s_add_u32 s60, s3, 2
    s_and_b32 s60, s60, 7
    s_lshl_b32 s60, s60, 9
    s_lshl_b32 s49, s66, 12
    s_lshr_b32 s60, s3, 1
    s_add_u32 s60, s60, 1
    s_and_b32 s60, s60, 3
    s_lshl_b32 s60, s60, 10
    s_add_u32 s49, s49, s60
    s_add_u32 s49, s49, 77594624
    s_add_u32 s60, s3, 3
    s_and_b32 s60, s60, 7
    s_lshl_b32 s60, s60, 9
    s_lshl_b32 s50, s66, 12
    s_lshr_b32 s60, s3, 1
    s_add_u32 s60, s60, 2
    s_and_b32 s60, s60, 3
    s_lshl_b32 s60, s60, 10
    s_add_u32 s50, s50, s60
    s_add_u32 s50, s50, 77594624
    s_add_u32 s60, s3, 4
    s_and_b32 s60, s60, 7
    s_lshl_b32 s60, s60, 9
    s_lshl_b32 s51, s66, 12
    s_lshr_b32 s60, s3, 1
    s_add_u32 s60, s60, 3
    s_and_b32 s60, s60, 3
    s_lshl_b32 s60, s60, 10
    s_add_u32 s51, s51, s60
    s_add_u32 s51, s51, 77594624
    s_add_u32 s60, s3, 5
    s_and_b32 s60, s60, 7
    s_lshl_b32 s60, s60, 9
    s_lshl_b32 s52, s66, 12
    s_lshr_b32 s60, s3, 1
    s_add_u32 s60, s60, 4
    s_and_b32 s60, s60, 3
    s_lshl_b32 s60, s60, 10
    s_add_u32 s52, s52, s60
    s_add_u32 s52, s52, 77594624
    s_add_u32 s60, s3, 6
    s_and_b32 s60, s60, 7
    s_lshl_b32 s60, s60, 9
    s_lshl_b32 s53, s66, 12
    s_lshr_b32 s60, s3, 1
    s_add_u32 s60, s60, 5
    s_and_b32 s60, s60, 3
    s_lshl_b32 s60, s60, 10
    s_add_u32 s53, s53, s60
    s_add_u32 s53, s53, 77594624
    s_add_u32 s60, s3, 7
    s_and_b32 s60, s60, 7
    s_lshl_b32 s60, s60, 9
    s_lshl_b32 s54, s66, 12
    s_lshr_b32 s60, s3, 1
    s_add_u32 s60, s60, 6
    s_and_b32 s60, s60, 3
    s_lshl_b32 s60, s60, 10
    s_add_u32 s54, s54, s60
    s_add_u32 s54, s54, 77594624
    s_bitcmp1_b32 s3, 0
    s_cselect_b32 s40, 0, -1
    s_cselect_b32 s41, -1, 0
    s_mul_i32 s32, s66, 52
    s_lshr_b32 s32, s32, 8
    s_cmp_eq_u32 s32, s3
    s_cselect_b32 s32, 1, 0
    s_add_u32 s60, s4, 1
    s_and_b32 s60, s60, 3
    s_mul_i32 s33, s60, 5120
    s_mul_i32 s36, s60, 6144
    s_add_u32 s60, s4, 2
    s_and_b32 s60, s60, 3
    s_mul_i32 s34, s60, 5120
    s_mul_i32 s37, s60, 6144
    s_add_u32 s60, s4, 3
    s_and_b32 s60, s60, 3
    s_mul_i32 s35, s60, 5120
    s_mul_i32 s38, s60, 6144
    s_mul_i32 s27, s3, 12
    s_add_u32 s27, s27, s5
    s_lshl_b32 s27, s27, 10
    s_add_u32 s27, s27, 2686976
    s_mul_i32 s81, s4, 5120
    s_mul_i32 s61, s4, 6144
    s_lshl_b32 s63, s4, 10
    s_lshr_b32 s62, s4, 1
    s_lshl_b32 s62, s62, 10
    s_and_b32 s60, s4, 1
    s_lshl_b32 s60, s60, 3
    s_add_u32 s62, s62, s60
    v_mov_b32 v255, v34
    v_lshlrev_b32 v22, 2, v0
L_wi_94:
    buffer_load_dword v21, v22, s[12:15], 0 offen sc1
    s_waitcnt vmcnt(0)
    v_cmp_ne_u32 vcc, 32, v21
    s_mov_b32 s92, 0x10101010
    s_mov_b32 s93, 0x10101010
    s_and_b64 s[94:95], vcc, s[92:93]
    s_cbranch_scc0 L_wid_95
    s_sleep 2
    s_sub_u32 s6, s6, 1
    s_cbranch_scc0 L_wi_94
    s_branch L_fail
L_wid_95:
    s_mov_b32 s92, 0x01010101
    s_mov_b32 s93, 0x01010101
    s_and_b64 s[94:95], vcc, s[92:93]
    s_cselect_b32 s7, 0, 1
    s_mov_b32 s67, 0
    s_mov_b32 s42, 0
    s_mov_b32 s43, 0
    s_cmp_eq_u32 s7, 0
    s_cbranch_scc1 L_ch_init_s
L_ch_init_f:
    s_add_u32 s92, s67, 1
    s_and_b32 s60, s67, 3
    s_mul_i32 s84, s60, 147456
    s_add_u32 s84, s84, 116391936
    s_cmp_lt_u32 s67, 64
    s_cselect_b32 s82, s92, 0
    s_cselect_b32 s84, s84, s10
    s_sub_u32 s60, s67, 7
    s_and_b32 s60, s60, 3
    s_mul_i32 s85, s60, 147456
    s_add_u32 s85, s85, 116981760
    s_sub_u32 s92, s92, 7
    s_cmp_ge_u32 s67, 7
    s_cselect_b32 s83, s92, 0
    s_cselect_b32 s85, s85, s10
    s_cmp_ge_u32 s67, 71
    s_cselect_b32 s83, 0, s83
    s_cselect_b32 s85, s10, s85
    s_mov_b32 s30, 1
    s_mov_b32 s31, 48
    s_mov_b32 s28, 0
    s_mov_b32 s29, 0
    s_and_b32 s60, s67, 3
    s_mul_i32 s92, s60, 20480
    s_add_u32 s55, s92, s68
    s_add_u32 s56, s55, 4096
    s_mul_i32 s92, s60, 36864
    s_add_u32 s57, s92, s71
    s_add_u32 s58, s92, s73
    s_add_u32 s59, s92, s74
    s_mul_i32 s92, s60, 24576
    s_add_u32 s70, s92, s75
    s_add_u32 s72, s92, s77
    s_add_u32 s76, s72, 4096
    s_xor_b32 s60, s60, 2
    s_mul_i32 s92, s60, 24576
    s_add_u32 s19, s92, s75
    s_mul_i32 s92, s60, 36864
    s_add_u32 s20, s92, s71
    s_cmp_eq_u32 s4, 3
    s_cselect_b32 s20, s27, s20
    s_and_b32 s60, s67, 127
    s_mul_i32 s79, s60, 163840
    s_add_u32 s92, s67, 1
    s_and_b32 s93, s92, 3
    s_mul_i32 s94, s93, 20480
    s_add_u32 s16, s94, s69
    s_xor_b32 s93, s93, 2
    s_mul_i32 s94, s93, 20480
    s_add_u32 s21, s94, s69
    s_cmp_lt_u32 s67, 64
    s_cselect_b32 s22, -1, 0
    s_cselect_b32 s24, 0x00ff00ff, 0
    s_cmp_ge_u32 s67, 7
    s_cselect_b32 s23, -1, 0
    s_cselect_b32 s92, 0xff00ff00, 0
    s_or_b32 s24, s24, s92
    s_mov_b32 s25, s24
    s_and_b32 s60, s67, 3
    s_mul_i32 s17, s60, 24576
    s_sub_u32 s60, s67, 7
    s_and_b32 s60, s60, 3
    s_mul_i32 s18, s60, 24576
    s_cmp_eq_u32 s67, 0
    s_cselect_b32 s26, 1, 0
    s_cmp_eq_u32 s67, 7
    s_cselect_b32 s26, 1, s26
    v_add_u32 v29, s81, v2
L_ch_step_f:
    s_cmp_lg_u32 s26, 0
    s_cbranch_scc1 L_ch_sp_f
    s_sleep 4
    buffer_load_dwordx4 v[96:99], v4, s[8:11], s55 offen offset:0 sc1
    buffer_load_dwordx4 v[100:103], v4, s[8:11], s55 offen offset:1024 sc1
    buffer_load_dwordx4 v[104:107], v4, s[8:11], s55 offen offset:2048 sc1
    buffer_load_dwordx4 v[108:111], v4, s[8:11], s55 offen offset:3072 sc1
    buffer_load_dwordx4 v[112:115], v4, s[8:11], s56 offen offset:0 sc1
    buffer_load_dword v58, v6, s[8:11], s86 offen sc1
    buffer_load_dword v59, v6, s[8:11], s86 offen offset:2048 sc1
    v_add_u32 v88, s33, v2
    v_add_u32 v89, s34, v2
    v_add_u32 v90, s35, v2
    s_waitcnt vmcnt(6)
L_agc0_f:
    ds_write_b128 v29, v[96:99] offset:0
    v_max3_u32 v30, v96, v97, v98
    v_max_u32 v30, v30, v99
    v_cmp_eq_u32 vcc, -1, v30
    s_cbranch_vccnz L_agr0_f
L_agp0_f:
    s_waitcnt vmcnt(5)
L_agc1_f:
    ds_write_b128 v29, v[100:103] offset:1024
    v_max3_u32 v30, v100, v101, v102
    v_max_u32 v30, v30, v103
    v_cmp_eq_u32 vcc, -1, v30
    s_cbranch_vccnz L_agr1_f
L_agp1_f:
    s_waitcnt vmcnt(4)
L_agc2_f:
    ds_write_b128 v29, v[104:107] offset:2048
    v_max3_u32 v30, v104, v105, v106
    v_max_u32 v30, v30, v107
    v_cmp_eq_u32 vcc, -1, v30
    s_cbranch_vccnz L_agr2_f
L_agp2_f:
    s_waitcnt vmcnt(3)
L_agc3_f:
    ds_write_b128 v29, v[108:111] offset:3072
    v_max3_u32 v30, v108, v109, v110
    v_max_u32 v30, v30, v111
    v_cmp_eq_u32 vcc, -1, v30
    s_cbranch_vccnz L_agr3_f
L_agp3_f:
    s_waitcnt vmcnt(2)
L_agc4_f:
    ds_write_b128 v29, v[112:115] offset:4096
    v_max3_u32 v30, v112, v113, v114
    v_max_u32 v30, v30, v115
    v_cmp_eq_u32 vcc, -1, v30
    s_cbranch_vccnz L_agr4_f
L_agp4_f:
L_ch_ag_f:
    s_waitcnt lgkmcnt(0)
    s_barrier
    ds_read_b128 v[116:119], v88 offset:0
    ds_read_b128 v[120:123], v88 offset:1024
    v_mfma_f32_16x16x32_bf16 v[16:19], a[0:3], v[96:99], 0
    v_mfma_f32_16x16x32_bf16 v[20:23], a[80:83], v[96:99], 0
    ds_read_b128 v[124:127], v88 offset:2048
    ds_read_b128 v[128:131], v88 offset:3072
    ds_read_b128 v[132:135], v88 offset:4096
    s_waitcnt vmcnt(0)
    v_readlane_b32 s42, v58, 0
    v_readlane_b32 s92, v58, 1
    v_readlane_b32 s43, v59, 0
    v_readlane_b32 s93, v59, 1
    v_mfma_f32_16x16x32_bf16 v[16:19], a[4:7], v[100:103], v[16:19]
    v_mfma_f32_16x16x32_bf16 v[20:23], a[84:87], v[100:103], v[20:23]
    ds_read_b128 v[136:139], v89 offset:0
    ds_read_b128 v[140:143], v89 offset:1024
    ds_read_b128 v[144:147], v89 offset:2048
    s_min_u32 s42, s42, s92
    s_min_u32 s43, s43, s93
    s_cmp_gt_u32 s82, s42
    s_cbranch_scc1 L_ch_fl_f
    s_cmp_gt_u32 s83, s43
    s_cbranch_scc1 L_ch_fl_f
L_ch_fc_f:
    v_mfma_f32_16x16x32_bf16 v[16:19], a[8:11], v[104:107], v[16:19]
    v_mfma_f32_16x16x32_bf16 v[20:23], a[88:91], v[104:107], v[20:23]
    buffer_load_dwordx4 v[32:35], v7, s[8:11], s84 offen sc1
    v_mfma_f32_16x16x32_bf16 v[16:19], a[12:15], v[108:111], v[16:19]
    v_mfma_f32_16x16x32_bf16 v[20:23], a[92:95], v[108:111], v[20:23]
    buffer_load_dwordx4 v[36:39], v7, s[8:11], s84 offen offset:2048 sc1
    v_mfma_f32_16x16x32_bf16 v[16:19], a[16:19], v[112:115], v[16:19]
    v_mfma_f32_16x16x32_bf16 v[20:23], a[96:99], v[112:115], v[20:23]
    buffer_load_dwordx4 v[40:43], v7, s[8:11], s85 offen sc1
    s_waitcnt lgkmcnt(7)
    v_mfma_f32_16x16x32_bf16 v[16:19], a[20:23], v[116:119], v[16:19]
    ds_read_b128 v[148:151], v89 offset:3072
    v_mfma_f32_16x16x32_bf16 v[20:23], a[100:103], v[116:119], v[20:23]
    buffer_load_dwordx4 v[44:47], v7, s[8:11], s85 offen offset:2048 sc1
    s_waitcnt lgkmcnt(7)
    v_mfma_f32_16x16x32_bf16 v[16:19], a[24:27], v[120:123], v[16:19]
    ds_read_b128 v[152:155], v89 offset:4096
    v_mfma_f32_16x16x32_bf16 v[20:23], a[104:107], v[120:123], v[20:23]
    s_waitcnt lgkmcnt(7)
    v_mfma_f32_16x16x32_bf16 v[16:19], a[28:31], v[124:127], v[16:19]
    ds_read_b128 v[156:159], v90 offset:0
    v_mfma_f32_16x16x32_bf16 v[20:23], a[108:111], v[124:127], v[20:23]
    s_waitcnt lgkmcnt(7)
    v_mfma_f32_16x16x32_bf16 v[16:19], a[32:35], v[128:131], v[16:19]
    ds_read_b128 v[160:163], v90 offset:1024
    v_mfma_f32_16x16x32_bf16 v[20:23], a[112:115], v[128:131], v[20:23]
    s_waitcnt lgkmcnt(7)
    v_mfma_f32_16x16x32_bf16 v[16:19], a[36:39], v[132:135], v[16:19]
    ds_read_b128 v[164:167], v90 offset:2048
    v_mfma_f32_16x16x32_bf16 v[20:23], a[116:119], v[132:135], v[20:23]
    s_waitcnt lgkmcnt(7)
    v_mfma_f32_16x16x32_bf16 v[16:19], a[40:43], v[136:139], v[16:19]
    ds_read_b128 v[168:171], v90 offset:3072
    v_mfma_f32_16x16x32_bf16 v[20:23], a[120:123], v[136:139], v[20:23]
    s_waitcnt lgkmcnt(7)
    v_mfma_f32_16x16x32_bf16 v[16:19], a[44:47], v[140:143], v[16:19]
    ds_read_b128 v[172:175], v90 offset:4096
    v_mfma_f32_16x16x32_bf16 v[20:23], a[124:127], v[140:143], v[20:23]
    buffer_load_dwordx4 v[48:51], v12, s[8:11], s84 offen sc1
    s_waitcnt lgkmcnt(7)
    v_mfma_f32_16x16x32_bf16 v[16:19], a[48:51], v[144:147], v[16:19]
    v_mfma_f32_16x16x32_bf16 v[20:23], a[128:131], v[144:147], v[20:23]
    buffer_load_dwordx4 v[52:55], v12, s[8:11], s85 offen sc1
    s_mov_b32 s80, s16
    s_waitcnt lgkmcnt(6)
    v_mfma_f32_16x16x32_bf16 v[16:19], a[52:55], v[148:151], v[16:19]
    v_mfma_f32_16x16x32_bf16 v[20:23], a[132:135], v[148:151], v[20:23]
    v_mov_b32 v92, 0x3f803f80
    s_waitcnt lgkmcnt(5)
    v_mfma_f32_16x16x32_bf16 v[16:19], a[56:59], v[152:155], v[16:19]
    v_mfma_f32_16x16x32_bf16 v[20:23], a[136:139], v[152:155], v[20:23]
    v_mov_b32 v93, 0x3f803f80
    s_waitcnt lgkmcnt(4)
    v_mfma_f32_16x16x32_bf16 v[16:19], a[60:63], v[156:159], v[16:19]
    v_mfma_f32_16x16x32_bf16 v[20:23], a[140:143], v[156:159], v[20:23]
    v_mov_b32 v94, 0x3f803f80
    s_waitcnt lgkmcnt(3)
    v_mfma_f32_16x16x32_bf16 v[16:19], a[64:67], v[160:163], v[16:19]
    v_mfma_f32_16x16x32_bf16 v[20:23], a[144:147], v[160:163], v[20:23]
    v_mov_b32 v95, 0x3f803f80
    s_waitcnt lgkmcnt(2)
    v_mfma_f32_16x16x32_bf16 v[16:19], a[68:71], v[164:167], v[16:19]
    v_mfma_f32_16x16x32_bf16 v[20:23], a[148:151], v[164:167], v[20:23]
    v_add_u32 v30, s62, v2
    s_waitcnt lgkmcnt(1)
    v_mfma_f32_16x16x32_bf16 v[16:19], a[72:75], v[168:171], v[16:19]
    v_mfma_f32_16x16x32_bf16 v[20:23], a[152:155], v[168:171], v[20:23]
    v_add_u32 v31, s63, v2
    s_waitcnt lgkmcnt(0)
    v_mfma_f32_16x16x32_bf16 v[16:19], a[76:79], v[172:175], v[16:19]
    v_mfma_f32_16x16x32_bf16 v[20:23], a[156:159], v[172:175], v[20:23]
    s_nop 6
    v_cvt_pk_bf16_f32 v72, v16, v17
    v_cvt_pk_bf16_f32 v73, v18, v19
    ds_write_b64 v30, v[72:73] offset:45056
    v_cvt_pk_bf16_f32 v74, v20, v21
    v_cvt_pk_bf16_f32 v75, v22, v23
    ds_write_b64 v30, v[74:75] offset:47104
    v_mfma_f32_16x16x32_bf16 v[24:27], v[96:99], a[160:163], 0
    v_mfma_f32_16x16x32_bf16 v[24:27], v[100:103], a[164:167], v[24:27]
    v_mfma_f32_16x16x32_bf16 v[24:27], v[104:107], a[168:171], v[24:27]
    s_waitcnt lgkmcnt(0)
    s_barrier
    ds_read_b128 v[56:59], v2 offset:45056
    ds_read_b128 v[60:63], v2 offset:46080
    ds_read_b128 v[64:67], v2 offset:47104
    ds_read_b128 v[68:71], v2 offset:48128
    v_mfma_f32_16x16x32_bf16 v[24:27], v[108:111], a[172:175], v[24:27]
    v_mfma_f32_16x16x32_bf16 v[24:27], v[112:115], a[176:179], v[24:27]
    v_mfma_f32_16x16x32_bf16 v[24:27], v[116:119], a[180:183], v[24:27]
    v_mfma_f32_16x16x32_bf16 v[24:27], v[120:123], a[184:187], v[24:27]
    s_cmp_ge_u32 s4, 2
    s_cbranch_scc1 L_w2_96
    s_waitcnt vmcnt(2) lgkmcnt(2)
    v_mfma_f32_16x16x32_bf16 v[16:19], v[32:35], v[56:59], 0
    v_mfma_f32_16x16x32_bf16 v[20:23], v[40:43], v[56:59], 0
    v_mfma_f32_16x16x32_bf16 v[16:19], v[36:39], v[60:63], v[16:19]
    v_mfma_f32_16x16x32_bf16 v[20:23], v[44:47], v[60:63], v[20:23]
    s_nop 7
    v_cndmask_b32 v76, v16, v20, s[88:89]
    v_cndmask_b32 v77, v17, v21, s[88:89]
    v_cndmask_b32 v78, v18, v22, s[88:89]
    v_cndmask_b32 v79, v19, v23, s[88:89]
    buffer_store_dwordx4 v[76:79], v2, s[8:11], s57 offen
    v_mfma_f32_16x16x32_bf16 v[24:27], v[124:127], a[188:191], v[24:27]
    v_mfma_f32_16x16x32_bf16 v[24:27], v[128:131], a[192:195], v[24:27]
    v_mfma_f32_16x16x32_bf16 v[24:27], v[132:135], a[196:199], v[24:27]
    v_mfma_f32_16x16x32_bf16 v[24:27], v[136:139], a[200:203], v[24:27]
    v_mfma_f32_16x16x32_bf16 v[24:27], v[140:143], a[204:207], v[24:27]
    v_mfma_f32_16x16x32_bf16 v[24:27], v[144:147], a[208:211], v[24:27]
    v_mfma_f32_16x16x32_bf16 v[24:27], v[148:151], a[212:215], v[24:27]
    v_mfma_f32_16x16x32_bf16 v[24:27], v[152:155], a[216:219], v[24:27]
    v_mfma_f32_16x16x32_bf16 v[24:27], v[156:159], a[220:223], v[24:27]
    buffer_load_dwordx4 v[96:99], v2, s[8:11], s58 offen sc1
    buffer_load_dwordx4 v[100:103], v2, s[8:11], s59 offen sc1
    v_mfma_f32_16x16x32_bf16 v[24:27], v[160:163], a[224:227], v[24:27]
    v_mfma_f32_16x16x32_bf16 v[24:27], v[164:167], a[228:231], v[24:27]
    v_mfma_f32_16x16x32_bf16 v[24:27], v[168:171], a[232:235], v[24:27]
    v_mfma_f32_16x16x32_bf16 v[24:27], v[172:175], a[236:239], v[24:27]
    buffer_load_dwordx4 v[112:115], v2, s[8:11], s58 offen sc1
    buffer_load_dwordx4 v[116:119], v2, s[8:11], s59 offen sc1
    v_mov_b32 v87, s17
    v_mov_b32 v86, s18
    s_mov_b32 s92, 0
    s_mov_b32 s93, -1
    v_cndmask_b32 v84, v87, v86, s[88:89]
    v_cndmask_b32 v85, v87, v86, s[92:93]
    v_add_u32 v84, v84, v13
    v_add_u32 v85, v85, v1
    v_cvt_pk_bf16_f32 v28, v24, v25
    v_cvt_pk_bf16_f32 v29, v26, v27
    s_waitcnt vmcnt(2)
    v_pk_add_f32 v[104:105], v[96:97], v[100:101]
    v_pk_add_f32 v[106:107], v[98:99], v[102:103]
    v_pk_add_f32 v[16:17], v[76:77], v[104:105]
    v_pk_add_f32 v[18:19], v[78:79], v[106:107]
    ds_write_b128 v31, v[16:19] offset:49152
    v_cmp_u_f32 vcc, v104, v105
    v_cmp_u_f32 s[92:93], v106, v107
    s_or_b64 vcc, vcc, s[92:93]
    s_cbranch_vccnz L_sp_99
L_so_100:
L_we_98:
    s_mov_b32 s60, 0x3dd53b95
    s_waitcnt lgkmcnt(0)
    s_barrier
    ds_read_b128 v[72:75], v2 offset:49152
    ds_read_b128 v[76:79], v2 offset:50176
    ds_read_b128 v[80:83], v2 offset:51200
    s_mov_b64 exec, s[22:23]
    buffer_store_dwordx2 v[28:29], v85, s[8:11], 0 offen
    s_mov_b64 exec, -1
    v_mov_b32 v88, s60
    v_mov_b32 v89, s60
    s_waitcnt lgkmcnt(1)
    v_max3_f32 v30, v72, v73, v74
    v_max3_f32 v31, v75, v76, v77
    v_max3_f32 v30, v30, v78, v79
    s_waitcnt lgkmcnt(0)
    v_max3_f32 v31, v31, v80, v81
    v_max3_f32 v30, v30, v82, v83
    v_max_f32 v30, v30, v31
    v_mov_b32 v31, v30
    v_pk_mul_f32 v[80:81], v[80:81], v[88:89]
    v_pk_mul_f32 v[82:83], v[82:83], v[88:89]
    v_permlane32_swap_b32 v31, v30
    v_max_f32 v30, v30, v31
    v_mov_b32 v31, v30
    v_pk_mul_f32 v[72:73], v[72:73], v[88:89]
    v_pk_mul_f32 v[74:75], v[74:75], v[88:89]
    v_permlane16_swap_b32 v31, v30
    v_max_f32 v30, v30, v31
    v_mul_f32 v30, s60, v30
    v_pk_add_f32 v[80:81], v[80:81], v[30:31] op_sel_hi:[1,0] neg_lo:[0,1] neg_hi:[0,1]
    v_pk_add_f32 v[82:83], v[82:83], v[30:31] op_sel_hi:[1,0] neg_lo:[0,1] neg_hi:[0,1]
    v_exp_f32 v80, v80
    v_pk_add_f32 v[72:73], v[72:73], v[30:31] op_sel_hi:[1,0] neg_lo:[0,1] neg_hi:[0,1]
    v_exp_f32 v81, v81
    v_pk_add_f32 v[74:75], v[74:75], v[30:31] op_sel_hi:[1,0] neg_lo:[0,1] neg_hi:[0,1]
    v_exp_f32 v82, v82
    v_pk_mul_f32 v[76:77], v[76:77], v[88:89]
    v_exp_f32 v83, v83
    v_pk_mul_f32 v[78:79], v[78:79], v[88:89]
    v_exp_f32 v72, v72
    v_pk_add_f32 v[76:77], v[76:77], v[30:31] op_sel_hi:[1,0] neg_lo:[0,1] neg_hi:[0,1]
    v_cvt_pk_bf16_f32 v60, v80, v81
    v_cvt_pk_bf16_f32 v61, v82, v83
    v_exp_f32 v73, v73
    v_pk_add_f32 v[78:79], v[78:79], v[30:31] op_sel_hi:[1,0] neg_lo:[0,1] neg_hi:[0,1]
    v_exp_f32 v74, v74
    v_mfma_f32_16x16x16_bf16 v[16:19], v[28:29], v[60:61], 0
    v_exp_f32 v75, v75
    v_cvt_pk_bf16_f32 v56, v72, v73
    v_exp_f32 v76, v76
    v_mfma_f32_16x16x16_bf16 v[20:23], v[28:29], v[60:61], 0
    v_exp_f32 v77, v77
    v_cvt_pk_bf16_f32 v57, v74, v75
    v_exp_f32 v78, v78
    v_mfma_f32_16x16x16_bf16 v[24:27], v[92:93], v[60:61], 0
    v_exp_f32 v79, v79
    v_cvt_pk_bf16_f32 v58, v76, v77
    v_cvt_pk_bf16_f32 v59, v78, v79
    s_nop 1
    v_mfma_f32_16x16x32_bf16 v[16:19], v[48:51], v[56:59], v[16:19]
    v_mfma_f32_16x16x32_bf16 v[20:23], v[52:55], v[56:59], v[20:23]
    v_mfma_f32_16x16x32_bf16 v[24:27], v[92:95], v[56:59], v[24:27]
    v_add_u32 v31, s61, v2
    s_add_u32 s67, s67, 1
    s_nop 4
    v_cndmask_b32 v72, v16, v20, s[88:89]
    v_cndmask_b32 v73, v17, v21, s[88:89]
    v_rcp_f32 v30, v24
    v_cndmask_b32 v74, v18, v22, s[88:89]
    v_cndmask_b32 v75, v19, v23, s[88:89]
    v_pk_mul_f32 v[72:73], v[72:73], v[30:31] op_sel_hi:[1,0]
    v_pk_mul_f32 v[74:75], v[74:75], v[30:31] op_sel_hi:[1,0]
    v_cvt_pk_bf16_f32 v62, v72, v73
    v_cvt_pk_bf16_f32 v63, v74, v75
    v_min_u32 v62, -2, v62
    v_min_u32 v63, -2, v63
    buffer_store_dwordx2 v[62:63], v3, s[8:11], s70 offen
    s_cmp_ge_u32 s5, 10
    s_cbranch_scc1 L_ch_noop_f
    s_cmp_eq_u32 s67, 1
    s_cbranch_scc1 L_ch_wo_f
L_ch_wp_f:
    s_sleep 2
    buffer_load_dwordx4 v[72:75], v5, s[8:11], s72 offen offset:0 sc1
    buffer_load_dwordx4 v[76:79], v5, s[8:11], s72 offen offset:1024 sc1
    buffer_load_dwordx4 v[80:83], v5, s[8:11], s72 offen offset:2048 sc1
    buffer_load_dwordx4 v[84:87], v5, s[8:11], s72 offen offset:3072 sc1
    buffer_load_dwordx4 v[88:91], v5, s[8:11], s76 offen offset:0 sc1
    buffer_load_dwordx4 v[92:95], v5, s[8:11], s76 offen offset:1024 sc1
    v_add_u32 v59, s36, v2
    v_add_u32 v60, s37, v2
    v_add_u32 v61, s38, v2
    s_waitcnt vmcnt(5)
L_ogc0_f:
    ds_write_b128 v31, v[72:75] offset:20480
    v_max3_u32 v30, v72, v73, v74
    v_max_u32 v30, v30, v75
    v_cmp_eq_u32 vcc, -1, v30
    s_cbranch_vccnz L_ogr0_f
L_ogp0_f:
    v_mfma_f32_16x16x32_bf16 v[16:19], a[240:243], v[72:75], 0
    s_waitcnt vmcnt(4)
L_ogc1_f:
    ds_write_b128 v31, v[76:79] offset:21504
    v_max3_u32 v30, v76, v77, v78
    v_max_u32 v30, v30, v79
    v_cmp_eq_u32 vcc, -1, v30
    s_cbranch_vccnz L_ogr1_f
L_ogp1_f:
    v_mfma_f32_16x16x32_bf16 v[16:19], a[244:247], v[76:79], v[16:19]
    s_waitcnt vmcnt(3)
L_ogc2_f:
    ds_write_b128 v31, v[80:83] offset:22528
    v_max3_u32 v30, v80, v81, v82
    v_max_u32 v30, v30, v83
    v_cmp_eq_u32 vcc, -1, v30
    s_cbranch_vccnz L_ogr2_f
L_ogp2_f:
    s_waitcnt vmcnt(2)
L_ogc3_f:
    ds_write_b128 v31, v[84:87] offset:23552
    v_max3_u32 v30, v84, v85, v86
    v_max_u32 v30, v30, v87
    v_cmp_eq_u32 vcc, -1, v30
    s_cbranch_vccnz L_ogr3_f
L_ogp3_f:
    s_waitcnt vmcnt(1)
L_ogc4_f:
    ds_write_b128 v31, v[88:91] offset:24576
    v_max3_u32 v30, v88, v89, v90
    v_max_u32 v30, v30, v91
    v_cmp_eq_u32 vcc, -1, v30
    s_cbranch_vccnz L_ogr4_f
L_ogp4_f:
    s_waitcnt vmcnt(0)
L_ogc5_f:
    ds_write_b128 v31, v[92:95] offset:25600
    v_max3_u32 v30, v92, v93, v94
    v_max_u32 v30, v30, v95
    v_cmp_eq_u32 vcc, -1, v30
    s_cbranch_vccnz L_ogr5_f
L_ogp5_f:
    s_waitcnt lgkmcnt(0)
    s_barrier
    ds_read_b128 v[96:99], v59 offset:20480
    ds_read_b128 v[100:103], v59 offset:21504
    v_mfma_f32_16x16x32_bf16 v[16:19], a[248:251], v[80:83], v[16:19]
    ds_read_b128 v[104:107], v59 offset:22528
    ds_read_b128 v[108:111], v59 offset:23552
    v_mfma_f32_16x16x32_bf16 v[16:19], a[252:255], v[84:87], v[16:19]
    ds_read_b128 v[112:115], v59 offset:24576
    ds_read_b128 v[116:119], v59 offset:25600
    v_mfma_f32_16x16x32_bf16 v[16:19], v[176:179], v[88:91], v[16:19]
    ds_read_b128 v[120:123], v60 offset:20480
    ds_read_b128 v[124:127], v60 offset:21504
    v_mfma_f32_16x16x32_bf16 v[16:19], v[180:183], v[92:95], v[16:19]
    ds_read_b128 v[128:131], v60 offset:22528
    s_waitcnt lgkmcnt(8)
    v_mfma_f32_16x16x32_bf16 v[16:19], v[184:187], v[96:99], v[16:19]
    v_mov_b32 v29, s67
    s_mov_b64 exec, 1
    buffer_store_dword v29, off, s[8:11], s87
    s_mov_b64 exec, -1
    ds_read_b128 v[132:135], v60 offset:23552
    s_waitcnt lgkmcnt(8)
    v_mfma_f32_16x16x32_bf16 v[16:19], v[188:191], v[100:103], v[16:19]
    ds_read_b128 v[136:139], v60 offset:24576
    s_waitcnt lgkmcnt(8)
    v_mfma_f32_16x16x32_bf16 v[16:19], v[192:195], v[104:107], v[16:19]
    ds_read_b128 v[140:143], v60 offset:25600
    s_waitcnt lgkmcnt(8)
    v_mfma_f32_16x16x32_bf16 v[16:19], v[196:199], v[108:111], v[16:19]
    ds_read_b128 v[144:147], v61 offset:20480
    s_waitcnt lgkmcnt(8)
    v_mfma_f32_16x16x32_bf16 v[16:19], v[200:203], v[112:115], v[16:19]
    ds_read_b128 v[148:151], v61 offset:21504
    s_waitcnt lgkmcnt(8)
    v_mfma_f32_16x16x32_bf16 v[16:19], v[204:207], v[116:119], v[16:19]
    ds_read_b128 v[152:155], v61 offset:22528
    s_waitcnt lgkmcnt(8)
    v_mfma_f32_16x16x32_bf16 v[16:19], v[208:211], v[120:123], v[16:19]
    ds_read_b128 v[156:159], v61 offset:23552
    s_waitcnt lgkmcnt(8)
    v_mfma_f32_16x16x32_bf16 v[16:19], v[212:215], v[124:127], v[16:19]
    ds_read_b128 v[160:163], v61 offset:24576
    s_waitcnt lgkmcnt(8)
    v_mfma_f32_16x16x32_bf16 v[16:19], v[216:219], v[128:131], v[16:19]
    ds_read_b128 v[164:167], v61 offset:25600
    s_waitcnt lgkmcnt(8)
    v_mfma_f32_16x16x32_bf16 v[16:19], v[220:223], v[132:135], v[16:19]
    s_waitcnt lgkmcnt(7)
    v_mfma_f32_16x16x32_bf16 v[16:19], v[224:227], v[136:139], v[16:19]
    s_waitcnt lgkmcnt(6)
    v_mfma_f32_16x16x32_bf16 v[16:19], v[228:231], v[140:143], v[16:19]
    v_mov_b32 v20, -1
    s_waitcnt lgkmcnt(5)
    v_mfma_f32_16x16x32_bf16 v[16:19], v[232:235], v[144:147], v[16:19]
    v_mov_b32 v21, -1
    s_waitcnt lgkmcnt(4)
    v_mfma_f32_16x16x32_bf16 v[16:19], v[236:239], v[148:151], v[16:19]
    v_mov_b32 v22, -1
    s_waitcnt lgkmcnt(3)
    v_mfma_f32_16x16x32_bf16 v[16:19], v[240:243], v[152:155], v[16:19]
    v_mov_b32 v23, -1
    s_waitcnt lgkmcnt(2)
    v_mfma_f32_16x16x32_bf16 v[16:19], v[244:247], v[156:159], v[16:19]
    v_add_u32 v28, s79, v15
    v_add_u32 v56, s79, v2
    s_waitcnt lgkmcnt(1)
    v_mfma_f32_16x16x32_bf16 v[16:19], v[248:251], v[160:163], v[16:19]
    v_mov_b32 v57, s10
    v_cndmask_b32 v57, v56, v57, s[40:41]
    s_waitcnt lgkmcnt(0)
    v_mfma_f32_16x16x32_bf16 v[16:19], v[252:255], v[164:167], v[16:19]
    s_nop 7
    v_cvt_pk_bf16_f32 v24, v16, v17
    v_cvt_pk_bf16_f32 v25, v18, v19
    v_min_u32 v24, -2, v24
    v_min_u32 v25, -2, v25
    buffer_store_dwordx2 v[24:25], v28, s[8:11], s78 offen sc1
    s_sleep 9
    buffer_load_dwordx4 v[72:75], v57, s[8:11], s48 offen sc1
    buffer_load_dwordx4 v[76:79], v56, s[8:11], s49 offen sc1
    buffer_load_dwordx4 v[80:83], v56, s[8:11], s50 offen sc1
    buffer_load_dwordx4 v[84:87], v56, s[8:11], s51 offen sc1
    s_mov_b32 s29, 0
    buffer_store_dwordx2 v[20:21], v3, s[8:11], s19 offen
    buffer_store_dwordx2 v[20:21], v3, s[8:11], s21 offen
    buffer_store_dwordx4 v[20:23], v2, s[8:11], s20 offen
    s_add_u32 s92, s67, 1
    s_and_b32 s60, s67, 3
    s_mul_i32 s84, s60, 147456
    s_add_u32 s84, s84, 116391936
    s_cmp_lt_u32 s67, 64
    s_cselect_b32 s82, s92, 0
    s_cselect_b32 s84, s84, s10
    s_sub_u32 s60, s67, 7
    s_and_b32 s60, s60, 3
    s_mul_i32 s85, s60, 147456
    s_add_u32 s85, s85, 116981760
    s_sub_u32 s92, s92, 7
    s_cmp_ge_u32 s67, 7
    s_cselect_b32 s83, s92, 0
    s_cselect_b32 s85, s85, s10
    s_cmp_ge_u32 s67, 71
    s_cselect_b32 s83, 0, s83
    s_cselect_b32 s85, s10, s85
    s_and_b32 s60, s67, 3
    s_mul_i32 s92, s60, 20480
    s_add_u32 s55, s92, s68
    s_add_u32 s56, s55, 4096
    s_mul_i32 s92, s60, 36864
    s_add_u32 s57, s92, s71
    s_add_u32 s58, s92, s73
    s_add_u32 s59, s92, s74
    s_mul_i32 s92, s60, 24576
    s_add_u32 s70, s92, s75
    s_add_u32 s72, s92, s77
    s_add_u32 s76, s72, 4096
    s_xor_b32 s60, s60, 2
    s_mul_i32 s92, s60, 24576
    s_add_u32 s19, s92, s75
    s_mul_i32 s92, s60, 36864
    s_add_u32 s20, s92, s71
    s_cmp_eq_u32 s4, 3
    s_cselect_b32 s20, s27, s20
    s_and_b32 s60, s67, 127
    s_mul_i32 s79, s60, 163840
    s_add_u32 s92, s67, 1
    s_and_b32 s93, s92, 3
    s_mul_i32 s94, s93, 20480
    s_add_u32 s16, s94, s69
    s_xor_b32 s93, s93, 2
    s_mul_i32 s94, s93, 20480
    s_add_u32 s21, s94, s69
    s_cmp_lt_u32 s67, 64
    s_cselect_b32 s22, -1, 0
    s_cselect_b32 s24, 0x00ff00ff, 0
    s_cmp_ge_u32 s67, 7
    s_cselect_b32 s23, -1, 0
    s_cselect_b32 s92, 0xff00ff00, 0
    s_or_b32 s24, s24, s92
    s_mov_b32 s25, s24
    s_and_b32 s60, s67, 3
    s_mul_i32 s17, s60, 24576
    s_sub_u32 s60, s67, 7
    s_and_b32 s60, s60, 3
    s_mul_i32 s18, s60, 24576
    s_cmp_eq_u32 s67, 0
    s_cselect_b32 s26, 1, 0
    s_cmp_eq_u32 s67, 7
    s_cselect_b32 s26, 1, s26
    v_add_u32 v29, s81, v2
    s_sleep 4
    buffer_load_dwordx4 v[96:99], v57, s[8:11], s48 offen sc1
    buffer_load_dwordx4 v[100:103], v56, s[8:11], s49 offen sc1
    buffer_load_dwordx4 v[104:107], v56, s[8:11], s50 offen sc1
    buffer_load_dwordx4 v[108:111], v56, s[8:11], s51 offen sc1
    s_waitcnt vmcnt(10)
    v_mfma_f32_16x16x32_bf16 v[64:67], v[8:11], v[72:75], v[16:19]
    s_waitcnt vmcnt(9)
    v_mfma_f32_16x16x32_bf16 v[64:67], v[8:11], v[76:79], v[64:67]
    s_waitcnt vmcnt(8)
    v_mfma_f32_16x16x32_bf16 v[64:67], v[8:11], v[80:83], v[64:67]
    s_waitcnt vmcnt(7)
    v_mfma_f32_16x16x32_bf16 v[64:67], v[8:11], v[84:87], v[64:67]
L_cp_101:
    s_nop 7
    v_cmp_u_f32 vcc, v64, v65
    v_cvt_pk_bf16_f32 v24, v64, v65
    v_cvt_pk_bf16_f32 v25, v66, v67
    s_cbranch_vccnz L_cp_101x
L_co_102:
    v_min_u32 v24, -2, v24
    v_min_u32 v25, -2, v25
    buffer_store_dwordx2 v[24:25], v3, s[8:11], s80 offen
L_ch_next_f:
    s_cmp_lt_u32 s67, 71
    s_cbranch_scc1 L_ch_step_f
    s_endpgm
L_ch_noop_f:
    v_mov_b32 v20, -1
    v_mov_b32 v21, -1
    v_mov_b32 v22, -1
    v_mov_b32 v23, -1
    s_add_u32 s92, s67, 1
    s_and_b32 s60, s67, 3
    s_mul_i32 s84, s60, 147456
    s_add_u32 s84, s84, 116391936
    s_cmp_lt_u32 s67, 64
    s_cselect_b32 s82, s92, 0
    s_cselect_b32 s84, s84, s10
    s_sub_u32 s60, s67, 7
    s_and_b32 s60, s60, 3
    s_mul_i32 s85, s60, 147456
    s_add_u32 s85, s85, 116981760
    s_sub_u32 s92, s92, 7
    s_cmp_ge_u32 s67, 7
    s_cselect_b32 s83, s92, 0
    s_cselect_b32 s85, s85, s10
    s_cmp_ge_u32 s67, 71
    s_cselect_b32 s83, 0, s83
    s_cselect_b32 s85, s10, s85
    s_waitcnt vmcnt(0)
    v_mov_b32 v29, s67
    s_mov_b64 exec, 1
    buffer_store_dword v29, off, s[8:11], s87
    s_mov_b64 exec, -1
    buffer_store_dwordx2 v[20:21], v3, s[8:11], s19 offen
    buffer_store_dwordx4 v[20:23], v2, s[8:11], s20 offen
    s_add_u32 s92, s67, 1
    s_and_b32 s92, s92, 127
    s_mul_i32 s92, s92, 163840
    s_sub_u32 s93, s66, 40
    s_mul_i32 s93, s93, 20480
    s_add_u32 s92, s92, s93
    s_lshl_b32 s93, s3, 9
    s_add_u32 s92, s92, s93
    s_add_u32 s92, s92, 77594624
    buffer_store_dwordx2 v[20:21], v3, s[8:11], s92 offen sc1
    s_add_u32 s92, s92, 4096
    buffer_store_dwordx2 v[20:21], v3, s[8:11], s92 offen sc1
    s_add_u32 s92, s92, 4096
    buffer_store_dwordx2 v[20:21], v3, s[8:11], s92 offen sc1
    s_add_u32 s92, s92, 4096
    buffer_store_dwordx2 v[20:21], v3, s[8:11], s92 offen sc1
    s_add_u32 s92, s92, 4096
    buffer_store_dwordx2 v[20:21], v3, s[8:11], s92 offen sc1
    s_and_b32 s60, s67, 3
    s_mul_i32 s92, s60, 20480
    s_add_u32 s55, s92, s68
    s_add_u32 s56, s55, 4096
    s_mul_i32 s92, s60, 36864
    s_add_u32 s57, s92, s71
    s_add_u32 s58, s92, s73
    s_add_u32 s59, s92, s74
    s_mul_i32 s92, s60, 24576
    s_add_u32 s70, s92, s75
    s_add_u32 s72, s92, s77
    s_add_u32 s76, s72, 4096
    s_xor_b32 s60, s60, 2
    s_mul_i32 s92, s60, 24576
    s_add_u32 s19, s92, s75
    s_mul_i32 s92, s60, 36864
    s_add_u32 s20, s92, s71
    s_cmp_eq_u32 s4, 3
    s_cselect_b32 s20, s27, s20
    s_and_b32 s60, s67, 127
    s_mul_i32 s79, s60, 163840
    s_add_u32 s92, s67, 1
    s_and_b32 s93, s92, 3
    s_mul_i32 s94, s93, 20480
    s_add_u32 s16, s94, s69
    s_xor_b32 s93, s93, 2
    s_mul_i32 s94, s93, 20480
    s_add_u32 s21, s94, s69
    s_cmp_lt_u32 s67, 64
    s_cselect_b32 s22, -1, 0
    s_cselect_b32 s24, 0x00ff00ff, 0
    s_cmp_ge_u32 s67, 7
    s_cselect_b32 s23, -1, 0
    s_cselect_b32 s92, 0xff00ff00, 0
    s_or_b32 s24, s24, s92
    s_mov_b32 s25, s24
    s_and_b32 s60, s67, 3
    s_mul_i32 s17, s60, 24576
    s_sub_u32 s60, s67, 7
    s_and_b32 s60, s60, 3
    s_mul_i32 s18, s60, 24576
    s_cmp_eq_u32 s67, 0
    s_cselect_b32 s26, 1, 0
    s_cmp_eq_u32 s67, 7
    s_cselect_b32 s26, 1, s26
    v_add_u32 v29, s81, v2
    s_sleep 20
    s_waitcnt vmcnt(0)
    s_branch L_ch_next_f
L_agr0_f:
    buffer_load_dwordx4 v[96:99], v4, s[8:11], s55 offen offset:0 sc1
    buffer_load_dwordx4 v[100:103], v4, s[8:11], s55 offen offset:1024 sc1
    buffer_load_dwordx4 v[104:107], v4, s[8:11], s55 offen offset:2048 sc1
    buffer_load_dwordx4 v[108:111], v4, s[8:11], s55 offen offset:3072 sc1
    buffer_load_dwordx4 v[112:115], v4, s[8:11], s56 offen offset:0 sc1
    buffer_load_dword v58, v6, s[8:11], s86 offen sc1
    buffer_load_dword v59, v6, s[8:11], s86 offen offset:2048 sc1
    s_sub_u32 s6, s6, 1
    s_cbranch_scc1 L_fail
    s_waitcnt vmcnt(6)
    s_branch L_agc0_f
L_agr1_f:
    buffer_load_dwordx4 v[100:103], v4, s[8:11], s55 offen offset:1024 sc1
    buffer_load_dwordx4 v[104:107], v4, s[8:11], s55 offen offset:2048 sc1
    buffer_load_dwordx4 v[108:111], v4, s[8:11], s55 offen offset:3072 sc1
    buffer_load_dwordx4 v[112:115], v4, s[8:11], s56 offen offset:0 sc1
    buffer_load_dword v58, v6, s[8:11], s86 offen sc1
    buffer_load_dword v59, v6, s[8:11], s86 offen offset:2048 sc1
    s_sub_u32 s6, s6, 1
    s_cbranch_scc1 L_fail
    s_waitcnt vmcnt(5)
    s_branch L_agc1_f
L_agr2_f:
    buffer_load_dwordx4 v[104:107], v4, s[8:11], s55 offen offset:2048 sc1
    buffer_load_dwordx4 v[108:111], v4, s[8:11], s55 offen offset:3072 sc1
    buffer_load_dwordx4 v[112:115], v4, s[8:11], s56 offen offset:0 sc1
    buffer_load_dword v58, v6, s[8:11], s86 offen sc1
    buffer_load_dword v59, v6, s[8:11], s86 offen offset:2048 sc1
    s_sub_u32 s6, s6, 1
    s_cbranch_scc1 L_fail
    s_waitcnt vmcnt(4)
    s_branch L_agc2_f
L_agr3_f:
    buffer_load_dwordx4 v[108:111], v4, s[8:11], s55 offen offset:3072 sc1
    buffer_load_dwordx4 v[112:115], v4, s[8:11], s56 offen offset:0 sc1
    buffer_load_dword v58, v6, s[8:11], s86 offen sc1
    buffer_load_dword v59, v6, s[8:11], s86 offen offset:2048 sc1
    s_sub_u32 s6, s6, 1
    s_cbranch_scc1 L_fail
    s_waitcnt vmcnt(3)
    s_branch L_agc3_f
L_agr4_f:
    buffer_load_dwordx4 v[112:115], v4, s[8:11], s56 offen offset:0 sc1
    buffer_load_dword v58, v6, s[8:11], s86 offen sc1
    buffer_load_dword v59, v6, s[8:11], s86 offen offset:2048 sc1
    s_sub_u32 s6, s6, 1
    s_cbranch_scc1 L_fail
    s_waitcnt vmcnt(2)
    s_branch L_agc4_f
L_ch_sp_f:
    v_and_b32 v28, 7, v0
    v_mul_u32_u24 v28, 1280, v28
    v_lshrrev_b32 v30, 4, v0
    v_lshl_add_u32 v28, v30, 4, v28
    s_mul_i32 s60, s4, 320
    v_add_u32 v28, s60, v28
    buffer_load_dwordx4 v[72:75], v28, s[44:47], 0 offen offset:0
    buffer_load_dwordx4 v[76:79], v28, s[44:47], 0 offen offset:64
    buffer_load_dwordx4 v[80:83], v28, s[44:47], 0 offen offset:128
    buffer_load_dwordx4 v[84:87], v28, s[44:47], 0 offen offset:192
    buffer_load_dwordx4 v[88:91], v28, s[44:47], 0 offen offset:256
    s_mov_b64 s[92:93], -1
    s_cmp_eq_u32 s67, 0
    s_cbranch_scc1 L_ch_sq_f
    s_mov_b64 s[92:93], s[88:89]
L_ch_sr_f:
    buffer_load_dwordx4 v[96:99], v4, s[8:11], s55 offen offset:0 sc1
    buffer_load_dwordx4 v[100:103], v4, s[8:11], s55 offen offset:1024 sc1
    buffer_load_dwordx4 v[104:107], v4, s[8:11], s55 offen offset:2048 sc1
    buffer_load_dwordx4 v[108:111], v4, s[8:11], s55 offen offset:3072 sc1
    buffer_load_dwordx4 v[112:115], v4, s[8:11], s56 offen offset:0 sc1
    s_waitcnt vmcnt(0)
    v_max3_u32 v28, v96, v97, v98
    v_max3_u32 v28, v28, v99, v100
    v_max3_u32 v28, v28, v101, v102
    v_max3_u32 v28, v28, v103, v104
    v_max_u32 v28, v28, v105
    v_max3_u32 v30, v106, v107, v108
    v_max3_u32 v30, v30, v109, v110
    v_max3_u32 v30, v30, v111, v112
    v_max3_u32 v30, v30, v113, v114
    v_max_u32 v30, v30, v115
    v_max_u32 v28, v28, v30
    v_cmp_eq_u32 vcc, -1, v28
    s_cbranch_vccz L_ch_sq_f
    s_sub_u32 s6, s6, 1
    s_cbranch_scc0 L_ch_sr_f
    s_branch L_fail
L_ch_sq_f:
    s_waitcnt vmcnt(0)
    v_cndmask_b32 v96, v96, v72, s[92:93]
    v_cndmask_b32 v97, v97, v73, s[92:93]
    v_cndmask_b32 v98, v98, v74, s[92:93]
    v_cndmask_b32 v99, v99, v75, s[92:93]
    v_cndmask_b32 v100, v100, v76, s[92:93]
    v_cndmask_b32 v101, v101, v77, s[92:93]
    v_cndmask_b32 v102, v102, v78, s[92:93]
    v_cndmask_b32 v103, v103, v79, s[92:93]
    v_cndmask_b32 v104, v104, v80, s[92:93]
    v_cndmask_b32 v105, v105, v81, s[92:93]
    v_cndmask_b32 v106, v106, v82, s[92:93]
    v_cndmask_b32 v107, v107, v83, s[92:93]
    v_cndmask_b32 v108, v108, v84, s[92:93]
    v_cndmask_b32 v109, v109, v85, s[92:93]
    v_cndmask_b32 v110, v110, v86, s[92:93]
    v_cndmask_b32 v111, v111, v87, s[92:93]
    v_cndmask_b32 v112, v112, v88, s[92:93]
    v_cndmask_b32 v113, v113, v89, s[92:93]
    v_cndmask_b32 v114, v114, v90, s[92:93]
    v_cndmask_b32 v115, v115, v91, s[92:93]
    ds_write_b128 v29, v[96:99] offset:0
    ds_write_b128 v29, v[100:103] offset:1024
    ds_write_b128 v29, v[104:107] offset:2048
    ds_write_b128 v29, v[108:111] offset:3072
    ds_write_b128 v29, v[112:115] offset:4096
    buffer_load_dword v58, v6, s[8:11], s86 offen sc1
    buffer_load_dword v59, v6, s[8:11], s86 offen offset:2048 sc1
    v_add_u32 v88, s33, v2
    v_add_u32 v89, s34, v2
    v_add_u32 v90, s35, v2
    s_branch L_ch_ag_f
L_ch_fl_f:
    buffer_load_dword v58, v6, s[8:11], s86 offen sc1
    buffer_load_dword v59, v6, s[8:11], s86 offen offset:2048 sc1
    s_waitcnt vmcnt(0)
    v_readlane_b32 s42, v58, 0
    v_readlane_b32 s92, v58, 1
    v_readlane_b32 s43, v59, 0
    v_readlane_b32 s93, v59, 1
    s_min_u32 s42, s42, s92
    s_min_u32 s43, s43, s93
    s_cmp_gt_u32 s82, s42
    s_cselect_b32 s30, 1, 0
    s_cmp_gt_u32 s83, s43
    s_cselect_b32 s30, 1, s30
    s_cmp_eq_u32 s30, 0
    s_cbranch_scc1 L_ch_fc_f
    s_sleep 2
    s_sub_u32 s6, s6, 1
    s_cbranch_scc0 L_ch_fl_f
    s_branch L_fail
L_sp_99:
    v_max3_u32 v30, v96, v97, v98
    v_max_u32 v30, v30, v99
    v_max3_u32 v20, v100, v101, v102
    v_max_u32 v20, v20, v103
    v_max_u32 v30, v30, v20
    v_cmp_eq_u32 vcc, -1, v30
    s_cbranch_vccz L_so_100
    buffer_load_dwordx4 v[96:99], v2, s[8:11], s58 offen sc1
    buffer_load_dwordx4 v[100:103], v2, s[8:11], s59 offen sc1
    s_waitcnt vmcnt(2)
    v_pk_add_f32 v[120:121], v[112:113], v[116:117]
    v_pk_add_f32 v[122:123], v[114:115], v[118:119]
    v_pk_add_f32 v[16:17], v[76:77], v[120:121]
    v_pk_add_f32 v[18:19], v[78:79], v[122:123]
    ds_write_b128 v31, v[16:19] offset:49152
    v_cmp_u_f32 vcc, v120, v121
    v_cmp_u_f32 s[92:93], v122, v123
    s_or_b64 vcc, vcc, s[92:93]
    s_cbranch_vccz L_so_100
    v_max3_u32 v30, v112, v113, v114
    v_max_u32 v30, v30, v115
    v_max3_u32 v20, v116, v117, v118
    v_max_u32 v20, v20, v119
    v_max_u32 v30, v30, v20
    v_cmp_eq_u32 vcc, -1, v30
    s_cbranch_vccz L_so_100
    buffer_load_dwordx4 v[112:115], v2, s[8:11], s58 offen sc1
    buffer_load_dwordx4 v[116:119], v2, s[8:11], s59 offen sc1
    s_waitcnt vmcnt(2)
    v_pk_add_f32 v[104:105], v[96:97], v[100:101]
    v_pk_add_f32 v[106:107], v[98:99], v[102:103]
    v_pk_add_f32 v[16:17], v[76:77], v[104:105]
    v_pk_add_f32 v[18:19], v[78:79], v[106:107]
    ds_write_b128 v31, v[16:19] offset:49152
    v_cmp_u_f32 vcc, v104, v105
    v_cmp_u_f32 s[92:93], v106, v107
    s_or_b64 vcc, vcc, s[92:93]
    s_cbranch_vccz L_so_100
    s_sub_u32 s6, s6, 1
    s_cbranch_scc0 L_sp_99
    s_branch L_fail
L_w2_96:
    s_cmp_eq_u32 s4, 3
    s_cbranch_scc1 L_w3_97
    s_waitcnt lgkmcnt(0)
    v_mfma_f32_16x16x32_bf16 v[76:79], v[64:67], v[56:59], 0
    v_mfma_f32_16x16x32_bf16 v[76:79], v[68:71], v[60:63], v[76:79]
    s_nop 7
    buffer_store_dwordx4 v[76:79], v2, s[8:11], s57 offen
    v_mfma_f32_16x16x32_bf16 v[24:27], v[124:127], a[188:191], v[24:27]
    v_mfma_f32_16x16x32_bf16 v[24:27], v[128:131], a[192:195], v[24:27]
    v_mfma_f32_16x16x32_bf16 v[24:27], v[132:135], a[196:199], v[24:27]
    v_mfma_f32_16x16x32_bf16 v[24:27], v[136:139], a[200:203], v[24:27]
    v_mfma_f32_16x16x32_bf16 v[24:27], v[140:143], a[204:207], v[24:27]
    v_mfma_f32_16x16x32_bf16 v[24:27], v[144:147], a[208:211], v[24:27]
    v_mfma_f32_16x16x32_bf16 v[24:27], v[148:151], a[212:215], v[24:27]
    v_mfma_f32_16x16x32_bf16 v[24:27], v[152:155], a[216:219], v[24:27]
    v_mfma_f32_16x16x32_bf16 v[24:27], v[156:159], a[220:223], v[24:27]
    buffer_load_dwordx4 v[96:99], v2, s[8:11], s58 offen sc1
    buffer_load_dwordx4 v[100:103], v2, s[8:11], s59 offen sc1
    v_mfma_f32_16x16x32_bf16 v[24:27], v[160:163], a[224:227], v[24:27]
    v_mfma_f32_16x16x32_bf16 v[24:27], v[164:167], a[228:231], v[24:27]
    v_mfma_f32_16x16x32_bf16 v[24:27], v[168:171], a[232:235], v[24:27]
    v_mfma_f32_16x16x32_bf16 v[24:27], v[172:175], a[236:239], v[24:27]
    v_mov_b32 v28, 0xff800000
    v_cndmask_b32 v80, v76, v28, s[90:91]
    v_cndmask_b32 v81, v77, v28, s[90:91]
    v_cndmask_b32 v82, v78, v28, s[90:91]
    v_cndmask_b32 v83, v79, v28, s[90:91]
    buffer_load_dwordx4 v[112:115], v2, s[8:11], s58 offen sc1
    buffer_load_dwordx4 v[116:119], v2, s[8:11], s59 offen sc1
    v_mov_b32 v87, s17
    v_mov_b32 v86, s18
    s_mov_b32 s92, 0
    s_mov_b32 s93, -1
    v_cndmask_b32 v84, v87, v86, s[88:89]
    v_cndmask_b32 v85, v87, v86, s[92:93]
    v_add_u32 v84, v84, v13
    v_add_u32 v85, v85, v1
    v_cvt_pk_bf16_f32 v28, v24, v25
    v_cvt_pk_bf16_f32 v29, v26, v27
    s_waitcnt vmcnt(2)
    v_pk_add_f32 v[104:105], v[96:97], v[100:101]
    v_pk_add_f32 v[106:107], v[98:99], v[102:103]
    v_pk_add_f32 v[16:17], v[80:81], v[104:105]
    v_pk_add_f32 v[18:19], v[82:83], v[106:107]
    ds_write_b128 v31, v[16:19] offset:49152
    v_cmp_u_f32 vcc, v104, v105
    v_cmp_u_f32 s[92:93], v106, v107
    s_or_b64 vcc, vcc, s[92:93]
    s_cbranch_vccnz L_sp_103
L_so_104:
    s_branch L_we_98
L_w3_97:
    v_mfma_f32_16x16x32_bf16 v[24:27], v[124:127], a[188:191], v[24:27]
    v_mfma_f32_16x16x32_bf16 v[24:27], v[128:131], a[192:195], v[24:27]
    v_mfma_f32_16x16x32_bf16 v[24:27], v[132:135], a[196:199], v[24:27]
    v_mfma_f32_16x16x32_bf16 v[24:27], v[136:139], a[200:203], v[24:27]
    v_mfma_f32_16x16x32_bf16 v[24:27], v[140:143], a[204:207], v[24:27]
    v_mfma_f32_16x16x32_bf16 v[24:27], v[144:147], a[208:211], v[24:27]
    v_mfma_f32_16x16x32_bf16 v[24:27], v[148:151], a[212:215], v[24:27]
    v_mfma_f32_16x16x32_bf16 v[24:27], v[152:155], a[216:219], v[24:27]
    v_mfma_f32_16x16x32_bf16 v[24:27], v[156:159], a[220:223], v[24:27]
    v_mfma_f32_16x16x32_bf16 v[24:27], v[160:163], a[224:227], v[24:27]
    v_mfma_f32_16x16x32_bf16 v[24:27], v[164:167], a[228:231], v[24:27]
    v_mfma_f32_16x16x32_bf16 v[24:27], v[168:171], a[232:235], v[24:27]
    v_mfma_f32_16x16x32_bf16 v[24:27], v[172:175], a[236:239], v[24:27]
    v_mov_b32 v87, s17
    v_mov_b32 v86, s18
    s_mov_b32 s92, 0
    s_mov_b32 s93, -1
    v_cndmask_b32 v84, v87, v86, s[88:89]
    v_cndmask_b32 v85, v87, v86, s[92:93]
    v_add_u32 v84, v84, v13
    v_add_u32 v85, v85, v1
    s_waitcnt lgkmcnt(0)
    s_mov_b64 exec, s[24:25]
    buffer_store_dwordx4 v[64:67], v84, s[8:11], 0 offen
    buffer_store_dwordx4 v[68:71], v84, s[8:11], 0 offen offset:256
    s_mov_b64 exec, -1
    v_cvt_pk_bf16_f32 v28, v24, v25
    v_cvt_pk_bf16_f32 v29, v26, v27
    s_waitcnt vmcnt(2)
    s_branch L_we_98
L_ch_wo_f:
    v_mov_b32 v136, v255
    s_add_u32 s60, s4, 0
    s_and_b32 s60, s60, 3
    s_mul_i32 s60, s60, 24576
    s_add_u32 s60, s60, 61440
    v_add_u32 v137, s60, v136
    ds_read_b64_tr_b16 a[240:241], v137 offset:0
    ds_read_b64_tr_b16 a[242:243], v137 offset:512
    ds_read_b64_tr_b16 a[244:245], v137 offset:4096
    ds_read_b64_tr_b16 a[246:247], v137 offset:4608
    ds_read_b64_tr_b16 a[248:249], v137 offset:8192
    ds_read_b64_tr_b16 a[250:251], v137 offset:8704
    ds_read_b64_tr_b16 a[252:253], v137 offset:12288
    ds_read_b64_tr_b16 a[254:255], v137 offset:12800
    ds_read_b64_tr_b16 v[176:177], v137 offset:16384
    ds_read_b64_tr_b16 v[178:179], v137 offset:16896
    ds_read_b64_tr_b16 v[180:181], v137 offset:20480
    ds_read_b64_tr_b16 v[182:183], v137 offset:20992
    s_add_u32 s60, s4, 1
    s_and_b32 s60, s60, 3
    s_mul_i32 s60, s60, 24576
    s_add_u32 s60, s60, 61440
    v_add_u32 v137, s60, v136
    ds_read_b64_tr_b16 v[184:185], v137 offset:0
    ds_read_b64_tr_b16 v[186:187], v137 offset:512
    ds_read_b64_tr_b16 v[188:189], v137 offset:4096
    ds_read_b64_tr_b16 v[190:191], v137 offset:4608
    ds_read_b64_tr_b16 v[192:193], v137 offset:8192
    ds_read_b64_tr_b16 v[194:195], v137 offset:8704
    ds_read_b64_tr_b16 v[196:197], v137 offset:12288
    ds_read_b64_tr_b16 v[198:199], v137 offset:12800
    ds_read_b64_tr_b16 v[200:201], v137 offset:16384
    ds_read_b64_tr_b16 v[202:203], v137 offset:16896
    ds_read_b64_tr_b16 v[204:205], v137 offset:20480
    ds_read_b64_tr_b16 v[206:207], v137 offset:20992
    s_add_u32 s60, s4, 2
    s_and_b32 s60, s60, 3
    s_mul_i32 s60, s60, 24576
    s_add_u32 s60, s60, 61440
    v_add_u32 v137, s60, v136
    ds_read_b64_tr_b16 v[208:209], v137 offset:0
    ds_read_b64_tr_b16 v[210:211], v137 offset:512
    ds_read_b64_tr_b16 v[212:213], v137 offset:4096
    ds_read_b64_tr_b16 v[214:215], v137 offset:4608
    ds_read_b64_tr_b16 v[216:217], v137 offset:8192
    ds_read_b64_tr_b16 v[218:219], v137 offset:8704
    ds_read_b64_tr_b16 v[220:221], v137 offset:12288
    ds_read_b64_tr_b16 v[222:223], v137 offset:12800
    ds_read_b64_tr_b16 v[224:225], v137 offset:16384
    ds_read_b64_tr_b16 v[226:227], v137 offset:16896
    ds_read_b64_tr_b16 v[228:229], v137 offset:20480
    ds_read_b64_tr_b16 v[230:231], v137 offset:20992
    s_add_u32 s60, s4, 3
    s_and_b32 s60, s60, 3
    s_mul_i32 s60, s60, 24576
    s_add_u32 s60, s60, 61440
    v_add_u32 v137, s60, v136
    ds_read_b64_tr_b16 v[232:233], v137 offset:0
    ds_read_b64_tr_b16 v[234:235], v137 offset:512
    ds_read_b64_tr_b16 v[236:237], v137 offset:4096
    ds_read_b64_tr_b16 v[238:239], v137 offset:4608
    ds_read_b64_tr_b16 v[240:241], v137 offset:8192
    ds_read_b64_tr_b16 v[242:243], v137 offset:8704
    ds_read_b64_tr_b16 v[244:245], v137 offset:12288
    ds_read_b64_tr_b16 v[246:247], v137 offset:12800
    ds_read_b64_tr_b16 v[248:249], v137 offset:16384
    ds_read_b64_tr_b16 v[250:251], v137 offset:16896
    ds_read_b64_tr_b16 v[252:253], v137 offset:20480
    ds_read_b64_tr_b16 v[254:255], v137 offset:20992
    s_waitcnt lgkmcnt(0)
    s_branch L_ch_wp_f
L_ogr0_f:
    buffer_load_dwordx4 v[72:75], v5, s[8:11], s72 offen offset:0 sc1
    buffer_load_dwordx4 v[76:79], v5, s[8:11], s72 offen offset:1024 sc1
    buffer_load_dwordx4 v[80:83], v5, s[8:11], s72 offen offset:2048 sc1
    buffer_load_dwordx4 v[84:87], v5, s[8:11], s72 offen offset:3072 sc1
    buffer_load_dwordx4 v[88:91], v5, s[8:11], s76 offen offset:0 sc1
    buffer_load_dwordx4 v[92:95], v5, s[8:11], s76 offen offset:1024 sc1
    s_sub_u32 s6, s6, 1
    s_cbranch_scc1 L_fail
    s_waitcnt vmcnt(5)
    s_branch L_ogc0_f
L_ogr1_f:
    buffer_load_dwordx4 v[76:79], v5, s[8:11], s72 offen offset:1024 sc1
    buffer_load_dwordx4 v[80:83], v5, s[8:11], s72 offen offset:2048 sc1
    buffer_load_dwordx4 v[84:87], v5, s[8:11], s72 offen offset:3072 sc1
    buffer_load_dwordx4 v[88:91], v5, s[8:11], s76 offen offset:0 sc1
    buffer_load_dwordx4 v[92:95], v5, s[8:11], s76 offen offset:1024 sc1
    s_sub_u32 s6, s6, 1
    s_cbranch_scc1 L_fail
    s_waitcnt vmcnt(4)
    s_branch L_ogc1_f
L_ogr2_f:
    buffer_load_dwordx4 v[80:83], v5, s[8:11], s72 offen offset:2048 sc1
    buffer_load_dwordx4 v[84:87], v5, s[8:11], s72 offen offset:3072 sc1
    buffer_load_dwordx4 v[88:91], v5, s[8:11], s76 offen offset:0 sc1
    buffer_load_dwordx4 v[92:95], v5, s[8:11], s76 offen offset:1024 sc1
    s_sub_u32 s6, s6, 1
    s_cbranch_scc1 L_fail
    s_waitcnt vmcnt(3)
    s_branch L_ogc2_f
L_ogr3_f:
    buffer_load_dwordx4 v[84:87], v5, s[8:11], s72 offen offset:3072 sc1
    buffer_load_dwordx4 v[88:91], v5, s[8:11], s76 offen offset:0 sc1
    buffer_load_dwordx4 v[92:95], v5, s[8:11], s76 offen offset:1024 sc1
    s_sub_u32 s6, s6, 1
    s_cbranch_scc1 L_fail
    s_waitcnt vmcnt(2)
    s_branch L_ogc3_f
L_ogr4_f:
    buffer_load_dwordx4 v[88:91], v5, s[8:11], s76 offen offset:0 sc1
    buffer_load_dwordx4 v[92:95], v5, s[8:11], s76 offen offset:1024 sc1
    s_sub_u32 s6, s6, 1
    s_cbranch_scc1 L_fail
    s_waitcnt vmcnt(1)
    s_branch L_ogc4_f
L_ogr5_f:
    buffer_load_dwordx4 v[92:95], v5, s[8:11], s76 offen offset:1024 sc1
    s_sub_u32 s6, s6, 1
    s_cbranch_scc1 L_fail
    s_waitcnt vmcnt(0)
    s_branch L_ogc5_f
L_cp_101x:
    v_max3_u32 v26, v72, v73, v74
    v_max3_u32 v26, v26, v75, v76
    v_max3_u32 v26, v26, v77, v78
    v_max_u32 v26, v26, v79
    v_max3_u32 v27, v80, v81, v82
    v_max3_u32 v27, v27, v83, v84
    v_max3_u32 v27, v27, v85, v86
    v_max_u32 v27, v27, v87
    v_max_u32 v26, v26, v27
    v_cmp_eq_u32 vcc, -1, v26
    s_cbranch_vccz L_co_102
    s_mov_b32 s29, 1
L_cp_101y:
    buffer_load_dwordx4 v[72:75], v57, s[8:11], s48 offen sc1
    buffer_load_dwordx4 v[76:79], v56, s[8:11], s49 offen sc1
    buffer_load_dwordx4 v[80:83], v56, s[8:11], s50 offen sc1
    buffer_load_dwordx4 v[84:87], v56, s[8:11], s51 offen sc1
    s_waitcnt vmcnt(4)
    v_max3_u32 v26, v96, v97, v98
    v_max3_u32 v26, v26, v99, v100
    v_max3_u32 v26, v26, v101, v102
    v_max_u32 v26, v26, v103
    v_max3_u32 v27, v104, v105, v106
    v_max3_u32 v27, v27, v107, v108
    v_max3_u32 v27, v27, v109, v110
    v_max_u32 v27, v27, v111
    v_max_u32 v26, v26, v27
    v_cmp_eq_u32 vcc, -1, v26
    s_cbranch_vccz L_cp_101z96
    buffer_load_dwordx4 v[96:99], v57, s[8:11], s48 offen sc1
    buffer_load_dwordx4 v[100:103], v56, s[8:11], s49 offen sc1
    buffer_load_dwordx4 v[104:107], v56, s[8:11], s50 offen sc1
    buffer_load_dwordx4 v[108:111], v56, s[8:11], s51 offen sc1
    s_waitcnt vmcnt(4)
    v_max3_u32 v26, v72, v73, v74
    v_max3_u32 v26, v26, v75, v76
    v_max3_u32 v26, v26, v77, v78
    v_max_u32 v26, v26, v79
    v_max3_u32 v27, v80, v81, v82
    v_max3_u32 v27, v27, v83, v84
    v_max3_u32 v27, v27, v85, v86
    v_max_u32 v27, v27, v87
    v_max_u32 v26, v26, v27
    v_cmp_eq_u32 vcc, -1, v26
    s_cbranch_vccz L_cp_101z72
    s_sub_u32 s6, s6, 1
    s_cbranch_scc0 L_cp_101y
    s_branch L_fail
L_cp_101z72:
    v_mfma_f32_16x16x32_bf16 v[64:67], v[8:11], v[72:75], v[16:19]
    v_mfma_f32_16x16x32_bf16 v[64:67], v[8:11], v[76:79], v[64:67]
    v_mfma_f32_16x16x32_bf16 v[64:67], v[8:11], v[80:83], v[64:67]
    v_mfma_f32_16x16x32_bf16 v[64:67], v[8:11], v[84:87], v[64:67]
    s_nop 7
    v_cvt_pk_bf16_f32 v24, v64, v65
    v_cvt_pk_bf16_f32 v25, v66, v67
    s_branch L_co_102
L_cp_101z96:
    v_mfma_f32_16x16x32_bf16 v[64:67], v[8:11], v[96:99], v[16:19]
    v_mfma_f32_16x16x32_bf16 v[64:67], v[8:11], v[100:103], v[64:67]
    v_mfma_f32_16x16x32_bf16 v[64:67], v[8:11], v[104:107], v[64:67]
    v_mfma_f32_16x16x32_bf16 v[64:67], v[8:11], v[108:111], v[64:67]
    s_nop 7
    v_cvt_pk_bf16_f32 v24, v64, v65
    v_cvt_pk_bf16_f32 v25, v66, v67
    s_branch L_co_102
L_sp_103:
    v_max3_u32 v30, v96, v97, v98
    v_max_u32 v30, v30, v99
    v_max3_u32 v20, v100, v101, v102
    v_max_u32 v20, v20, v103
    v_max_u32 v30, v30, v20
    v_cmp_eq_u32 vcc, -1, v30
    s_cbranch_vccz L_so_104
    buffer_load_dwordx4 v[96:99], v2, s[8:11], s58 offen sc1
    buffer_load_dwordx4 v[100:103], v2, s[8:11], s59 offen sc1
    s_waitcnt vmcnt(2)
    v_pk_add_f32 v[120:121], v[112:113], v[116:117]
    v_pk_add_f32 v[122:123], v[114:115], v[118:119]
    v_pk_add_f32 v[16:17], v[80:81], v[120:121]
    v_pk_add_f32 v[18:19], v[82:83], v[122:123]
    ds_write_b128 v31, v[16:19] offset:49152
    v_cmp_u_f32 vcc, v120, v121
    v_cmp_u_f32 s[92:93], v122, v123
    s_or_b64 vcc, vcc, s[92:93]
    s_cbranch_vccz L_so_104
    v_max3_u32 v30, v112, v113, v114
    v_max_u32 v30, v30, v115
    v_max3_u32 v20, v116, v117, v118
    v_max_u32 v20, v20, v119
    v_max_u32 v30, v30, v20
    v_cmp_eq_u32 vcc, -1, v30
    s_cbranch_vccz L_so_104
    buffer_load_dwordx4 v[112:115], v2, s[8:11], s58 offen sc1
    buffer_load_dwordx4 v[116:119], v2, s[8:11], s59 offen sc1
    s_waitcnt vmcnt(2)
    v_pk_add_f32 v[104:105], v[96:97], v[100:101]
    v_pk_add_f32 v[106:107], v[98:99], v[102:103]
    v_pk_add_f32 v[16:17], v[80:81], v[104:105]
    v_pk_add_f32 v[18:19], v[82:83], v[106:107]
    ds_write_b128 v31, v[16:19] offset:49152
    v_cmp_u_f32 vcc, v104, v105
    v_cmp_u_f32 s[92:93], v106, v107
    s_or_b64 vcc, vcc, s[92:93]
    s_cbranch_vccz L_so_104
    s_sub_u32 s6, s6, 1
    s_cbranch_scc0 L_sp_103
    s_branch L_fail
L_ch_init_s:
    s_add_u32 s92, s67, 1
    s_and_b32 s60, s67, 3
    s_mul_i32 s84, s60, 147456
    s_add_u32 s84, s84, 116391936
    s_cmp_lt_u32 s67, 64
    s_cselect_b32 s82, s92, 0
    s_cselect_b32 s84, s84, s10
    s_sub_u32 s60, s67, 7
    s_and_b32 s60, s60, 3
    s_mul_i32 s85, s60, 147456
    s_add_u32 s85, s85, 116981760
    s_sub_u32 s92, s92, 7
    s_cmp_ge_u32 s67, 7
    s_cselect_b32 s83, s92, 0
    s_cselect_b32 s85, s85, s10
    s_cmp_ge_u32 s67, 71
    s_cselect_b32 s83, 0, s83
    s_cselect_b32 s85, s10, s85
    s_mov_b32 s30, 1
    s_mov_b32 s31, 48
    s_mov_b32 s28, 0
    s_mov_b32 s29, 0
    s_and_b32 s60, s67, 3
    s_mul_i32 s92, s60, 20480
    s_add_u32 s55, s92, s68
    s_add_u32 s56, s55, 4096
    s_mul_i32 s92, s60, 36864
    s_add_u32 s57, s92, s71
    s_add_u32 s58, s92, s73
    s_add_u32 s59, s92, s74
    s_mul_i32 s92, s60, 24576
    s_add_u32 s70, s92, s75
    s_add_u32 s72, s92, s77
    s_add_u32 s76, s72, 4096
    s_xor_b32 s60, s60, 2
    s_mul_i32 s92, s60, 24576
    s_add_u32 s19, s92, s75
    s_mul_i32 s92, s60, 36864
    s_add_u32 s20, s92, s71
    s_cmp_eq_u32 s4, 3
    s_cselect_b32 s20, s27, s20
    s_and_b32 s60, s67, 127
    s_mul_i32 s79, s60, 163840
    s_add_u32 s92, s67, 1
    s_and_b32 s93, s92, 3
    s_mul_i32 s94, s93, 20480
    s_add_u32 s16, s94, s69
    s_xor_b32 s93, s93, 2
    s_mul_i32 s94, s93, 20480
    s_add_u32 s21, s94, s69
    s_cmp_lt_u32 s67, 64
    s_cselect_b32 s22, -1, 0
    s_cselect_b32 s24, 0x00ff00ff, 0
    s_cmp_ge_u32 s67, 7
    s_cselect_b32 s23, -1, 0
    s_cselect_b32 s92, 0xff00ff00, 0
    s_or_b32 s24, s24, s92
    s_mov_b32 s25, s24
    s_and_b32 s60, s67, 3
    s_mul_i32 s17, s60, 24576
    s_sub_u32 s60, s67, 7
    s_and_b32 s60, s60, 3
    s_mul_i32 s18, s60, 24576
    s_cmp_eq_u32 s67, 0
    s_cselect_b32 s26, 1, 0
    s_cmp_eq_u32 s67, 7
    s_cselect_b32 s26, 1, s26
    v_add_u32 v29, s81, v2
L_ch_step_s:
    s_cmp_lg_u32 s26, 0
    s_cbranch_scc1 L_ch_sp_s
    s_sleep 4
    buffer_load_dwordx4 v[96:99], v4, s[8:11], s55 offen offset:0 sc1
    buffer_load_dwordx4 v[100:103], v4, s[8:11], s55 offen offset:1024 sc1
    buffer_load_dwordx4 v[104:107], v4, s[8:11], s55 offen offset:2048 sc1
    buffer_load_dwordx4 v[108:111], v4, s[8:11], s55 offen offset:3072 sc1
    buffer_load_dwordx4 v[112:115], v4, s[8:11], s56 offen offset:0 sc1
    buffer_load_dword v58, v6, s[8:11], s86 offen sc1
    buffer_load_dword v59, v6, s[8:11], s86 offen offset:2048 sc1
    v_add_u32 v88, s33, v2
    v_add_u32 v89, s34, v2
    v_add_u32 v90, s35, v2
    s_waitcnt vmcnt(6)
L_agc0_s:
    ds_write_b128 v29, v[96:99] offset:0
    v_max3_u32 v30, v96, v97, v98
    v_max_u32 v30, v30, v99
    v_cmp_eq_u32 vcc, -1, v30
    s_cbranch_vccnz L_agr0_s
L_agp0_s:
    s_waitcnt vmcnt(5)
L_agc1_s:
    ds_write_b128 v29, v[100:103] offset:1024
    v_max3_u32 v30, v100, v101, v102
    v_max_u32 v30, v30, v103
    v_cmp_eq_u32 vcc, -1, v30
    s_cbranch_vccnz L_agr1_s
L_agp1_s:
    s_waitcnt vmcnt(4)
L_agc2_s:
    ds_write_b128 v29, v[104:107] offset:2048
    v_max3_u32 v30, v104, v105, v106
    v_max_u32 v30, v30, v107
    v_cmp_eq_u32 vcc, -1, v30
    s_cbranch_vccnz L_agr2_s
L_agp2_s:
    s_waitcnt vmcnt(3)
L_agc3_s:
    ds_write_b128 v29, v[108:111] offset:3072
    v_max3_u32 v30, v108, v109, v110
    v_max_u32 v30, v30, v111
    v_cmp_eq_u32 vcc, -1, v30
    s_cbranch_vccnz L_agr3_s
L_agp3_s:
    s_waitcnt vmcnt(2)
L_agc4_s:
    ds_write_b128 v29, v[112:115] offset:4096
    v_max3_u32 v30, v112, v113, v114
    v_max_u32 v30, v30, v115
    v_cmp_eq_u32 vcc, -1, v30
    s_cbranch_vccnz L_agr4_s
L_agp4_s:
L_ch_ag_s:
    s_waitcnt lgkmcnt(0)
    s_barrier
    ds_read_b128 v[116:119], v88 offset:0
    ds_read_b128 v[120:123], v88 offset:1024
    v_mfma_f32_16x16x32_bf16 v[16:19], a[0:3], v[96:99], 0
    v_mfma_f32_16x16x32_bf16 v[20:23], a[80:83], v[96:99], 0
    ds_read_b128 v[124:127], v88 offset:2048
    ds_read_b128 v[128:131], v88 offset:3072
    ds_read_b128 v[132:135], v88 offset:4096
    s_waitcnt vmcnt(0)
    v_readlane_b32 s42, v58, 0
    v_readlane_b32 s92, v58, 1
    v_readlane_b32 s43, v59, 0
    v_readlane_b32 s93, v59, 1
    v_mfma_f32_16x16x32_bf16 v[16:19], a[4:7], v[100:103], v[16:19]
    v_mfma_f32_16x16x32_bf16 v[20:23], a[84:87], v[100:103], v[20:23]
    ds_read_b128 v[136:139], v89 offset:0
    ds_read_b128 v[140:143], v89 offset:1024
    ds_read_b128 v[144:147], v89 offset:2048
    s_min_u32 s42, s42, s92
    s_min_u32 s43, s43, s93
    s_cmp_gt_u32 s82, s42
    s_cbranch_scc1 L_ch_fl_s
    s_cmp_gt_u32 s83, s43
    s_cbranch_scc1 L_ch_fl_s
L_ch_fc_s:
    v_mfma_f32_16x16x32_bf16 v[16:19], a[8:11], v[104:107], v[16:19]
    v_mfma_f32_16x16x32_bf16 v[20:23], a[88:91], v[104:107], v[20:23]
    buffer_load_dwordx4 v[32:35], v7, s[8:11], s84 offen sc1
    v_mfma_f32_16x16x32_bf16 v[16:19], a[12:15], v[108:111], v[16:19]
    v_mfma_f32_16x16x32_bf16 v[20:23], a[92:95], v[108:111], v[20:23]
    buffer_load_dwordx4 v[36:39], v7, s[8:11], s84 offen offset:2048 sc1
    v_mfma_f32_16x16x32_bf16 v[16:19], a[16:19], v[112:115], v[16:19]
    v_mfma_f32_16x16x32_bf16 v[20:23], a[96:99], v[112:115], v[20:23]
    buffer_load_dwordx4 v[40:43], v7, s[8:11], s85 offen sc1
    s_waitcnt lgkmcnt(7)
    v_mfma_f32_16x16x32_bf16 v[16:19], a[20:23], v[116:119], v[16:19]
    ds_read_b128 v[148:151], v89 offset:3072
    v_mfma_f32_16x16x32_bf16 v[20:23], a[100:103], v[116:119], v[20:23]
    buffer_load_dwordx4 v[44:47], v7, s[8:11], s85 offen offset:2048 sc1
    s_waitcnt lgkmcnt(7)
    v_mfma_f32_16x16x32_bf16 v[16:19], a[24:27], v[120:123], v[16:19]
    ds_read_b128 v[152:155], v89 offset:4096
    v_mfma_f32_16x16x32_bf16 v[20:23], a[104:107], v[120:123], v[20:23]
    s_waitcnt lgkmcnt(7)
    v_mfma_f32_16x16x32_bf16 v[16:19], a[28:31], v[124:127], v[16:19]
    ds_read_b128 v[156:159], v90 offset:0
    v_mfma_f32_16x16x32_bf16 v[20:23], a[108:111], v[124:127], v[20:23]
    s_waitcnt lgkmcnt(7)
    v_mfma_f32_16x16x32_bf16 v[16:19], a[32:35], v[128:131], v[16:19]
    ds_read_b128 v[160:163], v90 offset:1024
    v_mfma_f32_16x16x32_bf16 v[20:23], a[112:115], v[128:131], v[20:23]
    s_waitcnt lgkmcnt(7)
    v_mfma_f32_16x16x32_bf16 v[16:19], a[36:39], v[132:135], v[16:19]
    ds_read_b128 v[164:167], v90 offset:2048
    v_mfma_f32_16x16x32_bf16 v[20:23], a[116:119], v[132:135], v[20:23]
    s_waitcnt lgkmcnt(7)
    v_mfma_f32_16x16x32_bf16 v[16:19], a[40:43], v[136:139], v[16:19]
    ds_read_b128 v[168:171], v90 offset:3072
    v_mfma_f32_16x16x32_bf16 v[20:23], a[120:123], v[136:139], v[20:23]
    s_waitcnt lgkmcnt(7)
    v_mfma_f32_16x16x32_bf16 v[16:19], a[44:47], v[140:143], v[16:19]
    ds_read_b128 v[172:175], v90 offset:4096
    v_mfma_f32_16x16x32_bf16 v[20:23], a[124:127], v[140:143], v[20:23]
    buffer_load_dwordx4 v[48:51], v12, s[8:11], s84 offen sc1
    s_waitcnt lgkmcnt(7)
    v_mfma_f32_16x16x32_bf16 v[16:19], a[48:51], v[144:147], v[16:19]
    v_mfma_f32_16x16x32_bf16 v[20:23], a[128:131], v[144:147], v[20:23]
    buffer_load_dwordx4 v[52:55], v12, s[8:11], s85 offen sc1
    s_mov_b32 s80, s16
    s_waitcnt lgkmcnt(6)
    v_mfma_f32_16x16x32_bf16 v[16:19], a[52:55], v[148:151], v[16:19]
    v_mfma_f32_16x16x32_bf16 v[20:23], a[132:135], v[148:151], v[20:23]
    v_mov_b32 v92, 0x3f803f80
    s_waitcnt lgkmcnt(5)
    v_mfma_f32_16x16x32_bf16 v[16:19], a[56:59], v[152:155], v[16:19]
    v_mfma_f32_16x16x32_bf16 v[20:23], a[136:139], v[152:155], v[20:23]
    v_mov_b32 v93, 0x3f803f80
    s_waitcnt lgkmcnt(4)
    v_mfma_f32_16x16x32_bf16 v[16:19], a[60:63], v[156:159], v[16:19]
    v_mfma_f32_16x16x32_bf16 v[20:23], a[140:143], v[156:159], v[20:23]
    v_mov_b32 v94, 0x3f803f80
    s_waitcnt lgkmcnt(3)
    v_mfma_f32_16x16x32_bf16 v[16:19], a[64:67], v[160:163], v[16:19]
    v_mfma_f32_16x16x32_bf16 v[20:23], a[144:147], v[160:163], v[20:23]
    v_mov_b32 v95, 0x3f803f80
    s_waitcnt lgkmcnt(2)
    v_mfma_f32_16x16x32_bf16 v[16:19], a[68:71], v[164:167], v[16:19]
    v_mfma_f32_16x16x32_bf16 v[20:23], a[148:151], v[164:167], v[20:23]
    v_add_u32 v30, s62, v2
    s_waitcnt lgkmcnt(1)
    v_mfma_f32_16x16x32_bf16 v[16:19], a[72:75], v[168:171], v[16:19]
    v_mfma_f32_16x16x32_bf16 v[20:23], a[152:155], v[168:171], v[20:23]
    v_add_u32 v31, s63, v2
    s_waitcnt lgkmcnt(0)
    v_mfma_f32_16x16x32_bf16 v[16:19], a[76:79], v[172:175], v[16:19]
    v_mfma_f32_16x16x32_bf16 v[20:23], a[156:159], v[172:175], v[20:23]
    s_nop 6
    v_cvt_pk_bf16_f32 v72, v16, v17
    v_cvt_pk_bf16_f32 v73, v18, v19
    ds_write_b64 v30, v[72:73] offset:45056
    v_cvt_pk_bf16_f32 v74, v20, v21
    v_cvt_pk_bf16_f32 v75, v22, v23
    ds_write_b64 v30, v[74:75] offset:47104
    v_mfma_f32_16x16x32_bf16 v[24:27], v[96:99], a[160:163], 0
    v_mfma_f32_16x16x32_bf16 v[24:27], v[100:103], a[164:167], v[24:27]
    v_mfma_f32_16x16x32_bf16 v[24:27], v[104:107], a[168:171], v[24:27]
    s_waitcnt lgkmcnt(0)
    s_barrier
    ds_read_b128 v[56:59], v2 offset:45056
    ds_read_b128 v[60:63], v2 offset:46080
    ds_read_b128 v[64:67], v2 offset:47104
    ds_read_b128 v[68:71], v2 offset:48128
    v_mfma_f32_16x16x32_bf16 v[24:27], v[108:111], a[172:175], v[24:27]
    v_mfma_f32_16x16x32_bf16 v[24:27], v[112:115], a[176:179], v[24:27]
    v_mfma_f32_16x16x32_bf16 v[24:27], v[116:119], a[180:183], v[24:27]
    v_mfma_f32_16x16x32_bf16 v[24:27], v[120:123], a[184:187], v[24:27]
    s_cmp_ge_u32 s4, 2
    s_cbranch_scc1 L_w2_105
    s_waitcnt vmcnt(2) lgkmcnt(2)
    v_mfma_f32_16x16x32_bf16 v[16:19], v[32:35], v[56:59], 0
    v_mfma_f32_16x16x32_bf16 v[20:23], v[40:43], v[56:59], 0
    v_mfma_f32_16x16x32_bf16 v[16:19], v[36:39], v[60:63], v[16:19]
    v_mfma_f32_16x16x32_bf16 v[20:23], v[44:47], v[60:63], v[20:23]
    s_nop 7
    v_cndmask_b32 v76, v16, v20, s[88:89]
    v_cndmask_b32 v77, v17, v21, s[88:89]
    v_cndmask_b32 v78, v18, v22, s[88:89]
    v_cndmask_b32 v79, v19, v23, s[88:89]
    buffer_store_dwordx4 v[76:79], v2, s[8:11], s57 offen sc1
    v_mfma_f32_16x16x32_bf16 v[24:27], v[124:127], a[188:191], v[24:27]
    v_mfma_f32_16x16x32_bf16 v[24:27], v[128:131], a[192:195], v[24:27]
    v_mfma_f32_16x16x32_bf16 v[24:27], v[132:135], a[196:199], v[24:27]
    v_mfma_f32_16x16x32_bf16 v[24:27], v[136:139], a[200:203], v[24:27]
    v_mfma_f32_16x16x32_bf16 v[24:27], v[140:143], a[204:207], v[24:27]
    v_mfma_f32_16x16x32_bf16 v[24:27], v[144:147], a[208:211], v[24:27]
    v_mfma_f32_16x16x32_bf16 v[24:27], v[148:151], a[212:215], v[24:27]
    v_mfma_f32_16x16x32_bf16 v[24:27], v[152:155], a[216:219], v[24:27]
    v_mfma_f32_16x16x32_bf16 v[24:27], v[156:159], a[220:223], v[24:27]
    buffer_load_dwordx4 v[96:99], v2, s[8:11], s58 offen sc1
    buffer_load_dwordx4 v[100:103], v2, s[8:11], s59 offen sc1
    v_mfma_f32_16x16x32_bf16 v[24:27], v[160:163], a[224:227], v[24:27]
    v_mfma_f32_16x16x32_bf16 v[24:27], v[164:167], a[228:231], v[24:27]
    v_mfma_f32_16x16x32_bf16 v[24:27], v[168:171], a[232:235], v[24:27]
    v_mfma_f32_16x16x32_bf16 v[24:27], v[172:175], a[236:239], v[24:27]
    buffer_load_dwordx4 v[112:115], v2, s[8:11], s58 offen sc1
    buffer_load_dwordx4 v[116:119], v2, s[8:11], s59 offen sc1
    v_mov_b32 v87, s17
    v_mov_b32 v86, s18
    s_mov_b32 s92, 0
    s_mov_b32 s93, -1
    v_cndmask_b32 v84, v87, v86, s[88:89]
    v_cndmask_b32 v85, v87, v86, s[92:93]
    v_add_u32 v84, v84, v13
    v_add_u32 v85, v85, v1
    v_cvt_pk_bf16_f32 v28, v24, v25
    v_cvt_pk_bf16_f32 v29, v26, v27
    s_waitcnt vmcnt(2)
    v_pk_add_f32 v[104:105], v[96:97], v[100:101]
    v_pk_add_f32 v[106:107], v[98:99], v[102:103]
    v_pk_add_f32 v[16:17], v[76:77], v[104:105]
    v_pk_add_f32 v[18:19], v[78:79], v[106:107]
    ds_write_b128 v31, v[16:19] offset:49152
    v_cmp_u_f32 vcc, v104, v105
    v_cmp_u_f32 s[92:93], v106, v107
    s_or_b64 vcc, vcc, s[92:93]
    s_cbranch_vccnz L_sp_108
L_so_109:
L_we_107:
    s_mov_b32 s60, 0x3dd53b95
    s_waitcnt lgkmcnt(0)
    s_barrier
    ds_read_b128 v[72:75], v2 offset:49152
    ds_read_b128 v[76:79], v2 offset:50176
    ds_read_b128 v[80:83], v2 offset:51200
    s_mov_b64 exec, s[22:23]
    buffer_store_dwordx2 v[28:29], v85, s[8:11], 0 offen sc1
    s_mov_b64 exec, -1
    v_mov_b32 v88, s60
    v_mov_b32 v89, s60
    s_waitcnt lgkmcnt(1)
    v_max3_f32 v30, v72, v73, v74
    v_max3_f32 v31, v75, v76, v77
    v_max3_f32 v30, v30, v78, v79
    s_waitcnt lgkmcnt(0)
    v_max3_f32 v31, v31, v80, v81
    v_max3_f32 v30, v30, v82, v83
    v_max_f32 v30, v30, v31
    v_mov_b32 v31, v30
    v_pk_mul_f32 v[80:81], v[80:81], v[88:89]
    v_pk_mul_f32 v[82:83], v[82:83], v[88:89]
    v_permlane32_swap_b32 v31, v30
    v_max_f32 v30, v30, v31
    v_mov_b32 v31, v30
    v_pk_mul_f32 v[72:73], v[72:73], v[88:89]
    v_pk_mul_f32 v[74:75], v[74:75], v[88:89]
    v_permlane16_swap_b32 v31, v30
    v_max_f32 v30, v30, v31
    v_mul_f32 v30, s60, v30
    v_pk_add_f32 v[80:81], v[80:81], v[30:31] op_sel_hi:[1,0] neg_lo:[0,1] neg_hi:[0,1]
    v_pk_add_f32 v[82:83], v[82:83], v[30:31] op_sel_hi:[1,0] neg_lo:[0,1] neg_hi:[0,1]
    v_exp_f32 v80, v80
    v_pk_add_f32 v[72:73], v[72:73], v[30:31] op_sel_hi:[1,0] neg_lo:[0,1] neg_hi:[0,1]
    v_exp_f32 v81, v81
    v_pk_add_f32 v[74:75], v[74:75], v[30:31] op_sel_hi:[1,0] neg_lo:[0,1] neg_hi:[0,1]
    v_exp_f32 v82, v82
    v_pk_mul_f32 v[76:77], v[76:77], v[88:89]
    v_exp_f32 v83, v83
    v_pk_mul_f32 v[78:79], v[78:79], v[88:89]
    v_exp_f32 v72, v72
    v_pk_add_f32 v[76:77], v[76:77], v[30:31] op_sel_hi:[1,0] neg_lo:[0,1] neg_hi:[0,1]
    v_cvt_pk_bf16_f32 v60, v80, v81
    v_cvt_pk_bf16_f32 v61, v82, v83
    v_exp_f32 v73, v73
    v_pk_add_f32 v[78:79], v[78:79], v[30:31] op_sel_hi:[1,0] neg_lo:[0,1] neg_hi:[0,1]
    v_exp_f32 v74, v74
    v_mfma_f32_16x16x16_bf16 v[16:19], v[28:29], v[60:61], 0
    v_exp_f32 v75, v75
    v_cvt_pk_bf16_f32 v56, v72, v73
    v_exp_f32 v76, v76
    v_mfma_f32_16x16x16_bf16 v[20:23], v[28:29], v[60:61], 0
    v_exp_f32 v77, v77
    v_cvt_pk_bf16_f32 v57, v74, v75
    v_exp_f32 v78, v78
    v_mfma_f32_16x16x16_bf16 v[24:27], v[92:93], v[60:61], 0
    v_exp_f32 v79, v79
    v_cvt_pk_bf16_f32 v58, v76, v77
    v_cvt_pk_bf16_f32 v59, v78, v79
    s_nop 1
    v_mfma_f32_16x16x32_bf16 v[16:19], v[48:51], v[56:59], v[16:19]
    v_mfma_f32_16x16x32_bf16 v[20:23], v[52:55], v[56:59], v[20:23]
    v_mfma_f32_16x16x32_bf16 v[24:27], v[92:95], v[56:59], v[24:27]
    v_add_u32 v31, s61, v2
    s_add_u32 s67, s67, 1
    s_nop 4
    v_cndmask_b32 v72, v16, v20, s[88:89]
    v_cndmask_b32 v73, v17, v21, s[88:89]
    v_rcp_f32 v30, v24
    v_cndmask_b32 v74, v18, v22, s[88:89]
    v_cndmask_b32 v75, v19, v23, s[88:89]
    v_pk_mul_f32 v[72:73], v[72:73], v[30:31] op_sel_hi:[1,0]
    v_pk_mul_f32 v[74:75], v[74:75], v[30:31] op_sel_hi:[1,0]
    v_cvt_pk_bf16_f32 v62, v72, v73
    v_cvt_pk_bf16_f32 v63, v74, v75
    v_min_u32 v62, -2, v62
    v_min_u32 v63, -2, v63
    buffer_store_dwordx2 v[62:63], v3, s[8:11], s70 offen sc1
    s_cmp_ge_u32 s5, 10
    s_cbranch_scc1 L_ch_noop_s
    s_cmp_eq_u32 s67, 1
    s_cbranch_scc1 L_ch_wo_s
L_ch_wp_s:
    s_sleep 2
    buffer_load_dwordx4 v[72:75], v5, s[8:11], s72 offen offset:0 sc1
    buffer_load_dwordx4 v[76:79], v5, s[8:11], s72 offen offset:1024 sc1
    buffer_load_dwordx4 v[80:83], v5, s[8:11], s72 offen offset:2048 sc1
    buffer_load_dwordx4 v[84:87], v5, s[8:11], s72 offen offset:3072 sc1
    buffer_load_dwordx4 v[88:91], v5, s[8:11], s76 offen offset:0 sc1
    buffer_load_dwordx4 v[92:95], v5, s[8:11], s76 offen offset:1024 sc1
    v_add_u32 v59, s36, v2
    v_add_u32 v60, s37, v2
    v_add_u32 v61, s38, v2
    s_waitcnt vmcnt(5)
L_ogc0_s:
    ds_write_b128 v31, v[72:75] offset:20480
    v_max3_u32 v30, v72, v73, v74
    v_max_u32 v30, v30, v75
    v_cmp_eq_u32 vcc, -1, v30
    s_cbranch_vccnz L_ogr0_s
L_ogp0_s:
    v_mfma_f32_16x16x32_bf16 v[16:19], a[240:243], v[72:75], 0
    s_waitcnt vmcnt(4)
L_ogc1_s:
    ds_write_b128 v31, v[76:79] offset:21504
    v_max3_u32 v30, v76, v77, v78
    v_max_u32 v30, v30, v79
    v_cmp_eq_u32 vcc, -1, v30
    s_cbranch_vccnz L_ogr1_s
L_ogp1_s:
    v_mfma_f32_16x16x32_bf16 v[16:19], a[244:247], v[76:79], v[16:19]
    s_waitcnt vmcnt(3)
L_ogc2_s:
    ds_write_b128 v31, v[80:83] offset:22528
    v_max3_u32 v30, v80, v81, v82
    v_max_u32 v30, v30, v83
    v_cmp_eq_u32 vcc, -1, v30
    s_cbranch_vccnz L_ogr2_s
L_ogp2_s:
    s_waitcnt vmcnt(2)
L_ogc3_s:
    ds_write_b128 v31, v[84:87] offset:23552
    v_max3_u32 v30, v84, v85, v86
    v_max_u32 v30, v30, v87
    v_cmp_eq_u32 vcc, -1, v30
    s_cbranch_vccnz L_ogr3_s
L_ogp3_s:
    s_waitcnt vmcnt(1)
L_ogc4_s:
    ds_write_b128 v31, v[88:91] offset:24576
    v_max3_u32 v30, v88, v89, v90
    v_max_u32 v30, v30, v91
    v_cmp_eq_u32 vcc, -1, v30
    s_cbranch_vccnz L_ogr4_s
L_ogp4_s:
    s_waitcnt vmcnt(0)
L_ogc5_s:
    ds_write_b128 v31, v[92:95] offset:25600
    v_max3_u32 v30, v92, v93, v94
    v_max_u32 v30, v30, v95
    v_cmp_eq_u32 vcc, -1, v30
    s_cbranch_vccnz L_ogr5_s
L_ogp5_s:
    s_waitcnt lgkmcnt(0)
    s_barrier
    ds_read_b128 v[96:99], v59 offset:20480
    ds_read_b128 v[100:103], v59 offset:21504
    v_mfma_f32_16x16x32_bf16 v[16:19], a[248:251], v[80:83], v[16:19]
    ds_read_b128 v[104:107], v59 offset:22528
    ds_read_b128 v[108:111], v59 offset:23552
    v_mfma_f32_16x16x32_bf16 v[16:19], a[252:255], v[84:87], v[16:19]
    ds_read_b128 v[112:115], v59 offset:24576
    ds_read_b128 v[116:119], v59 offset:25600
    v_mfma_f32_16x16x32_bf16 v[16:19], v[176:179], v[88:91], v[16:19]
    ds_read_b128 v[120:123], v60 offset:20480
    ds_read_b128 v[124:127], v60 offset:21504
    v_mfma_f32_16x16x32_bf16 v[16:19], v[180:183], v[92:95], v[16:19]
    ds_read_b128 v[128:131], v60 offset:22528
    s_waitcnt lgkmcnt(8)
    v_mfma_f32_16x16x32_bf16 v[16:19], v[184:187], v[96:99], v[16:19]
    v_mov_b32 v29, s67
    s_mov_b64 exec, 1
    buffer_store_dword v29, off, s[8:11], s87 sc1
    s_mov_b64 exec, -1
    ds_read_b128 v[132:135], v60 offset:23552
    s_waitcnt lgkmcnt(8)
    v_mfma_f32_16x16x32_bf16 v[16:19], v[188:191], v[100:103], v[16:19]
    ds_read_b128 v[136:139], v60 offset:24576
    s_waitcnt lgkmcnt(8)
    v_mfma_f32_16x16x32_bf16 v[16:19], v[192:195], v[104:107], v[16:19]
    ds_read_b128 v[140:143], v60 offset:25600
    s_waitcnt lgkmcnt(8)
    v_mfma_f32_16x16x32_bf16 v[16:19], v[196:199], v[108:111], v[16:19]
    ds_read_b128 v[144:147], v61 offset:20480
    s_waitcnt lgkmcnt(8)
    v_mfma_f32_16x16x32_bf16 v[16:19], v[200:203], v[112:115], v[16:19]
    ds_read_b128 v[148:151], v61 offset:21504
    s_waitcnt lgkmcnt(8)
    v_mfma_f32_16x16x32_bf16 v[16:19], v[204:207], v[116:119], v[16:19]
    ds_read_b128 v[152:155], v61 offset:22528
    s_waitcnt lgkmcnt(8)
    v_mfma_f32_16x16x32_bf16 v[16:19], v[208:211], v[120:123], v[16:19]
    ds_read_b128 v[156:159], v61 offset:23552
    s_waitcnt lgkmcnt(8)
    v_mfma_f32_16x16x32_bf16 v[16:19], v[212:215], v[124:127], v[16:19]
    ds_read_b128 v[160:163], v61 offset:24576
    s_waitcnt lgkmcnt(8)
    v_mfma_f32_16x16x32_bf16 v[16:19], v[216:219], v[128:131], v[16:19]
    ds_read_b128 v[164:167], v61 offset:25600
    s_waitcnt lgkmcnt(8)
    v_mfma_f32_16x16x32_bf16 v[16:19], v[220:223], v[132:135], v[16:19]
    s_waitcnt lgkmcnt(7)
    v_mfma_f32_16x16x32_bf16 v[16:19], v[224:227], v[136:139], v[16:19]
    s_waitcnt lgkmcnt(6)
    v_mfma_f32_16x16x32_bf16 v[16:19], v[228:231], v[140:143], v[16:19]
    v_mov_b32 v20, -1
    s_waitcnt lgkmcnt(5)
    v_mfma_f32_16x16x32_bf16 v[16:19], v[232:235], v[144:147], v[16:19]
    v_mov_b32 v21, -1
    s_waitcnt lgkmcnt(4)
    v_mfma_f32_16x16x32_bf16 v[16:19], v[236:239], v[148:151], v[16:19]
    v_mov_b32 v22, -1
    s_waitcnt lgkmcnt(3)
    v_mfma_f32_16x16x32_bf16 v[16:19], v[240:243], v[152:155], v[16:19]
    v_mov_b32 v23, -1
    s_waitcnt lgkmcnt(2)
    v_mfma_f32_16x16x32_bf16 v[16:19], v[244:247], v[156:159], v[16:19]
    v_add_u32 v28, s79, v15
    v_add_u32 v56, s79, v2
    s_waitcnt lgkmcnt(1)
    v_mfma_f32_16x16x32_bf16 v[16:19], v[248:251], v[160:163], v[16:19]
    v_mov_b32 v57, s10
    v_cndmask_b32 v57, v56, v57, s[40:41]
    s_waitcnt lgkmcnt(0)
    v_mfma_f32_16x16x32_bf16 v[16:19], v[252:255], v[164:167], v[16:19]
    s_nop 7
    v_cvt_pk_bf16_f32 v24, v16, v17
    v_cvt_pk_bf16_f32 v25, v18, v19
    v_min_u32 v24, -2, v24
    v_min_u32 v25, -2, v25
    buffer_store_dwordx2 v[24:25], v28, s[8:11], s78 offen sc1
    s_sleep 9
    buffer_load_dwordx4 v[72:75], v57, s[8:11], s48 offen sc1
    buffer_load_dwordx4 v[76:79], v56, s[8:11], s49 offen sc1
    buffer_load_dwordx4 v[80:83], v56, s[8:11], s50 offen sc1
    buffer_load_dwordx4 v[84:87], v56, s[8:11], s51 offen sc1
    s_mov_b32 s29, 0
    buffer_store_dwordx2 v[20:21], v3, s[8:11], s19 offen sc1
    buffer_store_dwordx2 v[20:21], v3, s[8:11], s21 offen sc1
    buffer_store_dwordx4 v[20:23], v2, s[8:11], s20 offen sc1
    s_add_u32 s92, s67, 1
    s_and_b32 s60, s67, 3
    s_mul_i32 s84, s60, 147456
    s_add_u32 s84, s84, 116391936
    s_cmp_lt_u32 s67, 64
    s_cselect_b32 s82, s92, 0
    s_cselect_b32 s84, s84, s10
    s_sub_u32 s60, s67, 7
    s_and_b32 s60, s60, 3
    s_mul_i32 s85, s60, 147456
    s_add_u32 s85, s85, 116981760
    s_sub_u32 s92, s92, 7
    s_cmp_ge_u32 s67, 7
    s_cselect_b32 s83, s92, 0
    s_cselect_b32 s85, s85, s10
    s_cmp_ge_u32 s67, 71
    s_cselect_b32 s83, 0, s83
    s_cselect_b32 s85, s10, s85
    s_and_b32 s60, s67, 3
    s_mul_i32 s92, s60, 20480
    s_add_u32 s55, s92, s68
    s_add_u32 s56, s55, 4096
    s_mul_i32 s92, s60, 36864
    s_add_u32 s57, s92, s71
    s_add_u32 s58, s92, s73
    s_add_u32 s59, s92, s74
    s_mul_i32 s92, s60, 24576
    s_add_u32 s70, s92, s75
    s_add_u32 s72, s92, s77
    s_add_u32 s76, s72, 4096
    s_xor_b32 s60, s60, 2
    s_mul_i32 s92, s60, 24576
    s_add_u32 s19, s92, s75
    s_mul_i32 s92, s60, 36864
    s_add_u32 s20, s92, s71
    s_cmp_eq_u32 s4, 3
    s_cselect_b32 s20, s27, s20
    s_and_b32 s60, s67, 127
    s_mul_i32 s79, s60, 163840
    s_add_u32 s92, s67, 1
    s_and_b32 s93, s92, 3
    s_mul_i32 s94, s93, 20480
    s_add_u32 s16, s94, s69
    s_xor_b32 s93, s93, 2
    s_mul_i32 s94, s93, 20480
    s_add_u32 s21, s94, s69
    s_cmp_lt_u32 s67, 64
    s_cselect_b32 s22, -1, 0
    s_cselect_b32 s24, 0x00ff00ff, 0
    s_cmp_ge_u32 s67, 7
    s_cselect_b32 s23, -1, 0
    s_cselect_b32 s92, 0xff00ff00, 0
    s_or_b32 s24, s24, s92
    s_mov_b32 s25, s24
    s_and_b32 s60, s67, 3
    s_mul_i32 s17, s60, 24576
    s_sub_u32 s60, s67, 7
    s_and_b32 s60, s60, 3
    s_mul_i32 s18, s60, 24576
    s_cmp_eq_u32 s67, 0
    s_cselect_b32 s26, 1, 0
    s_cmp_eq_u32 s67, 7
    s_cselect_b32 s26, 1, s26
    v_add_u32 v29, s81, v2
    s_sleep 4
    buffer_load_dwordx4 v[96:99], v57, s[8:11], s48 offen sc1
    buffer_load_dwordx4 v[100:103], v56, s[8:11], s49 offen sc1
    buffer_load_dwordx4 v[104:107], v56, s[8:11], s50 offen sc1
    buffer_load_dwordx4 v[108:111], v56, s[8:11], s51 offen sc1
    s_waitcnt vmcnt(10)
    v_mfma_f32_16x16x32_bf16 v[64:67], v[8:11], v[72:75], v[16:19]
    s_waitcnt vmcnt(9)
    v_mfma_f32_16x16x32_bf16 v[64:67], v[8:11], v[76:79], v[64:67]
    s_waitcnt vmcnt(8)
    v_mfma_f32_16x16x32_bf16 v[64:67], v[8:11], v[80:83], v[64:67]
    s_waitcnt vmcnt(7)
    v_mfma_f32_16x16x32_bf16 v[64:67], v[8:11], v[84:87], v[64:67]
L_cp_110:
    s_nop 7
    v_cmp_u_f32 vcc, v64, v65
    v_cvt_pk_bf16_f32 v24, v64, v65
    v_cvt_pk_bf16_f32 v25, v66, v67
    s_cbranch_vccnz L_cp_110x
L_co_111:
    v_min_u32 v24, -2, v24
    v_min_u32 v25, -2, v25
    buffer_store_dwordx2 v[24:25], v3, s[8:11], s80 offen sc1
L_ch_next_s:
    s_cmp_lt_u32 s67, 71
    s_cbranch_scc1 L_ch_step_s
    s_endpgm
L_ch_noop_s:
    v_mov_b32 v20, -1
    v_mov_b32 v21, -1
    v_mov_b32 v22, -1
    v_mov_b32 v23, -1
    s_add_u32 s92, s67, 1
    s_and_b32 s60, s67, 3
    s_mul_i32 s84, s60, 147456
    s_add_u32 s84, s84, 116391936
    s_cmp_lt_u32 s67, 64
    s_cselect_b32 s82, s92, 0
    s_cselect_b32 s84, s84, s10
    s_sub_u32 s60, s67, 7
    s_and_b32 s60, s60, 3
    s_mul_i32 s85, s60, 147456
    s_add_u32 s85, s85, 116981760
    s_sub_u32 s92, s92, 7
    s_cmp_ge_u32 s67, 7
    s_cselect_b32 s83, s92, 0
    s_cselect_b32 s85, s85, s10
    s_cmp_ge_u32 s67, 71
    s_cselect_b32 s83, 0, s83
    s_cselect_b32 s85, s10, s85
    s_waitcnt vmcnt(0)
    v_mov_b32 v29, s67
    s_mov_b64 exec, 1
    buffer_store_dword v29, off, s[8:11], s87 sc1
    s_mov_b64 exec, -1
    buffer_store_dwordx2 v[20:21], v3, s[8:11], s19 offen sc1
    buffer_store_dwordx4 v[20:23], v2, s[8:11], s20 offen sc1
    s_add_u32 s92, s67, 1
    s_and_b32 s92, s92, 127
    s_mul_i32 s92, s92, 163840
    s_sub_u32 s93, s66, 40
    s_mul_i32 s93, s93, 20480
    s_add_u32 s92, s92, s93
    s_lshl_b32 s93, s3, 9
    s_add_u32 s92, s92, s93
    s_add_u32 s92, s92, 77594624
    buffer_store_dwordx2 v[20:21], v3, s[8:11], s92 offen sc1
    s_add_u32 s92, s92, 4096
    buffer_store_dwordx2 v[20:21], v3, s[8:11], s92 offen sc1
    s_add_u32 s92, s92, 4096
    buffer_store_dwordx2 v[20:21], v3, s[8:11], s92 offen sc1
    s_add_u32 s92, s92, 4096
    buffer_store_dwordx2 v[20:21], v3, s[8:11], s92 offen sc1
    s_add_u32 s92, s92, 4096
    buffer_store_dwordx2 v[20:21], v3, s[8:11], s92 offen sc1
    s_and_b32 s60, s67, 3
    s_mul_i32 s92, s60, 20480
    s_add_u32 s55, s92, s68
    s_add_u32 s56, s55, 4096
    s_mul_i32 s92, s60, 36864
    s_add_u32 s57, s92, s71
    s_add_u32 s58, s92, s73
    s_add_u32 s59, s92, s74
    s_mul_i32 s92, s60, 24576
    s_add_u32 s70, s92, s75
    s_add_u32 s72, s92, s77
    s_add_u32 s76, s72, 4096
    s_xor_b32 s60, s60, 2
    s_mul_i32 s92, s60, 24576
    s_add_u32 s19, s92, s75
    s_mul_i32 s92, s60, 36864
    s_add_u32 s20, s92, s71
    s_cmp_eq_u32 s4, 3
    s_cselect_b32 s20, s27, s20
    s_and_b32 s60, s67, 127
    s_mul_i32 s79, s60, 163840
    s_add_u32 s92, s67, 1
    s_and_b32 s93, s92, 3
    s_mul_i32 s94, s93, 20480
    s_add_u32 s16, s94, s69
    s_xor_b32 s93, s93, 2
    s_mul_i32 s94, s93, 20480
    s_add_u32 s21, s94, s69
    s_cmp_lt_u32 s67, 64
    s_cselect_b32 s22, -1, 0
    s_cselect_b32 s24, 0x00ff00ff, 0
    s_cmp_ge_u32 s67, 7
    s_cselect_b32 s23, -1, 0
    s_cselect_b32 s92, 0xff00ff00, 0
    s_or_b32 s24, s24, s92
    s_mov_b32 s25, s24
    s_and_b32 s60, s67, 3
    s_mul_i32 s17, s60, 24576
    s_sub_u32 s60, s67, 7
    s_and_b32 s60, s60, 3
    s_mul_i32 s18, s60, 24576
    s_cmp_eq_u32 s67, 0
    s_cselect_b32 s26, 1, 0
    s_cmp_eq_u32 s67, 7
    s_cselect_b32 s26, 1, s26
    v_add_u32 v29, s81, v2
    s_sleep 20
    s_waitcnt vmcnt(0)
    s_branch L_ch_next_s
L_agr0_s:
    buffer_load_dwordx4 v[96:99], v4, s[8:11], s55 offen offset:0 sc1
    buffer_load_dwordx4 v[100:103], v4, s[8:11], s55 offen offset:1024 sc1
    buffer_load_dwordx4 v[104:107], v4, s[8:11], s55 offen offset:2048 sc1
    buffer_load_dwordx4 v[108:111], v4, s[8:11], s55 offen offset:3072 sc1
    buffer_load_dwordx4 v[112:115], v4, s[8:11], s56 offen offset:0 sc1
    buffer_load_dword v58, v6, s[8:11], s86 offen sc1
    buffer_load_dword v59, v6, s[8:11], s86 offen offset:2048 sc1
    s_sub_u32 s6, s6, 1
    s_cbranch_scc1 L_fail
    s_waitcnt vmcnt(6)
    s_branch L_agc0_s
L_agr1_s:
    buffer_load_dwordx4 v[100:103], v4, s[8:11], s55 offen offset:1024 sc1
    buffer_load_dwordx4 v[104:107], v4, s[8:11], s55 offen offset:2048 sc1
    buffer_load_dwordx4 v[108:111], v4, s[8:11], s55 offen offset:3072 sc1
    buffer_load_dwordx4 v[112:115], v4, s[8:11], s56 offen offset:0 sc1
    buffer_load_dword v58, v6, s[8:11], s86 offen sc1
    buffer_load_dword v59, v6, s[8:11], s86 offen offset:2048 sc1
    s_sub_u32 s6, s6, 1
    s_cbranch_scc1 L_fail
    s_waitcnt vmcnt(5)
    s_branch L_agc1_s
L_agr2_s:
    buffer_load_dwordx4 v[104:107], v4, s[8:11], s55 offen offset:2048 sc1
    buffer_load_dwordx4 v[108:111], v4, s[8:11], s55 offen offset:3072 sc1
    buffer_load_dwordx4 v[112:115], v4, s[8:11], s56 offen offset:0 sc1
    buffer_load_dword v58, v6, s[8:11], s86 offen sc1
    buffer_load_dword v59, v6, s[8:11], s86 offen offset:2048 sc1
    s_sub_u32 s6, s6, 1
    s_cbranch_scc1 L_fail
    s_waitcnt vmcnt(4)
    s_branch L_agc2_s
L_agr3_s:
    buffer_load_dwordx4 v[108:111], v4, s[8:11], s55 offen offset:3072 sc1
    buffer_load_dwordx4 v[112:115], v4, s[8:11], s56 offen offset:0 sc1
    buffer_load_dword v58, v6, s[8:11], s86 offen sc1
    buffer_load_dword v59, v6, s[8:11], s86 offen offset:2048 sc1
    s_sub_u32 s6, s6, 1
    s_cbranch_scc1 L_fail
    s_waitcnt vmcnt(3)
    s_branch L_agc3_s
L_agr4_s:
    buffer_load_dwordx4 v[112:115], v4, s[8:11], s56 offen offset:0 sc1
    buffer_load_dword v58, v6, s[8:11], s86 offen sc1
    buffer_load_dword v59, v6, s[8:11], s86 offen offset:2048 sc1
    s_sub_u32 s6, s6, 1
    s_cbranch_scc1 L_fail
    s_waitcnt vmcnt(2)
    s_branch L_agc4_s
L_ch_sp_s:
    v_and_b32 v28, 7, v0
    v_mul_u32_u24 v28, 1280, v28
    v_lshrrev_b32 v30, 4, v0
    v_lshl_add_u32 v28, v30, 4, v28
    s_mul_i32 s60, s4, 320
    v_add_u32 v28, s60, v28
    buffer_load_dwordx4 v[72:75], v28, s[44:47], 0 offen offset:0
    buffer_load_dwordx4 v[76:79], v28, s[44:47], 0 offen offset:64
    buffer_load_dwordx4 v[80:83], v28, s[44:47], 0 offen offset:128
    buffer_load_dwordx4 v[84:87], v28, s[44:47], 0 offen offset:192
    buffer_load_dwordx4 v[88:91], v28, s[44:47], 0 offen offset:256
    s_mov_b64 s[92:93], -1
    s_cmp_eq_u32 s67, 0
    s_cbranch_scc1 L_ch_sq_s
    s_mov_b64 s[92:93], s[88:89]
L_ch_sr_s:
    buffer_load_dwordx4 v[96:99], v4, s[8:11], s55 offen offset:0 sc1
    buffer_load_dwordx4 v[100:103], v4, s[8:11], s55 offen offset:1024 sc1
    buffer_load_dwordx4 v[104:107], v4, s[8:11], s55 offen offset:2048 sc1
    buffer_load_dwordx4 v[108:111], v4, s[8:11], s55 offen offset:3072 sc1
    buffer_load_dwordx4 v[112:115], v4, s[8:11], s56 offen offset:0 sc1
    s_waitcnt vmcnt(0)
    v_max3_u32 v28, v96, v97, v98
    v_max3_u32 v28, v28, v99, v100
    v_max3_u32 v28, v28, v101, v102
    v_max3_u32 v28, v28, v103, v104
    v_max_u32 v28, v28, v105
    v_max3_u32 v30, v106, v107, v108
    v_max3_u32 v30, v30, v109, v110
    v_max3_u32 v30, v30, v111, v112
    v_max3_u32 v30, v30, v113, v114
    v_max_u32 v30, v30, v115
    v_max_u32 v28, v28, v30
    v_cmp_eq_u32 vcc, -1, v28
    s_cbranch_vccz L_ch_sq_s
    s_sub_u32 s6, s6, 1
    s_cbranch_scc0 L_ch_sr_s
    s_branch L_fail
L_ch_sq_s:
    s_waitcnt vmcnt(0)
    v_cndmask_b32 v96, v96, v72, s[92:93]
    v_cndmask_b32 v97, v97, v73, s[92:93]
    v_cndmask_b32 v98, v98, v74, s[92:93]
    v_cndmask_b32 v99, v99, v75, s[92:93]
    v_cndmask_b32 v100, v100, v76, s[92:93]
    v_cndmask_b32 v101, v101, v77, s[92:93]
    v_cndmask_b32 v102, v102, v78, s[92:93]
    v_cndmask_b32 v103, v103, v79, s[92:93]
    v_cndmask_b32 v104, v104, v80, s[92:93]
    v_cndmask_b32 v105, v105, v81, s[92:93]
    v_cndmask_b32 v106, v106, v82, s[92:93]
    v_cndmask_b32 v107, v107, v83, s[92:93]
    v_cndmask_b32 v108, v108, v84, s[92:93]
    v_cndmask_b32 v109, v109, v85, s[92:93]
    v_cndmask_b32 v110, v110, v86, s[92:93]
    v_cndmask_b32 v111, v111, v87, s[92:93]
    v_cndmask_b32 v112, v112, v88, s[92:93]
    v_cndmask_b32 v113, v113, v89, s[92:93]
    v_cndmask_b32 v114, v114, v90, s[92:93]
    v_cndmask_b32 v115, v115, v91, s[92:93]
    ds_write_b128 v29, v[96:99] offset:0
    ds_write_b128 v29, v[100:103] offset:1024
    ds_write_b128 v29, v[104:107] offset:2048
    ds_write_b128 v29, v[108:111] offset:3072
    ds_write_b128 v29, v[112:115] offset:4096
    buffer_load_dword v58, v6, s[8:11], s86 offen sc1
    buffer_load_dword v59, v6, s[8:11], s86 offen offset:2048 sc1
    v_add_u32 v88, s33, v2
    v_add_u32 v89, s34, v2
    v_add_u32 v90, s35, v2
    s_branch L_ch_ag_s
L_ch_fl_s:
    buffer_load_dword v58, v6, s[8:11], s86 offen sc1
    buffer_load_dword v59, v6, s[8:11], s86 offen offset:2048 sc1
    s_waitcnt vmcnt(0)
    v_readlane_b32 s42, v58, 0
    v_readlane_b32 s92, v58, 1
    v_readlane_b32 s43, v59, 0
    v_readlane_b32 s93, v59, 1
    s_min_u32 s42, s42, s92
    s_min_u32 s43, s43, s93
    s_cmp_gt_u32 s82, s42
    s_cselect_b32 s30, 1, 0
    s_cmp_gt_u32 s83, s43
    s_cselect_b32 s30, 1, s30
    s_cmp_eq_u32 s30, 0
    s_cbranch_scc1 L_ch_fc_s
    s_sleep 2
    s_sub_u32 s6, s6, 1
    s_cbranch_scc0 L_ch_fl_s
    s_branch L_fail
L_sp_108:
    v_max3_u32 v30, v96, v97, v98
    v_max_u32 v30, v30, v99
    v_max3_u32 v20, v100, v101, v102
    v_max_u32 v20, v20, v103
    v_max_u32 v30, v30, v20
    v_cmp_eq_u32 vcc, -1, v30
    s_cbranch_vccz L_so_109
    buffer_load_dwordx4 v[96:99], v2, s[8:11], s58 offen sc1
    buffer_load_dwordx4 v[100:103], v2, s[8:11], s59 offen sc1
    s_waitcnt vmcnt(2)
    v_pk_add_f32 v[120:121], v[112:113], v[116:117]
    v_pk_add_f32 v[122:123], v[114:115], v[118:119]
    v_pk_add_f32 v[16:17], v[76:77], v[120:121]
    v_pk_add_f32 v[18:19], v[78:79], v[122:123]
    ds_write_b128 v31, v[16:19] offset:49152
    v_cmp_u_f32 vcc, v120, v121
    v_cmp_u_f32 s[92:93], v122, v123
    s_or_b64 vcc, vcc, s[92:93]
    s_cbranch_vccz L_so_109
    v_max3_u32 v30, v112, v113, v114
    v_max_u32 v30, v30, v115
    v_max3_u32 v20, v116, v117, v118
    v_max_u32 v20, v20, v119
    v_max_u32 v30, v30, v20
    v_cmp_eq_u32 vcc, -1, v30
    s_cbranch_vccz L_so_109
    buffer_load_dwordx4 v[112:115], v2, s[8:11], s58 offen sc1
    buffer_load_dwordx4 v[116:119], v2, s[8:11], s59 offen sc1
    s_waitcnt vmcnt(2)
    v_pk_add_f32 v[104:105], v[96:97], v[100:101]
    v_pk_add_f32 v[106:107], v[98:99], v[102:103]
    v_pk_add_f32 v[16:17], v[76:77], v[104:105]
    v_pk_add_f32 v[18:19], v[78:79], v[106:107]
    ds_write_b128 v31, v[16:19] offset:49152
    v_cmp_u_f32 vcc, v104, v105
    v_cmp_u_f32 s[92:93], v106, v107
    s_or_b64 vcc, vcc, s[92:93]
    s_cbranch_vccz L_so_109
    s_sub_u32 s6, s6, 1
    s_cbranch_scc0 L_sp_108
    s_branch L_fail
L_w2_105:
    s_cmp_eq_u32 s4, 3
    s_cbranch_scc1 L_w3_106
    s_waitcnt lgkmcnt(0)
    v_mfma_f32_16x16x32_bf16 v[76:79], v[64:67], v[56:59], 0
    v_mfma_f32_16x16x32_bf16 v[76:79], v[68:71], v[60:63], v[76:79]
    s_nop 7
    buffer_store_dwordx4 v[76:79], v2, s[8:11], s57 offen sc1
    v_mfma_f32_16x16x32_bf16 v[24:27], v[124:127], a[188:191], v[24:27]
    v_mfma_f32_16x16x32_bf16 v[24:27], v[128:131], a[192:195], v[24:27]
    v_mfma_f32_16x16x32_bf16 v[24:27], v[132:135], a[196:199], v[24:27]
    v_mfma_f32_16x16x32_bf16 v[24:27], v[136:139], a[200:203], v[24:27]
    v_mfma_f32_16x16x32_bf16 v[24:27], v[140:143], a[204:207], v[24:27]
    v_mfma_f32_16x16x32_bf16 v[24:27], v[144:147], a[208:211], v[24:27]
    v_mfma_f32_16x16x32_bf16 v[24:27], v[148:151], a[212:215], v[24:27]
    v_mfma_f32_16x16x32_bf16 v[24:27], v[152:155], a[216:219], v[24:27]
    v_mfma_f32_16x16x32_bf16 v[24:27], v[156:159], a[220:223], v[24:27]
    buffer_load_dwordx4 v[96:99], v2, s[8:11], s58 offen sc1
    buffer_load_dwordx4 v[100:103], v2, s[8:11], s59 offen sc1
    v_mfma_f32_16x16x32_bf16 v[24:27], v[160:163], a[224:227], v[24:27]
    v_mfma_f32_16x16x32_bf16 v[24:27], v[164:167], a[228:231], v[24:27]
    v_mfma_f32_16x16x32_bf16 v[24:27], v[168:171], a[232:235], v[24:27]
    v_mfma_f32_16x16x32_bf16 v[24:27], v[172:175], a[236:239], v[24:27]
    v_mov_b32 v28, 0xff800000
    v_cndmask_b32 v80, v76, v28, s[90:91]
    v_cndmask_b32 v81, v77, v28, s[90:91]
    v_cndmask_b32 v82, v78, v28, s[90:91]
    v_cndmask_b32 v83, v79, v28, s[90:91]
    buffer_load_dwordx4 v[112:115], v2, s[8:11], s58 offen sc1
    buffer_load_dwordx4 v[116:119], v2, s[8:11], s59 offen sc1
    v_mov_b32 v87, s17
    v_mov_b32 v86, s18
    s_mov_b32 s92, 0
    s_mov_b32 s93, -1
    v_cndmask_b32 v84, v87, v86, s[88:89]
    v_cndmask_b32 v85, v87, v86, s[92:93]
    v_add_u32 v84, v84, v13
    v_add_u32 v85, v85, v1
    v_cvt_pk_bf16_f32 v28, v24, v25
    v_cvt_pk_bf16_f32 v29, v26, v27
    s_waitcnt vmcnt(2)
    v_pk_add_f32 v[104:105], v[96:97], v[100:101]
    v_pk_add_f32 v[106:107], v[98:99], v[102:103]
    v_pk_add_f32 v[16:17], v[80:81], v[104:105]
    v_pk_add_f32 v[18:19], v[82:83], v[106:107]
    ds_write_b128 v31, v[16:19] offset:49152
    v_cmp_u_f32 vcc, v104, v105
    v_cmp_u_f32 s[92:93], v106, v107
    s_or_b64 vcc, vcc, s[92:93]
    s_cbranch_vccnz L_sp_112
L_so_113:
    s_branch L_we_107
L_w3_106:
    v_mfma_f32_16x16x32_bf16 v[24:27], v[124:127], a[188:191], v[24:27]
    v_mfma_f32_16x16x32_bf16 v[24:27], v[128:131], a[192:195], v[24:27]
    v_mfma_f32_16x16x32_bf16 v[24:27], v[132:135], a[196:199], v[24:27]
    v_mfma_f32_16x16x32_bf16 v[24:27], v[136:139], a[200:203], v[24:27]
    v_mfma_f32_16x16x32_bf16 v[24:27], v[140:143], a[204:207], v[24:27]
    v_mfma_f32_16x16x32_bf16 v[24:27], v[144:147], a[208:211], v[24:27]
    v_mfma_f32_16x16x32_bf16 v[24:27], v[148:151], a[212:215], v[24:27]
    v_mfma_f32_16x16x32_bf16 v[24:27], v[152:155], a[216:219], v[24:27]
    v_mfma_f32_16x16x32_bf16 v[24:27], v[156:159], a[220:223], v[24:27]
    v_mfma_f32_16x16x32_bf16 v[24:27], v[160:163], a[224:227], v[24:27]
    v_mfma_f32_16x16x32_bf16 v[24:27], v[164:167], a[228:231], v[24:27]
    v_mfma_f32_16x16x32_bf16 v[24:27], v[168:171], a[232:235], v[24:27]
    v_mfma_f32_16x16x32_bf16 v[24:27], v[172:175], a[236:239], v[24:27]
    v_mov_b32 v87, s17
    v_mov_b32 v86, s18
    s_mov_b32 s92, 0
    s_mov_b32 s93, -1
    v_cndmask_b32 v84, v87, v86, s[88:89]
    v_cndmask_b32 v85, v87, v86, s[92:93]
    v_add_u32 v84, v84, v13
    v_add_u32 v85, v85, v1
    s_waitcnt lgkmcnt(0)
    s_mov_b64 exec, s[24:25]
    buffer_store_dwordx4 v[64:67], v84, s[8:11], 0 offen sc1
    buffer_store_dwordx4 v[68:71], v84, s[8:11], 0 offen offset:256 sc1
    s_mov_b64 exec, -1
    v_cvt_pk_bf16_f32 v28, v24, v25
    v_cvt_pk_bf16_f32 v29, v26, v27
    s_waitcnt vmcnt(2)
    s_branch L_we_107
L_ch_wo_s:
    v_mov_b32 v136, v255
    s_add_u32 s60, s4, 0
    s_and_b32 s60, s60, 3
    s_mul_i32 s60, s60, 24576
    s_add_u32 s60, s60, 61440
    v_add_u32 v137, s60, v136
    ds_read_b64_tr_b16 a[240:241], v137 offset:0
    ds_read_b64_tr_b16 a[242:243], v137 offset:512
    ds_read_b64_tr_b16 a[244:245], v137 offset:4096
    ds_read_b64_tr_b16 a[246:247], v137 offset:4608
    ds_read_b64_tr_b16 a[248:249], v137 offset:8192
    ds_read_b64_tr_b16 a[250:251], v137 offset:8704
    ds_read_b64_tr_b16 a[252:253], v137 offset:12288
    ds_read_b64_tr_b16 a[254:255], v137 offset:12800
    ds_read_b64_tr_b16 v[176:177], v137 offset:16384
    ds_read_b64_tr_b16 v[178:179], v137 offset:16896
    ds_read_b64_tr_b16 v[180:181], v137 offset:20480
    ds_read_b64_tr_b16 v[182:183], v137 offset:20992
    s_add_u32 s60, s4, 1
    s_and_b32 s60, s60, 3
    s_mul_i32 s60, s60, 24576
    s_add_u32 s60, s60, 61440
    v_add_u32 v137, s60, v136
    ds_read_b64_tr_b16 v[184:185], v137 offset:0
    ds_read_b64_tr_b16 v[186:187], v137 offset:512
    ds_read_b64_tr_b16 v[188:189], v137 offset:4096
    ds_read_b64_tr_b16 v[190:191], v137 offset:4608
    ds_read_b64_tr_b16 v[192:193], v137 offset:8192
    ds_read_b64_tr_b16 v[194:195], v137 offset:8704
    ds_read_b64_tr_b16 v[196:197], v137 offset:12288
    ds_read_b64_tr_b16 v[198:199], v137 offset:12800
    ds_read_b64_tr_b16 v[200:201], v137 offset:16384
    ds_read_b64_tr_b16 v[202:203], v137 offset:16896
    ds_read_b64_tr_b16 v[204:205], v137 offset:20480
    ds_read_b64_tr_b16 v[206:207], v137 offset:20992
    s_add_u32 s60, s4, 2
    s_and_b32 s60, s60, 3
    s_mul_i32 s60, s60, 24576
    s_add_u32 s60, s60, 61440
    v_add_u32 v137, s60, v136
    ds_read_b64_tr_b16 v[208:209], v137 offset:0
    ds_read_b64_tr_b16 v[210:211], v137 offset:512
    ds_read_b64_tr_b16 v[212:213], v137 offset:4096
    ds_read_b64_tr_b16 v[214:215], v137 offset:4608
    ds_read_b64_tr_b16 v[216:217], v137 offset:8192
    ds_read_b64_tr_b16 v[218:219], v137 offset:8704
    ds_read_b64_tr_b16 v[220:221], v137 offset:12288
    ds_read_b64_tr_b16 v[222:223], v137 offset:12800
    ds_read_b64_tr_b16 v[224:225], v137 offset:16384
    ds_read_b64_tr_b16 v[226:227], v137 offset:16896
    ds_read_b64_tr_b16 v[228:229], v137 offset:20480
    ds_read_b64_tr_b16 v[230:231], v137 offset:20992
    s_add_u32 s60, s4, 3
    s_and_b32 s60, s60, 3
    s_mul_i32 s60, s60, 24576
    s_add_u32 s60, s60, 61440
    v_add_u32 v137, s60, v136
    ds_read_b64_tr_b16 v[232:233], v137 offset:0
    ds_read_b64_tr_b16 v[234:235], v137 offset:512
    ds_read_b64_tr_b16 v[236:237], v137 offset:4096
    ds_read_b64_tr_b16 v[238:239], v137 offset:4608
    ds_read_b64_tr_b16 v[240:241], v137 offset:8192
    ds_read_b64_tr_b16 v[242:243], v137 offset:8704
    ds_read_b64_tr_b16 v[244:245], v137 offset:12288
    ds_read_b64_tr_b16 v[246:247], v137 offset:12800
    ds_read_b64_tr_b16 v[248:249], v137 offset:16384
    ds_read_b64_tr_b16 v[250:251], v137 offset:16896
    ds_read_b64_tr_b16 v[252:253], v137 offset:20480
    ds_read_b64_tr_b16 v[254:255], v137 offset:20992
    s_waitcnt lgkmcnt(0)
    s_branch L_ch_wp_s
L_ogr0_s:
    buffer_load_dwordx4 v[72:75], v5, s[8:11], s72 offen offset:0 sc1
    buffer_load_dwordx4 v[76:79], v5, s[8:11], s72 offen offset:1024 sc1
    buffer_load_dwordx4 v[80:83], v5, s[8:11], s72 offen offset:2048 sc1
    buffer_load_dwordx4 v[84:87], v5, s[8:11], s72 offen offset:3072 sc1
    buffer_load_dwordx4 v[88:91], v5, s[8:11], s76 offen offset:0 sc1
    buffer_load_dwordx4 v[92:95], v5, s[8:11], s76 offen offset:1024 sc1
    s_sub_u32 s6, s6, 1
    s_cbranch_scc1 L_fail
    s_waitcnt vmcnt(5)
    s_branch L_ogc0_s
L_ogr1_s:
    buffer_load_dwordx4 v[76:79], v5, s[8:11], s72 offen offset:1024 sc1
    buffer_load_dwordx4 v[80:83], v5, s[8:11], s72 offen offset:2048 sc1
    buffer_load_dwordx4 v[84:87], v5, s[8:11], s72 offen offset:3072 sc1
    buffer_load_dwordx4 v[88:91], v5, s[8:11], s76 offen offset:0 sc1
    buffer_load_dwordx4 v[92:95], v5, s[8:11], s76 offen offset:1024 sc1
    s_sub_u32 s6, s6, 1
    s_cbranch_scc1 L_fail
    s_waitcnt vmcnt(4)
    s_branch L_ogc1_s
L_ogr2_s:
    buffer_load_dwordx4 v[80:83], v5, s[8:11], s72 offen offset:2048 sc1
    buffer_load_dwordx4 v[84:87], v5, s[8:11], s72 offen offset:3072 sc1
    buffer_load_dwordx4 v[88:91], v5, s[8:11], s76 offen offset:0 sc1
    buffer_load_dwordx4 v[92:95], v5, s[8:11], s76 offen offset:1024 sc1
    s_sub_u32 s6, s6, 1
    s_cbranch_scc1 L_fail
    s_waitcnt vmcnt(3)
    s_branch L_ogc2_s
L_ogr3_s:
    buffer_load_dwordx4 v[84:87], v5, s[8:11], s72 offen offset:3072 sc1
    buffer_load_dwordx4 v[88:91], v5, s[8:11], s76 offen offset:0 sc1
    buffer_load_dwordx4 v[92:95], v5, s[8:11], s76 offen offset:1024 sc1
    s_sub_u32 s6, s6, 1
    s_cbranch_scc1 L_fail
    s_waitcnt vmcnt(2)
    s_branch L_ogc3_s
L_ogr4_s:
    buffer_load_dwordx4 v[88:91], v5, s[8:11], s76 offen offset:0 sc1
    buffer_load_dwordx4 v[92:95], v5, s[8:11], s76 offen offset:1024 sc1
    s_sub_u32 s6, s6, 1
    s_cbranch_scc1 L_fail
    s_waitcnt vmcnt(1)
    s_branch L_ogc4_s
L_ogr5_s:
    buffer_load_dwordx4 v[92:95], v5, s[8:11], s76 offen offset:1024 sc1
    s_sub_u32 s6, s6, 1
    s_cbranch_scc1 L_fail
    s_waitcnt vmcnt(0)
    s_branch L_ogc5_s
L_cp_110x:
    v_max3_u32 v26, v72, v73, v74
    v_max3_u32 v26, v26, v75, v76
    v_max3_u32 v26, v26, v77, v78
    v_max_u32 v26, v26, v79
    v_max3_u32 v27, v80, v81, v82
    v_max3_u32 v27, v27, v83, v84
    v_max3_u32 v27, v27, v85, v86
    v_max_u32 v27, v27, v87
    v_max_u32 v26, v26, v27
    v_cmp_eq_u32 vcc, -1, v26
    s_cbranch_vccz L_co_111
    s_mov_b32 s29, 1
L_cp_110y:
    buffer_load_dwordx4 v[72:75], v57, s[8:11], s48 offen sc1
    buffer_load_dwordx4 v[76:79], v56, s[8:11], s49 offen sc1
    buffer_load_dwordx4 v[80:83], v56, s[8:11], s50 offen sc1
    buffer_load_dwordx4 v[84:87], v56, s[8:11], s51 offen sc1
    s_waitcnt vmcnt(4)
    v_max3_u32 v26, v96, v97, v98
    v_max3_u32 v26, v26, v99, v100
    v_max3_u32 v26, v26, v101, v102
    v_max_u32 v26, v26, v103
    v_max3_u32 v27, v104, v105, v106
    v_max3_u32 v27, v27, v107, v108
    v_max3_u32 v27, v27, v109, v110
    v_max_u32 v27, v27, v111
    v_max_u32 v26, v26, v27
    v_cmp_eq_u32 vcc, -1, v26
    s_cbranch_vccz L_cp_110z96
    buffer_load_dwordx4 v[96:99], v57, s[8:11], s48 offen sc1
    buffer_load_dwordx4 v[100:103], v56, s[8:11], s49 offen sc1
    buffer_load_dwordx4 v[104:107], v56, s[8:11], s50 offen sc1
    buffer_load_dwordx4 v[108:111], v56, s[8:11], s51 offen sc1
    s_waitcnt vmcnt(4)
    v_max3_u32 v26, v72, v73, v74
    v_max3_u32 v26, v26, v75, v76
    v_max3_u32 v26, v26, v77, v78
    v_max_u32 v26, v26, v79
    v_max3_u32 v27, v80, v81, v82
    v_max3_u32 v27, v27, v83, v84
    v_max3_u32 v27, v27, v85, v86
    v_max_u32 v27, v27, v87
    v_max_u32 v26, v26, v27
    v_cmp_eq_u32 vcc, -1, v26
    s_cbranch_vccz L_cp_110z72
    s_sub_u32 s6, s6, 1
    s_cbranch_scc0 L_cp_110y
    s_branch L_fail
L_cp_110z72:
    v_mfma_f32_16x16x32_bf16 v[64:67], v[8:11], v[72:75], v[16:19]
    v_mfma_f32_16x16x32_bf16 v[64:67], v[8:11], v[76:79], v[64:67]
    v_mfma_f32_16x16x32_bf16 v[64:67], v[8:11], v[80:83], v[64:67]
    v_mfma_f32_16x16x32_bf16 v[64:67], v[8:11], v[84:87], v[64:67]
    s_nop 7
    v_cvt_pk_bf16_f32 v24, v64, v65
    v_cvt_pk_bf16_f32 v25, v66, v67
    s_branch L_co_111
L_cp_110z96:
    v_mfma_f32_16x16x32_bf16 v[64:67], v[8:11], v[96:99], v[16:19]
    v_mfma_f32_16x16x32_bf16 v[64:67], v[8:11], v[100:103], v[64:67]
    v_mfma_f32_16x16x32_bf16 v[64:67], v[8:11], v[104:107], v[64:67]
    v_mfma_f32_16x16x32_bf16 v[64:67], v[8:11], v[108:111], v[64:67]
    s_nop 7
    v_cvt_pk_bf16_f32 v24, v64, v65
    v_cvt_pk_bf16_f32 v25, v66, v67
    s_branch L_co_111
L_sp_112:
    v_max3_u32 v30, v96, v97, v98
    v_max_u32 v30, v30, v99
    v_max3_u32 v20, v100, v101, v102
    v_max_u32 v20, v20, v103
    v_max_u32 v30, v30, v20
    v_cmp_eq_u32 vcc, -1, v30
    s_cbranch_vccz L_so_113
    buffer_load_dwordx4 v[96:99], v2, s[8:11], s58 offen sc1
    buffer_load_dwordx4 v[100:103], v2, s[8:11], s59 offen sc1
    s_waitcnt vmcnt(2)
    v_pk_add_f32 v[120:121], v[112:113], v[116:117]
    v_pk_add_f32 v[122:123], v[114:115], v[118:119]
    v_pk_add_f32 v[16:17], v[80:81], v[120:121]
    v_pk_add_f32 v[18:19], v[82:83], v[122:123]
    ds_write_b128 v31, v[16:19] offset:49152
    v_cmp_u_f32 vcc, v120, v121
    v_cmp_u_f32 s[92:93], v122, v123
    s_or_b64 vcc, vcc, s[92:93]
    s_cbranch_vccz L_so_113
    v_max3_u32 v30, v112, v113, v114
    v_max_u32 v30, v30, v115
    v_max3_u32 v20, v116, v117, v118
    v_max_u32 v20, v20, v119
    v_max_u32 v30, v30, v20
    v_cmp_eq_u32 vcc, -1, v30
    s_cbranch_vccz L_so_113
    buffer_load_dwordx4 v[112:115], v2, s[8:11], s58 offen sc1
    buffer_load_dwordx4 v[116:119], v2, s[8:11], s59 offen sc1
    s_waitcnt vmcnt(2)
    v_pk_add_f32 v[104:105], v[96:97], v[100:101]
    v_pk_add_f32 v[106:107], v[98:99], v[102:103]
    v_pk_add_f32 v[16:17], v[80:81], v[104:105]
    v_pk_add_f32 v[18:19], v[82:83], v[106:107]
    ds_write_b128 v31, v[16:19] offset:49152
    v_cmp_u_f32 vcc, v104, v105
    v_cmp_u_f32 s[92:93], v106, v107
    s_or_b64 vcc, vcc, s[92:93]
    s_cbranch_vccz L_so_113
    s_sub_u32 s6, s6, 1
    s_cbranch_scc0 L_sp_112
    s_branch L_fail
L_qkv:
    s_sub_u32 s64, s5, 12
    s_lshl_b32 s64, s64, 2
    s_add_u32 s64, s64, s4
    s_lshl_b32 s65, s3, 8
    s_lshl_b32 s66, s64, 2
    s_add_u32 s65, s65, s66
    s_add_u32 s65, s65, 12288
    s_add_u32 s66, s65, 2048
    v_mov_b32 v4, 0
    s_mov_b64 exec, 1
    buffer_store_dword v4, off, s[8:11], s65 sc1
    buffer_store_dword v4, off, s[8:11], s66 sc1
    s_mov_b64 exec, -1
    s_waitcnt vmcnt(0)
    s_barrier
    s_cmp_lg_u32 s4, 0
    s_cbranch_scc1 L_arr_114
    s_and_b32 s60, s2, 7
    s_lshl_b32 s60, s60, 5
    s_add_u32 s60, s60, 16
    v_mov_b32 v1, 1
    s_mov_b64 exec, 1
    buffer_atomic_add v1, off, s[12:15], s60
    s_mov_b64 exec, -1
L_arr_114:
    s_mul_i32 s67, s64, 57
    s_lshr_b32 s67, s67, 9
    s_mul_i32 s68, s67, 9
    s_sub_u32 s68, s64, s68
    s_mul_i32 s69, s68, 11
    s_lshr_b32 s69, s69, 5
    s_mul_i32 s70, s69, 3
    s_sub_u32 s70, s68, s70
    s_lshl_b32 s71, s3, 2
    s_add_u32 s71, s71, s67
    s_cmp_eq_u32 s69, 1
    s_cselect_b32 s44, s22, s20
    s_cselect_b32 s45, s23, s21
    s_cmp_eq_u32 s69, 2
    s_cselect_b32 s44, s24, s44
    s_cselect_b32 s45, s25, s45
    s_and_b32 s45, s45, 0xffff
    s_mov_b32 s46, 7864320
    s_mov_b32 s47, 0x20000
    s_mul_i32 s72, s71, 384
    s_lshl_b32 s73, s70, 7
    s_add_u32 s72, s72, s73
    v_lshrrev_b32 v1, 3, v0
    v_mul_u32_u24 v1, 12288, v1
    v_and_b32 v2, 7, v0
    v_lshl_add_u32 v5, v2, 4, v1
    v_add_u32 v5, s72, v5
    s_mul_i32 s73, s4, 40960
    v_lshrrev_b32 v1, 4, v0
    v_lshlrev_b32 v1, 3, v1
    v_bfe_u32 v2, v0, 2, 2
    v_add_u32 v1, v1, v2
    v_mul_u32_u24 v1, 128, v1
    v_and_b32 v2, 3, v0
    v_lshl_add_u32 v6, v2, 3, v1
    v_add_u32 v6, s73, v6
    s_add_u32 m0, s73, 0
    s_mov_b32 s74, 0
    buffer_load_dwordx4 v5, s[44:47], s74 offen nt lds
    s_add_u32 m0, m0, 1024
    s_add_u32 s74, s74, 98304
    buffer_load_dwordx4 v5, s[44:47], s74 offen nt lds
    s_add_u32 m0, m0, 1024
    s_add_u32 s74, s74, 98304
    buffer_load_dwordx4 v5, s[44:47], s74 offen nt lds
    s_add_u32 m0, m0, 1024
    s_add_u32 s74, s74, 98304
    buffer_load_dwordx4 v5, s[44:47], s74 offen nt lds
    s_add_u32 m0, m0, 1024
    s_add_u32 s74, s74, 98304
    buffer_load_dwordx4 v5, s[44:47], s74 offen nt lds
    s_add_u32 m0, m0, 1024
    s_add_u32 s74, s74, 98304
    buffer_load_dwordx4 v5, s[44:47], s74 offen nt lds
    s_add_u32 m0, m0, 1024
    s_add_u32 s74, s74, 98304
    buffer_load_dwordx4 v5, s[44:47], s74 offen nt lds
    s_add_u32 m0, m0, 1024
    s_add_u32 s74, s74, 98304
    buffer_load_dwordx4 v5, s[44:47], s74 offen nt lds
    s_add_u32 m0, m0, 1024
    s_add_u32 s74, s74, 98304
    buffer_load_dwordx4 v5, s[44:47], s74 offen nt lds
    s_add_u32 m0, m0, 1024
    s_add_u32 s74, s74, 98304
    buffer_load_dwordx4 v5, s[44:47], s74 offen nt lds
    s_add_u32 m0, m0, 1024
    s_add_u32 s74, s74, 98304
    buffer_load_dwordx4 v5, s[44:47], s74 offen nt lds
    s_add_u32 m0, m0, 1024
    s_add_u32 s74, s74, 98304
    buffer_load_dwordx4 v5, s[44:47], s74 offen nt lds
    s_add_u32 m0, m0, 1024
    s_add_u32 s74, s74, 98304
    buffer_load_dwordx4 v5, s[44:47], s74 offen nt lds
    s_add_u32 m0, m0, 1024
    s_add_u32 s74, s74, 98304
    buffer_load_dwordx4 v5, s[44:47], s74 offen nt lds
    s_add_u32 m0, m0, 1024
    s_add_u32 s74, s74, 98304
    buffer_load_dwordx4 v5, s[44:47], s74 offen nt lds
    s_add_u32 m0, m0, 1024
    s_add_u32 s74, s74, 98304
    buffer_load_dwordx4 v5, s[44:47], s74 offen nt lds
    s_add_u32 m0, m0, 1024
    s_add_u32 s74, s74, 98304
    buffer_load_dwordx4 v5, s[44:47], s74 offen nt lds
    s_add_u32 m0, m0, 1024
    s_add_u32 s74, s74, 98304
    buffer_load_dwordx4 v5, s[44:47], s74 offen nt lds
    s_add_u32 m0, m0, 1024
    s_add_u32 s74, s74, 98304
    buffer_load_dwordx4 v5, s[44:47], s74 offen nt lds
    s_add_u32 m0, m0, 1024
    s_add_u32 s74, s74, 98304
    buffer_load_dwordx4 v5, s[44:47], s74 offen nt lds
    s_add_u32 m0, s73, 20480
    s_mov_b32 s74, 1966080
    buffer_load_dwordx4 v5, s[44:47], s74 offen nt lds
    s_add_u32 m0, m0, 1024
    s_add_u32 s74, s74, 98304
    buffer_load_dwordx4 v5, s[44:47], s74 offen nt lds
    s_add_u32 m0, m0, 1024
    s_add_u32 s74, s74, 98304
    buffer_load_dwordx4 v5, s[44:47], s74 offen nt lds
    s_add_u32 m0, m0, 1024
    s_add_u32 s74, s74, 98304
    buffer_load_dwordx4 v5, s[44:47], s74 offen nt lds
    s_add_u32 m0, m0, 1024
    s_add_u32 s74, s74, 98304
    buffer_load_dwordx4 v5, s[44:47], s74 offen nt lds
    s_add_u32 m0, m0, 1024
    s_add_u32 s74, s74, 98304
    buffer_load_dwordx4 v5, s[44:47], s74 offen nt lds
    s_add_u32 m0, m0, 1024
    s_add_u32 s74, s74, 98304
    buffer_load_dwordx4 v5, s[44:47], s74 offen nt lds
    s_add_u32 m0, m0, 1024
    s_add_u32 s74, s74, 98304
    buffer_load_dwordx4 v5, s[44:47], s74 offen nt lds
    s_add_u32 m0, m0, 1024
    s_add_u32 s74, s74, 98304
    buffer_load_dwordx4 v5, s[44:47], s74 offen nt lds
    s_add_u32 m0, m0, 1024
    s_add_u32 s74, s74, 98304
    buffer_load_dwordx4 v5, s[44:47], s74 offen nt lds
    s_add_u32 m0, m0, 1024
    s_add_u32 s74, s74, 98304
    buffer_load_dwordx4 v5, s[44:47], s74 offen nt lds
    s_add_u32 m0, m0, 1024
    s_add_u32 s74, s74, 98304
    buffer_load_dwordx4 v5, s[44:47], s74 offen nt lds
    s_add_u32 m0, m0, 1024
    s_add_u32 s74, s74, 98304
    buffer_load_dwordx4 v5, s[44:47], s74 offen nt lds
    s_add_u32 m0, m0, 1024
    s_add_u32 s74, s74, 98304
    buffer_load_dwordx4 v5, s[44:47], s74 offen nt lds
    s_add_u32 m0, m0, 1024
    s_add_u32 s74, s74, 98304
    buffer_load_dwordx4 v5, s[44:47], s74 offen nt lds
    s_add_u32 m0, m0, 1024
    s_add_u32 s74, s74, 98304
    buffer_load_dwordx4 v5, s[44:47], s74 offen nt lds
    s_add_u32 m0, m0, 1024
    s_add_u32 s74, s74, 98304
    buffer_load_dwordx4 v5, s[44:47], s74 offen nt lds
    s_add_u32 m0, m0, 1024
    s_add_u32 s74, s74, 98304
    buffer_load_dwordx4 v5, s[44:47], s74 offen nt lds
    s_add_u32 m0, m0, 1024
    s_add_u32 s74, s74, 98304
    buffer_load_dwordx4 v5, s[44:47], s74 offen nt lds
    s_add_u32 m0, m0, 1024
    s_add_u32 s74, s74, 98304
    buffer_load_dwordx4 v5, s[44:47], s74 offen nt lds
    s_waitcnt vmcnt(20)
    ds_read_b64_tr_b16 a[0:1], v6 offset:0
    ds_read_b64_tr_b16 a[2:3], v6 offset:512
    ds_read_b64_tr_b16 a[80:81], v6 offset:32
    ds_read_b64_tr_b16 a[82:83], v6 offset:544
    ds_read_b64_tr_b16 a[160:161], v6 offset:64
    ds_read_b64_tr_b16 a[162:163], v6 offset:576
    ds_read_b64_tr_b16 a[240:241], v6 offset:96
    ds_read_b64_tr_b16 a[242:243], v6 offset:608
    ds_read_b64_tr_b16 a[4:5], v6 offset:4096
    ds_read_b64_tr_b16 a[6:7], v6 offset:4608
    ds_read_b64_tr_b16 a[84:85], v6 offset:4128
    ds_read_b64_tr_b16 a[86:87], v6 offset:4640
    ds_read_b64_tr_b16 a[164:165], v6 offset:4160
    ds_read_b64_tr_b16 a[166:167], v6 offset:4672
    ds_read_b64_tr_b16 a[244:245], v6 offset:4192
    ds_read_b64_tr_b16 a[246:247], v6 offset:4704
    ds_read_b64_tr_b16 a[8:9], v6 offset:8192
    ds_read_b64_tr_b16 a[10:11], v6 offset:8704
    ds_read_b64_tr_b16 a[88:89], v6 offset:8224
    ds_read_b64_tr_b16 a[90:91], v6 offset:8736
    ds_read_b64_tr_b16 a[168:169], v6 offset:8256
    ds_read_b64_tr_b16 a[170:171], v6 offset:8768
    ds_read_b64_tr_b16 a[248:249], v6 offset:8288
    ds_read_b64_tr_b16 a[250:251], v6 offset:8800
    ds_read_b64_tr_b16 a[12:13], v6 offset:12288
    ds_read_b64_tr_b16 a[14:15], v6 offset:12800
    ds_read_b64_tr_b16 a[92:93], v6 offset:12320
    ds_read_b64_tr_b16 a[94:95], v6 offset:12832
    ds_read_b64_tr_b16 a[172:173], v6 offset:12352
    ds_read_b64_tr_b16 a[174:175], v6 offset:12864
    ds_read_b64_tr_b16 a[252:253], v6 offset:12384
    ds_read_b64_tr_b16 a[254:255], v6 offset:12896
    ds_read_b64_tr_b16 a[16:17], v6 offset:16384
    ds_read_b64_tr_b16 a[18:19], v6 offset:16896
    ds_read_b64_tr_b16 a[96:97], v6 offset:16416
    ds_read_b64_tr_b16 a[98:99], v6 offset:16928
    ds_read_b64_tr_b16 a[176:177], v6 offset:16448
    ds_read_b64_tr_b16 a[178:179], v6 offset:16960
    ds_read_b64_tr_b16 v[192:193], v6 offset:16480
    ds_read_b64_tr_b16 v[194:195], v6 offset:16992
    s_waitcnt lgkmcnt(0)
    s_add_u32 m0, s73, 0
    s_mov_b32 s74, 3932160
    buffer_load_dwordx4 v5, s[44:47], s74 offen nt lds
    s_add_u32 m0, m0, 1024
    s_add_u32 s74, s74, 98304
    buffer_load_dwordx4 v5, s[44:47], s74 offen nt lds
    s_add_u32 m0, m0, 1024
    s_add_u32 s74, s74, 98304
    buffer_load_dwordx4 v5, s[44:47], s74 offen nt lds
    s_add_u32 m0, m0, 1024
    s_add_u32 s74, s74, 98304
    buffer_load_dwordx4 v5, s[44:47], s74 offen nt lds
    s_add_u32 m0, m0, 1024
    s_add_u32 s74, s74, 98304
    buffer_load_dwordx4 v5, s[44:47], s74 offen nt lds
    s_add_u32 m0, m0, 1024
    s_add_u32 s74, s74, 98304
    buffer_load_dwordx4 v5, s[44:47], s74 offen nt lds
    s_add_u32 m0, m0, 1024
    s_add_u32 s74, s74, 98304
    buffer_load_dwordx4 v5, s[44:47], s74 offen nt lds
    s_add_u32 m0, m0, 1024
    s_add_u32 s74, s74, 98304
    buffer_load_dwordx4 v5, s[44:47], s74 offen nt lds
    s_add_u32 m0, m0, 1024
    s_add_u32 s74, s74, 98304
    buffer_load_dwordx4 v5, s[44:47], s74 offen nt lds
    s_add_u32 m0, m0, 1024
    s_add_u32 s74, s74, 98304
    buffer_load_dwordx4 v5, s[44:47], s74 offen nt lds
    s_add_u32 m0, m0, 1024
    s_add_u32 s74, s74, 98304
    buffer_load_dwordx4 v5, s[44:47], s74 offen nt lds
    s_add_u32 m0, m0, 1024
    s_add_u32 s74, s74, 98304
    buffer_load_dwordx4 v5, s[44:47], s74 offen nt lds
    s_add_u32 m0, m0, 1024
    s_add_u32 s74, s74, 98304
    buffer_load_dwordx4 v5, s[44:47], s74 offen nt lds
    s_add_u32 m0, m0, 1024
    s_add_u32 s74, s74, 98304
    buffer_load_dwordx4 v5, s[44:47], s74 offen nt lds
    s_add_u32 m0, m0, 1024
    s_add_u32 s74, s74, 98304
    buffer_load_dwordx4 v5, s[44:47], s74 offen nt lds
    s_add_u32 m0, m0, 1024
    s_add_u32 s74, s74, 98304
    buffer_load_dwordx4 v5, s[44:47], s74 offen nt lds
    s_add_u32 m0, m0, 1024
    s_add_u32 s74, s74, 98304
    buffer_load_dwordx4 v5, s[44:47], s74 offen nt lds
    s_add_u32 m0, m0, 1024
    s_add_u32 s74, s74, 98304
    buffer_load_dwordx4 v5, s[44:47], s74 offen nt lds
    s_add_u32 m0, m0, 1024
    s_add_u32 s74, s74, 98304
    buffer_load_dwordx4 v5, s[44:47], s74 offen nt lds
    s_add_u32 m0, m0, 1024
    s_add_u32 s74, s74, 98304
    buffer_load_dwordx4 v5, s[44:47], s74 offen nt lds
    s_waitcnt vmcnt(20)
    ds_read_b64_tr_b16 a[20:21], v6 offset:20480
    ds_read_b64_tr_b16 a[22:23], v6 offset:20992
    ds_read_b64_tr_b16 a[100:101], v6 offset:20512
    ds_read_b64_tr_b16 a[102:103], v6 offset:21024
    ds_read_b64_tr_b16 a[180:181], v6 offset:20544
    ds_read_b64_tr_b16 a[182:183], v6 offset:21056
    ds_read_b64_tr_b16 v[196:197], v6 offset:20576
    ds_read_b64_tr_b16 v[198:199], v6 offset:21088
    ds_read_b64_tr_b16 a[24:25], v6 offset:24576
    ds_read_b64_tr_b16 a[26:27], v6 offset:25088
    ds_read_b64_tr_b16 a[104:105], v6 offset:24608
    ds_read_b64_tr_b16 a[106:107], v6 offset:25120
    ds_read_b64_tr_b16 a[184:185], v6 offset:24640
    ds_read_b64_tr_b16 a[186:187], v6 offset:25152
    ds_read_b64_tr_b16 v[200:201], v6 offset:24672
    ds_read_b64_tr_b16 v[202:203], v6 offset:25184
    ds_read_b64_tr_b16 a[28:29], v6 offset:28672
    ds_read_b64_tr_b16 a[30:31], v6 offset:29184
    ds_read_b64_tr_b16 a[108:109], v6 offset:28704
    ds_read_b64_tr_b16 a[110:111], v6 offset:29216
    ds_read_b64_tr_b16 a[188:189], v6 offset:28736
    ds_read_b64_tr_b16 a[190:191], v6 offset:29248
    ds_read_b64_tr_b16 v[204:205], v6 offset:28768
    ds_read_b64_tr_b16 v[206:207], v6 offset:29280
    ds_read_b64_tr_b16 a[32:33], v6 offset:32768
    ds_read_b64_tr_b16 a[34:35], v6 offset:33280
    ds_read_b64_tr_b16 a[112:113], v6 offset:32800
    ds_read_b64_tr_b16 a[114:115], v6 offset:33312
    ds_read_b64_tr_b16 a[192:193], v6 offset:32832
    ds_read_b64_tr_b16 a[194:195], v6 offset:33344
    ds_read_b64_tr_b16 v[208:209], v6 offset:32864
    ds_read_b64_tr_b16 v[210:211], v6 offset:33376
    ds_read_b64_tr_b16 a[36:37], v6 offset:36864
    ds_read_b64_tr_b16 a[38:39], v6 offset:37376
    ds_read_b64_tr_b16 a[116:117], v6 offset:36896
    ds_read_b64_tr_b16 a[118:119], v6 offset:37408
    ds_read_b64_tr_b16 a[196:197], v6 offset:36928
    ds_read_b64_tr_b16 a[198:199], v6 offset:37440
    ds_read_b64_tr_b16 v[212:213], v6 offset:36960
    ds_read_b64_tr_b16 v[214:215], v6 offset:37472
    s_waitcnt lgkmcnt(0)
    s_add_u32 m0, s73, 20480
    s_mov_b32 s74, 5898240
    buffer_load_dwordx4 v5, s[44:47], s74 offen nt lds
    s_add_u32 m0, m0, 1024
    s_add_u32 s74, s74, 98304
    buffer_load_dwordx4 v5, s[44:47], s74 offen nt lds
    s_add_u32 m0, m0, 1024
    s_add_u32 s74, s74, 98304
    buffer_load_dwordx4 v5, s[44:47], s74 offen nt lds
    s_add_u32 m0, m0, 1024
    s_add_u32 s74, s74, 98304
    buffer_load_dwordx4 v5, s[44:47], s74 offen nt lds
    s_add_u32 m0, m0, 1024
    s_add_u32 s74, s74, 98304
    buffer_load_dwordx4 v5, s[44:47], s74 offen nt lds
    s_add_u32 m0, m0, 1024
    s_add_u32 s74, s74, 98304
    buffer_load_dwordx4 v5, s[44:47], s74 offen nt lds
    s_add_u32 m0, m0, 1024
    s_add_u32 s74, s74, 98304
    buffer_load_dwordx4 v5, s[44:47], s74 offen nt lds
    s_add_u32 m0, m0, 1024
    s_add_u32 s74, s74, 98304
    buffer_load_dwordx4 v5, s[44:47], s74 offen nt lds
    s_add_u32 m0, m0, 1024
    s_add_u32 s74, s74, 98304
    buffer_load_dwordx4 v5, s[44:47], s74 offen nt lds
    s_add_u32 m0, m0, 1024
    s_add_u32 s74, s74, 98304
    buffer_load_dwordx4 v5, s[44:47], s74 offen nt lds
    s_add_u32 m0, m0, 1024
    s_add_u32 s74, s74, 98304
    buffer_load_dwordx4 v5, s[44:47], s74 offen nt lds
    s_add_u32 m0, m0, 1024
    s_add_u32 s74, s74, 98304
    buffer_load_dwordx4 v5, s[44:47], s74 offen nt lds
    s_add_u32 m0, m0, 1024
    s_add_u32 s74, s74, 98304
    buffer_load_dwordx4 v5, s[44:47], s74 offen nt lds
    s_add_u32 m0, m0, 1024
    s_add_u32 s74, s74, 98304
    buffer_load_dwordx4 v5, s[44:47], s74 offen nt lds
    s_add_u32 m0, m0, 1024
    s_add_u32 s74, s74, 98304
    buffer_load_dwordx4 v5, s[44:47], s74 offen nt lds
    s_add_u32 m0, m0, 1024
    s_add_u32 s74, s74, 98304
    buffer_load_dwordx4 v5, s[44:47], s74 offen nt lds
    s_add_u32 m0, m0, 1024
    s_add_u32 s74, s74, 98304
    buffer_load_dwordx4 v5, s[44:47], s74 offen nt lds
    s_add_u32 m0, m0, 1024
    s_add_u32 s74, s74, 98304
    buffer_load_dwordx4 v5, s[44:47], s74 offen nt lds
    s_add_u32 m0, m0, 1024
    s_add_u32 s74, s74, 98304
    buffer_load_dwordx4 v5, s[44:47], s74 offen nt lds
    s_add_u32 m0, m0, 1024
    s_add_u32 s74, s74, 98304
    buffer_load_dwordx4 v5, s[44:47], s74 offen nt lds
    s_waitcnt vmcnt(20)
    ds_read_b64_tr_b16 a[40:41], v6 offset:0
    ds_read_b64_tr_b16 a[42:43], v6 offset:512
    ds_read_b64_tr_b16 a[120:121], v6 offset:32
    ds_read_b64_tr_b16 a[122:123], v6 offset:544
    ds_read_b64_tr_b16 a[200:201], v6 offset:64
    ds_read_b64_tr_b16 a[202:203], v6 offset:576
    ds_read_b64_tr_b16 v[216:217], v6 offset:96
    ds_read_b64_tr_b16 v[218:219], v6 offset:608
    ds_read_b64_tr_b16 a[44:45], v6 offset:4096
    ds_read_b64_tr_b16 a[46:47], v6 offset:4608
    ds_read_b64_tr_b16 a[124:125], v6 offset:4128
    ds_read_b64_tr_b16 a[126:127], v6 offset:4640
    ds_read_b64_tr_b16 a[204:205], v6 offset:4160
    ds_read_b64_tr_b16 a[206:207], v6 offset:4672
    ds_read_b64_tr_b16 v[220:221], v6 offset:4192
    ds_read_b64_tr_b16 v[222:223], v6 offset:4704
    ds_read_b64_tr_b16 a[48:49], v6 offset:8192
    ds_read_b64_tr_b16 a[50:51], v6 offset:8704
    ds_read_b64_tr_b16 a[128:129], v6 offset:8224
    ds_read_b64_tr_b16 a[130:131], v6 offset:8736
    ds_read_b64_tr_b16 a[208:209], v6 offset:8256
    ds_read_b64_tr_b16 a[210:211], v6 offset:8768
    ds_read_b64_tr_b16 v[224:225], v6 offset:8288
    ds_read_b64_tr_b16 v[226:227], v6 offset:8800
    ds_read_b64_tr_b16 a[52:53], v6 offset:12288
    ds_read_b64_tr_b16 a[54:55], v6 offset:12800
    ds_read_b64_tr_b16 a[132:133], v6 offset:12320
    ds_read_b64_tr_b16 a[134:135], v6 offset:12832
    ds_read_b64_tr_b16 a[212:213], v6 offset:12352
    ds_read_b64_tr_b16 a[214:215], v6 offset:12864
    ds_read_b64_tr_b16 v[228:229], v6 offset:12384
    ds_read_b64_tr_b16 v[230:231], v6 offset:12896
    ds_read_b64_tr_b16 a[56:57], v6 offset:16384
    ds_read_b64_tr_b16 a[58:59], v6 offset:16896
    ds_read_b64_tr_b16 a[136:137], v6 offset:16416
    ds_read_b64_tr_b16 a[138:139], v6 offset:16928
    ds_read_b64_tr_b16 a[216:217], v6 offset:16448
    ds_read_b64_tr_b16 a[218:219], v6 offset:16960
    ds_read_b64_tr_b16 v[232:233], v6 offset:16480
    ds_read_b64_tr_b16 v[234:235], v6 offset:16992
    s_waitcnt lgkmcnt(0)
    s_waitcnt vmcnt(0)
    ds_read_b64_tr_b16 a[60:61], v6 offset:20480
    ds_read_b64_tr_b16 a[62:63], v6 offset:20992
    ds_read_b64_tr_b16 a[140:141], v6 offset:20512
    ds_read_b64_tr_b16 a[142:143], v6 offset:21024
    ds_read_b64_tr_b16 a[220:221], v6 offset:20544
    ds_read_b64_tr_b16 a[222:223], v6 offset:21056
    ds_read_b64_tr_b16 v[236:237], v6 offset:20576
    ds_read_b64_tr_b16 v[238:239], v6 offset:21088
    ds_read_b64_tr_b16 a[64:65], v6 offset:24576
    ds_read_b64_tr_b16 a[66:67], v6 offset:25088
    ds_read_b64_tr_b16 a[144:145], v6 offset:24608
    ds_read_b64_tr_b16 a[146:147], v6 offset:25120
    ds_read_b64_tr_b16 a[224:225], v6 offset:24640
    ds_read_b64_tr_b16 a[226:227], v6 offset:25152
    ds_read_b64_tr_b16 v[240:241], v6 offset:24672
    ds_read_b64_tr_b16 v[242:243], v6 offset:25184
    ds_read_b64_tr_b16 a[68:69], v6 offset:28672
    ds_read_b64_tr_b16 a[70:71], v6 offset:29184
    ds_read_b64_tr_b16 a[148:149], v6 offset:28704
    ds_read_b64_tr_b16 a[150:151], v6 offset:29216
    ds_read_b64_tr_b16 a[228:229], v6 offset:28736
    ds_read_b64_tr_b16 a[230:231], v6 offset:29248
    ds_read_b64_tr_b16 v[244:245], v6 offset:28768
    ds_read_b64_tr_b16 v[246:247], v6 offset:29280
    ds_read_b64_tr_b16 a[72:73], v6 offset:32768
    ds_read_b64_tr_b16 a[74:75], v6 offset:33280
    ds_read_b64_tr_b16 a[152:153], v6 offset:32800
    ds_read_b64_tr_b16 a[154:155], v6 offset:33312
    ds_read_b64_tr_b16 a[232:233], v6 offset:32832
    ds_read_b64_tr_b16 a[234:235], v6 offset:33344
    ds_read_b64_tr_b16 v[248:249], v6 offset:32864
    ds_read_b64_tr_b16 v[250:251], v6 offset:33376
    ds_read_b64_tr_b16 a[76:77], v6 offset:36864
    ds_read_b64_tr_b16 a[78:79], v6 offset:37376
    ds_read_b64_tr_b16 a[156:157], v6 offset:36896
    ds_read_b64_tr_b16 a[158:159], v6 offset:37408
    ds_read_b64_tr_b16 a[236:237], v6 offset:36928
    ds_read_b64_tr_b16 a[238:239], v6 offset:37440
    ds_read_b64_tr_b16 v[252:253], v6 offset:36960
    ds_read_b64_tr_b16 v[254:255], v6 offset:37472
    s_waitcnt lgkmcnt(0)
    v_lshrrev_b32 v1, 3, v0
    v_and_b32 v2, 7, v0
    v_xor_b32 v2, v2, v1
    s_lshl_b32 s60, s4, 3
    v_add_u32 v1, s60, v1
    v_mul_u32_u24 v1, 1280, v1
    v_lshl_add_u32 v8, v2, 4, v1
    v_bfe_u32 v1, v0, 3, 1
    v_and_b32 v2, 7, v0
    v_mul_u32_u24 v3, 10240, v1
    v_lshl_add_u32 v3, v2, 7, v3
    v_lshrrev_b32 v1, 4, v0
    v_xor_b32 v2, v2, v1
    v_xor_b32 v1, 0, v2
    v_lshl_add_u32 v10, v1, 4, v3
    v_add_u32 v12, 20480, v10
    v_xor_b32 v1, 4, v2
    v_lshl_add_u32 v11, v1, 4, v3
    v_add_u32 v13, 20480, v11
    v_bfe_u32 v1, v0, 4, 1
    v_lshrrev_b32 v2, 5, v0
    v_lshlrev_b32 v1, 5, v1
    v_lshl_add_u32 v1, v2, 4, v1
    v_and_b32 v2, 15, v0
    v_add_u32 v1, v1, v2
    v_lshlrev_b32 v9, 4, v1
    v_and_b32 v5, 7, v0
    v_lshlrev_b32 v5, 2, v5
    s_mul_i32 s72, s71, 36864
    s_mul_i32 s73, s3, 1032192
    s_add_u32 s72, s72, s73
    s_mul_i32 s73, s69, 12288
    s_add_u32 s72, s72, s73
    s_lshl_b32 s73, s70, 12
    s_add_u32 s72, s72, s73
    s_add_u32 s72, s72, 116391936
    v_lshlrev_b32 v7, 2, v0
L_wi_115:
    buffer_load_dword v6, v7, s[12:15], 0 offen sc1
    s_waitcnt vmcnt(0)
    v_cmp_ne_u32 vcc, 32, v6
    s_mov_b32 s60, 0x10101010
    s_mov_b32 s61, 0x10101010
    s_and_b64 s[62:63], vcc, s[60:61]
    s_cbranch_scc0 L_wid_116
    s_sleep 2
    s_sub_u32 s6, s6, 1
    s_cbranch_scc0 L_wi_115
    s_branch L_fail
L_wid_116:
    s_mov_b32 s60, 0x01010101
    s_mov_b32 s61, 0x01010101
    s_and_b64 s[62:63], vcc, s[60:61]
    s_cselect_b32 s7, 0, 1
    s_barrier
    v_min_u32 v7, 4, v0
    v_lshlrev_b32 v7, 2, v7
    s_lshl_b32 s82, s3, 7
    s_add_u32 s82, s82, 18432
    s_mul_i32 s83, s4, 10240
    s_mov_b32 s84, 22528
    v_lshlrev_b32 v6, 2, v0
L_ln_117:
    buffer_load_dword v16, v6, s[8:11], 0 offen offset:0 sc1
    buffer_load_dword v17, v6, s[8:11], 0 offen offset:256 sc1
    buffer_load_dword v18, v6, s[8:11], 0 offen offset:512 sc1
    buffer_load_dword v19, v6, s[8:11], 0 offen offset:768 sc1
    buffer_load_dword v20, v6, s[8:11], 0 offen offset:1024 sc1
    buffer_load_dword v21, v6, s[8:11], 0 offen offset:1280 sc1
    buffer_load_dword v22, v6, s[8:11], 0 offen offset:1536 sc1
    buffer_load_dword v23, v6, s[8:11], 0 offen offset:1792 sc1
    s_waitcnt vmcnt(0)
    v_min3_u32 v16, v16, v17, v18
    v_min3_u32 v19, v19, v20, v21
    v_min3_u32 v16, v16, v22, v23
    v_min_u32 v16, v16, v19
    v_cmp_eq_u32 vcc, 0, v16
    s_cbranch_vccz L_lnok_118
    s_sleep 2
    s_sub_u32 s6, s6, 1
    s_cbranch_scc0 L_ln_117
    s_branch L_fail
L_lnok_118:
    s_branch L_qkv_go
L_qkv_fin:
    s_endpgm
L_qkv_go:
    s_cmp_eq_u32 s69, 2
    s_cbranch_scc1 L_qkv_v
    v_and_b32 v6, 7, v0
    v_lshlrev_b32 v6, 7, v6
    s_mov_b32 s75, 0
    s_mov_b32 s76, 0
    s_mov_b32 s79, 4194304
    s_add_u32 m0, s83, 40960
    s_nop 0
    buffer_load_dwordx4 v8, s[8:11], s79 offen offset:0 sc1 lds
    s_add_u32 m0, m0, 896
    s_nop 0
    buffer_load_dwordx4 v8, s[8:11], s79 offen offset:128 sc1 lds
    s_add_u32 m0, m0, 896
    s_nop 0
    buffer_load_dwordx4 v8, s[8:11], s79 offen offset:256 sc1 lds
    s_add_u32 m0, m0, 896
    s_nop 0
    buffer_load_dwordx4 v8, s[8:11], s79 offen offset:384 sc1 lds
    s_add_u32 m0, m0, 896
    s_nop 0
    buffer_load_dwordx4 v8, s[8:11], s79 offen offset:512 sc1 lds
    s_add_u32 m0, m0, 896
    s_nop 0
    buffer_load_dwordx4 v8, s[8:11], s79 offen offset:640 sc1 lds
    s_add_u32 m0, m0, 896
    s_nop 0
    buffer_load_dwordx4 v8, s[8:11], s79 offen offset:768 sc1 lds
    s_add_u32 m0, m0, 896
    s_nop 0
    buffer_load_dwordx4 v8, s[8:11], s79 offen offset:896 sc1 lds
    s_add_u32 m0, m0, 896
    s_nop 0
    buffer_load_dwordx4 v8, s[8:11], s79 offen offset:1024 sc1 lds
    s_add_u32 m0, m0, 896
    s_nop 0
    buffer_load_dwordx4 v8, s[8:11], s79 offen offset:1152 sc1 lds
    s_waitcnt vmcnt(0)
    s_barrier
    s_branch L_qkv_a_q1
L_qkv_a_q:
    s_add_u32 s79, s79, 40960
    s_and_b32 s88, s75, 3
    s_mul_i32 s88, s88, 147456
    s_add_u32 s88, s88, s72
    s_sub_u32 s89, s75, 3
    s_cselect_b32 s89, 0, s89
    ds_read_b128 v[96:99], v10 offset:0
    ds_read_b128 v[100:103], v12 offset:0
    ds_read_b128 v[104:107], v11 offset:0
    ds_read_b128 v[108:111], v13 offset:0
    ds_read_b128 v[112:115], v10 offset:1024
    ds_read_b128 v[116:119], v12 offset:1024
    s_waitcnt lgkmcnt(5)
    v_mfma_f32_16x16x32_bf16 v[16:19], a[0:3], v[96:99], 0
    v_mfma_f32_16x16x32_bf16 v[24:27], a[80:83], v[96:99], 0
    v_mfma_f32_16x16x32_bf16 v[32:35], a[160:163], v[96:99], 0
    v_mfma_f32_16x16x32_bf16 v[40:43], a[240:243], v[96:99], 0
    s_add_u32 m0, s83, 40960
    s_nop 0
    buffer_load_dwordx4 v8, s[8:11], s79 offen offset:0 sc1 lds
    s_waitcnt lgkmcnt(4)
    v_mfma_f32_16x16x32_bf16 v[20:23], a[0:3], v[100:103], 0
    v_mfma_f32_16x16x32_bf16 v[28:31], a[80:83], v[100:103], 0
    v_mfma_f32_16x16x32_bf16 v[36:39], a[160:163], v[100:103], 0
    v_mfma_f32_16x16x32_bf16 v[44:47], a[240:243], v[100:103], 0
    s_add_u32 m0, m0, 896
    s_nop 0
    buffer_load_dwordx4 v8, s[8:11], s79 offen offset:128 sc1 lds
    ds_read_b128 v[120:123], v11 offset:1024
    ds_read_b128 v[124:127], v13 offset:1024
    s_waitcnt lgkmcnt(5)
    v_mfma_f32_16x16x32_bf16 v[16:19], a[4:7], v[104:107], v[16:19]
    v_mfma_f32_16x16x32_bf16 v[24:27], a[84:87], v[104:107], v[24:27]
    v_mfma_f32_16x16x32_bf16 v[32:35], a[164:167], v[104:107], v[32:35]
    v_mfma_f32_16x16x32_bf16 v[40:43], a[244:247], v[104:107], v[40:43]
    s_add_u32 m0, m0, 896
    s_nop 0
    buffer_load_dwordx4 v8, s[8:11], s79 offen offset:256 sc1 lds
    s_waitcnt lgkmcnt(4)
    v_mfma_f32_16x16x32_bf16 v[20:23], a[4:7], v[108:111], v[20:23]
    v_mfma_f32_16x16x32_bf16 v[28:31], a[84:87], v[108:111], v[28:31]
    v_mfma_f32_16x16x32_bf16 v[36:39], a[164:167], v[108:111], v[36:39]
    v_mfma_f32_16x16x32_bf16 v[44:47], a[244:247], v[108:111], v[44:47]
    s_add_u32 m0, m0, 896
    s_nop 0
    buffer_load_dwordx4 v8, s[8:11], s79 offen offset:384 sc1 lds
    ds_read_b128 v[96:99], v10 offset:2048
    ds_read_b128 v[100:103], v12 offset:2048
    s_waitcnt lgkmcnt(5)
    v_mfma_f32_16x16x32_bf16 v[16:19], a[8:11], v[112:115], v[16:19]
    v_mfma_f32_16x16x32_bf16 v[24:27], a[88:91], v[112:115], v[24:27]
    v_mfma_f32_16x16x32_bf16 v[32:35], a[168:171], v[112:115], v[32:35]
    v_mfma_f32_16x16x32_bf16 v[40:43], a[248:251], v[112:115], v[40:43]
    s_add_u32 m0, m0, 896
    s_nop 0
    buffer_load_dwordx4 v8, s[8:11], s79 offen offset:512 sc1 lds
    s_waitcnt lgkmcnt(4)
    v_mfma_f32_16x16x32_bf16 v[20:23], a[8:11], v[116:119], v[20:23]
    v_mfma_f32_16x16x32_bf16 v[28:31], a[88:91], v[116:119], v[28:31]
    v_mfma_f32_16x16x32_bf16 v[36:39], a[168:171], v[116:119], v[36:39]
    v_mfma_f32_16x16x32_bf16 v[44:47], a[248:251], v[116:119], v[44:47]
    s_add_u32 m0, m0, 896
    s_nop 0
    buffer_load_dwordx4 v8, s[8:11], s79 offen offset:640 sc1 lds
    ds_read_b128 v[104:107], v11 offset:2048
    ds_read_b128 v[108:111], v13 offset:2048
    s_waitcnt lgkmcnt(5)
    v_mfma_f32_16x16x32_bf16 v[16:19], a[12:15], v[120:123], v[16:19]
    v_mfma_f32_16x16x32_bf16 v[24:27], a[92:95], v[120:123], v[24:27]
    v_mfma_f32_16x16x32_bf16 v[32:35], a[172:175], v[120:123], v[32:35]
    v_mfma_f32_16x16x32_bf16 v[40:43], a[252:255], v[120:123], v[40:43]
    s_add_u32 m0, m0, 896
    s_nop 0
    buffer_load_dwordx4 v8, s[8:11], s79 offen offset:768 sc1 lds
    s_waitcnt lgkmcnt(4)
    v_mfma_f32_16x16x32_bf16 v[20:23], a[12:15], v[124:127], v[20:23]
    v_mfma_f32_16x16x32_bf16 v[28:31], a[92:95], v[124:127], v[28:31]
    v_mfma_f32_16x16x32_bf16 v[36:39], a[172:175], v[124:127], v[36:39]
    v_mfma_f32_16x16x32_bf16 v[44:47], a[252:255], v[124:127], v[44:47]
    s_add_u32 m0, m0, 896
    s_nop 0
    buffer_load_dwordx4 v8, s[8:11], s79 offen offset:896 sc1 lds
    ds_read_b128 v[112:115], v10 offset:3072
    ds_read_b128 v[116:119], v12 offset:3072
    s_waitcnt lgkmcnt(5)
    v_mfma_f32_16x16x32_bf16 v[16:19], a[16:19], v[96:99], v[16:19]
    v_mfma_f32_16x16x32_bf16 v[24:27], a[96:99], v[96:99], v[24:27]
    v_mfma_f32_16x16x32_bf16 v[32:35], a[176:179], v[96:99], v[32:35]
    v_mfma_f32_16x16x32_bf16 v[40:43], v[192:195], v[96:99], v[40:43]
    s_add_u32 m0, m0, 896
    s_nop 0
    buffer_load_dwordx4 v8, s[8:11], s79 offen offset:1024 sc1 lds
    s_waitcnt lgkmcnt(4)
    v_mfma_f32_16x16x32_bf16 v[20:23], a[16:19], v[100:103], v[20:23]
    v_mfma_f32_16x16x32_bf16 v[28:31], a[96:99], v[100:103], v[28:31]
    v_mfma_f32_16x16x32_bf16 v[36:39], a[176:179], v[100:103], v[36:39]
    v_mfma_f32_16x16x32_bf16 v[44:47], v[192:195], v[100:103], v[44:47]
    s_add_u32 m0, m0, 896
    s_nop 0
    buffer_load_dwordx4 v8, s[8:11], s79 offen offset:1152 sc1 lds
    ds_read_b128 v[120:123], v11 offset:3072
    ds_read_b128 v[124:127], v13 offset:3072
    s_waitcnt lgkmcnt(5)
    v_mfma_f32_16x16x32_bf16 v[16:19], a[20:23], v[104:107], v[16:19]
    v_mfma_f32_16x16x32_bf16 v[24:27], a[100:103], v[104:107], v[24:27]
    v_mfma_f32_16x16x32_bf16 v[32:35], a[180:183], v[104:107], v[32:35]
    v_mfma_f32_16x16x32_bf16 v[40:43], v[196:199], v[104:107], v[40:43]
    s_waitcnt lgkmcnt(4)
    v_mfma_f32_16x16x32_bf16 v[20:23], a[20:23], v[108:111], v[20:23]
    v_mfma_f32_16x16x32_bf16 v[28:31], a[100:103], v[108:111], v[28:31]
    v_mfma_f32_16x16x32_bf16 v[36:39], a[180:183], v[108:111], v[36:39]
    v_mfma_f32_16x16x32_bf16 v[44:47], v[196:199], v[108:111], v[44:47]
    ds_read_b128 v[96:99], v10 offset:4096
    ds_read_b128 v[100:103], v12 offset:4096
    s_waitcnt lgkmcnt(5)
    v_mfma_f32_16x16x32_bf16 v[16:19], a[24:27], v[112:115], v[16:19]
    v_mfma_f32_16x16x32_bf16 v[24:27], a[104:107], v[112:115], v[24:27]
    v_mfma_f32_16x16x32_bf16 v[32:35], a[184:187], v[112:115], v[32:35]
    v_mfma_f32_16x16x32_bf16 v[40:43], v[200:203], v[112:115], v[40:43]
    buffer_load_dword v3, v7, s[8:11], s82 offen offset:0 sc1
    s_waitcnt lgkmcnt(4)
    v_mfma_f32_16x16x32_bf16 v[20:23], a[24:27], v[116:119], v[20:23]
    v_mfma_f32_16x16x32_bf16 v[28:31], a[104:107], v[116:119], v[28:31]
    v_mfma_f32_16x16x32_bf16 v[36:39], a[184:187], v[116:119], v[36:39]
    v_mfma_f32_16x16x32_bf16 v[44:47], v[200:203], v[116:119], v[44:47]
    ds_read_b128 v[104:107], v11 offset:4096
    ds_read_b128 v[108:111], v13 offset:4096
    s_waitcnt lgkmcnt(5)
    v_mfma_f32_16x16x32_bf16 v[16:19], a[28:31], v[120:123], v[16:19]
    v_mfma_f32_16x16x32_bf16 v[24:27], a[108:111], v[120:123], v[24:27]
    v_mfma_f32_16x16x32_bf16 v[32:35], a[188:191], v[120:123], v[32:35]
    v_mfma_f32_16x16x32_bf16 v[40:43], v[204:207], v[120:123], v[40:43]
    s_waitcnt lgkmcnt(4)
    v_mfma_f32_16x16x32_bf16 v[20:23], a[28:31], v[124:127], v[20:23]
    v_mfma_f32_16x16x32_bf16 v[28:31], a[108:111], v[124:127], v[28:31]
    v_mfma_f32_16x16x32_bf16 v[36:39], a[188:191], v[124:127], v[36:39]
    v_mfma_f32_16x16x32_bf16 v[44:47], v[204:207], v[124:127], v[44:47]
    ds_read_b128 v[112:115], v10 offset:5120
    ds_read_b128 v[116:119], v12 offset:5120
    s_waitcnt lgkmcnt(5)
    v_mfma_f32_16x16x32_bf16 v[16:19], a[32:35], v[96:99], v[16:19]
    v_mfma_f32_16x16x32_bf16 v[24:27], a[112:115], v[96:99], v[24:27]
    v_mfma_f32_16x16x32_bf16 v[32:35], a[192:195], v[96:99], v[32:35]
    v_mfma_f32_16x16x32_bf16 v[40:43], v[208:211], v[96:99], v[40:43]
    s_waitcnt lgkmcnt(4)
    v_mfma_f32_16x16x32_bf16 v[20:23], a[32:35], v[100:103], v[20:23]
    v_mfma_f32_16x16x32_bf16 v[28:31], a[112:115], v[100:103], v[28:31]
    v_mfma_f32_16x16x32_bf16 v[36:39], a[192:195], v[100:103], v[36:39]
    v_mfma_f32_16x16x32_bf16 v[44:47], v[208:211], v[100:103], v[44:47]
    ds_read_b128 v[120:123], v11 offset:5120
    ds_read_b128 v[124:127], v13 offset:5120
    s_waitcnt lgkmcnt(5)
    v_mfma_f32_16x16x32_bf16 v[16:19], a[36:39], v[104:107], v[16:19]
    v_mfma_f32_16x16x32_bf16 v[24:27], a[116:119], v[104:107], v[24:27]
    v_mfma_f32_16x16x32_bf16 v[32:35], a[196:199], v[104:107], v[32:35]
    v_mfma_f32_16x16x32_bf16 v[40:43], v[212:215], v[104:107], v[40:43]
    s_waitcnt lgkmcnt(4)
    v_mfma_f32_16x16x32_bf16 v[20:23], a[36:39], v[108:111], v[20:23]
    v_mfma_f32_16x16x32_bf16 v[28:31], a[116:119], v[108:111], v[28:31]
    v_mfma_f32_16x16x32_bf16 v[36:39], a[196:199], v[108:111], v[36:39]
    v_mfma_f32_16x16x32_bf16 v[44:47], v[212:215], v[108:111], v[44:47]
    ds_read_b128 v[96:99], v10 offset:6144
    ds_read_b128 v[100:103], v12 offset:6144
    s_waitcnt lgkmcnt(5)
    v_mfma_f32_16x16x32_bf16 v[16:19], a[40:43], v[112:115], v[16:19]
    v_mfma_f32_16x16x32_bf16 v[24:27], a[120:123], v[112:115], v[24:27]
    v_mfma_f32_16x16x32_bf16 v[32:35], a[200:203], v[112:115], v[32:35]
    v_mfma_f32_16x16x32_bf16 v[40:43], v[216:219], v[112:115], v[40:43]
    s_waitcnt lgkmcnt(4)
    v_mfma_f32_16x16x32_bf16 v[20:23], a[40:43], v[116:119], v[20:23]
    v_mfma_f32_16x16x32_bf16 v[28:31], a[120:123], v[116:119], v[28:31]
    v_mfma_f32_16x16x32_bf16 v[36:39], a[200:203], v[116:119], v[36:39]
    v_mfma_f32_16x16x32_bf16 v[44:47], v[216:219], v[116:119], v[44:47]
    ds_read_b128 v[104:107], v11 offset:6144
    ds_read_b128 v[108:111], v13 offset:6144
    s_waitcnt lgkmcnt(5)
    v_mfma_f32_16x16x32_bf16 v[16:19], a[44:47], v[120:123], v[16:19]
    v_mfma_f32_16x16x32_bf16 v[24:27], a[124:127], v[120:123], v[24:27]
    v_mfma_f32_16x16x32_bf16 v[32:35], a[204:207], v[120:123], v[32:35]
    v_mfma_f32_16x16x32_bf16 v[40:43], v[220:223], v[120:123], v[40:43]
    s_waitcnt lgkmcnt(4)
    v_mfma_f32_16x16x32_bf16 v[20:23], a[44:47], v[124:127], v[20:23]
    v_mfma_f32_16x16x32_bf16 v[28:31], a[124:127], v[124:127], v[28:31]
    v_mfma_f32_16x16x32_bf16 v[36:39], a[204:207], v[124:127], v[36:39]
    v_mfma_f32_16x16x32_bf16 v[44:47], v[220:223], v[124:127], v[44:47]
    ds_read_b128 v[112:115], v10 offset:7168
    ds_read_b128 v[116:119], v12 offset:7168
    s_waitcnt lgkmcnt(5)
    v_mfma_f32_16x16x32_bf16 v[16:19], a[48:51], v[96:99], v[16:19]
    v_mfma_f32_16x16x32_bf16 v[24:27], a[128:131], v[96:99], v[24:27]
    v_mfma_f32_16x16x32_bf16 v[32:35], a[208:211], v[96:99], v[32:35]
    v_mfma_f32_16x16x32_bf16 v[40:43], v[224:227], v[96:99], v[40:43]
    s_waitcnt lgkmcnt(4)
    v_mfma_f32_16x16x32_bf16 v[20:23], a[48:51], v[100:103], v[20:23]
    v_mfma_f32_16x16x32_bf16 v[28:31], a[128:131], v[100:103], v[28:31]
    v_mfma_f32_16x16x32_bf16 v[36:39], a[208:211], v[100:103], v[36:39]
    v_mfma_f32_16x16x32_bf16 v[44:47], v[224:227], v[100:103], v[44:47]
    ds_read_b128 v[120:123], v11 offset:7168
    ds_read_b128 v[124:127], v13 offset:7168
    s_waitcnt lgkmcnt(5)
    v_mfma_f32_16x16x32_bf16 v[16:19], a[52:55], v[104:107], v[16:19]
    v_mfma_f32_16x16x32_bf16 v[24:27], a[132:135], v[104:107], v[24:27]
    v_mfma_f32_16x16x32_bf16 v[32:35], a[212:215], v[104:107], v[32:35]
    v_mfma_f32_16x16x32_bf16 v[40:43], v[228:231], v[104:107], v[40:43]
    s_waitcnt lgkmcnt(4)
    v_mfma_f32_16x16x32_bf16 v[20:23], a[52:55], v[108:111], v[20:23]
    v_mfma_f32_16x16x32_bf16 v[28:31], a[132:135], v[108:111], v[28:31]
    v_mfma_f32_16x16x32_bf16 v[36:39], a[212:215], v[108:111], v[36:39]
    v_mfma_f32_16x16x32_bf16 v[44:47], v[228:231], v[108:111], v[44:47]
    ds_read_b128 v[96:99], v10 offset:8192
    ds_read_b128 v[100:103], v12 offset:8192
    s_waitcnt lgkmcnt(5)
    v_mfma_f32_16x16x32_bf16 v[16:19], a[56:59], v[112:115], v[16:19]
    v_mfma_f32_16x16x32_bf16 v[24:27], a[136:139], v[112:115], v[24:27]
    v_mfma_f32_16x16x32_bf16 v[32:35], a[216:219], v[112:115], v[32:35]
    v_mfma_f32_16x16x32_bf16 v[40:43], v[232:235], v[112:115], v[40:43]
    s_waitcnt lgkmcnt(4)
    v_mfma_f32_16x16x32_bf16 v[20:23], a[56:59], v[116:119], v[20:23]
    v_mfma_f32_16x16x32_bf16 v[28:31], a[136:139], v[116:119], v[28:31]
    v_mfma_f32_16x16x32_bf16 v[36:39], a[216:219], v[116:119], v[36:39]
    v_mfma_f32_16x16x32_bf16 v[44:47], v[232:235], v[116:119], v[44:47]
    ds_read_b128 v[104:107], v11 offset:8192
    ds_read_b128 v[108:111], v13 offset:8192
    s_waitcnt lgkmcnt(5)
    v_mfma_f32_16x16x32_bf16 v[16:19], a[60:63], v[120:123], v[16:19]
    v_mfma_f32_16x16x32_bf16 v[24:27], a[140:143], v[120:123], v[24:27]
    v_mfma_f32_16x16x32_bf16 v[32:35], a[220:223], v[120:123], v[32:35]
    v_mfma_f32_16x16x32_bf16 v[40:43], v[236:239], v[120:123], v[40:43]
    s_waitcnt lgkmcnt(4)
    v_mfma_f32_16x16x32_bf16 v[20:23], a[60:63], v[124:127], v[20:23]
    v_mfma_f32_16x16x32_bf16 v[28:31], a[140:143], v[124:127], v[28:31]
    v_mfma_f32_16x16x32_bf16 v[36:39], a[220:223], v[124:127], v[36:39]
    v_mfma_f32_16x16x32_bf16 v[44:47], v[236:239], v[124:127], v[44:47]
    ds_read_b128 v[112:115], v10 offset:9216
    ds_read_b128 v[116:119], v12 offset:9216
    s_waitcnt lgkmcnt(5)
    v_mfma_f32_16x16x32_bf16 v[16:19], a[64:67], v[96:99], v[16:19]
    v_mfma_f32_16x16x32_bf16 v[24:27], a[144:147], v[96:99], v[24:27]
    v_mfma_f32_16x16x32_bf16 v[32:35], a[224:227], v[96:99], v[32:35]
    v_mfma_f32_16x16x32_bf16 v[40:43], v[240:243], v[96:99], v[40:43]
    s_waitcnt lgkmcnt(4)
    v_mfma_f32_16x16x32_bf16 v[20:23], a[64:67], v[100:103], v[20:23]
    v_mfma_f32_16x16x32_bf16 v[28:31], a[144:147], v[100:103], v[28:31]
    v_mfma_f32_16x16x32_bf16 v[36:39], a[224:227], v[100:103], v[36:39]
    v_mfma_f32_16x16x32_bf16 v[44:47], v[240:243], v[100:103], v[44:47]
    ds_read_b128 v[120:123], v11 offset:9216
    ds_read_b128 v[124:127], v13 offset:9216
    s_waitcnt lgkmcnt(5)
    v_mfma_f32_16x16x32_bf16 v[16:19], a[68:71], v[104:107], v[16:19]
    v_mfma_f32_16x16x32_bf16 v[24:27], a[148:151], v[104:107], v[24:27]
    v_mfma_f32_16x16x32_bf16 v[32:35], a[228:231], v[104:107], v[32:35]
    v_mfma_f32_16x16x32_bf16 v[40:43], v[244:247], v[104:107], v[40:43]
    s_waitcnt lgkmcnt(4)
    v_mfma_f32_16x16x32_bf16 v[20:23], a[68:71], v[108:111], v[20:23]
    v_mfma_f32_16x16x32_bf16 v[28:31], a[148:151], v[108:111], v[28:31]
    v_mfma_f32_16x16x32_bf16 v[36:39], a[228:231], v[108:111], v[36:39]
    v_mfma_f32_16x16x32_bf16 v[44:47], v[244:247], v[108:111], v[44:47]
    s_waitcnt lgkmcnt(3)
    v_mfma_f32_16x16x32_bf16 v[16:19], a[72:75], v[112:115], v[16:19]
    v_mfma_f32_16x16x32_bf16 v[24:27], a[152:155], v[112:115], v[24:27]
    v_mfma_f32_16x16x32_bf16 v[32:35], a[232:235], v[112:115], v[32:35]
    v_mfma_f32_16x16x32_bf16 v[40:43], v[248:251], v[112:115], v[40:43]
    s_waitcnt lgkmcnt(2)
    v_mfma_f32_16x16x32_bf16 v[20:23], a[72:75], v[116:119], v[20:23]
    v_mfma_f32_16x16x32_bf16 v[28:31], a[152:155], v[116:119], v[28:31]
    v_mfma_f32_16x16x32_bf16 v[36:39], a[232:235], v[116:119], v[36:39]
    v_mfma_f32_16x16x32_bf16 v[44:47], v[248:251], v[116:119], v[44:47]
    s_waitcnt lgkmcnt(1)
    v_mfma_f32_16x16x32_bf16 v[16:19], a[76:79], v[120:123], v[16:19]
    v_mfma_f32_16x16x32_bf16 v[24:27], a[156:159], v[120:123], v[24:27]
    v_mfma_f32_16x16x32_bf16 v[32:35], a[236:239], v[120:123], v[32:35]
    v_mfma_f32_16x16x32_bf16 v[40:43], v[252:255], v[120:123], v[40:43]
    s_waitcnt lgkmcnt(0)
    v_mfma_f32_16x16x32_bf16 v[20:23], a[76:79], v[124:127], v[20:23]
    v_mfma_f32_16x16x32_bf16 v[28:31], a[156:159], v[124:127], v[28:31]
    v_mfma_f32_16x16x32_bf16 v[36:39], a[236:239], v[124:127], v[36:39]
    v_mfma_f32_16x16x32_bf16 v[44:47], v[252:255], v[124:127], v[44:47]
    s_waitcnt vmcnt(0)
    v_cvt_pk_bf16_f32 v80, v16, v17
    v_cvt_pk_bf16_f32 v81, v18, v19
    s_nop 1
    v_cvt_pk_bf16_f32 v82, v20, v21
    v_cvt_pk_bf16_f32 v83, v22, v23
    v_cvt_pk_bf16_f32 v84, v24, v25
    v_cvt_pk_bf16_f32 v85, v26, v27
    v_cvt_pk_bf16_f32 v86, v28, v29
    v_cvt_pk_bf16_f32 v87, v30, v31
    v_permlane32_swap_b32 v80, v82
    v_permlane32_swap_b32 v81, v83
    v_permlane32_swap_b32 v84, v86
    v_permlane32_swap_b32 v85, v87
    v_cmp_gt_u32 vcc, s89, v3
    s_cbranch_vccz L_bp_119
L_poll_120:
    buffer_load_dword v3, v7, s[8:11], s82 offen offset:0 sc1
    s_waitcnt vmcnt(0)
    v_cmp_gt_u32 vcc, s89, v3
    s_cbranch_vccz L_pok_121
    s_sleep 1
    s_sub_u32 s6, s6, 1
    s_cbranch_scc0 L_poll_120
    s_branch L_fail
L_pok_121:
L_bp_119:
    s_cmp_eq_u32 s7, 0
    s_cbranch_scc1 L_sl_122
    buffer_store_dwordx4 v[80:83], v9, s[8:11], s88 offen offset:0
    buffer_store_dwordx4 v[84:87], v9, s[8:11], s88 offen offset:1024
    s_branch L_sd_123
L_sl_122:
    buffer_store_dwordx4 v[80:83], v9, s[8:11], s88 offen offset:0 sc1
    buffer_store_dwordx4 v[84:87], v9, s[8:11], s88 offen offset:1024 sc1
L_sd_123:
    v_cvt_pk_bf16_f32 v88, v32, v33
    v_cvt_pk_bf16_f32 v89, v34, v35
    v_cvt_pk_bf16_f32 v90, v36, v37
    v_cvt_pk_bf16_f32 v91, v38, v39
    v_cvt_pk_bf16_f32 v92, v40, v41
    v_cvt_pk_bf16_f32 v93, v42, v43
    v_cvt_pk_bf16_f32 v94, v44, v45
    v_cvt_pk_bf16_f32 v95, v46, v47
    v_permlane32_swap_b32 v88, v90
    v_permlane32_swap_b32 v89, v91
    v_permlane32_swap_b32 v92, v94
    v_permlane32_swap_b32 v93, v95
    s_cmp_eq_u32 s7, 0
    s_cbranch_scc1 L_sl_124
    buffer_store_dwordx4 v[88:91], v9, s[8:11], s88 offen offset:2048
    buffer_store_dwordx4 v[92:95], v9, s[8:11], s88 offen offset:3072
    s_branch L_sd_125
L_sl_124:
    buffer_store_dwordx4 v[88:91], v9, s[8:11], s88 offen offset:2048 sc1
    buffer_store_dwordx4 v[92:95], v9, s[8:11], s88 offen offset:3072 sc1
L_sd_125:
    s_add_u32 s75, s75, 1
    s_waitcnt vmcnt(0)
    v_mov_b32 v4, s75
    s_mov_b64 exec, 1
    s_cmp_eq_u32 s7, 0
    s_cbranch_scc1 L_sl_126
    buffer_store_dword v4, off, s[8:11], s65
    s_branch L_sd_127
L_sl_126:
    buffer_store_dword v4, off, s[8:11], s65 sc1
L_sd_127:
    s_mov_b64 exec, -1
    s_barrier
L_qkv_a_q1:
    s_add_u32 s79, s79, 40960
    s_and_b32 s88, s75, 3
    s_mul_i32 s88, s88, 147456
    s_add_u32 s88, s88, s72
    s_sub_u32 s89, s75, 3
    s_cselect_b32 s89, 0, s89
    ds_read_b128 v[96:99], v10 offset:40960
    ds_read_b128 v[100:103], v12 offset:40960
    ds_read_b128 v[104:107], v11 offset:40960
    ds_read_b128 v[108:111], v13 offset:40960
    ds_read_b128 v[112:115], v10 offset:41984
    ds_read_b128 v[116:119], v12 offset:41984
    s_waitcnt lgkmcnt(5)
    v_mfma_f32_16x16x32_bf16 v[48:51], a[0:3], v[96:99], 0
    v_mfma_f32_16x16x32_bf16 v[56:59], a[80:83], v[96:99], 0
    v_mfma_f32_16x16x32_bf16 v[64:67], a[160:163], v[96:99], 0
    v_mfma_f32_16x16x32_bf16 v[72:75], a[240:243], v[96:99], 0
    s_add_u32 m0, s83, 0
    s_nop 0
    buffer_load_dwordx4 v8, s[8:11], s79 offen offset:0 sc1 lds
    s_waitcnt lgkmcnt(4)
    v_mfma_f32_16x16x32_bf16 v[52:55], a[0:3], v[100:103], 0
    v_mfma_f32_16x16x32_bf16 v[60:63], a[80:83], v[100:103], 0
    v_mfma_f32_16x16x32_bf16 v[68:71], a[160:163], v[100:103], 0
    v_mfma_f32_16x16x32_bf16 v[76:79], a[240:243], v[100:103], 0
    s_add_u32 m0, m0, 896
    s_nop 0
    buffer_load_dwordx4 v8, s[8:11], s79 offen offset:128 sc1 lds
    ds_read_b128 v[120:123], v11 offset:41984
    ds_read_b128 v[124:127], v13 offset:41984
    s_waitcnt lgkmcnt(5)
    v_mfma_f32_16x16x32_bf16 v[48:51], a[4:7], v[104:107], v[48:51]
    v_mfma_f32_16x16x32_bf16 v[56:59], a[84:87], v[104:107], v[56:59]
    v_mfma_f32_16x16x32_bf16 v[64:67], a[164:167], v[104:107], v[64:67]
    v_mfma_f32_16x16x32_bf16 v[72:75], a[244:247], v[104:107], v[72:75]
    s_add_u32 m0, m0, 896
    s_nop 0
    buffer_load_dwordx4 v8, s[8:11], s79 offen offset:256 sc1 lds
    s_waitcnt lgkmcnt(4)
    v_mfma_f32_16x16x32_bf16 v[52:55], a[4:7], v[108:111], v[52:55]
    v_mfma_f32_16x16x32_bf16 v[60:63], a[84:87], v[108:111], v[60:63]
    v_mfma_f32_16x16x32_bf16 v[68:71], a[164:167], v[108:111], v[68:71]
    v_mfma_f32_16x16x32_bf16 v[76:79], a[244:247], v[108:111], v[76:79]
    s_add_u32 m0, m0, 896
    s_nop 0
    buffer_load_dwordx4 v8, s[8:11], s79 offen offset:384 sc1 lds
    ds_read_b128 v[96:99], v10 offset:43008
    ds_read_b128 v[100:103], v12 offset:43008
    s_waitcnt lgkmcnt(5)
    v_mfma_f32_16x16x32_bf16 v[48:51], a[8:11], v[112:115], v[48:51]
    v_mfma_f32_16x16x32_bf16 v[56:59], a[88:91], v[112:115], v[56:59]
    v_mfma_f32_16x16x32_bf16 v[64:67], a[168:171], v[112:115], v[64:67]
    v_mfma_f32_16x16x32_bf16 v[72:75], a[248:251], v[112:115], v[72:75]
    s_add_u32 m0, m0, 896
    s_nop 0
    buffer_load_dwordx4 v8, s[8:11], s79 offen offset:512 sc1 lds
    s_waitcnt lgkmcnt(4)
    v_mfma_f32_16x16x32_bf16 v[52:55], a[8:11], v[116:119], v[52:55]
    v_mfma_f32_16x16x32_bf16 v[60:63], a[88:91], v[116:119], v[60:63]
    v_mfma_f32_16x16x32_bf16 v[68:71], a[168:171], v[116:119], v[68:71]
    v_mfma_f32_16x16x32_bf16 v[76:79], a[248:251], v[116:119], v[76:79]
    s_add_u32 m0, m0, 896
    s_nop 0
    buffer_load_dwordx4 v8, s[8:11], s79 offen offset:640 sc1 lds
    ds_read_b128 v[104:107], v11 offset:43008
    ds_read_b128 v[108:111], v13 offset:43008
    s_waitcnt lgkmcnt(5)
    v_mfma_f32_16x16x32_bf16 v[48:51], a[12:15], v[120:123], v[48:51]
    v_mfma_f32_16x16x32_bf16 v[56:59], a[92:95], v[120:123], v[56:59]
    v_mfma_f32_16x16x32_bf16 v[64:67], a[172:175], v[120:123], v[64:67]
    v_mfma_f32_16x16x32_bf16 v[72:75], a[252:255], v[120:123], v[72:75]
    s_add_u32 m0, m0, 896
    s_nop 0
    buffer_load_dwordx4 v8, s[8:11], s79 offen offset:768 sc1 lds
    s_waitcnt lgkmcnt(4)
    v_mfma_f32_16x16x32_bf16 v[52:55], a[12:15], v[124:127], v[52:55]
    v_mfma_f32_16x16x32_bf16 v[60:63], a[92:95], v[124:127], v[60:63]
    v_mfma_f32_16x16x32_bf16 v[68:71], a[172:175], v[124:127], v[68:71]
    v_mfma_f32_16x16x32_bf16 v[76:79], a[252:255], v[124:127], v[76:79]
    s_add_u32 m0, m0, 896
    s_nop 0
    buffer_load_dwordx4 v8, s[8:11], s79 offen offset:896 sc1 lds
    ds_read_b128 v[112:115], v10 offset:44032
    ds_read_b128 v[116:119], v12 offset:44032
    s_waitcnt lgkmcnt(5)
    v_mfma_f32_16x16x32_bf16 v[48:51], a[16:19], v[96:99], v[48:51]
    v_mfma_f32_16x16x32_bf16 v[56:59], a[96:99], v[96:99], v[56:59]
    v_mfma_f32_16x16x32_bf16 v[64:67], a[176:179], v[96:99], v[64:67]
    v_mfma_f32_16x16x32_bf16 v[72:75], v[192:195], v[96:99], v[72:75]
    s_add_u32 m0, m0, 896
    s_nop 0
    buffer_load_dwordx4 v8, s[8:11], s79 offen offset:1024 sc1 lds
    s_waitcnt lgkmcnt(4)
    v_mfma_f32_16x16x32_bf16 v[52:55], a[16:19], v[100:103], v[52:55]
    v_mfma_f32_16x16x32_bf16 v[60:63], a[96:99], v[100:103], v[60:63]
    v_mfma_f32_16x16x32_bf16 v[68:71], a[176:179], v[100:103], v[68:71]
    v_mfma_f32_16x16x32_bf16 v[76:79], v[192:195], v[100:103], v[76:79]
    s_add_u32 m0, m0, 896
    s_nop 0
    buffer_load_dwordx4 v8, s[8:11], s79 offen offset:1152 sc1 lds
    ds_read_b128 v[120:123], v11 offset:44032
    ds_read_b128 v[124:127], v13 offset:44032
    s_waitcnt lgkmcnt(5)
    v_mfma_f32_16x16x32_bf16 v[48:51], a[20:23], v[104:107], v[48:51]
    v_mfma_f32_16x16x32_bf16 v[56:59], a[100:103], v[104:107], v[56:59]
    v_mfma_f32_16x16x32_bf16 v[64:67], a[180:183], v[104:107], v[64:67]
    v_mfma_f32_16x16x32_bf16 v[72:75], v[196:199], v[104:107], v[72:75]
    s_waitcnt lgkmcnt(4)
    v_mfma_f32_16x16x32_bf16 v[52:55], a[20:23], v[108:111], v[52:55]
    v_mfma_f32_16x16x32_bf16 v[60:63], a[100:103], v[108:111], v[60:63]
    v_mfma_f32_16x16x32_bf16 v[68:71], a[180:183], v[108:111], v[68:71]
    v_mfma_f32_16x16x32_bf16 v[76:79], v[196:199], v[108:111], v[76:79]
    ds_read_b128 v[96:99], v10 offset:45056
    ds_read_b128 v[100:103], v12 offset:45056
    s_waitcnt lgkmcnt(5)
    v_mfma_f32_16x16x32_bf16 v[48:51], a[24:27], v[112:115], v[48:51]
    v_mfma_f32_16x16x32_bf16 v[56:59], a[104:107], v[112:115], v[56:59]
    v_mfma_f32_16x16x32_bf16 v[64:67], a[184:187], v[112:115], v[64:67]
    v_mfma_f32_16x16x32_bf16 v[72:75], v[200:203], v[112:115], v[72:75]
    buffer_load_dword v3, v7, s[8:11], s82 offen offset:0 sc1
    s_waitcnt lgkmcnt(4)
    v_mfma_f32_16x16x32_bf16 v[52:55], a[24:27], v[116:119], v[52:55]
    v_mfma_f32_16x16x32_bf16 v[60:63], a[104:107], v[116:119], v[60:63]
    v_mfma_f32_16x16x32_bf16 v[68:71], a[184:187], v[116:119], v[68:71]
    v_mfma_f32_16x16x32_bf16 v[76:79], v[200:203], v[116:119], v[76:79]
    ds_read_b128 v[104:107], v11 offset:45056
    ds_read_b128 v[108:111], v13 offset:45056
    s_waitcnt lgkmcnt(5)
    v_mfma_f32_16x16x32_bf16 v[48:51], a[28:31], v[120:123], v[48:51]
    v_mfma_f32_16x16x32_bf16 v[56:59], a[108:111], v[120:123], v[56:59]
    v_mfma_f32_16x16x32_bf16 v[64:67], a[188:191], v[120:123], v[64:67]
    v_mfma_f32_16x16x32_bf16 v[72:75], v[204:207], v[120:123], v[72:75]
    s_waitcnt lgkmcnt(4)
    v_mfma_f32_16x16x32_bf16 v[52:55], a[28:31], v[124:127], v[52:55]
    v_mfma_f32_16x16x32_bf16 v[60:63], a[108:111], v[124:127], v[60:63]
    v_mfma_f32_16x16x32_bf16 v[68:71], a[188:191], v[124:127], v[68:71]
    v_mfma_f32_16x16x32_bf16 v[76:79], v[204:207], v[124:127], v[76:79]
    ds_read_b128 v[112:115], v10 offset:46080
    ds_read_b128 v[116:119], v12 offset:46080
    s_waitcnt lgkmcnt(5)
    v_mfma_f32_16x16x32_bf16 v[48:51], a[32:35], v[96:99], v[48:51]
    v_mfma_f32_16x16x32_bf16 v[56:59], a[112:115], v[96:99], v[56:59]
    v_mfma_f32_16x16x32_bf16 v[64:67], a[192:195], v[96:99], v[64:67]
    v_mfma_f32_16x16x32_bf16 v[72:75], v[208:211], v[96:99], v[72:75]
    s_waitcnt lgkmcnt(4)
    v_mfma_f32_16x16x32_bf16 v[52:55], a[32:35], v[100:103], v[52:55]
    v_mfma_f32_16x16x32_bf16 v[60:63], a[112:115], v[100:103], v[60:63]
    v_mfma_f32_16x16x32_bf16 v[68:71], a[192:195], v[100:103], v[68:71]
    v_mfma_f32_16x16x32_bf16 v[76:79], v[208:211], v[100:103], v[76:79]
    ds_read_b128 v[120:123], v11 offset:46080
    ds_read_b128 v[124:127], v13 offset:46080
    s_waitcnt lgkmcnt(5)
    v_mfma_f32_16x16x32_bf16 v[48:51], a[36:39], v[104:107], v[48:51]
    v_mfma_f32_16x16x32_bf16 v[56:59], a[116:119], v[104:107], v[56:59]
    v_mfma_f32_16x16x32_bf16 v[64:67], a[196:199], v[104:107], v[64:67]
    v_mfma_f32_16x16x32_bf16 v[72:75], v[212:215], v[104:107], v[72:75]
    s_waitcnt lgkmcnt(4)
    v_mfma_f32_16x16x32_bf16 v[52:55], a[36:39], v[108:111], v[52:55]
    v_mfma_f32_16x16x32_bf16 v[60:63], a[116:119], v[108:111], v[60:63]
    v_mfma_f32_16x16x32_bf16 v[68:71], a[196:199], v[108:111], v[68:71]
    v_mfma_f32_16x16x32_bf16 v[76:79], v[212:215], v[108:111], v[76:79]
    ds_read_b128 v[96:99], v10 offset:47104
    ds_read_b128 v[100:103], v12 offset:47104
    s_waitcnt lgkmcnt(5)
    v_mfma_f32_16x16x32_bf16 v[48:51], a[40:43], v[112:115], v[48:51]
    v_mfma_f32_16x16x32_bf16 v[56:59], a[120:123], v[112:115], v[56:59]
    v_mfma_f32_16x16x32_bf16 v[64:67], a[200:203], v[112:115], v[64:67]
    v_mfma_f32_16x16x32_bf16 v[72:75], v[216:219], v[112:115], v[72:75]
    s_waitcnt lgkmcnt(4)
    v_mfma_f32_16x16x32_bf16 v[52:55], a[40:43], v[116:119], v[52:55]
    v_mfma_f32_16x16x32_bf16 v[60:63], a[120:123], v[116:119], v[60:63]
    v_mfma_f32_16x16x32_bf16 v[68:71], a[200:203], v[116:119], v[68:71]
    v_mfma_f32_16x16x32_bf16 v[76:79], v[216:219], v[116:119], v[76:79]
    ds_read_b128 v[104:107], v11 offset:47104
    ds_read_b128 v[108:111], v13 offset:47104
    s_waitcnt lgkmcnt(5)
    v_mfma_f32_16x16x32_bf16 v[48:51], a[44:47], v[120:123], v[48:51]
    v_mfma_f32_16x16x32_bf16 v[56:59], a[124:127], v[120:123], v[56:59]
    v_mfma_f32_16x16x32_bf16 v[64:67], a[204:207], v[120:123], v[64:67]
    v_mfma_f32_16x16x32_bf16 v[72:75], v[220:223], v[120:123], v[72:75]
    s_waitcnt lgkmcnt(4)
    v_mfma_f32_16x16x32_bf16 v[52:55], a[44:47], v[124:127], v[52:55]
    v_mfma_f32_16x16x32_bf16 v[60:63], a[124:127], v[124:127], v[60:63]
    v_mfma_f32_16x16x32_bf16 v[68:71], a[204:207], v[124:127], v[68:71]
    v_mfma_f32_16x16x32_bf16 v[76:79], v[220:223], v[124:127], v[76:79]
    ds_read_b128 v[112:115], v10 offset:48128
    ds_read_b128 v[116:119], v12 offset:48128
    s_waitcnt lgkmcnt(5)
    v_mfma_f32_16x16x32_bf16 v[48:51], a[48:51], v[96:99], v[48:51]
    v_mfma_f32_16x16x32_bf16 v[56:59], a[128:131], v[96:99], v[56:59]
    v_mfma_f32_16x16x32_bf16 v[64:67], a[208:211], v[96:99], v[64:67]
    v_mfma_f32_16x16x32_bf16 v[72:75], v[224:227], v[96:99], v[72:75]
    s_waitcnt lgkmcnt(4)
    v_mfma_f32_16x16x32_bf16 v[52:55], a[48:51], v[100:103], v[52:55]
    v_mfma_f32_16x16x32_bf16 v[60:63], a[128:131], v[100:103], v[60:63]
    v_mfma_f32_16x16x32_bf16 v[68:71], a[208:211], v[100:103], v[68:71]
    v_mfma_f32_16x16x32_bf16 v[76:79], v[224:227], v[100:103], v[76:79]
    ds_read_b128 v[120:123], v11 offset:48128
    ds_read_b128 v[124:127], v13 offset:48128
    s_waitcnt lgkmcnt(5)
    v_mfma_f32_16x16x32_bf16 v[48:51], a[52:55], v[104:107], v[48:51]
    v_mfma_f32_16x16x32_bf16 v[56:59], a[132:135], v[104:107], v[56:59]
    v_mfma_f32_16x16x32_bf16 v[64:67], a[212:215], v[104:107], v[64:67]
    v_mfma_f32_16x16x32_bf16 v[72:75], v[228:231], v[104:107], v[72:75]
    s_waitcnt lgkmcnt(4)
    v_mfma_f32_16x16x32_bf16 v[52:55], a[52:55], v[108:111], v[52:55]
    v_mfma_f32_16x16x32_bf16 v[60:63], a[132:135], v[108:111], v[60:63]
    v_mfma_f32_16x16x32_bf16 v[68:71], a[212:215], v[108:111], v[68:71]
    v_mfma_f32_16x16x32_bf16 v[76:79], v[228:231], v[108:111], v[76:79]
    ds_read_b128 v[96:99], v10 offset:49152
    ds_read_b128 v[100:103], v12 offset:49152
    s_waitcnt lgkmcnt(5)
    v_mfma_f32_16x16x32_bf16 v[48:51], a[56:59], v[112:115], v[48:51]
    v_mfma_f32_16x16x32_bf16 v[56:59], a[136:139], v[112:115], v[56:59]
    v_mfma_f32_16x16x32_bf16 v[64:67], a[216:219], v[112:115], v[64:67]
    v_mfma_f32_16x16x32_bf16 v[72:75], v[232:235], v[112:115], v[72:75]
    s_waitcnt lgkmcnt(4)
    v_mfma_f32_16x16x32_bf16 v[52:55], a[56:59], v[116:119], v[52:55]
    v_mfma_f32_16x16x32_bf16 v[60:63], a[136:139], v[116:119], v[60:63]
    v_mfma_f32_16x16x32_bf16 v[68:71], a[216:219], v[116:119], v[68:71]
    v_mfma_f32_16x16x32_bf16 v[76:79], v[232:235], v[116:119], v[76:79]
    ds_read_b128 v[104:107], v11 offset:49152
    ds_read_b128 v[108:111], v13 offset:49152
    s_waitcnt lgkmcnt(5)
    v_mfma_f32_16x16x32_bf16 v[48:51], a[60:63], v[120:123], v[48:51]
    v_mfma_f32_16x16x32_bf16 v[56:59], a[140:143], v[120:123], v[56:59]
    v_mfma_f32_16x16x32_bf16 v[64:67], a[220:223], v[120:123], v[64:67]
    v_mfma_f32_16x16x32_bf16 v[72:75], v[236:239], v[120:123], v[72:75]
    s_waitcnt lgkmcnt(4)
    v_mfma_f32_16x16x32_bf16 v[52:55], a[60:63], v[124:127], v[52:55]
    v_mfma_f32_16x16x32_bf16 v[60:63], a[140:143], v[124:127], v[60:63]
    v_mfma_f32_16x16x32_bf16 v[68:71], a[220:223], v[124:127], v[68:71]
    v_mfma_f32_16x16x32_bf16 v[76:79], v[236:239], v[124:127], v[76:79]
    ds_read_b128 v[112:115], v10 offset:50176
    ds_read_b128 v[116:119], v12 offset:50176
    s_waitcnt lgkmcnt(5)
    v_mfma_f32_16x16x32_bf16 v[48:51], a[64:67], v[96:99], v[48:51]
    v_mfma_f32_16x16x32_bf16 v[56:59], a[144:147], v[96:99], v[56:59]
    v_mfma_f32_16x16x32_bf16 v[64:67], a[224:227], v[96:99], v[64:67]
    v_mfma_f32_16x16x32_bf16 v[72:75], v[240:243], v[96:99], v[72:75]
    s_waitcnt lgkmcnt(4)
    v_mfma_f32_16x16x32_bf16 v[52:55], a[64:67], v[100:103], v[52:55]
    v_mfma_f32_16x16x32_bf16 v[60:63], a[144:147], v[100:103], v[60:63]
    v_mfma_f32_16x16x32_bf16 v[68:71], a[224:227], v[100:103], v[68:71]
    v_mfma_f32_16x16x32_bf16 v[76:79], v[240:243], v[100:103], v[76:79]
    ds_read_b128 v[120:123], v11 offset:50176
    ds_read_b128 v[124:127], v13 offset:50176
    s_waitcnt lgkmcnt(5)
    v_mfma_f32_16x16x32_bf16 v[48:51], a[68:71], v[104:107], v[48:51]
    v_mfma_f32_16x16x32_bf16 v[56:59], a[148:151], v[104:107], v[56:59]
    v_mfma_f32_16x16x32_bf16 v[64:67], a[228:231], v[104:107], v[64:67]
    v_mfma_f32_16x16x32_bf16 v[72:75], v[244:247], v[104:107], v[72:75]
    s_waitcnt lgkmcnt(4)
    v_mfma_f32_16x16x32_bf16 v[52:55], a[68:71], v[108:111], v[52:55]
    v_mfma_f32_16x16x32_bf16 v[60:63], a[148:151], v[108:111], v[60:63]
    v_mfma_f32_16x16x32_bf16 v[68:71], a[228:231], v[108:111], v[68:71]
    v_mfma_f32_16x16x32_bf16 v[76:79], v[244:247], v[108:111], v[76:79]
    s_waitcnt lgkmcnt(3)
    v_mfma_f32_16x16x32_bf16 v[48:51], a[72:75], v[112:115], v[48:51]
    v_mfma_f32_16x16x32_bf16 v[56:59], a[152:155], v[112:115], v[56:59]
    v_mfma_f32_16x16x32_bf16 v[64:67], a[232:235], v[112:115], v[64:67]
    v_mfma_f32_16x16x32_bf16 v[72:75], v[248:251], v[112:115], v[72:75]
    s_waitcnt lgkmcnt(2)
    v_mfma_f32_16x16x32_bf16 v[52:55], a[72:75], v[116:119], v[52:55]
    v_mfma_f32_16x16x32_bf16 v[60:63], a[152:155], v[116:119], v[60:63]
    v_mfma_f32_16x16x32_bf16 v[68:71], a[232:235], v[116:119], v[68:71]
    v_mfma_f32_16x16x32_bf16 v[76:79], v[248:251], v[116:119], v[76:79]
    s_waitcnt lgkmcnt(1)
    v_mfma_f32_16x16x32_bf16 v[48:51], a[76:79], v[120:123], v[48:51]
    v_mfma_f32_16x16x32_bf16 v[56:59], a[156:159], v[120:123], v[56:59]
    v_mfma_f32_16x16x32_bf16 v[64:67], a[236:239], v[120:123], v[64:67]
    v_mfma_f32_16x16x32_bf16 v[72:75], v[252:255], v[120:123], v[72:75]
    s_waitcnt lgkmcnt(0)
    v_mfma_f32_16x16x32_bf16 v[52:55], a[76:79], v[124:127], v[52:55]
    v_mfma_f32_16x16x32_bf16 v[60:63], a[156:159], v[124:127], v[60:63]
    v_mfma_f32_16x16x32_bf16 v[68:71], a[236:239], v[124:127], v[68:71]
    v_mfma_f32_16x16x32_bf16 v[76:79], v[252:255], v[124:127], v[76:79]
    s_waitcnt vmcnt(0)
    v_cvt_pk_bf16_f32 v80, v48, v49
    v_cvt_pk_bf16_f32 v81, v50, v51
    s_nop 1
    v_cvt_pk_bf16_f32 v82, v52, v53
    v_cvt_pk_bf16_f32 v83, v54, v55
    v_cvt_pk_bf16_f32 v84, v56, v57
    v_cvt_pk_bf16_f32 v85, v58, v59
    v_cvt_pk_bf16_f32 v86, v60, v61
    v_cvt_pk_bf16_f32 v87, v62, v63
    v_permlane32_swap_b32 v80, v82
    v_permlane32_swap_b32 v81, v83
    v_permlane32_swap_b32 v84, v86
    v_permlane32_swap_b32 v85, v87
    v_cmp_gt_u32 vcc, s89, v3
    s_cbranch_vccz L_bp_128
L_poll_129:
    buffer_load_dword v3, v7, s[8:11], s82 offen offset:0 sc1
    s_waitcnt vmcnt(0)
    v_cmp_gt_u32 vcc, s89, v3
    s_cbranch_vccz L_pok_130
    s_sleep 1
    s_sub_u32 s6, s6, 1
    s_cbranch_scc0 L_poll_129
    s_branch L_fail
L_pok_130:
L_bp_128:
    s_cmp_eq_u32 s7, 0
    s_cbranch_scc1 L_sl_131
    buffer_store_dwordx4 v[80:83], v9, s[8:11], s88 offen offset:0
    buffer_store_dwordx4 v[84:87], v9, s[8:11], s88 offen offset:1024
    s_branch L_sd_132
L_sl_131:
    buffer_store_dwordx4 v[80:83], v9, s[8:11], s88 offen offset:0 sc1
    buffer_store_dwordx4 v[84:87], v9, s[8:11], s88 offen offset:1024 sc1
L_sd_132:
    v_cvt_pk_bf16_f32 v88, v64, v65
    v_cvt_pk_bf16_f32 v89, v66, v67
    v_cvt_pk_bf16_f32 v90, v68, v69
    v_cvt_pk_bf16_f32 v91, v70, v71
    v_cvt_pk_bf16_f32 v92, v72, v73
    v_cvt_pk_bf16_f32 v93, v74, v75
    v_cvt_pk_bf16_f32 v94, v76, v77
    v_cvt_pk_bf16_f32 v95, v78, v79
    v_permlane32_swap_b32 v88, v90
    v_permlane32_swap_b32 v89, v91
    v_permlane32_swap_b32 v92, v94
    v_permlane32_swap_b32 v93, v95
    s_cmp_eq_u32 s7, 0
    s_cbranch_scc1 L_sl_133
    buffer_store_dwordx4 v[88:91], v9, s[8:11], s88 offen offset:2048
    buffer_store_dwordx4 v[92:95], v9, s[8:11], s88 offen offset:3072
    s_branch L_sd_134
L_sl_133:
    buffer_store_dwordx4 v[88:91], v9, s[8:11], s88 offen offset:2048 sc1
    buffer_store_dwordx4 v[92:95], v9, s[8:11], s88 offen offset:3072 sc1
L_sd_134:
    s_add_u32 s75, s75, 1
    s_waitcnt vmcnt(0)
    v_mov_b32 v4, s75
    s_mov_b64 exec, 1
    s_cmp_eq_u32 s7, 0
    s_cbranch_scc1 L_sl_135
    buffer_store_dword v4, off, s[8:11], s65
    s_branch L_sd_136
L_sl_135:
    buffer_store_dword v4, off, s[8:11], s65 sc1
L_sd_136:
    s_mov_b64 exec, -1
    s_barrier
    s_cmp_lt_u32 s75, 7
    s_cbranch_scc1 L_qkv_a_q
    s_mov_b32 s87, 0
L_qkv_b_q:
    s_add_u32 s80, s76, 1
    s_mul_i32 s81, s76, 40960
    s_add_u32 s81, s81, 14680064
    s_cmp_eq_u32 s87, 0
    s_cbranch_scc1 L_h0_140
    v_cmp_gt_u32 vcc, s89, v3
    s_cbranch_vccz L_bp_142
L_poll_143:
    buffer_load_dword v3, v7, s[8:11], s82 offen offset:32 sc1
    s_waitcnt vmcnt(0)
    v_cmp_gt_u32 vcc, s89, v3
    s_cbranch_vccz L_pok_144
    s_sleep 1
    s_sub_u32 s6, s6, 1
    s_cbranch_scc0 L_poll_143
    s_branch L_fail
L_pok_144:
L_bp_142:
    ds_read_b128 v[96:99], v10 offset:0
    ds_read_b128 v[100:103], v12 offset:0
    ds_read_b128 v[104:107], v11 offset:0
    ds_read_b128 v[108:111], v13 offset:0
    ds_read_b128 v[112:115], v10 offset:1024
    ds_read_b128 v[116:119], v12 offset:1024
    s_waitcnt lgkmcnt(5)
    v_mfma_f32_16x16x32_bf16 v[16:19], a[0:3], v[96:99], 0
    v_mfma_f32_16x16x32_bf16 v[24:27], a[80:83], v[96:99], 0
    v_mfma_f32_16x16x32_bf16 v[32:35], a[160:163], v[96:99], 0
    v_mfma_f32_16x16x32_bf16 v[40:43], a[240:243], v[96:99], 0
    v_cvt_pk_bf16_f32 v80, v48, v49
    v_cvt_pk_bf16_f32 v82, v52, v53
    s_waitcnt lgkmcnt(4)
    v_mfma_f32_16x16x32_bf16 v[20:23], a[0:3], v[100:103], 0
    v_mfma_f32_16x16x32_bf16 v[28:31], a[80:83], v[100:103], 0
    v_mfma_f32_16x16x32_bf16 v[36:39], a[160:163], v[100:103], 0
    v_mfma_f32_16x16x32_bf16 v[44:47], a[240:243], v[100:103], 0
    v_cvt_pk_bf16_f32 v81, v50, v51
    v_cvt_pk_bf16_f32 v83, v54, v55
    ds_read_b128 v[120:123], v11 offset:1024
    ds_read_b128 v[124:127], v13 offset:1024
    s_waitcnt lgkmcnt(5)
    v_mfma_f32_16x16x32_bf16 v[16:19], a[4:7], v[104:107], v[16:19]
    v_mfma_f32_16x16x32_bf16 v[24:27], a[84:87], v[104:107], v[24:27]
    v_mfma_f32_16x16x32_bf16 v[32:35], a[164:167], v[104:107], v[32:35]
    v_mfma_f32_16x16x32_bf16 v[40:43], a[244:247], v[104:107], v[40:43]
    v_permlane32_swap_b32 v80, v82
    v_permlane32_swap_b32 v81, v83
    s_waitcnt lgkmcnt(4)
    v_mfma_f32_16x16x32_bf16 v[20:23], a[4:7], v[108:111], v[20:23]
    v_mfma_f32_16x16x32_bf16 v[28:31], a[84:87], v[108:111], v[28:31]
    v_mfma_f32_16x16x32_bf16 v[36:39], a[164:167], v[108:111], v[36:39]
    v_mfma_f32_16x16x32_bf16 v[44:47], a[244:247], v[108:111], v[44:47]
    buffer_store_dwordx4 v[80:83], v9, s[8:11], s88 offen offset:0
    v_cvt_pk_bf16_f32 v84, v56, v57
    v_cvt_pk_bf16_f32 v86, v60, v61
    ds_read_b128 v[96:99], v10 offset:2048
    ds_read_b128 v[100:103], v12 offset:2048
    s_waitcnt lgkmcnt(5)
    v_mfma_f32_16x16x32_bf16 v[16:19], a[8:11], v[112:115], v[16:19]
    v_mfma_f32_16x16x32_bf16 v[24:27], a[88:91], v[112:115], v[24:27]
    v_mfma_f32_16x16x32_bf16 v[32:35], a[168:171], v[112:115], v[32:35]
    v_mfma_f32_16x16x32_bf16 v[40:43], a[248:251], v[112:115], v[40:43]
    v_cvt_pk_bf16_f32 v85, v58, v59
    v_cvt_pk_bf16_f32 v87, v62, v63
    s_waitcnt lgkmcnt(4)
    v_mfma_f32_16x16x32_bf16 v[20:23], a[8:11], v[116:119], v[20:23]
    v_mfma_f32_16x16x32_bf16 v[28:31], a[88:91], v[116:119], v[28:31]
    v_mfma_f32_16x16x32_bf16 v[36:39], a[168:171], v[116:119], v[36:39]
    v_mfma_f32_16x16x32_bf16 v[44:47], a[248:251], v[116:119], v[44:47]
    v_permlane32_swap_b32 v84, v86
    v_permlane32_swap_b32 v85, v87
    ds_read_b128 v[104:107], v11 offset:2048
    ds_read_b128 v[108:111], v13 offset:2048
    s_waitcnt lgkmcnt(5)
    v_mfma_f32_16x16x32_bf16 v[16:19], a[12:15], v[120:123], v[16:19]
    v_mfma_f32_16x16x32_bf16 v[24:27], a[92:95], v[120:123], v[24:27]
    v_mfma_f32_16x16x32_bf16 v[32:35], a[172:175], v[120:123], v[32:35]
    v_mfma_f32_16x16x32_bf16 v[40:43], a[252:255], v[120:123], v[40:43]
    buffer_store_dwordx4 v[84:87], v9, s[8:11], s88 offen offset:1024
    v_cvt_pk_bf16_f32 v88, v64, v65
    v_cvt_pk_bf16_f32 v90, v68, v69
    s_waitcnt lgkmcnt(4)
    v_mfma_f32_16x16x32_bf16 v[20:23], a[12:15], v[124:127], v[20:23]
    v_mfma_f32_16x16x32_bf16 v[28:31], a[92:95], v[124:127], v[28:31]
    v_mfma_f32_16x16x32_bf16 v[36:39], a[172:175], v[124:127], v[36:39]
    v_mfma_f32_16x16x32_bf16 v[44:47], a[252:255], v[124:127], v[44:47]
    v_cvt_pk_bf16_f32 v89, v66, v67
    v_cvt_pk_bf16_f32 v91, v70, v71
    ds_read_b128 v[112:115], v10 offset:3072
    ds_read_b128 v[116:119], v12 offset:3072
    s_waitcnt lgkmcnt(5)
    v_mfma_f32_16x16x32_bf16 v[16:19], a[16:19], v[96:99], v[16:19]
    v_mfma_f32_16x16x32_bf16 v[24:27], a[96:99], v[96:99], v[24:27]
    v_mfma_f32_16x16x32_bf16 v[32:35], a[176:179], v[96:99], v[32:35]
    v_mfma_f32_16x16x32_bf16 v[40:43], v[192:195], v[96:99], v[40:43]
    v_permlane32_swap_b32 v88, v90
    v_permlane32_swap_b32 v89, v91
    s_waitcnt lgkmcnt(4)
    v_mfma_f32_16x16x32_bf16 v[20:23], a[16:19], v[100:103], v[20:23]
    v_mfma_f32_16x16x32_bf16 v[28:31], a[96:99], v[100:103], v[28:31]
    v_mfma_f32_16x16x32_bf16 v[36:39], a[176:179], v[100:103], v[36:39]
    v_mfma_f32_16x16x32_bf16 v[44:47], v[192:195], v[100:103], v[44:47]
    buffer_store_dwordx4 v[88:91], v9, s[8:11], s88 offen offset:2048
    v_cvt_pk_bf16_f32 v92, v72, v73
    v_cvt_pk_bf16_f32 v94, v76, v77
    ds_read_b128 v[120:123], v11 offset:3072
    ds_read_b128 v[124:127], v13 offset:3072
    s_waitcnt lgkmcnt(5)
    v_mfma_f32_16x16x32_bf16 v[16:19], a[20:23], v[104:107], v[16:19]
    v_mfma_f32_16x16x32_bf16 v[24:27], a[100:103], v[104:107], v[24:27]
    v_mfma_f32_16x16x32_bf16 v[32:35], a[180:183], v[104:107], v[32:35]
    v_mfma_f32_16x16x32_bf16 v[40:43], v[196:199], v[104:107], v[40:43]
    v_cvt_pk_bf16_f32 v93, v74, v75
    v_cvt_pk_bf16_f32 v95, v78, v79
    s_waitcnt lgkmcnt(4)
    v_mfma_f32_16x16x32_bf16 v[20:23], a[20:23], v[108:111], v[20:23]
    v_mfma_f32_16x16x32_bf16 v[28:31], a[100:103], v[108:111], v[28:31]
    v_mfma_f32_16x16x32_bf16 v[36:39], a[180:183], v[108:111], v[36:39]
    v_mfma_f32_16x16x32_bf16 v[44:47], v[196:199], v[108:111], v[44:47]
    v_permlane32_swap_b32 v92, v94
    v_permlane32_swap_b32 v93, v95
    ds_read_b128 v[96:99], v10 offset:4096
    ds_read_b128 v[100:103], v12 offset:4096
    s_waitcnt lgkmcnt(5)
    v_mfma_f32_16x16x32_bf16 v[16:19], a[24:27], v[112:115], v[16:19]
    v_mfma_f32_16x16x32_bf16 v[24:27], a[104:107], v[112:115], v[24:27]
    v_mfma_f32_16x16x32_bf16 v[32:35], a[184:187], v[112:115], v[32:35]
    v_mfma_f32_16x16x32_bf16 v[40:43], v[200:203], v[112:115], v[40:43]
    buffer_store_dwordx4 v[92:95], v9, s[8:11], s88 offen offset:3072
    s_waitcnt lgkmcnt(4)
    v_mfma_f32_16x16x32_bf16 v[20:23], a[24:27], v[116:119], v[20:23]
    v_mfma_f32_16x16x32_bf16 v[28:31], a[104:107], v[116:119], v[28:31]
    v_mfma_f32_16x16x32_bf16 v[36:39], a[184:187], v[116:119], v[36:39]
    v_mfma_f32_16x16x32_bf16 v[44:47], v[200:203], v[116:119], v[44:47]
    buffer_load_dword v5, v6, s[8:11], s84 offen sc1
    ds_read_b128 v[104:107], v11 offset:4096
    ds_read_b128 v[108:111], v13 offset:4096
    s_waitcnt lgkmcnt(5)
    v_mfma_f32_16x16x32_bf16 v[16:19], a[28:31], v[120:123], v[16:19]
    v_mfma_f32_16x16x32_bf16 v[24:27], a[108:111], v[120:123], v[24:27]
    v_mfma_f32_16x16x32_bf16 v[32:35], a[188:191], v[120:123], v[32:35]
    v_mfma_f32_16x16x32_bf16 v[40:43], v[204:207], v[120:123], v[40:43]
    s_waitcnt lgkmcnt(4)
    v_mfma_f32_16x16x32_bf16 v[20:23], a[28:31], v[124:127], v[20:23]
    v_mfma_f32_16x16x32_bf16 v[28:31], a[108:111], v[124:127], v[28:31]
    v_mfma_f32_16x16x32_bf16 v[36:39], a[188:191], v[124:127], v[36:39]
    v_mfma_f32_16x16x32_bf16 v[44:47], v[204:207], v[124:127], v[44:47]
    ds_read_b128 v[112:115], v10 offset:5120
    ds_read_b128 v[116:119], v12 offset:5120
    s_waitcnt lgkmcnt(5)
    v_mfma_f32_16x16x32_bf16 v[16:19], a[32:35], v[96:99], v[16:19]
    v_mfma_f32_16x16x32_bf16 v[24:27], a[112:115], v[96:99], v[24:27]
    v_mfma_f32_16x16x32_bf16 v[32:35], a[192:195], v[96:99], v[32:35]
    v_mfma_f32_16x16x32_bf16 v[40:43], v[208:211], v[96:99], v[40:43]
    s_waitcnt lgkmcnt(4)
    v_mfma_f32_16x16x32_bf16 v[20:23], a[32:35], v[100:103], v[20:23]
    v_mfma_f32_16x16x32_bf16 v[28:31], a[112:115], v[100:103], v[28:31]
    v_mfma_f32_16x16x32_bf16 v[36:39], a[192:195], v[100:103], v[36:39]
    v_mfma_f32_16x16x32_bf16 v[44:47], v[208:211], v[100:103], v[44:47]
    ds_read_b128 v[120:123], v11 offset:5120
    ds_read_b128 v[124:127], v13 offset:5120
    s_waitcnt lgkmcnt(5)
    v_mfma_f32_16x16x32_bf16 v[16:19], a[36:39], v[104:107], v[16:19]
    v_mfma_f32_16x16x32_bf16 v[24:27], a[116:119], v[104:107], v[24:27]
    v_mfma_f32_16x16x32_bf16 v[32:35], a[196:199], v[104:107], v[32:35]
    v_mfma_f32_16x16x32_bf16 v[40:43], v[212:215], v[104:107], v[40:43]
    s_waitcnt lgkmcnt(4)
    v_mfma_f32_16x16x32_bf16 v[20:23], a[36:39], v[108:111], v[20:23]
    v_mfma_f32_16x16x32_bf16 v[28:31], a[116:119], v[108:111], v[28:31]
    v_mfma_f32_16x16x32_bf16 v[36:39], a[196:199], v[108:111], v[36:39]
    v_mfma_f32_16x16x32_bf16 v[44:47], v[212:215], v[108:111], v[44:47]
    s_branch L_h1_141
L_h0_140:
    ds_read_b128 v[96:99], v10 offset:0
    ds_read_b128 v[100:103], v12 offset:0
    ds_read_b128 v[104:107], v11 offset:0
    ds_read_b128 v[108:111], v13 offset:0
    ds_read_b128 v[112:115], v10 offset:1024
    ds_read_b128 v[116:119], v12 offset:1024
    s_waitcnt lgkmcnt(5)
    v_mfma_f32_16x16x32_bf16 v[16:19], a[0:3], v[96:99], 0
    v_mfma_f32_16x16x32_bf16 v[24:27], a[80:83], v[96:99], 0
    v_mfma_f32_16x16x32_bf16 v[32:35], a[160:163], v[96:99], 0
    v_mfma_f32_16x16x32_bf16 v[40:43], a[240:243], v[96:99], 0
    s_waitcnt lgkmcnt(4)
    v_mfma_f32_16x16x32_bf16 v[20:23], a[0:3], v[100:103], 0
    v_mfma_f32_16x16x32_bf16 v[28:31], a[80:83], v[100:103], 0
    v_mfma_f32_16x16x32_bf16 v[36:39], a[160:163], v[100:103], 0
    v_mfma_f32_16x16x32_bf16 v[44:47], a[240:243], v[100:103], 0
    ds_read_b128 v[120:123], v11 offset:1024
    ds_read_b128 v[124:127], v13 offset:1024
    s_waitcnt lgkmcnt(5)
    v_mfma_f32_16x16x32_bf16 v[16:19], a[4:7], v[104:107], v[16:19]
    v_mfma_f32_16x16x32_bf16 v[24:27], a[84:87], v[104:107], v[24:27]
    v_mfma_f32_16x16x32_bf16 v[32:35], a[164:167], v[104:107], v[32:35]
    v_mfma_f32_16x16x32_bf16 v[40:43], a[244:247], v[104:107], v[40:43]
    s_waitcnt lgkmcnt(4)
    v_mfma_f32_16x16x32_bf16 v[20:23], a[4:7], v[108:111], v[20:23]
    v_mfma_f32_16x16x32_bf16 v[28:31], a[84:87], v[108:111], v[28:31]
    v_mfma_f32_16x16x32_bf16 v[36:39], a[164:167], v[108:111], v[36:39]
    v_mfma_f32_16x16x32_bf16 v[44:47], a[244:247], v[108:111], v[44:47]
    ds_read_b128 v[96:99], v10 offset:2048
    ds_read_b128 v[100:103], v12 offset:2048
    s_waitcnt lgkmcnt(5)
    v_mfma_f32_16x16x32_bf16 v[16:19], a[8:11], v[112:115], v[16:19]
    v_mfma_f32_16x16x32_bf16 v[24:27], a[88:91], v[112:115], v[24:27]
    v_mfma_f32_16x16x32_bf16 v[32:35], a[168:171], v[112:115], v[32:35]
    v_mfma_f32_16x16x32_bf16 v[40:43], a[248:251], v[112:115], v[40:43]
    s_waitcnt lgkmcnt(4)
    v_mfma_f32_16x16x32_bf16 v[20:23], a[8:11], v[116:119], v[20:23]
    v_mfma_f32_16x16x32_bf16 v[28:31], a[88:91], v[116:119], v[28:31]
    v_mfma_f32_16x16x32_bf16 v[36:39], a[168:171], v[116:119], v[36:39]
    v_mfma_f32_16x16x32_bf16 v[44:47], a[248:251], v[116:119], v[44:47]
    ds_read_b128 v[104:107], v11 offset:2048
    ds_read_b128 v[108:111], v13 offset:2048
    s_waitcnt lgkmcnt(5)
    v_mfma_f32_16x16x32_bf16 v[16:19], a[12:15], v[120:123], v[16:19]
    v_mfma_f32_16x16x32_bf16 v[24:27], a[92:95], v[120:123], v[24:27]
    v_mfma_f32_16x16x32_bf16 v[32:35], a[172:175], v[120:123], v[32:35]
    v_mfma_f32_16x16x32_bf16 v[40:43], a[252:255], v[120:123], v[40:43]
    s_waitcnt lgkmcnt(4)
    v_mfma_f32_16x16x32_bf16 v[20:23], a[12:15], v[124:127], v[20:23]
    v_mfma_f32_16x16x32_bf16 v[28:31], a[92:95], v[124:127], v[28:31]
    v_mfma_f32_16x16x32_bf16 v[36:39], a[172:175], v[124:127], v[36:39]
    v_mfma_f32_16x16x32_bf16 v[44:47], a[252:255], v[124:127], v[44:47]
    ds_read_b128 v[112:115], v10 offset:3072
    ds_read_b128 v[116:119], v12 offset:3072
    s_waitcnt lgkmcnt(5)
    v_mfma_f32_16x16x32_bf16 v[16:19], a[16:19], v[96:99], v[16:19]
    v_mfma_f32_16x16x32_bf16 v[24:27], a[96:99], v[96:99], v[24:27]
    v_mfma_f32_16x16x32_bf16 v[32:35], a[176:179], v[96:99], v[32:35]
    v_mfma_f32_16x16x32_bf16 v[40:43], v[192:195], v[96:99], v[40:43]
    s_waitcnt lgkmcnt(4)
    v_mfma_f32_16x16x32_bf16 v[20:23], a[16:19], v[100:103], v[20:23]
    v_mfma_f32_16x16x32_bf16 v[28:31], a[96:99], v[100:103], v[28:31]
    v_mfma_f32_16x16x32_bf16 v[36:39], a[176:179], v[100:103], v[36:39]
    v_mfma_f32_16x16x32_bf16 v[44:47], v[192:195], v[100:103], v[44:47]
    ds_read_b128 v[120:123], v11 offset:3072
    ds_read_b128 v[124:127], v13 offset:3072
    s_waitcnt lgkmcnt(5)
    v_mfma_f32_16x16x32_bf16 v[16:19], a[20:23], v[104:107], v[16:19]
    v_mfma_f32_16x16x32_bf16 v[24:27], a[100:103], v[104:107], v[24:27]
    v_mfma_f32_16x16x32_bf16 v[32:35], a[180:183], v[104:107], v[32:35]
    v_mfma_f32_16x16x32_bf16 v[40:43], v[196:199], v[104:107], v[40:43]
    s_waitcnt lgkmcnt(4)
    v_mfma_f32_16x16x32_bf16 v[20:23], a[20:23], v[108:111], v[20:23]
    v_mfma_f32_16x16x32_bf16 v[28:31], a[100:103], v[108:111], v[28:31]
    v_mfma_f32_16x16x32_bf16 v[36:39], a[180:183], v[108:111], v[36:39]
    v_mfma_f32_16x16x32_bf16 v[44:47], v[196:199], v[108:111], v[44:47]
    ds_read_b128 v[96:99], v10 offset:4096
    ds_read_b128 v[100:103], v12 offset:4096
    s_waitcnt lgkmcnt(5)
    v_mfma_f32_16x16x32_bf16 v[16:19], a[24:27], v[112:115], v[16:19]
    v_mfma_f32_16x16x32_bf16 v[24:27], a[104:107], v[112:115], v[24:27]
    v_mfma_f32_16x16x32_bf16 v[32:35], a[184:187], v[112:115], v[32:35]
    v_mfma_f32_16x16x32_bf16 v[40:43], v[200:203], v[112:115], v[40:43]
    s_waitcnt lgkmcnt(4)
    v_mfma_f32_16x16x32_bf16 v[20:23], a[24:27], v[116:119], v[20:23]
    v_mfma_f32_16x16x32_bf16 v[28:31], a[104:107], v[116:119], v[28:31]
    v_mfma_f32_16x16x32_bf16 v[36:39], a[184:187], v[116:119], v[36:39]
    v_mfma_f32_16x16x32_bf16 v[44:47], v[200:203], v[116:119], v[44:47]
    buffer_load_dword v5, v6, s[8:11], s84 offen sc1
    ds_read_b128 v[104:107], v11 offset:4096
    ds_read_b128 v[108:111], v13 offset:4096
    s_waitcnt lgkmcnt(5)
    v_mfma_f32_16x16x32_bf16 v[16:19], a[28:31], v[120:123], v[16:19]
    v_mfma_f32_16x16x32_bf16 v[24:27], a[108:111], v[120:123], v[24:27]
    v_mfma_f32_16x16x32_bf16 v[32:35], a[188:191], v[120:123], v[32:35]
    v_mfma_f32_16x16x32_bf16 v[40:43], v[204:207], v[120:123], v[40:43]
    s_waitcnt lgkmcnt(4)
    v_mfma_f32_16x16x32_bf16 v[20:23], a[28:31], v[124:127], v[20:23]
    v_mfma_f32_16x16x32_bf16 v[28:31], a[108:111], v[124:127], v[28:31]
    v_mfma_f32_16x16x32_bf16 v[36:39], a[188:191], v[124:127], v[36:39]
    v_mfma_f32_16x16x32_bf16 v[44:47], v[204:207], v[124:127], v[44:47]
    ds_read_b128 v[112:115], v10 offset:5120
    ds_read_b128 v[116:119], v12 offset:5120
    s_waitcnt lgkmcnt(5)
    v_mfma_f32_16x16x32_bf16 v[16:19], a[32:35], v[96:99], v[16:19]
    v_mfma_f32_16x16x32_bf16 v[24:27], a[112:115], v[96:99], v[24:27]
    v_mfma_f32_16x16x32_bf16 v[32:35], a[192:195], v[96:99], v[32:35]
    v_mfma_f32_16x16x32_bf16 v[40:43], v[208:211], v[96:99], v[40:43]
    s_waitcnt lgkmcnt(4)
    v_mfma_f32_16x16x32_bf16 v[20:23], a[32:35], v[100:103], v[20:23]
    v_mfma_f32_16x16x32_bf16 v[28:31], a[112:115], v[100:103], v[28:31]
    v_mfma_f32_16x16x32_bf16 v[36:39], a[192:195], v[100:103], v[36:39]
    v_mfma_f32_16x16x32_bf16 v[44:47], v[208:211], v[100:103], v[44:47]
    ds_read_b128 v[120:123], v11 offset:5120
    ds_read_b128 v[124:127], v13 offset:5120
    s_waitcnt lgkmcnt(5)
    v_mfma_f32_16x16x32_bf16 v[16:19], a[36:39], v[104:107], v[16:19]
    v_mfma_f32_16x16x32_bf16 v[24:27], a[116:119], v[104:107], v[24:27]
    v_mfma_f32_16x16x32_bf16 v[32:35], a[196:199], v[104:107], v[32:35]
    v_mfma_f32_16x16x32_bf16 v[40:43], v[212:215], v[104:107], v[40:43]
    s_waitcnt lgkmcnt(4)
    v_mfma_f32_16x16x32_bf16 v[20:23], a[36:39], v[108:111], v[20:23]
    v_mfma_f32_16x16x32_bf16 v[28:31], a[116:119], v[108:111], v[28:31]
    v_mfma_f32_16x16x32_bf16 v[36:39], a[196:199], v[108:111], v[36:39]
    v_mfma_f32_16x16x32_bf16 v[44:47], v[212:215], v[108:111], v[44:47]
L_h1_141:
    s_waitcnt vmcnt(0)
    v_mov_b32 v4, s76
    s_mov_b64 exec, 1
    s_cmp_eq_u32 s7, 0
    s_cbranch_scc1 L_sl_145
    buffer_store_dword v4, off, s[8:11], s66
    s_branch L_sd_146
L_sl_145:
    buffer_store_dword v4, off, s[8:11], s66 sc1
L_sd_146:
    s_mov_b64 exec, -1
    s_and_b32 s88, s75, 3
    s_mul_i32 s88, s88, 147456
    s_add_u32 s88, s88, s72
    s_sub_u32 s89, s75, 3
    s_cselect_b32 s89, 0, s89
    buffer_load_dword v3, v7, s[8:11], s82 offen offset:0 sc1
    v_cmp_gt_u32 vcc, s80, v5
    s_cbranch_vccz L_qa_147
    ds_read_b128 v[96:99], v10 offset:6144
    ds_read_b128 v[100:103], v12 offset:6144
    s_waitcnt lgkmcnt(5)
    v_mfma_f32_16x16x32_bf16 v[16:19], a[40:43], v[112:115], v[16:19]
    v_mfma_f32_16x16x32_bf16 v[24:27], a[120:123], v[112:115], v[24:27]
    v_mfma_f32_16x16x32_bf16 v[32:35], a[200:203], v[112:115], v[32:35]
    v_mfma_f32_16x16x32_bf16 v[40:43], v[216:219], v[112:115], v[40:43]
    s_waitcnt lgkmcnt(4)
    v_mfma_f32_16x16x32_bf16 v[20:23], a[40:43], v[116:119], v[20:23]
    v_mfma_f32_16x16x32_bf16 v[28:31], a[120:123], v[116:119], v[28:31]
    v_mfma_f32_16x16x32_bf16 v[36:39], a[200:203], v[116:119], v[36:39]
    v_mfma_f32_16x16x32_bf16 v[44:47], v[216:219], v[116:119], v[44:47]
    ds_read_b128 v[104:107], v11 offset:6144
    ds_read_b128 v[108:111], v13 offset:6144
    s_waitcnt lgkmcnt(5)
    v_mfma_f32_16x16x32_bf16 v[16:19], a[44:47], v[120:123], v[16:19]
    v_mfma_f32_16x16x32_bf16 v[24:27], a[124:127], v[120:123], v[24:27]
    v_mfma_f32_16x16x32_bf16 v[32:35], a[204:207], v[120:123], v[32:35]
    v_mfma_f32_16x16x32_bf16 v[40:43], v[220:223], v[120:123], v[40:43]
    s_waitcnt lgkmcnt(4)
    v_mfma_f32_16x16x32_bf16 v[20:23], a[44:47], v[124:127], v[20:23]
    v_mfma_f32_16x16x32_bf16 v[28:31], a[124:127], v[124:127], v[28:31]
    v_mfma_f32_16x16x32_bf16 v[36:39], a[204:207], v[124:127], v[36:39]
    v_mfma_f32_16x16x32_bf16 v[44:47], v[220:223], v[124:127], v[44:47]
    buffer_load_dword v5, v6, s[8:11], s84 offen sc1
    ds_read_b128 v[112:115], v10 offset:7168
    ds_read_b128 v[116:119], v12 offset:7168
    s_waitcnt lgkmcnt(5)
    v_mfma_f32_16x16x32_bf16 v[16:19], a[48:51], v[96:99], v[16:19]
    v_mfma_f32_16x16x32_bf16 v[24:27], a[128:131], v[96:99], v[24:27]
    v_mfma_f32_16x16x32_bf16 v[32:35], a[208:211], v[96:99], v[32:35]
    v_mfma_f32_16x16x32_bf16 v[40:43], v[224:227], v[96:99], v[40:43]
    s_waitcnt lgkmcnt(4)
    v_mfma_f32_16x16x32_bf16 v[20:23], a[48:51], v[100:103], v[20:23]
    v_mfma_f32_16x16x32_bf16 v[28:31], a[128:131], v[100:103], v[28:31]
    v_mfma_f32_16x16x32_bf16 v[36:39], a[208:211], v[100:103], v[36:39]
    v_mfma_f32_16x16x32_bf16 v[44:47], v[224:227], v[100:103], v[44:47]
    ds_read_b128 v[120:123], v11 offset:7168
    ds_read_b128 v[124:127], v13 offset:7168
    s_waitcnt lgkmcnt(5)
    v_mfma_f32_16x16x32_bf16 v[16:19], a[52:55], v[104:107], v[16:19]
    v_mfma_f32_16x16x32_bf16 v[24:27], a[132:135], v[104:107], v[24:27]
    v_mfma_f32_16x16x32_bf16 v[32:35], a[212:215], v[104:107], v[32:35]
    v_mfma_f32_16x16x32_bf16 v[40:43], v[228:231], v[104:107], v[40:43]
    s_waitcnt lgkmcnt(4)
    v_mfma_f32_16x16x32_bf16 v[20:23], a[52:55], v[108:111], v[20:23]
    v_mfma_f32_16x16x32_bf16 v[28:31], a[132:135], v[108:111], v[28:31]
    v_mfma_f32_16x16x32_bf16 v[36:39], a[212:215], v[108:111], v[36:39]
    v_mfma_f32_16x16x32_bf16 v[44:47], v[228:231], v[108:111], v[44:47]
    ds_read_b128 v[96:99], v10 offset:8192
    ds_read_b128 v[100:103], v12 offset:8192
    s_waitcnt lgkmcnt(5)
    v_mfma_f32_16x16x32_bf16 v[16:19], a[56:59], v[112:115], v[16:19]
    v_mfma_f32_16x16x32_bf16 v[24:27], a[136:139], v[112:115], v[24:27]
    v_mfma_f32_16x16x32_bf16 v[32:35], a[216:219], v[112:115], v[32:35]
    v_mfma_f32_16x16x32_bf16 v[40:43], v[232:235], v[112:115], v[40:43]
    s_waitcnt lgkmcnt(4)
    v_mfma_f32_16x16x32_bf16 v[20:23], a[56:59], v[116:119], v[20:23]
    v_mfma_f32_16x16x32_bf16 v[28:31], a[136:139], v[116:119], v[28:31]
    v_mfma_f32_16x16x32_bf16 v[36:39], a[216:219], v[116:119], v[36:39]
    v_mfma_f32_16x16x32_bf16 v[44:47], v[232:235], v[116:119], v[44:47]
    s_waitcnt vmcnt(0)
    v_cmp_gt_u32 vcc, s80, v5
    s_cbranch_vccz L_qb_148
    ds_read_b128 v[104:107], v11 offset:8192
    ds_read_b128 v[108:111], v13 offset:8192
    s_waitcnt lgkmcnt(5)
    v_mfma_f32_16x16x32_bf16 v[16:19], a[60:63], v[120:123], v[16:19]
    v_mfma_f32_16x16x32_bf16 v[24:27], a[140:143], v[120:123], v[24:27]
    v_mfma_f32_16x16x32_bf16 v[32:35], a[220:223], v[120:123], v[32:35]
    v_mfma_f32_16x16x32_bf16 v[40:43], v[236:239], v[120:123], v[40:43]
    s_waitcnt lgkmcnt(4)
    v_mfma_f32_16x16x32_bf16 v[20:23], a[60:63], v[124:127], v[20:23]
    v_mfma_f32_16x16x32_bf16 v[28:31], a[140:143], v[124:127], v[28:31]
    v_mfma_f32_16x16x32_bf16 v[36:39], a[220:223], v[124:127], v[36:39]
    v_mfma_f32_16x16x32_bf16 v[44:47], v[236:239], v[124:127], v[44:47]
    ds_read_b128 v[112:115], v10 offset:9216
    ds_read_b128 v[116:119], v12 offset:9216
    s_waitcnt lgkmcnt(5)
    v_mfma_f32_16x16x32_bf16 v[16:19], a[64:67], v[96:99], v[16:19]
    v_mfma_f32_16x16x32_bf16 v[24:27], a[144:147], v[96:99], v[24:27]
    v_mfma_f32_16x16x32_bf16 v[32:35], a[224:227], v[96:99], v[32:35]
    v_mfma_f32_16x16x32_bf16 v[40:43], v[240:243], v[96:99], v[40:43]
    s_waitcnt lgkmcnt(4)
    v_mfma_f32_16x16x32_bf16 v[20:23], a[64:67], v[100:103], v[20:23]
    v_mfma_f32_16x16x32_bf16 v[28:31], a[144:147], v[100:103], v[28:31]
    v_mfma_f32_16x16x32_bf16 v[36:39], a[224:227], v[100:103], v[36:39]
    v_mfma_f32_16x16x32_bf16 v[44:47], v[240:243], v[100:103], v[44:47]
    ds_read_b128 v[120:123], v11 offset:9216
    ds_read_b128 v[124:127], v13 offset:9216
    s_waitcnt lgkmcnt(5)
    v_mfma_f32_16x16x32_bf16 v[16:19], a[68:71], v[104:107], v[16:19]
    v_mfma_f32_16x16x32_bf16 v[24:27], a[148:151], v[104:107], v[24:27]
    v_mfma_f32_16x16x32_bf16 v[32:35], a[228:231], v[104:107], v[32:35]
    v_mfma_f32_16x16x32_bf16 v[40:43], v[244:247], v[104:107], v[40:43]
    buffer_load_dword v5, v6, s[8:11], s84 offen sc1
    s_waitcnt lgkmcnt(4)
    v_mfma_f32_16x16x32_bf16 v[20:23], a[68:71], v[108:111], v[20:23]
    v_mfma_f32_16x16x32_bf16 v[28:31], a[148:151], v[108:111], v[28:31]
    v_mfma_f32_16x16x32_bf16 v[36:39], a[228:231], v[108:111], v[36:39]
    v_mfma_f32_16x16x32_bf16 v[44:47], v[244:247], v[108:111], v[44:47]
    s_waitcnt lgkmcnt(3)
    v_mfma_f32_16x16x32_bf16 v[16:19], a[72:75], v[112:115], v[16:19]
    v_mfma_f32_16x16x32_bf16 v[24:27], a[152:155], v[112:115], v[24:27]
    v_mfma_f32_16x16x32_bf16 v[32:35], a[232:235], v[112:115], v[32:35]
    v_mfma_f32_16x16x32_bf16 v[40:43], v[248:251], v[112:115], v[40:43]
    s_waitcnt lgkmcnt(2)
    v_mfma_f32_16x16x32_bf16 v[20:23], a[72:75], v[116:119], v[20:23]
    v_mfma_f32_16x16x32_bf16 v[28:31], a[152:155], v[116:119], v[28:31]
    v_mfma_f32_16x16x32_bf16 v[36:39], a[232:235], v[116:119], v[36:39]
    v_mfma_f32_16x16x32_bf16 v[44:47], v[248:251], v[116:119], v[44:47]
    s_waitcnt lgkmcnt(1)
    v_mfma_f32_16x16x32_bf16 v[16:19], a[76:79], v[120:123], v[16:19]
    v_mfma_f32_16x16x32_bf16 v[24:27], a[156:159], v[120:123], v[24:27]
    v_mfma_f32_16x16x32_bf16 v[32:35], a[236:239], v[120:123], v[32:35]
    v_mfma_f32_16x16x32_bf16 v[40:43], v[252:255], v[120:123], v[40:43]
    s_waitcnt lgkmcnt(0)
    v_mfma_f32_16x16x32_bf16 v[20:23], a[76:79], v[124:127], v[20:23]
    v_mfma_f32_16x16x32_bf16 v[28:31], a[156:159], v[124:127], v[28:31]
    v_mfma_f32_16x16x32_bf16 v[36:39], a[236:239], v[124:127], v[36:39]
    v_mfma_f32_16x16x32_bf16 v[44:47], v[252:255], v[124:127], v[44:47]
    s_waitcnt vmcnt(0)
    s_add_u32 s75, s75, 1
    s_mov_b32 s87, s7
    v_cmp_gt_u32 vcc, s80, v5
    s_cmp_eq_u32 s7, 0
    s_cbranch_scc1 L_qd_150s
    s_cbranch_vccz L_qd_150
L_qd_150s:
    v_cvt_pk_bf16_f32 v80, v16, v17
    v_cvt_pk_bf16_f32 v81, v18, v19
    v_cvt_pk_bf16_f32 v82, v20, v21
    v_cvt_pk_bf16_f32 v83, v22, v23
    v_cvt_pk_bf16_f32 v84, v24, v25
    v_cvt_pk_bf16_f32 v85, v26, v27
    v_cvt_pk_bf16_f32 v86, v28, v29
    v_cvt_pk_bf16_f32 v87, v30, v31
    v_permlane32_swap_b32 v80, v82
    v_permlane32_swap_b32 v81, v83
    v_permlane32_swap_b32 v84, v86
    v_permlane32_swap_b32 v85, v87
    v_cmp_gt_u32 vcc, s89, v3
    s_cbranch_vccz L_bp_151
L_poll_152:
    buffer_load_dword v3, v7, s[8:11], s82 offen offset:0 sc1
    s_waitcnt vmcnt(0)
    v_cmp_gt_u32 vcc, s89, v3
    s_cbranch_vccz L_pok_153
    s_sleep 1
    s_sub_u32 s6, s6, 1
    s_cbranch_scc0 L_poll_152
    s_branch L_fail
L_pok_153:
L_bp_151:
    s_cmp_eq_u32 s7, 0
    s_cbranch_scc1 L_sl_154
    buffer_store_dwordx4 v[80:83], v9, s[8:11], s88 offen offset:0
    buffer_store_dwordx4 v[84:87], v9, s[8:11], s88 offen offset:1024
    s_branch L_sd_155
L_sl_154:
    buffer_store_dwordx4 v[80:83], v9, s[8:11], s88 offen offset:0 sc1
    buffer_store_dwordx4 v[84:87], v9, s[8:11], s88 offen offset:1024 sc1
L_sd_155:
    v_cvt_pk_bf16_f32 v88, v32, v33
    v_cvt_pk_bf16_f32 v89, v34, v35
    v_cvt_pk_bf16_f32 v90, v36, v37
    v_cvt_pk_bf16_f32 v91, v38, v39
    v_cvt_pk_bf16_f32 v92, v40, v41
    v_cvt_pk_bf16_f32 v93, v42, v43
    v_cvt_pk_bf16_f32 v94, v44, v45
    v_cvt_pk_bf16_f32 v95, v46, v47
    v_permlane32_swap_b32 v88, v90
    v_permlane32_swap_b32 v89, v91
    v_permlane32_swap_b32 v92, v94
    v_permlane32_swap_b32 v93, v95
    s_cmp_eq_u32 s7, 0
    s_cbranch_scc1 L_sl_156
    buffer_store_dwordx4 v[88:91], v9, s[8:11], s88 offen offset:2048
    buffer_store_dwordx4 v[92:95], v9, s[8:11], s88 offen offset:3072
    s_branch L_sd_157
L_sl_156:
    buffer_store_dwordx4 v[88:91], v9, s[8:11], s88 offen offset:2048 sc1
    buffer_store_dwordx4 v[92:95], v9, s[8:11], s88 offen offset:3072 sc1
L_sd_157:
    buffer_load_dword v5, v6, s[8:11], s84 offen sc1
    s_waitcnt vmcnt(0)
    v_mov_b32 v4, s75
    s_mov_b64 exec, 1
    s_cmp_eq_u32 s7, 0
    s_cbranch_scc1 L_sl_158
    buffer_store_dword v4, off, s[8:11], s65
    s_branch L_sd_159
L_sl_158:
    buffer_store_dword v4, off, s[8:11], s65 sc1
L_sd_159:
    s_mov_b64 exec, -1
    s_mov_b32 s87, 0
    v_cmp_gt_u32 vcc, s80, v5
    s_cbranch_vccz L_qd_150
L_blk_137:
    buffer_load_dword v5, v6, s[8:11], s84 offen sc1
    s_waitcnt vmcnt(0)
    v_cmp_gt_u32 vcc, s80, v5
    s_cbranch_vccz L_bok_160
    s_sleep 1
    s_sub_u32 s6, s6, 1
    s_cbranch_scc0 L_blk_137
    s_branch L_fail
L_bok_160:
L_qd_150:
    s_add_u32 m0, s83, 40960
    s_nop 0
    buffer_load_dwordx4 v8, s[8:11], s81 offen offset:0 sc1 lds
    s_add_u32 m0, m0, 896
    s_nop 0
    buffer_load_dwordx4 v8, s[8:11], s81 offen offset:128 sc1 lds
    s_add_u32 m0, m0, 896
    s_nop 0
    buffer_load_dwordx4 v8, s[8:11], s81 offen offset:256 sc1 lds
    s_add_u32 m0, m0, 896
    s_nop 0
    buffer_load_dwordx4 v8, s[8:11], s81 offen offset:384 sc1 lds
    s_add_u32 m0, m0, 896
    s_nop 0
    buffer_load_dwordx4 v8, s[8:11], s81 offen offset:512 sc1 lds
    s_add_u32 m0, m0, 896
    s_nop 0
    buffer_load_dwordx4 v8, s[8:11], s81 offen offset:640 sc1 lds
    s_add_u32 m0, m0, 896
    s_nop 0
    buffer_load_dwordx4 v8, s[8:11], s81 offen offset:768 sc1 lds
    s_add_u32 m0, m0, 896
    s_nop 0
    buffer_load_dwordx4 v8, s[8:11], s81 offen offset:896 sc1 lds
    s_add_u32 m0, m0, 896
    s_nop 0
    buffer_load_dwordx4 v8, s[8:11], s81 offen offset:1024 sc1 lds
    s_add_u32 m0, m0, 896
    s_nop 0
    buffer_load_dwordx4 v8, s[8:11], s81 offen offset:1152 sc1 lds
    s_branch L_got2_138
L_qb_148:
    ds_read_b128 v[104:107], v11 offset:8192
    ds_read_b128 v[108:111], v13 offset:8192
    s_waitcnt lgkmcnt(5)
    v_mfma_f32_16x16x32_bf16 v[16:19], a[60:63], v[120:123], v[16:19]
    v_mfma_f32_16x16x32_bf16 v[24:27], a[140:143], v[120:123], v[24:27]
    v_mfma_f32_16x16x32_bf16 v[32:35], a[220:223], v[120:123], v[32:35]
    v_mfma_f32_16x16x32_bf16 v[40:43], v[236:239], v[120:123], v[40:43]
    s_add_u32 m0, s83, 40960
    s_nop 0
    buffer_load_dwordx4 v8, s[8:11], s81 offen offset:0 sc1 lds
    s_waitcnt lgkmcnt(4)
    v_mfma_f32_16x16x32_bf16 v[20:23], a[60:63], v[124:127], v[20:23]
    v_mfma_f32_16x16x32_bf16 v[28:31], a[140:143], v[124:127], v[28:31]
    v_mfma_f32_16x16x32_bf16 v[36:39], a[220:223], v[124:127], v[36:39]
    v_mfma_f32_16x16x32_bf16 v[44:47], v[236:239], v[124:127], v[44:47]
    s_add_u32 m0, m0, 896
    s_nop 0
    buffer_load_dwordx4 v8, s[8:11], s81 offen offset:128 sc1 lds
    ds_read_b128 v[112:115], v10 offset:9216
    ds_read_b128 v[116:119], v12 offset:9216
    s_waitcnt lgkmcnt(5)
    v_mfma_f32_16x16x32_bf16 v[16:19], a[64:67], v[96:99], v[16:19]
    v_mfma_f32_16x16x32_bf16 v[24:27], a[144:147], v[96:99], v[24:27]
    v_mfma_f32_16x16x32_bf16 v[32:35], a[224:227], v[96:99], v[32:35]
    v_mfma_f32_16x16x32_bf16 v[40:43], v[240:243], v[96:99], v[40:43]
    s_add_u32 m0, m0, 896
    s_nop 0
    buffer_load_dwordx4 v8, s[8:11], s81 offen offset:256 sc1 lds
    s_waitcnt lgkmcnt(4)
    v_mfma_f32_16x16x32_bf16 v[20:23], a[64:67], v[100:103], v[20:23]
    v_mfma_f32_16x16x32_bf16 v[28:31], a[144:147], v[100:103], v[28:31]
    v_mfma_f32_16x16x32_bf16 v[36:39], a[224:227], v[100:103], v[36:39]
    v_mfma_f32_16x16x32_bf16 v[44:47], v[240:243], v[100:103], v[44:47]
    s_add_u32 m0, m0, 896
    s_nop 0
    buffer_load_dwordx4 v8, s[8:11], s81 offen offset:384 sc1 lds
    ds_read_b128 v[120:123], v11 offset:9216
    ds_read_b128 v[124:127], v13 offset:9216
    s_waitcnt lgkmcnt(5)
    v_mfma_f32_16x16x32_bf16 v[16:19], a[68:71], v[104:107], v[16:19]
    v_mfma_f32_16x16x32_bf16 v[24:27], a[148:151], v[104:107], v[24:27]
    v_mfma_f32_16x16x32_bf16 v[32:35], a[228:231], v[104:107], v[32:35]
    v_mfma_f32_16x16x32_bf16 v[40:43], v[244:247], v[104:107], v[40:43]
    s_add_u32 m0, m0, 896
    s_nop 0
    buffer_load_dwordx4 v8, s[8:11], s81 offen offset:512 sc1 lds
    s_waitcnt lgkmcnt(4)
    v_mfma_f32_16x16x32_bf16 v[20:23], a[68:71], v[108:111], v[20:23]
    v_mfma_f32_16x16x32_bf16 v[28:31], a[148:151], v[108:111], v[28:31]
    v_mfma_f32_16x16x32_bf16 v[36:39], a[228:231], v[108:111], v[36:39]
    v_mfma_f32_16x16x32_bf16 v[44:47], v[244:247], v[108:111], v[44:47]
    s_add_u32 m0, m0, 896
    s_nop 0
    buffer_load_dwordx4 v8, s[8:11], s81 offen offset:640 sc1 lds
    s_waitcnt lgkmcnt(3)
    v_mfma_f32_16x16x32_bf16 v[16:19], a[72:75], v[112:115], v[16:19]
    v_mfma_f32_16x16x32_bf16 v[24:27], a[152:155], v[112:115], v[24:27]
    v_mfma_f32_16x16x32_bf16 v[32:35], a[232:235], v[112:115], v[32:35]
    v_mfma_f32_16x16x32_bf16 v[40:43], v[248:251], v[112:115], v[40:43]
    s_add_u32 m0, m0, 896
    s_nop 0
    buffer_load_dwordx4 v8, s[8:11], s81 offen offset:768 sc1 lds
    s_waitcnt lgkmcnt(2)
    v_mfma_f32_16x16x32_bf16 v[20:23], a[72:75], v[116:119], v[20:23]
    v_mfma_f32_16x16x32_bf16 v[28:31], a[152:155], v[116:119], v[28:31]
    v_mfma_f32_16x16x32_bf16 v[36:39], a[232:235], v[116:119], v[36:39]
    v_mfma_f32_16x16x32_bf16 v[44:47], v[248:251], v[116:119], v[44:47]
    s_add_u32 m0, m0, 896
    s_nop 0
    buffer_load_dwordx4 v8, s[8:11], s81 offen offset:896 sc1 lds
    s_waitcnt lgkmcnt(1)
    v_mfma_f32_16x16x32_bf16 v[16:19], a[76:79], v[120:123], v[16:19]
    v_mfma_f32_16x16x32_bf16 v[24:27], a[156:159], v[120:123], v[24:27]
    v_mfma_f32_16x16x32_bf16 v[32:35], a[236:239], v[120:123], v[32:35]
    v_mfma_f32_16x16x32_bf16 v[40:43], v[252:255], v[120:123], v[40:43]
    s_add_u32 m0, m0, 896
    s_nop 0
    buffer_load_dwordx4 v8, s[8:11], s81 offen offset:1024 sc1 lds
    s_waitcnt lgkmcnt(0)
    v_mfma_f32_16x16x32_bf16 v[20:23], a[76:79], v[124:127], v[20:23]
    v_mfma_f32_16x16x32_bf16 v[28:31], a[156:159], v[124:127], v[28:31]
    v_mfma_f32_16x16x32_bf16 v[36:39], a[236:239], v[124:127], v[36:39]
    v_mfma_f32_16x16x32_bf16 v[44:47], v[252:255], v[124:127], v[44:47]
    s_add_u32 m0, m0, 896
    s_nop 0
    buffer_load_dwordx4 v8, s[8:11], s81 offen offset:1152 sc1 lds
    s_branch L_qc_149
L_qa_147:
    ds_read_b128 v[96:99], v10 offset:6144
    ds_read_b128 v[100:103], v12 offset:6144
    s_waitcnt lgkmcnt(5)
    v_mfma_f32_16x16x32_bf16 v[16:19], a[40:43], v[112:115], v[16:19]
    v_mfma_f32_16x16x32_bf16 v[24:27], a[120:123], v[112:115], v[24:27]
    v_mfma_f32_16x16x32_bf16 v[32:35], a[200:203], v[112:115], v[32:35]
    v_mfma_f32_16x16x32_bf16 v[40:43], v[216:219], v[112:115], v[40:43]
    s_add_u32 m0, s83, 40960
    s_nop 0
    buffer_load_dwordx4 v8, s[8:11], s81 offen offset:0 sc1 lds
    s_waitcnt lgkmcnt(4)
    v_mfma_f32_16x16x32_bf16 v[20:23], a[40:43], v[116:119], v[20:23]
    v_mfma_f32_16x16x32_bf16 v[28:31], a[120:123], v[116:119], v[28:31]
    v_mfma_f32_16x16x32_bf16 v[36:39], a[200:203], v[116:119], v[36:39]
    v_mfma_f32_16x16x32_bf16 v[44:47], v[216:219], v[116:119], v[44:47]
    s_add_u32 m0, m0, 896
    s_nop 0
    buffer_load_dwordx4 v8, s[8:11], s81 offen offset:128 sc1 lds
    ds_read_b128 v[104:107], v11 offset:6144
    ds_read_b128 v[108:111], v13 offset:6144
    s_waitcnt lgkmcnt(5)
    v_mfma_f32_16x16x32_bf16 v[16:19], a[44:47], v[120:123], v[16:19]
    v_mfma_f32_16x16x32_bf16 v[24:27], a[124:127], v[120:123], v[24:27]
    v_mfma_f32_16x16x32_bf16 v[32:35], a[204:207], v[120:123], v[32:35]
    v_mfma_f32_16x16x32_bf16 v[40:43], v[220:223], v[120:123], v[40:43]
    s_add_u32 m0, m0, 896
    s_nop 0
    buffer_load_dwordx4 v8, s[8:11], s81 offen offset:256 sc1 lds
    s_waitcnt lgkmcnt(4)
    v_mfma_f32_16x16x32_bf16 v[20:23], a[44:47], v[124:127], v[20:23]
    v_mfma_f32_16x16x32_bf16 v[28:31], a[124:127], v[124:127], v[28:31]
    v_mfma_f32_16x16x32_bf16 v[36:39], a[204:207], v[124:127], v[36:39]
    v_mfma_f32_16x16x32_bf16 v[44:47], v[220:223], v[124:127], v[44:47]
    s_add_u32 m0, m0, 896
    s_nop 0
    buffer_load_dwordx4 v8, s[8:11], s81 offen offset:384 sc1 lds
    ds_read_b128 v[112:115], v10 offset:7168
    ds_read_b128 v[116:119], v12 offset:7168
    s_waitcnt lgkmcnt(5)
    v_mfma_f32_16x16x32_bf16 v[16:19], a[48:51], v[96:99], v[16:19]
    v_mfma_f32_16x16x32_bf16 v[24:27], a[128:131], v[96:99], v[24:27]
    v_mfma_f32_16x16x32_bf16 v[32:35], a[208:211], v[96:99], v[32:35]
    v_mfma_f32_16x16x32_bf16 v[40:43], v[224:227], v[96:99], v[40:43]
    s_add_u32 m0, m0, 896
    s_nop 0
    buffer_load_dwordx4 v8, s[8:11], s81 offen offset:512 sc1 lds
    s_waitcnt lgkmcnt(4)
    v_mfma_f32_16x16x32_bf16 v[20:23], a[48:51], v[100:103], v[20:23]
    v_mfma_f32_16x16x32_bf16 v[28:31], a[128:131], v[100:103], v[28:31]
    v_mfma_f32_16x16x32_bf16 v[36:39], a[208:211], v[100:103], v[36:39]
    v_mfma_f32_16x16x32_bf16 v[44:47], v[224:227], v[100:103], v[44:47]
    s_add_u32 m0, m0, 896
    s_nop 0
    buffer_load_dwordx4 v8, s[8:11], s81 offen offset:640 sc1 lds
    ds_read_b128 v[120:123], v11 offset:7168
    ds_read_b128 v[124:127], v13 offset:7168
    s_waitcnt lgkmcnt(5)
    v_mfma_f32_16x16x32_bf16 v[16:19], a[52:55], v[104:107], v[16:19]
    v_mfma_f32_16x16x32_bf16 v[24:27], a[132:135], v[104:107], v[24:27]
    v_mfma_f32_16x16x32_bf16 v[32:35], a[212:215], v[104:107], v[32:35]
    v_mfma_f32_16x16x32_bf16 v[40:43], v[228:231], v[104:107], v[40:43]
    s_add_u32 m0, m0, 896
    s_nop 0
    buffer_load_dwordx4 v8, s[8:11], s81 offen offset:768 sc1 lds
    s_waitcnt lgkmcnt(4)
    v_mfma_f32_16x16x32_bf16 v[20:23], a[52:55], v[108:111], v[20:23]
    v_mfma_f32_16x16x32_bf16 v[28:31], a[132:135], v[108:111], v[28:31]
    v_mfma_f32_16x16x32_bf16 v[36:39], a[212:215], v[108:111], v[36:39]
    v_mfma_f32_16x16x32_bf16 v[44:47], v[228:231], v[108:111], v[44:47]
    s_add_u32 m0, m0, 896
    s_nop 0
    buffer_load_dwordx4 v8, s[8:11], s81 offen offset:896 sc1 lds
    ds_read_b128 v[96:99], v10 offset:8192
    ds_read_b128 v[100:103], v12 offset:8192
    s_waitcnt lgkmcnt(5)
    v_mfma_f32_16x16x32_bf16 v[16:19], a[56:59], v[112:115], v[16:19]
    v_mfma_f32_16x16x32_bf16 v[24:27], a[136:139], v[112:115], v[24:27]
    v_mfma_f32_16x16x32_bf16 v[32:35], a[216:219], v[112:115], v[32:35]
    v_mfma_f32_16x16x32_bf16 v[40:43], v[232:235], v[112:115], v[40:43]
    s_add_u32 m0, m0, 896
    s_nop 0
    buffer_load_dwordx4 v8, s[8:11], s81 offen offset:1024 sc1 lds
    s_waitcnt lgkmcnt(4)
    v_mfma_f32_16x16x32_bf16 v[20:23], a[56:59], v[116:119], v[20:23]
    v_mfma_f32_16x16x32_bf16 v[28:31], a[136:139], v[116:119], v[28:31]
    v_mfma_f32_16x16x32_bf16 v[36:39], a[216:219], v[116:119], v[36:39]
    v_mfma_f32_16x16x32_bf16 v[44:47], v[232:235], v[116:119], v[44:47]
    s_add_u32 m0, m0, 896
    s_nop 0
    buffer_load_dwordx4 v8, s[8:11], s81 offen offset:1152 sc1 lds
    ds_read_b128 v[104:107], v11 offset:8192
    ds_read_b128 v[108:111], v13 offset:8192
    s_waitcnt lgkmcnt(5)
    v_mfma_f32_16x16x32_bf16 v[16:19], a[60:63], v[120:123], v[16:19]
    v_mfma_f32_16x16x32_bf16 v[24:27], a[140:143], v[120:123], v[24:27]
    v_mfma_f32_16x16x32_bf16 v[32:35], a[220:223], v[120:123], v[32:35]
    v_mfma_f32_16x16x32_bf16 v[40:43], v[236:239], v[120:123], v[40:43]
    s_waitcnt lgkmcnt(4)
    v_mfma_f32_16x16x32_bf16 v[20:23], a[60:63], v[124:127], v[20:23]
    v_mfma_f32_16x16x32_bf16 v[28:31], a[140:143], v[124:127], v[28:31]
    v_mfma_f32_16x16x32_bf16 v[36:39], a[220:223], v[124:127], v[36:39]
    v_mfma_f32_16x16x32_bf16 v[44:47], v[236:239], v[124:127], v[44:47]
    ds_read_b128 v[112:115], v10 offset:9216
    ds_read_b128 v[116:119], v12 offset:9216
    s_waitcnt lgkmcnt(5)
    v_mfma_f32_16x16x32_bf16 v[16:19], a[64:67], v[96:99], v[16:19]
    v_mfma_f32_16x16x32_bf16 v[24:27], a[144:147], v[96:99], v[24:27]
    v_mfma_f32_16x16x32_bf16 v[32:35], a[224:227], v[96:99], v[32:35]
    v_mfma_f32_16x16x32_bf16 v[40:43], v[240:243], v[96:99], v[40:43]
    s_waitcnt lgkmcnt(4)
    v_mfma_f32_16x16x32_bf16 v[20:23], a[64:67], v[100:103], v[20:23]
    v_mfma_f32_16x16x32_bf16 v[28:31], a[144:147], v[100:103], v[28:31]
    v_mfma_f32_16x16x32_bf16 v[36:39], a[224:227], v[100:103], v[36:39]
    v_mfma_f32_16x16x32_bf16 v[44:47], v[240:243], v[100:103], v[44:47]
    ds_read_b128 v[120:123], v11 offset:9216
    ds_read_b128 v[124:127], v13 offset:9216
    s_waitcnt lgkmcnt(5)
    v_mfma_f32_16x16x32_bf16 v[16:19], a[68:71], v[104:107], v[16:19]
    v_mfma_f32_16x16x32_bf16 v[24:27], a[148:151], v[104:107], v[24:27]
    v_mfma_f32_16x16x32_bf16 v[32:35], a[228:231], v[104:107], v[32:35]
    v_mfma_f32_16x16x32_bf16 v[40:43], v[244:247], v[104:107], v[40:43]
    s_waitcnt lgkmcnt(4)
    v_mfma_f32_16x16x32_bf16 v[20:23], a[68:71], v[108:111], v[20:23]
    v_mfma_f32_16x16x32_bf16 v[28:31], a[148:151], v[108:111], v[28:31]
    v_mfma_f32_16x16x32_bf16 v[36:39], a[228:231], v[108:111], v[36:39]
    v_mfma_f32_16x16x32_bf16 v[44:47], v[244:247], v[108:111], v[44:47]
    s_waitcnt lgkmcnt(3)
    v_mfma_f32_16x16x32_bf16 v[16:19], a[72:75], v[112:115], v[16:19]
    v_mfma_f32_16x16x32_bf16 v[24:27], a[152:155], v[112:115], v[24:27]
    v_mfma_f32_16x16x32_bf16 v[32:35], a[232:235], v[112:115], v[32:35]
    v_mfma_f32_16x16x32_bf16 v[40:43], v[248:251], v[112:115], v[40:43]
    s_waitcnt lgkmcnt(2)
    v_mfma_f32_16x16x32_bf16 v[20:23], a[72:75], v[116:119], v[20:23]
    v_mfma_f32_16x16x32_bf16 v[28:31], a[152:155], v[116:119], v[28:31]
    v_mfma_f32_16x16x32_bf16 v[36:39], a[232:235], v[116:119], v[36:39]
    v_mfma_f32_16x16x32_bf16 v[44:47], v[248:251], v[116:119], v[44:47]
    s_waitcnt lgkmcnt(1)
    v_mfma_f32_16x16x32_bf16 v[16:19], a[76:79], v[120:123], v[16:19]
    v_mfma_f32_16x16x32_bf16 v[24:27], a[156:159], v[120:123], v[24:27]
    v_mfma_f32_16x16x32_bf16 v[32:35], a[236:239], v[120:123], v[32:35]
    v_mfma_f32_16x16x32_bf16 v[40:43], v[252:255], v[120:123], v[40:43]
    s_waitcnt lgkmcnt(0)
    v_mfma_f32_16x16x32_bf16 v[20:23], a[76:79], v[124:127], v[20:23]
    v_mfma_f32_16x16x32_bf16 v[28:31], a[156:159], v[124:127], v[28:31]
    v_mfma_f32_16x16x32_bf16 v[36:39], a[236:239], v[124:127], v[36:39]
    v_mfma_f32_16x16x32_bf16 v[44:47], v[252:255], v[124:127], v[44:47]
L_qc_149:
    s_add_u32 s75, s75, 1
    s_mov_b32 s87, s7
    s_cmp_lg_u32 s7, 0
    s_cbranch_scc1 L_df_161
    s_waitcnt vmcnt(0)
    v_cvt_pk_bf16_f32 v80, v16, v17
    v_cvt_pk_bf16_f32 v81, v18, v19
    v_cvt_pk_bf16_f32 v82, v20, v21
    v_cvt_pk_bf16_f32 v83, v22, v23
    v_cvt_pk_bf16_f32 v84, v24, v25
    v_cvt_pk_bf16_f32 v85, v26, v27
    v_cvt_pk_bf16_f32 v86, v28, v29
    v_cvt_pk_bf16_f32 v87, v30, v31
    v_permlane32_swap_b32 v80, v82
    v_permlane32_swap_b32 v81, v83
    v_permlane32_swap_b32 v84, v86
    v_permlane32_swap_b32 v85, v87
    v_cmp_gt_u32 vcc, s89, v3
    s_cbranch_vccz L_bp_162
L_poll_163:
    buffer_load_dword v3, v7, s[8:11], s82 offen offset:0 sc1
    s_waitcnt vmcnt(0)
    v_cmp_gt_u32 vcc, s89, v3
    s_cbranch_vccz L_pok_164
    s_sleep 1
    s_sub_u32 s6, s6, 1
    s_cbranch_scc0 L_poll_163
    s_branch L_fail
L_pok_164:
L_bp_162:
    s_cmp_eq_u32 s7, 0
    s_cbranch_scc1 L_sl_165
    buffer_store_dwordx4 v[80:83], v9, s[8:11], s88 offen offset:0
    buffer_store_dwordx4 v[84:87], v9, s[8:11], s88 offen offset:1024
    s_branch L_sd_166
L_sl_165:
    buffer_store_dwordx4 v[80:83], v9, s[8:11], s88 offen offset:0 sc1
    buffer_store_dwordx4 v[84:87], v9, s[8:11], s88 offen offset:1024 sc1
L_sd_166:
    v_cvt_pk_bf16_f32 v88, v32, v33
    v_cvt_pk_bf16_f32 v89, v34, v35
    v_cvt_pk_bf16_f32 v90, v36, v37
    v_cvt_pk_bf16_f32 v91, v38, v39
    v_cvt_pk_bf16_f32 v92, v40, v41
    v_cvt_pk_bf16_f32 v93, v42, v43
    v_cvt_pk_bf16_f32 v94, v44, v45
    v_cvt_pk_bf16_f32 v95, v46, v47
    v_permlane32_swap_b32 v88, v90
    v_permlane32_swap_b32 v89, v91
    v_permlane32_swap_b32 v92, v94
    v_permlane32_swap_b32 v93, v95
    s_cmp_eq_u32 s7, 0
    s_cbranch_scc1 L_sl_167
    buffer_store_dwordx4 v[88:91], v9, s[8:11], s88 offen offset:2048
    buffer_store_dwordx4 v[92:95], v9, s[8:11], s88 offen offset:3072
    s_branch L_sd_168
L_sl_167:
    buffer_store_dwordx4 v[88:91], v9, s[8:11], s88 offen offset:2048 sc1
    buffer_store_dwordx4 v[92:95], v9, s[8:11], s88 offen offset:3072 sc1
L_sd_168:
L_df_161:
L_got2_138:
    s_waitcnt vmcnt(0)
    s_barrier
    s_cmp_eq_u32 s87, 0
    s_cbranch_scc1 L_h0_169
    v_cmp_gt_u32 vcc, s89, v3
    s_cbranch_vccz L_bp_171
L_poll_172:
    buffer_load_dword v3, v7, s[8:11], s82 offen offset:0 sc1
    s_waitcnt vmcnt(0)
    v_cmp_gt_u32 vcc, s89, v3
    s_cbranch_vccz L_pok_173
    s_sleep 1
    s_sub_u32 s6, s6, 1
    s_cbranch_scc0 L_poll_172
    s_branch L_fail
L_pok_173:
L_bp_171:
    ds_read_b128 v[96:99], v10 offset:40960
    ds_read_b128 v[100:103], v12 offset:40960
    ds_read_b128 v[104:107], v11 offset:40960
    ds_read_b128 v[108:111], v13 offset:40960
    ds_read_b128 v[112:115], v10 offset:41984
    ds_read_b128 v[116:119], v12 offset:41984
    s_waitcnt lgkmcnt(5)
    v_mfma_f32_16x16x32_bf16 v[48:51], a[0:3], v[96:99], 0
    v_mfma_f32_16x16x32_bf16 v[56:59], a[80:83], v[96:99], 0
    v_mfma_f32_16x16x32_bf16 v[64:67], a[160:163], v[96:99], 0
    v_mfma_f32_16x16x32_bf16 v[72:75], a[240:243], v[96:99], 0
    v_cvt_pk_bf16_f32 v80, v16, v17
    v_cvt_pk_bf16_f32 v82, v20, v21
    s_waitcnt lgkmcnt(4)
    v_mfma_f32_16x16x32_bf16 v[52:55], a[0:3], v[100:103], 0
    v_mfma_f32_16x16x32_bf16 v[60:63], a[80:83], v[100:103], 0
    v_mfma_f32_16x16x32_bf16 v[68:71], a[160:163], v[100:103], 0
    v_mfma_f32_16x16x32_bf16 v[76:79], a[240:243], v[100:103], 0
    v_cvt_pk_bf16_f32 v81, v18, v19
    v_cvt_pk_bf16_f32 v83, v22, v23
    ds_read_b128 v[120:123], v11 offset:41984
    ds_read_b128 v[124:127], v13 offset:41984
    s_waitcnt lgkmcnt(5)
    v_mfma_f32_16x16x32_bf16 v[48:51], a[4:7], v[104:107], v[48:51]
    v_mfma_f32_16x16x32_bf16 v[56:59], a[84:87], v[104:107], v[56:59]
    v_mfma_f32_16x16x32_bf16 v[64:67], a[164:167], v[104:107], v[64:67]
    v_mfma_f32_16x16x32_bf16 v[72:75], a[244:247], v[104:107], v[72:75]
    v_permlane32_swap_b32 v80, v82
    v_permlane32_swap_b32 v81, v83
    s_waitcnt lgkmcnt(4)
    v_mfma_f32_16x16x32_bf16 v[52:55], a[4:7], v[108:111], v[52:55]
    v_mfma_f32_16x16x32_bf16 v[60:63], a[84:87], v[108:111], v[60:63]
    v_mfma_f32_16x16x32_bf16 v[68:71], a[164:167], v[108:111], v[68:71]
    v_mfma_f32_16x16x32_bf16 v[76:79], a[244:247], v[108:111], v[76:79]
    buffer_store_dwordx4 v[80:83], v9, s[8:11], s88 offen offset:0
    v_cvt_pk_bf16_f32 v84, v24, v25
    v_cvt_pk_bf16_f32 v86, v28, v29
    ds_read_b128 v[96:99], v10 offset:43008
    ds_read_b128 v[100:103], v12 offset:43008
    s_waitcnt lgkmcnt(5)
    v_mfma_f32_16x16x32_bf16 v[48:51], a[8:11], v[112:115], v[48:51]
    v_mfma_f32_16x16x32_bf16 v[56:59], a[88:91], v[112:115], v[56:59]
    v_mfma_f32_16x16x32_bf16 v[64:67], a[168:171], v[112:115], v[64:67]
    v_mfma_f32_16x16x32_bf16 v[72:75], a[248:251], v[112:115], v[72:75]
    v_cvt_pk_bf16_f32 v85, v26, v27
    v_cvt_pk_bf16_f32 v87, v30, v31
    s_waitcnt lgkmcnt(4)
    v_mfma_f32_16x16x32_bf16 v[52:55], a[8:11], v[116:119], v[52:55]
    v_mfma_f32_16x16x32_bf16 v[60:63], a[88:91], v[116:119], v[60:63]
    v_mfma_f32_16x16x32_bf16 v[68:71], a[168:171], v[116:119], v[68:71]
    v_mfma_f32_16x16x32_bf16 v[76:79], a[248:251], v[116:119], v[76:79]
    v_permlane32_swap_b32 v84, v86
    v_permlane32_swap_b32 v85, v87
    ds_read_b128 v[104:107], v11 offset:43008
    ds_read_b128 v[108:111], v13 offset:43008
    s_waitcnt lgkmcnt(5)
    v_mfma_f32_16x16x32_bf16 v[48:51], a[12:15], v[120:123], v[48:51]
    v_mfma_f32_16x16x32_bf16 v[56:59], a[92:95], v[120:123], v[56:59]
    v_mfma_f32_16x16x32_bf16 v[64:67], a[172:175], v[120:123], v[64:67]
    v_mfma_f32_16x16x32_bf16 v[72:75], a[252:255], v[120:123], v[72:75]
    buffer_store_dwordx4 v[84:87], v9, s[8:11], s88 offen offset:1024
    v_cvt_pk_bf16_f32 v88, v32, v33
    v_cvt_pk_bf16_f32 v90, v36, v37
    s_waitcnt lgkmcnt(4)
    v_mfma_f32_16x16x32_bf16 v[52:55], a[12:15], v[124:127], v[52:55]
    v_mfma_f32_16x16x32_bf16 v[60:63], a[92:95], v[124:127], v[60:63]
    v_mfma_f32_16x16x32_bf16 v[68:71], a[172:175], v[124:127], v[68:71]
    v_mfma_f32_16x16x32_bf16 v[76:79], a[252:255], v[124:127], v[76:79]
    v_cvt_pk_bf16_f32 v89, v34, v35
    v_cvt_pk_bf16_f32 v91, v38, v39
    ds_read_b128 v[112:115], v10 offset:44032
    ds_read_b128 v[116:119], v12 offset:44032
    s_waitcnt lgkmcnt(5)
    v_mfma_f32_16x16x32_bf16 v[48:51], a[16:19], v[96:99], v[48:51]
    v_mfma_f32_16x16x32_bf16 v[56:59], a[96:99], v[96:99], v[56:59]
    v_mfma_f32_16x16x32_bf16 v[64:67], a[176:179], v[96:99], v[64:67]
    v_mfma_f32_16x16x32_bf16 v[72:75], v[192:195], v[96:99], v[72:75]
    v_permlane32_swap_b32 v88, v90
    v_permlane32_swap_b32 v89, v91
    s_waitcnt lgkmcnt(4)
    v_mfma_f32_16x16x32_bf16 v[52:55], a[16:19], v[100:103], v[52:55]
    v_mfma_f32_16x16x32_bf16 v[60:63], a[96:99], v[100:103], v[60:63]
    v_mfma_f32_16x16x32_bf16 v[68:71], a[176:179], v[100:103], v[68:71]
    v_mfma_f32_16x16x32_bf16 v[76:79], v[192:195], v[100:103], v[76:79]
    buffer_store_dwordx4 v[88:91], v9, s[8:11], s88 offen offset:2048
    v_cvt_pk_bf16_f32 v92, v40, v41
    v_cvt_pk_bf16_f32 v94, v44, v45
    ds_read_b128 v[120:123], v11 offset:44032
    ds_read_b128 v[124:127], v13 offset:44032
    s_waitcnt lgkmcnt(5)
    v_mfma_f32_16x16x32_bf16 v[48:51], a[20:23], v[104:107], v[48:51]
    v_mfma_f32_16x16x32_bf16 v[56:59], a[100:103], v[104:107], v[56:59]
    v_mfma_f32_16x16x32_bf16 v[64:67], a[180:183], v[104:107], v[64:67]
    v_mfma_f32_16x16x32_bf16 v[72:75], v[196:199], v[104:107], v[72:75]
    v_cvt_pk_bf16_f32 v93, v42, v43
    v_cvt_pk_bf16_f32 v95, v46, v47
    s_waitcnt lgkmcnt(4)
    v_mfma_f32_16x16x32_bf16 v[52:55], a[20:23], v[108:111], v[52:55]
    v_mfma_f32_16x16x32_bf16 v[60:63], a[100:103], v[108:111], v[60:63]
    v_mfma_f32_16x16x32_bf16 v[68:71], a[180:183], v[108:111], v[68:71]
    v_mfma_f32_16x16x32_bf16 v[76:79], v[196:199], v[108:111], v[76:79]
    v_permlane32_swap_b32 v92, v94
    v_permlane32_swap_b32 v93, v95
    ds_read_b128 v[96:99], v10 offset:45056
    ds_read_b128 v[100:103], v12 offset:45056
    s_waitcnt lgkmcnt(5)
    v_mfma_f32_16x16x32_bf16 v[48:51], a[24:27], v[112:115], v[48:51]
    v_mfma_f32_16x16x32_bf16 v[56:59], a[104:107], v[112:115], v[56:59]
    v_mfma_f32_16x16x32_bf16 v[64:67], a[184:187], v[112:115], v[64:67]
    v_mfma_f32_16x16x32_bf16 v[72:75], v[200:203], v[112:115], v[72:75]
    buffer_store_dwordx4 v[92:95], v9, s[8:11], s88 offen offset:3072
    s_waitcnt lgkmcnt(4)
    v_mfma_f32_16x16x32_bf16 v[52:55], a[24:27], v[116:119], v[52:55]
    v_mfma_f32_16x16x32_bf16 v[60:63], a[104:107], v[116:119], v[60:63]
    v_mfma_f32_16x16x32_bf16 v[68:71], a[184:187], v[116:119], v[68:71]
    v_mfma_f32_16x16x32_bf16 v[76:79], v[200:203], v[116:119], v[76:79]
    ds_read_b128 v[104:107], v11 offset:45056
    ds_read_b128 v[108:111], v13 offset:45056
    s_waitcnt lgkmcnt(5)
    v_mfma_f32_16x16x32_bf16 v[48:51], a[28:31], v[120:123], v[48:51]
    v_mfma_f32_16x16x32_bf16 v[56:59], a[108:111], v[120:123], v[56:59]
    v_mfma_f32_16x16x32_bf16 v[64:67], a[188:191], v[120:123], v[64:67]
    v_mfma_f32_16x16x32_bf16 v[72:75], v[204:207], v[120:123], v[72:75]
    s_waitcnt lgkmcnt(4)
    v_mfma_f32_16x16x32_bf16 v[52:55], a[28:31], v[124:127], v[52:55]
    v_mfma_f32_16x16x32_bf16 v[60:63], a[108:111], v[124:127], v[60:63]
    v_mfma_f32_16x16x32_bf16 v[68:71], a[188:191], v[124:127], v[68:71]
    v_mfma_f32_16x16x32_bf16 v[76:79], v[204:207], v[124:127], v[76:79]
    ds_read_b128 v[112:115], v10 offset:46080
    ds_read_b128 v[116:119], v12 offset:46080
    s_waitcnt lgkmcnt(5)
    v_mfma_f32_16x16x32_bf16 v[48:51], a[32:35], v[96:99], v[48:51]
    v_mfma_f32_16x16x32_bf16 v[56:59], a[112:115], v[96:99], v[56:59]
    v_mfma_f32_16x16x32_bf16 v[64:67], a[192:195], v[96:99], v[64:67]
    v_mfma_f32_16x16x32_bf16 v[72:75], v[208:211], v[96:99], v[72:75]
    s_waitcnt lgkmcnt(4)
    v_mfma_f32_16x16x32_bf16 v[52:55], a[32:35], v[100:103], v[52:55]
    v_mfma_f32_16x16x32_bf16 v[60:63], a[112:115], v[100:103], v[60:63]
    v_mfma_f32_16x16x32_bf16 v[68:71], a[192:195], v[100:103], v[68:71]
    v_mfma_f32_16x16x32_bf16 v[76:79], v[208:211], v[100:103], v[76:79]
    ds_read_b128 v[120:123], v11 offset:46080
    ds_read_b128 v[124:127], v13 offset:46080
    s_waitcnt lgkmcnt(5)
    v_mfma_f32_16x16x32_bf16 v[48:51], a[36:39], v[104:107], v[48:51]
    v_mfma_f32_16x16x32_bf16 v[56:59], a[116:119], v[104:107], v[56:59]
    v_mfma_f32_16x16x32_bf16 v[64:67], a[196:199], v[104:107], v[64:67]
    v_mfma_f32_16x16x32_bf16 v[72:75], v[212:215], v[104:107], v[72:75]
    s_waitcnt lgkmcnt(4)
    v_mfma_f32_16x16x32_bf16 v[52:55], a[36:39], v[108:111], v[52:55]
    v_mfma_f32_16x16x32_bf16 v[60:63], a[116:119], v[108:111], v[60:63]
    v_mfma_f32_16x16x32_bf16 v[68:71], a[196:199], v[108:111], v[68:71]
    v_mfma_f32_16x16x32_bf16 v[76:79], v[212:215], v[108:111], v[76:79]
    s_branch L_h1_170
L_h0_169:
    ds_read_b128 v[96:99], v10 offset:40960
    ds_read_b128 v[100:103], v12 offset:40960
    ds_read_b128 v[104:107], v11 offset:40960
    ds_read_b128 v[108:111], v13 offset:40960
    ds_read_b128 v[112:115], v10 offset:41984
    ds_read_b128 v[116:119], v12 offset:41984
    s_waitcnt lgkmcnt(5)
    v_mfma_f32_16x16x32_bf16 v[48:51], a[0:3], v[96:99], 0
    v_mfma_f32_16x16x32_bf16 v[56:59], a[80:83], v[96:99], 0
    v_mfma_f32_16x16x32_bf16 v[64:67], a[160:163], v[96:99], 0
    v_mfma_f32_16x16x32_bf16 v[72:75], a[240:243], v[96:99], 0
    s_waitcnt lgkmcnt(4)
    v_mfma_f32_16x16x32_bf16 v[52:55], a[0:3], v[100:103], 0
    v_mfma_f32_16x16x32_bf16 v[60:63], a[80:83], v[100:103], 0
    v_mfma_f32_16x16x32_bf16 v[68:71], a[160:163], v[100:103], 0
    v_mfma_f32_16x16x32_bf16 v[76:79], a[240:243], v[100:103], 0
    ds_read_b128 v[120:123], v11 offset:41984
    ds_read_b128 v[124:127], v13 offset:41984
    s_waitcnt lgkmcnt(5)
    v_mfma_f32_16x16x32_bf16 v[48:51], a[4:7], v[104:107], v[48:51]
    v_mfma_f32_16x16x32_bf16 v[56:59], a[84:87], v[104:107], v[56:59]
    v_mfma_f32_16x16x32_bf16 v[64:67], a[164:167], v[104:107], v[64:67]
    v_mfma_f32_16x16x32_bf16 v[72:75], a[244:247], v[104:107], v[72:75]
    s_waitcnt lgkmcnt(4)
    v_mfma_f32_16x16x32_bf16 v[52:55], a[4:7], v[108:111], v[52:55]
    v_mfma_f32_16x16x32_bf16 v[60:63], a[84:87], v[108:111], v[60:63]
    v_mfma_f32_16x16x32_bf16 v[68:71], a[164:167], v[108:111], v[68:71]
    v_mfma_f32_16x16x32_bf16 v[76:79], a[244:247], v[108:111], v[76:79]
    ds_read_b128 v[96:99], v10 offset:43008
    ds_read_b128 v[100:103], v12 offset:43008
    s_waitcnt lgkmcnt(5)
    v_mfma_f32_16x16x32_bf16 v[48:51], a[8:11], v[112:115], v[48:51]
    v_mfma_f32_16x16x32_bf16 v[56:59], a[88:91], v[112:115], v[56:59]
    v_mfma_f32_16x16x32_bf16 v[64:67], a[168:171], v[112:115], v[64:67]
    v_mfma_f32_16x16x32_bf16 v[72:75], a[248:251], v[112:115], v[72:75]
    s_waitcnt lgkmcnt(4)
    v_mfma_f32_16x16x32_bf16 v[52:55], a[8:11], v[116:119], v[52:55]
    v_mfma_f32_16x16x32_bf16 v[60:63], a[88:91], v[116:119], v[60:63]
    v_mfma_f32_16x16x32_bf16 v[68:71], a[168:171], v[116:119], v[68:71]
    v_mfma_f32_16x16x32_bf16 v[76:79], a[248:251], v[116:119], v[76:79]
    ds_read_b128 v[104:107], v11 offset:43008
    ds_read_b128 v[108:111], v13 offset:43008
    s_waitcnt lgkmcnt(5)
    v_mfma_f32_16x16x32_bf16 v[48:51], a[12:15], v[120:123], v[48:51]
    v_mfma_f32_16x16x32_bf16 v[56:59], a[92:95], v[120:123], v[56:59]
    v_mfma_f32_16x16x32_bf16 v[64:67], a[172:175], v[120:123], v[64:67]
    v_mfma_f32_16x16x32_bf16 v[72:75], a[252:255], v[120:123], v[72:75]
    s_waitcnt lgkmcnt(4)
    v_mfma_f32_16x16x32_bf16 v[52:55], a[12:15], v[124:127], v[52:55]
    v_mfma_f32_16x16x32_bf16 v[60:63], a[92:95], v[124:127], v[60:63]
    v_mfma_f32_16x16x32_bf16 v[68:71], a[172:175], v[124:127], v[68:71]
    v_mfma_f32_16x16x32_bf16 v[76:79], a[252:255], v[124:127], v[76:79]
    ds_read_b128 v[112:115], v10 offset:44032
    ds_read_b128 v[116:119], v12 offset:44032
    s_waitcnt lgkmcnt(5)
    v_mfma_f32_16x16x32_bf16 v[48:51], a[16:19], v[96:99], v[48:51]
    v_mfma_f32_16x16x32_bf16 v[56:59], a[96:99], v[96:99], v[56:59]
    v_mfma_f32_16x16x32_bf16 v[64:67], a[176:179], v[96:99], v[64:67]
    v_mfma_f32_16x16x32_bf16 v[72:75], v[192:195], v[96:99], v[72:75]
    s_waitcnt lgkmcnt(4)
    v_mfma_f32_16x16x32_bf16 v[52:55], a[16:19], v[100:103], v[52:55]
    v_mfma_f32_16x16x32_bf16 v[60:63], a[96:99], v[100:103], v[60:63]
    v_mfma_f32_16x16x32_bf16 v[68:71], a[176:179], v[100:103], v[68:71]
    v_mfma_f32_16x16x32_bf16 v[76:79], v[192:195], v[100:103], v[76:79]
    ds_read_b128 v[120:123], v11 offset:44032
    ds_read_b128 v[124:127], v13 offset:44032
    s_waitcnt lgkmcnt(5)
    v_mfma_f32_16x16x32_bf16 v[48:51], a[20:23], v[104:107], v[48:51]
    v_mfma_f32_16x16x32_bf16 v[56:59], a[100:103], v[104:107], v[56:59]
    v_mfma_f32_16x16x32_bf16 v[64:67], a[180:183], v[104:107], v[64:67]
    v_mfma_f32_16x16x32_bf16 v[72:75], v[196:199], v[104:107], v[72:75]
    s_waitcnt lgkmcnt(4)
    v_mfma_f32_16x16x32_bf16 v[52:55], a[20:23], v[108:111], v[52:55]
    v_mfma_f32_16x16x32_bf16 v[60:63], a[100:103], v[108:111], v[60:63]
    v_mfma_f32_16x16x32_bf16 v[68:71], a[180:183], v[108:111], v[68:71]
    v_mfma_f32_16x16x32_bf16 v[76:79], v[196:199], v[108:111], v[76:79]
    ds_read_b128 v[96:99], v10 offset:45056
    ds_read_b128 v[100:103], v12 offset:45056
    s_waitcnt lgkmcnt(5)
    v_mfma_f32_16x16x32_bf16 v[48:51], a[24:27], v[112:115], v[48:51]
    v_mfma_f32_16x16x32_bf16 v[56:59], a[104:107], v[112:115], v[56:59]
    v_mfma_f32_16x16x32_bf16 v[64:67], a[184:187], v[112:115], v[64:67]
    v_mfma_f32_16x16x32_bf16 v[72:75], v[200:203], v[112:115], v[72:75]
    s_waitcnt lgkmcnt(4)
    v_mfma_f32_16x16x32_bf16 v[52:55], a[24:27], v[116:119], v[52:55]
    v_mfma_f32_16x16x32_bf16 v[60:63], a[104:107], v[116:119], v[60:63]
    v_mfma_f32_16x16x32_bf16 v[68:71], a[184:187], v[116:119], v[68:71]
    v_mfma_f32_16x16x32_bf16 v[76:79], v[200:203], v[116:119], v[76:79]
    ds_read_b128 v[104:107], v11 offset:45056
    ds_read_b128 v[108:111], v13 offset:45056
    s_waitcnt lgkmcnt(5)
    v_mfma_f32_16x16x32_bf16 v[48:51], a[28:31], v[120:123], v[48:51]
    v_mfma_f32_16x16x32_bf16 v[56:59], a[108:111], v[120:123], v[56:59]
    v_mfma_f32_16x16x32_bf16 v[64:67], a[188:191], v[120:123], v[64:67]
    v_mfma_f32_16x16x32_bf16 v[72:75], v[204:207], v[120:123], v[72:75]
    s_waitcnt lgkmcnt(4)
    v_mfma_f32_16x16x32_bf16 v[52:55], a[28:31], v[124:127], v[52:55]
    v_mfma_f32_16x16x32_bf16 v[60:63], a[108:111], v[124:127], v[60:63]
    v_mfma_f32_16x16x32_bf16 v[68:71], a[188:191], v[124:127], v[68:71]
    v_mfma_f32_16x16x32_bf16 v[76:79], v[204:207], v[124:127], v[76:79]
    ds_read_b128 v[112:115], v10 offset:46080
    ds_read_b128 v[116:119], v12 offset:46080
    s_waitcnt lgkmcnt(5)
    v_mfma_f32_16x16x32_bf16 v[48:51], a[32:35], v[96:99], v[48:51]
    v_mfma_f32_16x16x32_bf16 v[56:59], a[112:115], v[96:99], v[56:59]
    v_mfma_f32_16x16x32_bf16 v[64:67], a[192:195], v[96:99], v[64:67]
    v_mfma_f32_16x16x32_bf16 v[72:75], v[208:211], v[96:99], v[72:75]
    s_waitcnt lgkmcnt(4)
    v_mfma_f32_16x16x32_bf16 v[52:55], a[32:35], v[100:103], v[52:55]
    v_mfma_f32_16x16x32_bf16 v[60:63], a[112:115], v[100:103], v[60:63]
    v_mfma_f32_16x16x32_bf16 v[68:71], a[192:195], v[100:103], v[68:71]
    v_mfma_f32_16x16x32_bf16 v[76:79], v[208:211], v[100:103], v[76:79]
    ds_read_b128 v[120:123], v11 offset:46080
    ds_read_b128 v[124:127], v13 offset:46080
    s_waitcnt lgkmcnt(5)
    v_mfma_f32_16x16x32_bf16 v[48:51], a[36:39], v[104:107], v[48:51]
    v_mfma_f32_16x16x32_bf16 v[56:59], a[116:119], v[104:107], v[56:59]
    v_mfma_f32_16x16x32_bf16 v[64:67], a[196:199], v[104:107], v[64:67]
    v_mfma_f32_16x16x32_bf16 v[72:75], v[212:215], v[104:107], v[72:75]
    s_waitcnt lgkmcnt(4)
    v_mfma_f32_16x16x32_bf16 v[52:55], a[36:39], v[108:111], v[52:55]
    v_mfma_f32_16x16x32_bf16 v[60:63], a[116:119], v[108:111], v[60:63]
    v_mfma_f32_16x16x32_bf16 v[68:71], a[196:199], v[108:111], v[68:71]
    v_mfma_f32_16x16x32_bf16 v[76:79], v[212:215], v[108:111], v[76:79]
L_h1_170:
    s_waitcnt vmcnt(0)
    v_mov_b32 v4, s75
    s_mov_b64 exec, 1
    s_cmp_eq_u32 s7, 0
    s_cbranch_scc1 L_sl_174
    buffer_store_dword v4, off, s[8:11], s65
    s_branch L_sd_175
L_sl_174:
    buffer_store_dword v4, off, s[8:11], s65 sc1
L_sd_175:
    s_mov_b64 exec, -1
    s_and_b32 s88, s76, 3
    s_add_u32 s88, s88, 4
    s_mul_i32 s88, s88, 147456
    s_add_u32 s88, s88, s72
    s_sub_u32 s89, s76, 3
    s_cselect_b32 s89, 0, s89
    buffer_load_dword v3, v7, s[8:11], s82 offen offset:32 sc1
    s_add_u32 s76, s76, 1
    s_cmp_ge_u32 s75, 64
    s_cbranch_scc1 L_tail_139
    s_add_u32 s79, s79, 40960
    ds_read_b128 v[96:99], v10 offset:47104
    ds_read_b128 v[100:103], v12 offset:47104
    s_waitcnt lgkmcnt(5)
    v_mfma_f32_16x16x32_bf16 v[48:51], a[40:43], v[112:115], v[48:51]
    v_mfma_f32_16x16x32_bf16 v[56:59], a[120:123], v[112:115], v[56:59]
    v_mfma_f32_16x16x32_bf16 v[64:67], a[200:203], v[112:115], v[64:67]
    v_mfma_f32_16x16x32_bf16 v[72:75], v[216:219], v[112:115], v[72:75]
    s_add_u32 m0, s83, 0
    s_nop 0
    buffer_load_dwordx4 v8, s[8:11], s79 offen offset:0 sc1 lds
    s_waitcnt lgkmcnt(4)
    v_mfma_f32_16x16x32_bf16 v[52:55], a[40:43], v[116:119], v[52:55]
    v_mfma_f32_16x16x32_bf16 v[60:63], a[120:123], v[116:119], v[60:63]
    v_mfma_f32_16x16x32_bf16 v[68:71], a[200:203], v[116:119], v[68:71]
    v_mfma_f32_16x16x32_bf16 v[76:79], v[216:219], v[116:119], v[76:79]
    s_add_u32 m0, m0, 896
    s_nop 0
    buffer_load_dwordx4 v8, s[8:11], s79 offen offset:128 sc1 lds
    ds_read_b128 v[104:107], v11 offset:47104
    ds_read_b128 v[108:111], v13 offset:47104
    s_waitcnt lgkmcnt(5)
    v_mfma_f32_16x16x32_bf16 v[48:51], a[44:47], v[120:123], v[48:51]
    v_mfma_f32_16x16x32_bf16 v[56:59], a[124:127], v[120:123], v[56:59]
    v_mfma_f32_16x16x32_bf16 v[64:67], a[204:207], v[120:123], v[64:67]
    v_mfma_f32_16x16x32_bf16 v[72:75], v[220:223], v[120:123], v[72:75]
    s_add_u32 m0, m0, 896
    s_nop 0
    buffer_load_dwordx4 v8, s[8:11], s79 offen offset:256 sc1 lds
    s_waitcnt lgkmcnt(4)
    v_mfma_f32_16x16x32_bf16 v[52:55], a[44:47], v[124:127], v[52:55]
    v_mfma_f32_16x16x32_bf16 v[60:63], a[124:127], v[124:127], v[60:63]
    v_mfma_f32_16x16x32_bf16 v[68:71], a[204:207], v[124:127], v[68:71]
    v_mfma_f32_16x16x32_bf16 v[76:79], v[220:223], v[124:127], v[76:79]
    s_add_u32 m0, m0, 896
    s_nop 0
    buffer_load_dwordx4 v8, s[8:11], s79 offen offset:384 sc1 lds
    ds_read_b128 v[112:115], v10 offset:48128
    ds_read_b128 v[116:119], v12 offset:48128
    s_waitcnt lgkmcnt(5)
    v_mfma_f32_16x16x32_bf16 v[48:51], a[48:51], v[96:99], v[48:51]
    v_mfma_f32_16x16x32_bf16 v[56:59], a[128:131], v[96:99], v[56:59]
    v_mfma_f32_16x16x32_bf16 v[64:67], a[208:211], v[96:99], v[64:67]
    v_mfma_f32_16x16x32_bf16 v[72:75], v[224:227], v[96:99], v[72:75]
    s_add_u32 m0, m0, 896
    s_nop 0
    buffer_load_dwordx4 v8, s[8:11], s79 offen offset:512 sc1 lds
    s_waitcnt lgkmcnt(4)
    v_mfma_f32_16x16x32_bf16 v[52:55], a[48:51], v[100:103], v[52:55]
    v_mfma_f32_16x16x32_bf16 v[60:63], a[128:131], v[100:103], v[60:63]
    v_mfma_f32_16x16x32_bf16 v[68:71], a[208:211], v[100:103], v[68:71]
    v_mfma_f32_16x16x32_bf16 v[76:79], v[224:227], v[100:103], v[76:79]
    s_add_u32 m0, m0, 896
    s_nop 0
    buffer_load_dwordx4 v8, s[8:11], s79 offen offset:640 sc1 lds
    ds_read_b128 v[120:123], v11 offset:48128
    ds_read_b128 v[124:127], v13 offset:48128
    s_waitcnt lgkmcnt(5)
    v_mfma_f32_16x16x32_bf16 v[48:51], a[52:55], v[104:107], v[48:51]
    v_mfma_f32_16x16x32_bf16 v[56:59], a[132:135], v[104:107], v[56:59]
    v_mfma_f32_16x16x32_bf16 v[64:67], a[212:215], v[104:107], v[64:67]
    v_mfma_f32_16x16x32_bf16 v[72:75], v[228:231], v[104:107], v[72:75]
    s_add_u32 m0, m0, 896
    s_nop 0
    buffer_load_dwordx4 v8, s[8:11], s79 offen offset:768 sc1 lds
    s_waitcnt lgkmcnt(4)
    v_mfma_f32_16x16x32_bf16 v[52:55], a[52:55], v[108:111], v[52:55]
    v_mfma_f32_16x16x32_bf16 v[60:63], a[132:135], v[108:111], v[60:63]
    v_mfma_f32_16x16x32_bf16 v[68:71], a[212:215], v[108:111], v[68:71]
    v_mfma_f32_16x16x32_bf16 v[76:79], v[228:231], v[108:111], v[76:79]
    s_add_u32 m0, m0, 896
    s_nop 0
    buffer_load_dwordx4 v8, s[8:11], s79 offen offset:896 sc1 lds
    ds_read_b128 v[96:99], v10 offset:49152
    ds_read_b128 v[100:103], v12 offset:49152
    s_waitcnt lgkmcnt(5)
    v_mfma_f32_16x16x32_bf16 v[48:51], a[56:59], v[112:115], v[48:51]
    v_mfma_f32_16x16x32_bf16 v[56:59], a[136:139], v[112:115], v[56:59]
    v_mfma_f32_16x16x32_bf16 v[64:67], a[216:219], v[112:115], v[64:67]
    v_mfma_f32_16x16x32_bf16 v[72:75], v[232:235], v[112:115], v[72:75]
    s_add_u32 m0, m0, 896
    s_nop 0
    buffer_load_dwordx4 v8, s[8:11], s79 offen offset:1024 sc1 lds
    s_waitcnt lgkmcnt(4)
    v_mfma_f32_16x16x32_bf16 v[52:55], a[56:59], v[116:119], v[52:55]
    v_mfma_f32_16x16x32_bf16 v[60:63], a[136:139], v[116:119], v[60:63]
    v_mfma_f32_16x16x32_bf16 v[68:71], a[216:219], v[116:119], v[68:71]
    v_mfma_f32_16x16x32_bf16 v[76:79], v[232:235], v[116:119], v[76:79]
    s_add_u32 m0, m0, 896
    s_nop 0
    buffer_load_dwordx4 v8, s[8:11], s79 offen offset:1152 sc1 lds
    ds_read_b128 v[104:107], v11 offset:49152
    ds_read_b128 v[108:111], v13 offset:49152
    s_waitcnt lgkmcnt(5)
    v_mfma_f32_16x16x32_bf16 v[48:51], a[60:63], v[120:123], v[48:51]
    v_mfma_f32_16x16x32_bf16 v[56:59], a[140:143], v[120:123], v[56:59]
    v_mfma_f32_16x16x32_bf16 v[64:67], a[220:223], v[120:123], v[64:67]
    v_mfma_f32_16x16x32_bf16 v[72:75], v[236:239], v[120:123], v[72:75]
    s_waitcnt lgkmcnt(4)
    v_mfma_f32_16x16x32_bf16 v[52:55], a[60:63], v[124:127], v[52:55]
    v_mfma_f32_16x16x32_bf16 v[60:63], a[140:143], v[124:127], v[60:63]
    v_mfma_f32_16x16x32_bf16 v[68:71], a[220:223], v[124:127], v[68:71]
    v_mfma_f32_16x16x32_bf16 v[76:79], v[236:239], v[124:127], v[76:79]
    ds_read_b128 v[112:115], v10 offset:50176
    ds_read_b128 v[116:119], v12 offset:50176
    s_waitcnt lgkmcnt(5)
    v_mfma_f32_16x16x32_bf16 v[48:51], a[64:67], v[96:99], v[48:51]
    v_mfma_f32_16x16x32_bf16 v[56:59], a[144:147], v[96:99], v[56:59]
    v_mfma_f32_16x16x32_bf16 v[64:67], a[224:227], v[96:99], v[64:67]
    v_mfma_f32_16x16x32_bf16 v[72:75], v[240:243], v[96:99], v[72:75]
    s_waitcnt lgkmcnt(4)
    v_mfma_f32_16x16x32_bf16 v[52:55], a[64:67], v[100:103], v[52:55]
    v_mfma_f32_16x16x32_bf16 v[60:63], a[144:147], v[100:103], v[60:63]
    v_mfma_f32_16x16x32_bf16 v[68:71], a[224:227], v[100:103], v[68:71]
    v_mfma_f32_16x16x32_bf16 v[76:79], v[240:243], v[100:103], v[76:79]
    ds_read_b128 v[120:123], v11 offset:50176
    ds_read_b128 v[124:127], v13 offset:50176
    s_waitcnt lgkmcnt(5)
    v_mfma_f32_16x16x32_bf16 v[48:51], a[68:71], v[104:107], v[48:51]
    v_mfma_f32_16x16x32_bf16 v[56:59], a[148:151], v[104:107], v[56:59]
    v_mfma_f32_16x16x32_bf16 v[64:67], a[228:231], v[104:107], v[64:67]
    v_mfma_f32_16x16x32_bf16 v[72:75], v[244:247], v[104:107], v[72:75]
    s_waitcnt lgkmcnt(4)
    v_mfma_f32_16x16x32_bf16 v[52:55], a[68:71], v[108:111], v[52:55]
    v_mfma_f32_16x16x32_bf16 v[60:63], a[148:151], v[108:111], v[60:63]
    v_mfma_f32_16x16x32_bf16 v[68:71], a[228:231], v[108:111], v[68:71]
    v_mfma_f32_16x16x32_bf16 v[76:79], v[244:247], v[108:111], v[76:79]
    s_waitcnt lgkmcnt(3)
    v_mfma_f32_16x16x32_bf16 v[48:51], a[72:75], v[112:115], v[48:51]
    v_mfma_f32_16x16x32_bf16 v[56:59], a[152:155], v[112:115], v[56:59]
    v_mfma_f32_16x16x32_bf16 v[64:67], a[232:235], v[112:115], v[64:67]
    v_mfma_f32_16x16x32_bf16 v[72:75], v[248:251], v[112:115], v[72:75]
    s_waitcnt lgkmcnt(2)
    v_mfma_f32_16x16x32_bf16 v[52:55], a[72:75], v[116:119], v[52:55]
    v_mfma_f32_16x16x32_bf16 v[60:63], a[152:155], v[116:119], v[60:63]
    v_mfma_f32_16x16x32_bf16 v[68:71], a[232:235], v[116:119], v[68:71]
    v_mfma_f32_16x16x32_bf16 v[76:79], v[248:251], v[116:119], v[76:79]
    s_waitcnt lgkmcnt(1)
    v_mfma_f32_16x16x32_bf16 v[48:51], a[76:79], v[120:123], v[48:51]
    v_mfma_f32_16x16x32_bf16 v[56:59], a[156:159], v[120:123], v[56:59]
    v_mfma_f32_16x16x32_bf16 v[64:67], a[236:239], v[120:123], v[64:67]
    v_mfma_f32_16x16x32_bf16 v[72:75], v[252:255], v[120:123], v[72:75]
    s_waitcnt lgkmcnt(0)
    v_mfma_f32_16x16x32_bf16 v[52:55], a[76:79], v[124:127], v[52:55]
    v_mfma_f32_16x16x32_bf16 v[60:63], a[156:159], v[124:127], v[60:63]
    v_mfma_f32_16x16x32_bf16 v[68:71], a[236:239], v[124:127], v[68:71]
    v_mfma_f32_16x16x32_bf16 v[76:79], v[252:255], v[124:127], v[76:79]
    s_mov_b32 s87, s7
    s_cmp_lg_u32 s7, 0
    s_cbranch_scc1 L_df_176
    s_waitcnt vmcnt(0)
    v_cvt_pk_bf16_f32 v80, v48, v49
    v_cvt_pk_bf16_f32 v81, v50, v51
    v_cvt_pk_bf16_f32 v82, v52, v53
    v_cvt_pk_bf16_f32 v83, v54, v55
    v_cvt_pk_bf16_f32 v84, v56, v57
    v_cvt_pk_bf16_f32 v85, v58, v59
    v_cvt_pk_bf16_f32 v86, v60, v61
    v_cvt_pk_bf16_f32 v87, v62, v63
    v_permlane32_swap_b32 v80, v82
    v_permlane32_swap_b32 v81, v83
    v_permlane32_swap_b32 v84, v86
    v_permlane32_swap_b32 v85, v87
    v_cmp_gt_u32 vcc, s89, v3
    s_cbranch_vccz L_bp_177
L_poll_178:
    buffer_load_dword v3, v7, s[8:11], s82 offen offset:32 sc1
    s_waitcnt vmcnt(0)
    v_cmp_gt_u32 vcc, s89, v3
    s_cbranch_vccz L_pok_179
    s_sleep 1
    s_sub_u32 s6, s6, 1
    s_cbranch_scc0 L_poll_178
    s_branch L_fail
L_pok_179:
L_bp_177:
    s_cmp_eq_u32 s7, 0
    s_cbranch_scc1 L_sl_180
    buffer_store_dwordx4 v[80:83], v9, s[8:11], s88 offen offset:0
    buffer_store_dwordx4 v[84:87], v9, s[8:11], s88 offen offset:1024
    s_branch L_sd_181
L_sl_180:
    buffer_store_dwordx4 v[80:83], v9, s[8:11], s88 offen offset:0 sc1
    buffer_store_dwordx4 v[84:87], v9, s[8:11], s88 offen offset:1024 sc1
L_sd_181:
    v_cvt_pk_bf16_f32 v88, v64, v65
    v_cvt_pk_bf16_f32 v89, v66, v67
    v_cvt_pk_bf16_f32 v90, v68, v69
    v_cvt_pk_bf16_f32 v91, v70, v71
    v_cvt_pk_bf16_f32 v92, v72, v73
    v_cvt_pk_bf16_f32 v93, v74, v75
    v_cvt_pk_bf16_f32 v94, v76, v77
    v_cvt_pk_bf16_f32 v95, v78, v79
    v_permlane32_swap_b32 v88, v90
    v_permlane32_swap_b32 v89, v91
    v_permlane32_swap_b32 v92, v94
    v_permlane32_swap_b32 v93, v95
    s_cmp_eq_u32 s7, 0
    s_cbranch_scc1 L_sl_182
    buffer_store_dwordx4 v[88:91], v9, s[8:11], s88 offen offset:2048
    buffer_store_dwordx4 v[92:95], v9, s[8:11], s88 offen offset:3072
    s_branch L_sd_183
L_sl_182:
    buffer_store_dwordx4 v[88:91], v9, s[8:11], s88 offen offset:2048 sc1
    buffer_store_dwordx4 v[92:95], v9, s[8:11], s88 offen offset:3072 sc1
L_sd_183:
L_df_176:
    s_waitcnt vmcnt(0)
    s_barrier
    s_branch L_qkv_b_q
L_tail_139:
    ds_read_b128 v[96:99], v10 offset:47104
    ds_read_b128 v[100:103], v12 offset:47104
    s_waitcnt lgkmcnt(5)
    v_mfma_f32_16x16x32_bf16 v[48:51], a[40:43], v[112:115], v[48:51]
    v_mfma_f32_16x16x32_bf16 v[56:59], a[120:123], v[112:115], v[56:59]
    v_mfma_f32_16x16x32_bf16 v[64:67], a[200:203], v[112:115], v[64:67]
    v_mfma_f32_16x16x32_bf16 v[72:75], v[216:219], v[112:115], v[72:75]
    s_waitcnt lgkmcnt(4)
    v_mfma_f32_16x16x32_bf16 v[52:55], a[40:43], v[116:119], v[52:55]
    v_mfma_f32_16x16x32_bf16 v[60:63], a[120:123], v[116:119], v[60:63]
    v_mfma_f32_16x16x32_bf16 v[68:71], a[200:203], v[116:119], v[68:71]
    v_mfma_f32_16x16x32_bf16 v[76:79], v[216:219], v[116:119], v[76:79]
    ds_read_b128 v[104:107], v11 offset:47104
    ds_read_b128 v[108:111], v13 offset:47104
    s_waitcnt lgkmcnt(5)
    v_mfma_f32_16x16x32_bf16 v[48:51], a[44:47], v[120:123], v[48:51]
    v_mfma_f32_16x16x32_bf16 v[56:59], a[124:127], v[120:123], v[56:59]
    v_mfma_f32_16x16x32_bf16 v[64:67], a[204:207], v[120:123], v[64:67]
    v_mfma_f32_16x16x32_bf16 v[72:75], v[220:223], v[120:123], v[72:75]
    s_waitcnt lgkmcnt(4)
    v_mfma_f32_16x16x32_bf16 v[52:55], a[44:47], v[124:127], v[52:55]
    v_mfma_f32_16x16x32_bf16 v[60:63], a[124:127], v[124:127], v[60:63]
    v_mfma_f32_16x16x32_bf16 v[68:71], a[204:207], v[124:127], v[68:71]
    v_mfma_f32_16x16x32_bf16 v[76:79], v[220:223], v[124:127], v[76:79]
    ds_read_b128 v[112:115], v10 offset:48128
    ds_read_b128 v[116:119], v12 offset:48128
    s_waitcnt lgkmcnt(5)
    v_mfma_f32_16x16x32_bf16 v[48:51], a[48:51], v[96:99], v[48:51]
    v_mfma_f32_16x16x32_bf16 v[56:59], a[128:131], v[96:99], v[56:59]
    v_mfma_f32_16x16x32_bf16 v[64:67], a[208:211], v[96:99], v[64:67]
    v_mfma_f32_16x16x32_bf16 v[72:75], v[224:227], v[96:99], v[72:75]
    s_waitcnt lgkmcnt(4)
    v_mfma_f32_16x16x32_bf16 v[52:55], a[48:51], v[100:103], v[52:55]
    v_mfma_f32_16x16x32_bf16 v[60:63], a[128:131], v[100:103], v[60:63]
    v_mfma_f32_16x16x32_bf16 v[68:71], a[208:211], v[100:103], v[68:71]
    v_mfma_f32_16x16x32_bf16 v[76:79], v[224:227], v[100:103], v[76:79]
    ds_read_b128 v[120:123], v11 offset:48128
    ds_read_b128 v[124:127], v13 offset:48128
    s_waitcnt lgkmcnt(5)
    v_mfma_f32_16x16x32_bf16 v[48:51], a[52:55], v[104:107], v[48:51]
    v_mfma_f32_16x16x32_bf16 v[56:59], a[132:135], v[104:107], v[56:59]
    v_mfma_f32_16x16x32_bf16 v[64:67], a[212:215], v[104:107], v[64:67]
    v_mfma_f32_16x16x32_bf16 v[72:75], v[228:231], v[104:107], v[72:75]
    s_waitcnt lgkmcnt(4)
    v_mfma_f32_16x16x32_bf16 v[52:55], a[52:55], v[108:111], v[52:55]
    v_mfma_f32_16x16x32_bf16 v[60:63], a[132:135], v[108:111], v[60:63]
    v_mfma_f32_16x16x32_bf16 v[68:71], a[212:215], v[108:111], v[68:71]
    v_mfma_f32_16x16x32_bf16 v[76:79], v[228:231], v[108:111], v[76:79]
    ds_read_b128 v[96:99], v10 offset:49152
    ds_read_b128 v[100:103], v12 offset:49152
    s_waitcnt lgkmcnt(5)
    v_mfma_f32_16x16x32_bf16 v[48:51], a[56:59], v[112:115], v[48:51]
    v_mfma_f32_16x16x32_bf16 v[56:59], a[136:139], v[112:115], v[56:59]
    v_mfma_f32_16x16x32_bf16 v[64:67], a[216:219], v[112:115], v[64:67]
    v_mfma_f32_16x16x32_bf16 v[72:75], v[232:235], v[112:115], v[72:75]
    s_waitcnt lgkmcnt(4)
    v_mfma_f32_16x16x32_bf16 v[52:55], a[56:59], v[116:119], v[52:55]
    v_mfma_f32_16x16x32_bf16 v[60:63], a[136:139], v[116:119], v[60:63]
    v_mfma_f32_16x16x32_bf16 v[68:71], a[216:219], v[116:119], v[68:71]
    v_mfma_f32_16x16x32_bf16 v[76:79], v[232:235], v[116:119], v[76:79]
    ds_read_b128 v[104:107], v11 offset:49152
    ds_read_b128 v[108:111], v13 offset:49152
    s_waitcnt lgkmcnt(5)
    v_mfma_f32_16x16x32_bf16 v[48:51], a[60:63], v[120:123], v[48:51]
    v_mfma_f32_16x16x32_bf16 v[56:59], a[140:143], v[120:123], v[56:59]
    v_mfma_f32_16x16x32_bf16 v[64:67], a[220:223], v[120:123], v[64:67]
    v_mfma_f32_16x16x32_bf16 v[72:75], v[236:239], v[120:123], v[72:75]
    s_waitcnt lgkmcnt(4)
    v_mfma_f32_16x16x32_bf16 v[52:55], a[60:63], v[124:127], v[52:55]
    v_mfma_f32_16x16x32_bf16 v[60:63], a[140:143], v[124:127], v[60:63]
    v_mfma_f32_16x16x32_bf16 v[68:71], a[220:223], v[124:127], v[68:71]
    v_mfma_f32_16x16x32_bf16 v[76:79], v[236:239], v[124:127], v[76:79]
    ds_read_b128 v[112:115], v10 offset:50176
    ds_read_b128 v[116:119], v12 offset:50176
    s_waitcnt lgkmcnt(5)
    v_mfma_f32_16x16x32_bf16 v[48:51], a[64:67], v[96:99], v[48:51]
    v_mfma_f32_16x16x32_bf16 v[56:59], a[144:147], v[96:99], v[56:59]
    v_mfma_f32_16x16x32_bf16 v[64:67], a[224:227], v[96:99], v[64:67]
    v_mfma_f32_16x16x32_bf16 v[72:75], v[240:243], v[96:99], v[72:75]
    s_waitcnt lgkmcnt(4)
    v_mfma_f32_16x16x32_bf16 v[52:55], a[64:67], v[100:103], v[52:55]
    v_mfma_f32_16x16x32_bf16 v[60:63], a[144:147], v[100:103], v[60:63]
    v_mfma_f32_16x16x32_bf16 v[68:71], a[224:227], v[100:103], v[68:71]
    v_mfma_f32_16x16x32_bf16 v[76:79], v[240:243], v[100:103], v[76:79]
    ds_read_b128 v[120:123], v11 offset:50176
    ds_read_b128 v[124:127], v13 offset:50176
    s_waitcnt lgkmcnt(5)
    v_mfma_f32_16x16x32_bf16 v[48:51], a[68:71], v[104:107], v[48:51]
    v_mfma_f32_16x16x32_bf16 v[56:59], a[148:151], v[104:107], v[56:59]
    v_mfma_f32_16x16x32_bf16 v[64:67], a[228:231], v[104:107], v[64:67]
    v_mfma_f32_16x16x32_bf16 v[72:75], v[244:247], v[104:107], v[72:75]
    s_waitcnt lgkmcnt(4)
    v_mfma_f32_16x16x32_bf16 v[52:55], a[68:71], v[108:111], v[52:55]
    v_mfma_f32_16x16x32_bf16 v[60:63], a[148:151], v[108:111], v[60:63]
    v_mfma_f32_16x16x32_bf16 v[68:71], a[228:231], v[108:111], v[68:71]
    v_mfma_f32_16x16x32_bf16 v[76:79], v[244:247], v[108:111], v[76:79]
    s_waitcnt lgkmcnt(3)
    v_mfma_f32_16x16x32_bf16 v[48:51], a[72:75], v[112:115], v[48:51]
    v_mfma_f32_16x16x32_bf16 v[56:59], a[152:155], v[112:115], v[56:59]
    v_mfma_f32_16x16x32_bf16 v[64:67], a[232:235], v[112:115], v[64:67]
    v_mfma_f32_16x16x32_bf16 v[72:75], v[248:251], v[112:115], v[72:75]
    s_waitcnt lgkmcnt(2)
    v_mfma_f32_16x16x32_bf16 v[52:55], a[72:75], v[116:119], v[52:55]
    v_mfma_f32_16x16x32_bf16 v[60:63], a[152:155], v[116:119], v[60:63]
    v_mfma_f32_16x16x32_bf16 v[68:71], a[232:235], v[116:119], v[68:71]
    v_mfma_f32_16x16x32_bf16 v[76:79], v[248:251], v[116:119], v[76:79]
    s_waitcnt lgkmcnt(1)
    v_mfma_f32_16x16x32_bf16 v[48:51], a[76:79], v[120:123], v[48:51]
    v_mfma_f32_16x16x32_bf16 v[56:59], a[156:159], v[120:123], v[56:59]
    v_mfma_f32_16x16x32_bf16 v[64:67], a[236:239], v[120:123], v[64:67]
    v_mfma_f32_16x16x32_bf16 v[72:75], v[252:255], v[120:123], v[72:75]
    s_waitcnt lgkmcnt(0)
    v_mfma_f32_16x16x32_bf16 v[52:55], a[76:79], v[124:127], v[52:55]
    v_mfma_f32_16x16x32_bf16 v[60:63], a[156:159], v[124:127], v[60:63]
    v_mfma_f32_16x16x32_bf16 v[68:71], a[236:239], v[124:127], v[68:71]
    v_mfma_f32_16x16x32_bf16 v[76:79], v[252:255], v[124:127], v[76:79]
    s_waitcnt vmcnt(0)
    v_cvt_pk_bf16_f32 v80, v48, v49
    v_cvt_pk_bf16_f32 v81, v50, v51
    s_nop 1
    v_cvt_pk_bf16_f32 v82, v52, v53
    v_cvt_pk_bf16_f32 v83, v54, v55
    v_cvt_pk_bf16_f32 v84, v56, v57
    v_cvt_pk_bf16_f32 v85, v58, v59
    v_cvt_pk_bf16_f32 v86, v60, v61
    v_cvt_pk_bf16_f32 v87, v62, v63
    v_permlane32_swap_b32 v80, v82
    v_permlane32_swap_b32 v81, v83
    v_permlane32_swap_b32 v84, v86
    v_permlane32_swap_b32 v85, v87
    v_cmp_gt_u32 vcc, s89, v3
    s_cbranch_vccz L_bp_184
L_poll_185:
    buffer_load_dword v3, v7, s[8:11], s82 offen offset:32 sc1
    s_waitcnt vmcnt(0)
    v_cmp_gt_u32 vcc, s89, v3
    s_cbranch_vccz L_pok_186
    s_sleep 1
    s_sub_u32 s6, s6, 1
    s_cbranch_scc0 L_poll_185
    s_branch L_fail
L_pok_186:
L_bp_184:
    s_cmp_eq_u32 s7, 0
    s_cbranch_scc1 L_sl_187
    buffer_store_dwordx4 v[80:83], v9, s[8:11], s88 offen offset:0
    buffer_store_dwordx4 v[84:87], v9, s[8:11], s88 offen offset:1024
    s_branch L_sd_188
L_sl_187:
    buffer_store_dwordx4 v[80:83], v9, s[8:11], s88 offen offset:0 sc1
    buffer_store_dwordx4 v[84:87], v9, s[8:11], s88 offen offset:1024 sc1
L_sd_188:
    v_cvt_pk_bf16_f32 v88, v64, v65
    v_cvt_pk_bf16_f32 v89, v66, v67
    v_cvt_pk_bf16_f32 v90, v68, v69
    v_cvt_pk_bf16_f32 v91, v70, v71
    v_cvt_pk_bf16_f32 v92, v72, v73
    v_cvt_pk_bf16_f32 v93, v74, v75
    v_cvt_pk_bf16_f32 v94, v76, v77
    v_cvt_pk_bf16_f32 v95, v78, v79
    v_permlane32_swap_b32 v88, v90
    v_permlane32_swap_b32 v89, v91
    v_permlane32_swap_b32 v92, v94
    v_permlane32_swap_b32 v93, v95
    s_cmp_eq_u32 s7, 0
    s_cbranch_scc1 L_sl_189
    buffer_store_dwordx4 v[88:91], v9, s[8:11], s88 offen offset:2048
    buffer_store_dwordx4 v[92:95], v9, s[8:11], s88 offen offset:3072
    s_branch L_sd_190
L_sl_189:
    buffer_store_dwordx4 v[88:91], v9, s[8:11], s88 offen offset:2048 sc1
    buffer_store_dwordx4 v[92:95], v9, s[8:11], s88 offen offset:3072 sc1
L_sd_190:
    s_waitcnt vmcnt(0)
    v_mov_b32 v4, s76
    s_mov_b64 exec, 1
    s_cmp_eq_u32 s7, 0
    s_cbranch_scc1 L_sl_191
    buffer_store_dword v4, off, s[8:11], s66
    s_branch L_sd_192
L_sl_191:
    buffer_store_dword v4, off, s[8:11], s66 sc1
L_sd_192:
    s_mov_b64 exec, -1
    s_cmp_ge_u32 s76, 64
    s_cbranch_scc1 L_qkv_fin
    s_barrier
    s_mov_b32 s87, 0
    s_add_u32 s80, s76, 1
    s_mul_i32 s81, s76, 40960
    s_add_u32 s81, s81, 14680064
    s_branch L_blk_137
L_qkv_v:
    v_and_b32 v6, 7, v0
    v_lshlrev_b32 v6, 7, v6
    s_mov_b32 s75, 0
    s_mov_b32 s76, 0
    s_mov_b32 s79, 4194304
    s_add_u32 m0, s83, 40960
    s_nop 0
    buffer_load_dwordx4 v8, s[8:11], s79 offen offset:0 sc1 lds
    s_add_u32 m0, m0, 896
    s_nop 0
    buffer_load_dwordx4 v8, s[8:11], s79 offen offset:128 sc1 lds
    s_add_u32 m0, m0, 896
    s_nop 0
    buffer_load_dwordx4 v8, s[8:11], s79 offen offset:256 sc1 lds
    s_add_u32 m0, m0, 896
    s_nop 0
    buffer_load_dwordx4 v8, s[8:11], s79 offen offset:384 sc1 lds
    s_add_u32 m0, m0, 896
    s_nop 0
    buffer_load_dwordx4 v8, s[8:11], s79 offen offset:512 sc1 lds
    s_add_u32 m0, m0, 896
    s_nop 0
    buffer_load_dwordx4 v8, s[8:11], s79 offen offset:640 sc1 lds
    s_add_u32 m0, m0, 896
    s_nop 0
    buffer_load_dwordx4 v8, s[8:11], s79 offen offset:768 sc1 lds
    s_add_u32 m0, m0, 896
    s_nop 0
    buffer_load_dwordx4 v8, s[8:11], s79 offen offset:896 sc1 lds
    s_add_u32 m0, m0, 896
    s_nop 0
    buffer_load_dwordx4 v8, s[8:11], s79 offen offset:1024 sc1 lds
    s_add_u32 m0, m0, 896
    s_nop 0
    buffer_load_dwordx4 v8, s[8:11], s79 offen offset:1152 sc1 lds
    s_waitcnt vmcnt(0)
    s_barrier
    s_branch L_qkv_a_v1
L_qkv_a_v:
    s_add_u32 s79, s79, 40960
    s_and_b32 s88, s75, 3
    s_mul_i32 s88, s88, 147456
    s_add_u32 s88, s88, s72
    s_sub_u32 s89, s75, 3
    s_cselect_b32 s89, 0, s89
    ds_read_b128 v[96:99], v10 offset:0
    ds_read_b128 v[100:103], v12 offset:0
    ds_read_b128 v[104:107], v11 offset:0
    ds_read_b128 v[108:111], v13 offset:0
    ds_read_b128 v[112:115], v10 offset:1024
    ds_read_b128 v[116:119], v12 offset:1024
    s_waitcnt lgkmcnt(5)
    v_mfma_f32_16x16x32_bf16 v[16:19], v[96:99], a[0:3], 0
    v_mfma_f32_16x16x32_bf16 v[24:27], v[96:99], a[80:83], 0
    v_mfma_f32_16x16x32_bf16 v[32:35], v[96:99], a[160:163], 0
    v_mfma_f32_16x16x32_bf16 v[40:43], v[96:99], a[240:243], 0
    s_add_u32 m0, s83, 40960
    s_nop 0
    buffer_load_dwordx4 v8, s[8:11], s79 offen offset:0 sc1 lds
    s_waitcnt lgkmcnt(4)
    v_mfma_f32_16x16x32_bf16 v[20:23], v[100:103], a[0:3], 0
    v_mfma_f32_16x16x32_bf16 v[28:31], v[100:103], a[80:83], 0
    v_mfma_f32_16x16x32_bf16 v[36:39], v[100:103], a[160:163], 0
    v_mfma_f32_16x16x32_bf16 v[44:47], v[100:103], a[240:243], 0
    s_add_u32 m0, m0, 896
    s_nop 0
    buffer_load_dwordx4 v8, s[8:11], s79 offen offset:128 sc1 lds
    ds_read_b128 v[120:123], v11 offset:1024
    ds_read_b128 v[124:127], v13 offset:1024
    s_waitcnt lgkmcnt(5)
    v_mfma_f32_16x16x32_bf16 v[16:19], v[104:107], a[4:7], v[16:19]
    v_mfma_f32_16x16x32_bf16 v[24:27], v[104:107], a[84:87], v[24:27]
    v_mfma_f32_16x16x32_bf16 v[32:35], v[104:107], a[164:167], v[32:35]
    v_mfma_f32_16x16x32_bf16 v[40:43], v[104:107], a[244:247], v[40:43]
    s_add_u32 m0, m0, 896
    s_nop 0
    buffer_load_dwordx4 v8, s[8:11], s79 offen offset:256 sc1 lds
    s_waitcnt lgkmcnt(4)
    v_mfma_f32_16x16x32_bf16 v[20:23], v[108:111], a[4:7], v[20:23]
    v_mfma_f32_16x16x32_bf16 v[28:31], v[108:111], a[84:87], v[28:31]
    v_mfma_f32_16x16x32_bf16 v[36:39], v[108:111], a[164:167], v[36:39]
    v_mfma_f32_16x16x32_bf16 v[44:47], v[108:111], a[244:247], v[44:47]
    s_add_u32 m0, m0, 896
    s_nop 0
    buffer_load_dwordx4 v8, s[8:11], s79 offen offset:384 sc1 lds
    ds_read_b128 v[96:99], v10 offset:2048
    ds_read_b128 v[100:103], v12 offset:2048
    s_waitcnt lgkmcnt(5)
    v_mfma_f32_16x16x32_bf16 v[16:19], v[112:115], a[8:11], v[16:19]
    v_mfma_f32_16x16x32_bf16 v[24:27], v[112:115], a[88:91], v[24:27]
    v_mfma_f32_16x16x32_bf16 v[32:35], v[112:115], a[168:171], v[32:35]
    v_mfma_f32_16x16x32_bf16 v[40:43], v[112:115], a[248:251], v[40:43]
    s_add_u32 m0, m0, 896
    s_nop 0
    buffer_load_dwordx4 v8, s[8:11], s79 offen offset:512 sc1 lds
    s_waitcnt lgkmcnt(4)
    v_mfma_f32_16x16x32_bf16 v[20:23], v[116:119], a[8:11], v[20:23]
    v_mfma_f32_16x16x32_bf16 v[28:31], v[116:119], a[88:91], v[28:31]
    v_mfma_f32_16x16x32_bf16 v[36:39], v[116:119], a[168:171], v[36:39]
    v_mfma_f32_16x16x32_bf16 v[44:47], v[116:119], a[248:251], v[44:47]
    s_add_u32 m0, m0, 896
    s_nop 0
    buffer_load_dwordx4 v8, s[8:11], s79 offen offset:640 sc1 lds
    ds_read_b128 v[104:107], v11 offset:2048
    ds_read_b128 v[108:111], v13 offset:2048
    s_waitcnt lgkmcnt(5)
    v_mfma_f32_16x16x32_bf16 v[16:19], v[120:123], a[12:15], v[16:19]
    v_mfma_f32_16x16x32_bf16 v[24:27], v[120:123], a[92:95], v[24:27]
    v_mfma_f32_16x16x32_bf16 v[32:35], v[120:123], a[172:175], v[32:35]
    v_mfma_f32_16x16x32_bf16 v[40:43], v[120:123], a[252:255], v[40:43]
    s_add_u32 m0, m0, 896
    s_nop 0
    buffer_load_dwordx4 v8, s[8:11], s79 offen offset:768 sc1 lds
    s_waitcnt lgkmcnt(4)
    v_mfma_f32_16x16x32_bf16 v[20:23], v[124:127], a[12:15], v[20:23]
    v_mfma_f32_16x16x32_bf16 v[28:31], v[124:127], a[92:95], v[28:31]
    v_mfma_f32_16x16x32_bf16 v[36:39], v[124:127], a[172:175], v[36:39]
    v_mfma_f32_16x16x32_bf16 v[44:47], v[124:127], a[252:255], v[44:47]
    s_add_u32 m0, m0, 896
    s_nop 0
    buffer_load_dwordx4 v8, s[8:11], s79 offen offset:896 sc1 lds
    ds_read_b128 v[112:115], v10 offset:3072
    ds_read_b128 v[116:119], v12 offset:3072
    s_waitcnt lgkmcnt(5)
    v_mfma_f32_16x16x32_bf16 v[16:19], v[96:99], a[16:19], v[16:19]
    v_mfma_f32_16x16x32_bf16 v[24:27], v[96:99], a[96:99], v[24:27]
    v_mfma_f32_16x16x32_bf16 v[32:35], v[96:99], a[176:179], v[32:35]
    v_mfma_f32_16x16x32_bf16 v[40:43], v[96:99], v[192:195], v[40:43]
    s_add_u32 m0, m0, 896
    s_nop 0
    buffer_load_dwordx4 v8, s[8:11], s79 offen offset:1024 sc1 lds
    s_waitcnt lgkmcnt(4)
    v_mfma_f32_16x16x32_bf16 v[20:23], v[100:103], a[16:19], v[20:23]
    v_mfma_f32_16x16x32_bf16 v[28:31], v[100:103], a[96:99], v[28:31]
    v_mfma_f32_16x16x32_bf16 v[36:39], v[100:103], a[176:179], v[36:39]
    v_mfma_f32_16x16x32_bf16 v[44:47], v[100:103], v[192:195], v[44:47]
    s_add_u32 m0, m0, 896
    s_nop 0
    buffer_load_dwordx4 v8, s[8:11], s79 offen offset:1152 sc1 lds
    ds_read_b128 v[120:123], v11 offset:3072
    ds_read_b128 v[124:127], v13 offset:3072
    s_waitcnt lgkmcnt(5)
    v_mfma_f32_16x16x32_bf16 v[16:19], v[104:107], a[20:23], v[16:19]
    v_mfma_f32_16x16x32_bf16 v[24:27], v[104:107], a[100:103], v[24:27]
    v_mfma_f32_16x16x32_bf16 v[32:35], v[104:107], a[180:183], v[32:35]
    v_mfma_f32_16x16x32_bf16 v[40:43], v[104:107], v[196:199], v[40:43]
    s_waitcnt lgkmcnt(4)
    v_mfma_f32_16x16x32_bf16 v[20:23], v[108:111], a[20:23], v[20:23]
    v_mfma_f32_16x16x32_bf16 v[28:31], v[108:111], a[100:103], v[28:31]
    v_mfma_f32_16x16x32_bf16 v[36:39], v[108:111], a[180:183], v[36:39]
    v_mfma_f32_16x16x32_bf16 v[44:47], v[108:111], v[196:199], v[44:47]
    ds_read_b128 v[96:99], v10 offset:4096
    ds_read_b128 v[100:103], v12 offset:4096
    s_waitcnt lgkmcnt(5)
    v_mfma_f32_16x16x32_bf16 v[16:19], v[112:115], a[24:27], v[16:19]
    v_mfma_f32_16x16x32_bf16 v[24:27], v[112:115], a[104:107], v[24:27]
    v_mfma_f32_16x16x32_bf16 v[32:35], v[112:115], a[184:187], v[32:35]
    v_mfma_f32_16x16x32_bf16 v[40:43], v[112:115], v[200:203], v[40:43]
    buffer_load_dword v3, v7, s[8:11], s82 offen offset:0 sc1
    s_waitcnt lgkmcnt(4)
    v_mfma_f32_16x16x32_bf16 v[20:23], v[116:119], a[24:27], v[20:23]
    v_mfma_f32_16x16x32_bf16 v[28:31], v[116:119], a[104:107], v[28:31]
    v_mfma_f32_16x16x32_bf16 v[36:39], v[116:119], a[184:187], v[36:39]
    v_mfma_f32_16x16x32_bf16 v[44:47], v[116:119], v[200:203], v[44:47]
    ds_read_b128 v[104:107], v11 offset:4096
    ds_read_b128 v[108:111], v13 offset:4096
    s_waitcnt lgkmcnt(5)
    v_mfma_f32_16x16x32_bf16 v[16:19], v[120:123], a[28:31], v[16:19]
    v_mfma_f32_16x16x32_bf16 v[24:27], v[120:123], a[108:111], v[24:27]
    v_mfma_f32_16x16x32_bf16 v[32:35], v[120:123], a[188:191], v[32:35]
    v_mfma_f32_16x16x32_bf16 v[40:43], v[120:123], v[204:207], v[40:43]
    s_waitcnt lgkmcnt(4)
    v_mfma_f32_16x16x32_bf16 v[20:23], v[124:127], a[28:31], v[20:23]
    v_mfma_f32_16x16x32_bf16 v[28:31], v[124:127], a[108:111], v[28:31]
    v_mfma_f32_16x16x32_bf16 v[36:39], v[124:127], a[188:191], v[36:39]
    v_mfma_f32_16x16x32_bf16 v[44:47], v[124:127], v[204:207], v[44:47]
    ds_read_b128 v[112:115], v10 offset:5120
    ds_read_b128 v[116:119], v12 offset:5120
    s_waitcnt lgkmcnt(5)
    v_mfma_f32_16x16x32_bf16 v[16:19], v[96:99], a[32:35], v[16:19]
    v_mfma_f32_16x16x32_bf16 v[24:27], v[96:99], a[112:115], v[24:27]
    v_mfma_f32_16x16x32_bf16 v[32:35], v[96:99], a[192:195], v[32:35]
    v_mfma_f32_16x16x32_bf16 v[40:43], v[96:99], v[208:211], v[40:43]
    s_waitcnt lgkmcnt(4)
    v_mfma_f32_16x16x32_bf16 v[20:23], v[100:103], a[32:35], v[20:23]
    v_mfma_f32_16x16x32_bf16 v[28:31], v[100:103], a[112:115], v[28:31]
    v_mfma_f32_16x16x32_bf16 v[36:39], v[100:103], a[192:195], v[36:39]
    v_mfma_f32_16x16x32_bf16 v[44:47], v[100:103], v[208:211], v[44:47]
    ds_read_b128 v[120:123], v11 offset:5120
    ds_read_b128 v[124:127], v13 offset:5120
    s_waitcnt lgkmcnt(5)
    v_mfma_f32_16x16x32_bf16 v[16:19], v[104:107], a[36:39], v[16:19]
    v_mfma_f32_16x16x32_bf16 v[24:27], v[104:107], a[116:119], v[24:27]
    v_mfma_f32_16x16x32_bf16 v[32:35], v[104:107], a[196:199], v[32:35]
    v_mfma_f32_16x16x32_bf16 v[40:43], v[104:107], v[212:215], v[40:43]
    s_waitcnt lgkmcnt(4)
    v_mfma_f32_16x16x32_bf16 v[20:23], v[108:111], a[36:39], v[20:23]
    v_mfma_f32_16x16x32_bf16 v[28:31], v[108:111], a[116:119], v[28:31]
    v_mfma_f32_16x16x32_bf16 v[36:39], v[108:111], a[196:199], v[36:39]
    v_mfma_f32_16x16x32_bf16 v[44:47], v[108:111], v[212:215], v[44:47]
    ds_read_b128 v[96:99], v10 offset:6144
    ds_read_b128 v[100:103], v12 offset:6144
    s_waitcnt lgkmcnt(5)
    v_mfma_f32_16x16x32_bf16 v[16:19], v[112:115], a[40:43], v[16:19]
    v_mfma_f32_16x16x32_bf16 v[24:27], v[112:115], a[120:123], v[24:27]
    v_mfma_f32_16x16x32_bf16 v[32:35], v[112:115], a[200:203], v[32:35]
    v_mfma_f32_16x16x32_bf16 v[40:43], v[112:115], v[216:219], v[40:43]
    s_waitcnt lgkmcnt(4)
    v_mfma_f32_16x16x32_bf16 v[20:23], v[116:119], a[40:43], v[20:23]
    v_mfma_f32_16x16x32_bf16 v[28:31], v[116:119], a[120:123], v[28:31]
    v_mfma_f32_16x16x32_bf16 v[36:39], v[116:119], a[200:203], v[36:39]
    v_mfma_f32_16x16x32_bf16 v[44:47], v[116:119], v[216:219], v[44:47]
    ds_read_b128 v[104:107], v11 offset:6144
    ds_read_b128 v[108:111], v13 offset:6144
    s_waitcnt lgkmcnt(5)
    v_mfma_f32_16x16x32_bf16 v[16:19], v[120:123], a[44:47], v[16:19]
    v_mfma_f32_16x16x32_bf16 v[24:27], v[120:123], a[124:127], v[24:27]
    v_mfma_f32_16x16x32_bf16 v[32:35], v[120:123], a[204:207], v[32:35]
    v_mfma_f32_16x16x32_bf16 v[40:43], v[120:123], v[220:223], v[40:43]
    s_waitcnt lgkmcnt(4)
    v_mfma_f32_16x16x32_bf16 v[20:23], v[124:127], a[44:47], v[20:23]
    v_mfma_f32_16x16x32_bf16 v[28:31], v[124:127], a[124:127], v[28:31]
    v_mfma_f32_16x16x32_bf16 v[36:39], v[124:127], a[204:207], v[36:39]
    v_mfma_f32_16x16x32_bf16 v[44:47], v[124:127], v[220:223], v[44:47]
    ds_read_b128 v[112:115], v10 offset:7168
    ds_read_b128 v[116:119], v12 offset:7168
    s_waitcnt lgkmcnt(5)
    v_mfma_f32_16x16x32_bf16 v[16:19], v[96:99], a[48:51], v[16:19]
    v_mfma_f32_16x16x32_bf16 v[24:27], v[96:99], a[128:131], v[24:27]
    v_mfma_f32_16x16x32_bf16 v[32:35], v[96:99], a[208:211], v[32:35]
    v_mfma_f32_16x16x32_bf16 v[40:43], v[96:99], v[224:227], v[40:43]
    s_waitcnt lgkmcnt(4)
    v_mfma_f32_16x16x32_bf16 v[20:23], v[100:103], a[48:51], v[20:23]
    v_mfma_f32_16x16x32_bf16 v[28:31], v[100:103], a[128:131], v[28:31]
    v_mfma_f32_16x16x32_bf16 v[36:39], v[100:103], a[208:211], v[36:39]
    v_mfma_f32_16x16x32_bf16 v[44:47], v[100:103], v[224:227], v[44:47]
    ds_read_b128 v[120:123], v11 offset:7168
    ds_read_b128 v[124:127], v13 offset:7168
    s_waitcnt lgkmcnt(5)
    v_mfma_f32_16x16x32_bf16 v[16:19], v[104:107], a[52:55], v[16:19]
    v_mfma_f32_16x16x32_bf16 v[24:27], v[104:107], a[132:135], v[24:27]
    v_mfma_f32_16x16x32_bf16 v[32:35], v[104:107], a[212:215], v[32:35]
    v_mfma_f32_16x16x32_bf16 v[40:43], v[104:107], v[228:231], v[40:43]
    s_waitcnt lgkmcnt(4)
    v_mfma_f32_16x16x32_bf16 v[20:23], v[108:111], a[52:55], v[20:23]
    v_mfma_f32_16x16x32_bf16 v[28:31], v[108:111], a[132:135], v[28:31]
    v_mfma_f32_16x16x32_bf16 v[36:39], v[108:111], a[212:215], v[36:39]
    v_mfma_f32_16x16x32_bf16 v[44:47], v[108:111], v[228:231], v[44:47]
    ds_read_b128 v[96:99], v10 offset:8192
    ds_read_b128 v[100:103], v12 offset:8192
    s_waitcnt lgkmcnt(5)
    v_mfma_f32_16x16x32_bf16 v[16:19], v[112:115], a[56:59], v[16:19]
    v_mfma_f32_16x16x32_bf16 v[24:27], v[112:115], a[136:139], v[24:27]
    v_mfma_f32_16x16x32_bf16 v[32:35], v[112:115], a[216:219], v[32:35]
    v_mfma_f32_16x16x32_bf16 v[40:43], v[112:115], v[232:235], v[40:43]
    s_waitcnt lgkmcnt(4)
    v_mfma_f32_16x16x32_bf16 v[20:23], v[116:119], a[56:59], v[20:23]
    v_mfma_f32_16x16x32_bf16 v[28:31], v[116:119], a[136:139], v[28:31]
    v_mfma_f32_16x16x32_bf16 v[36:39], v[116:119], a[216:219], v[36:39]
    v_mfma_f32_16x16x32_bf16 v[44:47], v[116:119], v[232:235], v[44:47]
    ds_read_b128 v[104:107], v11 offset:8192
    ds_read_b128 v[108:111], v13 offset:8192
    s_waitcnt lgkmcnt(5)
    v_mfma_f32_16x16x32_bf16 v[16:19], v[120:123], a[60:63], v[16:19]
    v_mfma_f32_16x16x32_bf16 v[24:27], v[120:123], a[140:143], v[24:27]
    v_mfma_f32_16x16x32_bf16 v[32:35], v[120:123], a[220:223], v[32:35]
    v_mfma_f32_16x16x32_bf16 v[40:43], v[120:123], v[236:239], v[40:43]
    s_waitcnt lgkmcnt(4)
    v_mfma_f32_16x16x32_bf16 v[20:23], v[124:127], a[60:63], v[20:23]
    v_mfma_f32_16x16x32_bf16 v[28:31], v[124:127], a[140:143], v[28:31]
    v_mfma_f32_16x16x32_bf16 v[36:39], v[124:127], a[220:223], v[36:39]
    v_mfma_f32_16x16x32_bf16 v[44:47], v[124:127], v[236:239], v[44:47]
    ds_read_b128 v[112:115], v10 offset:9216
    ds_read_b128 v[116:119], v12 offset:9216
    s_waitcnt lgkmcnt(5)
    v_mfma_f32_16x16x32_bf16 v[16:19], v[96:99], a[64:67], v[16:19]
    v_mfma_f32_16x16x32_bf16 v[24:27], v[96:99], a[144:147], v[24:27]
    v_mfma_f32_16x16x32_bf16 v[32:35], v[96:99], a[224:227], v[32:35]
    v_mfma_f32_16x16x32_bf16 v[40:43], v[96:99], v[240:243], v[40:43]
    s_waitcnt lgkmcnt(4)
    v_mfma_f32_16x16x32_bf16 v[20:23], v[100:103], a[64:67], v[20:23]
    v_mfma_f32_16x16x32_bf16 v[28:31], v[100:103], a[144:147], v[28:31]
    v_mfma_f32_16x16x32_bf16 v[36:39], v[100:103], a[224:227], v[36:39]
    v_mfma_f32_16x16x32_bf16 v[44:47], v[100:103], v[240:243], v[44:47]
    ds_read_b128 v[120:123], v11 offset:9216
    ds_read_b128 v[124:127], v13 offset:9216
    s_waitcnt lgkmcnt(5)
    v_mfma_f32_16x16x32_bf16 v[16:19], v[104:107], a[68:71], v[16:19]
    v_mfma_f32_16x16x32_bf16 v[24:27], v[104:107], a[148:151], v[24:27]
    v_mfma_f32_16x16x32_bf16 v[32:35], v[104:107], a[228:231], v[32:35]
    v_mfma_f32_16x16x32_bf16 v[40:43], v[104:107], v[244:247], v[40:43]
    s_waitcnt lgkmcnt(4)
    v_mfma_f32_16x16x32_bf16 v[20:23], v[108:111], a[68:71], v[20:23]
    v_mfma_f32_16x16x32_bf16 v[28:31], v[108:111], a[148:151], v[28:31]
    v_mfma_f32_16x16x32_bf16 v[36:39], v[108:111], a[228:231], v[36:39]
    v_mfma_f32_16x16x32_bf16 v[44:47], v[108:111], v[244:247], v[44:47]
    s_waitcnt lgkmcnt(3)
    v_mfma_f32_16x16x32_bf16 v[16:19], v[112:115], a[72:75], v[16:19]
    v_mfma_f32_16x16x32_bf16 v[24:27], v[112:115], a[152:155], v[24:27]
    v_mfma_f32_16x16x32_bf16 v[32:35], v[112:115], a[232:235], v[32:35]
    v_mfma_f32_16x16x32_bf16 v[40:43], v[112:115], v[248:251], v[40:43]
    s_waitcnt lgkmcnt(2)
    v_mfma_f32_16x16x32_bf16 v[20:23], v[116:119], a[72:75], v[20:23]
    v_mfma_f32_16x16x32_bf16 v[28:31], v[116:119], a[152:155], v[28:31]
    v_mfma_f32_16x16x32_bf16 v[36:39], v[116:119], a[232:235], v[36:39]
    v_mfma_f32_16x16x32_bf16 v[44:47], v[116:119], v[248:251], v[44:47]
    s_waitcnt lgkmcnt(1)
    v_mfma_f32_16x16x32_bf16 v[16:19], v[120:123], a[76:79], v[16:19]
    v_mfma_f32_16x16x32_bf16 v[24:27], v[120:123], a[156:159], v[24:27]
    v_mfma_f32_16x16x32_bf16 v[32:35], v[120:123], a[236:239], v[32:35]
    v_mfma_f32_16x16x32_bf16 v[40:43], v[120:123], v[252:255], v[40:43]
    s_waitcnt lgkmcnt(0)
    v_mfma_f32_16x16x32_bf16 v[20:23], v[124:127], a[76:79], v[20:23]
    v_mfma_f32_16x16x32_bf16 v[28:31], v[124:127], a[156:159], v[28:31]
    v_mfma_f32_16x16x32_bf16 v[36:39], v[124:127], a[236:239], v[36:39]
    v_mfma_f32_16x16x32_bf16 v[44:47], v[124:127], v[252:255], v[44:47]
    s_waitcnt vmcnt(0)
    v_cvt_pk_bf16_f32 v80, v16, v17
    v_cvt_pk_bf16_f32 v81, v18, v19
    v_cvt_pk_bf16_f32 v82, v24, v25
    v_cvt_pk_bf16_f32 v83, v26, v27
    v_cvt_pk_bf16_f32 v84, v20, v21
    v_cvt_pk_bf16_f32 v85, v22, v23
    v_cvt_pk_bf16_f32 v86, v28, v29
    v_cvt_pk_bf16_f32 v87, v30, v31
    v_permlane32_swap_b32 v80, v82
    v_permlane32_swap_b32 v81, v83
    v_permlane32_swap_b32 v84, v86
    v_permlane32_swap_b32 v85, v87
    v_cmp_gt_u32 vcc, s89, v3
    s_cbranch_vccz L_bp_193
L_poll_194:
    buffer_load_dword v3, v7, s[8:11], s82 offen offset:0 sc1
    s_waitcnt vmcnt(0)
    v_cmp_gt_u32 vcc, s89, v3
    s_cbranch_vccz L_pok_195
    s_sleep 1
    s_sub_u32 s6, s6, 1
    s_cbranch_scc0 L_poll_194
    s_branch L_fail
L_pok_195:
L_bp_193:
    s_cmp_eq_u32 s7, 0
    s_cbranch_scc1 L_sl_196
    buffer_store_dwordx4 v[80:83], v9, s[8:11], s88 offen offset:0
    buffer_store_dwordx4 v[84:87], v9, s[8:11], s88 offen offset:1024
    s_branch L_sd_197
L_sl_196:
    buffer_store_dwordx4 v[80:83], v9, s[8:11], s88 offen offset:0 sc1
    buffer_store_dwordx4 v[84:87], v9, s[8:11], s88 offen offset:1024 sc1
L_sd_197:
    v_cvt_pk_bf16_f32 v88, v32, v33
    v_cvt_pk_bf16_f32 v89, v34, v35
    v_cvt_pk_bf16_f32 v90, v40, v41
    v_cvt_pk_bf16_f32 v91, v42, v43
    v_cvt_pk_bf16_f32 v92, v36, v37
    v_cvt_pk_bf16_f32 v93, v38, v39
    v_cvt_pk_bf16_f32 v94, v44, v45
    v_cvt_pk_bf16_f32 v95, v46, v47
    v_permlane32_swap_b32 v88, v90
    v_permlane32_swap_b32 v89, v91
    v_permlane32_swap_b32 v92, v94
    v_permlane32_swap_b32 v93, v95
    s_cmp_eq_u32 s7, 0
    s_cbranch_scc1 L_sl_198
    buffer_store_dwordx4 v[88:91], v9, s[8:11], s88 offen offset:2048
    buffer_store_dwordx4 v[92:95], v9, s[8:11], s88 offen offset:3072
    s_branch L_sd_199
L_sl_198:
    buffer_store_dwordx4 v[88:91], v9, s[8:11], s88 offen offset:2048 sc1
    buffer_store_dwordx4 v[92:95], v9, s[8:11], s88 offen offset:3072 sc1
L_sd_199:
    s_add_u32 s75, s75, 1
    s_waitcnt vmcnt(0)
    v_mov_b32 v4, s75
    s_mov_b64 exec, 1
    s_cmp_eq_u32 s7, 0
    s_cbranch_scc1 L_sl_200
    buffer_store_dword v4, off, s[8:11], s65
    s_branch L_sd_201
L_sl_200:
    buffer_store_dword v4, off, s[8:11], s65 sc1
L_sd_201:
    s_mov_b64 exec, -1
    s_barrier
L_qkv_a_v1:
    s_add_u32 s79, s79, 40960
    s_and_b32 s88, s75, 3
    s_mul_i32 s88, s88, 147456
    s_add_u32 s88, s88, s72
    s_sub_u32 s89, s75, 3
    s_cselect_b32 s89, 0, s89
    ds_read_b128 v[96:99], v10 offset:40960
    ds_read_b128 v[100:103], v12 offset:40960
    ds_read_b128 v[104:107], v11 offset:40960
    ds_read_b128 v[108:111], v13 offset:40960
    ds_read_b128 v[112:115], v10 offset:41984
    ds_read_b128 v[116:119], v12 offset:41984
    s_waitcnt lgkmcnt(5)
    v_mfma_f32_16x16x32_bf16 v[48:51], v[96:99], a[0:3], 0
    v_mfma_f32_16x16x32_bf16 v[56:59], v[96:99], a[80:83], 0
    v_mfma_f32_16x16x32_bf16 v[64:67], v[96:99], a[160:163], 0
    v_mfma_f32_16x16x32_bf16 v[72:75], v[96:99], a[240:243], 0
    s_add_u32 m0, s83, 0
    s_nop 0
    buffer_load_dwordx4 v8, s[8:11], s79 offen offset:0 sc1 lds
    s_waitcnt lgkmcnt(4)
    v_mfma_f32_16x16x32_bf16 v[52:55], v[100:103], a[0:3], 0
    v_mfma_f32_16x16x32_bf16 v[60:63], v[100:103], a[80:83], 0
    v_mfma_f32_16x16x32_bf16 v[68:71], v[100:103], a[160:163], 0
    v_mfma_f32_16x16x32_bf16 v[76:79], v[100:103], a[240:243], 0
    s_add_u32 m0, m0, 896
    s_nop 0
    buffer_load_dwordx4 v8, s[8:11], s79 offen offset:128 sc1 lds
    ds_read_b128 v[120:123], v11 offset:41984
    ds_read_b128 v[124:127], v13 offset:41984
    s_waitcnt lgkmcnt(5)
    v_mfma_f32_16x16x32_bf16 v[48:51], v[104:107], a[4:7], v[48:51]
    v_mfma_f32_16x16x32_bf16 v[56:59], v[104:107], a[84:87], v[56:59]
    v_mfma_f32_16x16x32_bf16 v[64:67], v[104:107], a[164:167], v[64:67]
    v_mfma_f32_16x16x32_bf16 v[72:75], v[104:107], a[244:247], v[72:75]
    s_add_u32 m0, m0, 896
    s_nop 0
    buffer_load_dwordx4 v8, s[8:11], s79 offen offset:256 sc1 lds
    s_waitcnt lgkmcnt(4)
    v_mfma_f32_16x16x32_bf16 v[52:55], v[108:111], a[4:7], v[52:55]
    v_mfma_f32_16x16x32_bf16 v[60:63], v[108:111], a[84:87], v[60:63]
    v_mfma_f32_16x16x32_bf16 v[68:71], v[108:111], a[164:167], v[68:71]
    v_mfma_f32_16x16x32_bf16 v[76:79], v[108:111], a[244:247], v[76:79]
    s_add_u32 m0, m0, 896
    s_nop 0
    buffer_load_dwordx4 v8, s[8:11], s79 offen offset:384 sc1 lds
    ds_read_b128 v[96:99], v10 offset:43008
    ds_read_b128 v[100:103], v12 offset:43008
    s_waitcnt lgkmcnt(5)
    v_mfma_f32_16x16x32_bf16 v[48:51], v[112:115], a[8:11], v[48:51]
    v_mfma_f32_16x16x32_bf16 v[56:59], v[112:115], a[88:91], v[56:59]
    v_mfma_f32_16x16x32_bf16 v[64:67], v[112:115], a[168:171], v[64:67]
    v_mfma_f32_16x16x32_bf16 v[72:75], v[112:115], a[248:251], v[72:75]
    s_add_u32 m0, m0, 896
    s_nop 0
    buffer_load_dwordx4 v8, s[8:11], s79 offen offset:512 sc1 lds
    s_waitcnt lgkmcnt(4)
    v_mfma_f32_16x16x32_bf16 v[52:55], v[116:119], a[8:11], v[52:55]
    v_mfma_f32_16x16x32_bf16 v[60:63], v[116:119], a[88:91], v[60:63]
    v_mfma_f32_16x16x32_bf16 v[68:71], v[116:119], a[168:171], v[68:71]
    v_mfma_f32_16x16x32_bf16 v[76:79], v[116:119], a[248:251], v[76:79]
    s_add_u32 m0, m0, 896
    s_nop 0
    buffer_load_dwordx4 v8, s[8:11], s79 offen offset:640 sc1 lds
    ds_read_b128 v[104:107], v11 offset:43008
    ds_read_b128 v[108:111], v13 offset:43008
    s_waitcnt lgkmcnt(5)
    v_mfma_f32_16x16x32_bf16 v[48:51], v[120:123], a[12:15], v[48:51]
    v_mfma_f32_16x16x32_bf16 v[56:59], v[120:123], a[92:95], v[56:59]
    v_mfma_f32_16x16x32_bf16 v[64:67], v[120:123], a[172:175], v[64:67]
    v_mfma_f32_16x16x32_bf16 v[72:75], v[120:123], a[252:255], v[72:75]
    s_add_u32 m0, m0, 896
    s_nop 0
    buffer_load_dwordx4 v8, s[8:11], s79 offen offset:768 sc1 lds
    s_waitcnt lgkmcnt(4)
    v_mfma_f32_16x16x32_bf16 v[52:55], v[124:127], a[12:15], v[52:55]
    v_mfma_f32_16x16x32_bf16 v[60:63], v[124:127], a[92:95], v[60:63]
    v_mfma_f32_16x16x32_bf16 v[68:71], v[124:127], a[172:175], v[68:71]
    v_mfma_f32_16x16x32_bf16 v[76:79], v[124:127], a[252:255], v[76:79]
    s_add_u32 m0, m0, 896
    s_nop 0
    buffer_load_dwordx4 v8, s[8:11], s79 offen offset:896 sc1 lds
    ds_read_b128 v[112:115], v10 offset:44032
    ds_read_b128 v[116:119], v12 offset:44032
    s_waitcnt lgkmcnt(5)
    v_mfma_f32_16x16x32_bf16 v[48:51], v[96:99], a[16:19], v[48:51]
    v_mfma_f32_16x16x32_bf16 v[56:59], v[96:99], a[96:99], v[56:59]
    v_mfma_f32_16x16x32_bf16 v[64:67], v[96:99], a[176:179], v[64:67]
    v_mfma_f32_16x16x32_bf16 v[72:75], v[96:99], v[192:195], v[72:75]
    s_add_u32 m0, m0, 896
    s_nop 0
    buffer_load_dwordx4 v8, s[8:11], s79 offen offset:1024 sc1 lds
    s_waitcnt lgkmcnt(4)
    v_mfma_f32_16x16x32_bf16 v[52:55], v[100:103], a[16:19], v[52:55]
    v_mfma_f32_16x16x32_bf16 v[60:63], v[100:103], a[96:99], v[60:63]
    v_mfma_f32_16x16x32_bf16 v[68:71], v[100:103], a[176:179], v[68:71]
    v_mfma_f32_16x16x32_bf16 v[76:79], v[100:103], v[192:195], v[76:79]
    s_add_u32 m0, m0, 896
    s_nop 0
    buffer_load_dwordx4 v8, s[8:11], s79 offen offset:1152 sc1 lds
    ds_read_b128 v[120:123], v11 offset:44032
    ds_read_b128 v[124:127], v13 offset:44032
    s_waitcnt lgkmcnt(5)
    v_mfma_f32_16x16x32_bf16 v[48:51], v[104:107], a[20:23], v[48:51]
    v_mfma_f32_16x16x32_bf16 v[56:59], v[104:107], a[100:103], v[56:59]
    v_mfma_f32_16x16x32_bf16 v[64:67], v[104:107], a[180:183], v[64:67]
    v_mfma_f32_16x16x32_bf16 v[72:75], v[104:107], v[196:199], v[72:75]
    s_waitcnt lgkmcnt(4)
    v_mfma_f32_16x16x32_bf16 v[52:55], v[108:111], a[20:23], v[52:55]
    v_mfma_f32_16x16x32_bf16 v[60:63], v[108:111], a[100:103], v[60:63]
    v_mfma_f32_16x16x32_bf16 v[68:71], v[108:111], a[180:183], v[68:71]
    v_mfma_f32_16x16x32_bf16 v[76:79], v[108:111], v[196:199], v[76:79]
    ds_read_b128 v[96:99], v10 offset:45056
    ds_read_b128 v[100:103], v12 offset:45056
    s_waitcnt lgkmcnt(5)
    v_mfma_f32_16x16x32_bf16 v[48:51], v[112:115], a[24:27], v[48:51]
    v_mfma_f32_16x16x32_bf16 v[56:59], v[112:115], a[104:107], v[56:59]
    v_mfma_f32_16x16x32_bf16 v[64:67], v[112:115], a[184:187], v[64:67]
    v_mfma_f32_16x16x32_bf16 v[72:75], v[112:115], v[200:203], v[72:75]
    buffer_load_dword v3, v7, s[8:11], s82 offen offset:0 sc1
    s_waitcnt lgkmcnt(4)
    v_mfma_f32_16x16x32_bf16 v[52:55], v[116:119], a[24:27], v[52:55]
    v_mfma_f32_16x16x32_bf16 v[60:63], v[116:119], a[104:107], v[60:63]
    v_mfma_f32_16x16x32_bf16 v[68:71], v[116:119], a[184:187], v[68:71]
    v_mfma_f32_16x16x32_bf16 v[76:79], v[116:119], v[200:203], v[76:79]
    ds_read_b128 v[104:107], v11 offset:45056
    ds_read_b128 v[108:111], v13 offset:45056
    s_waitcnt lgkmcnt(5)
    v_mfma_f32_16x16x32_bf16 v[48:51], v[120:123], a[28:31], v[48:51]
    v_mfma_f32_16x16x32_bf16 v[56:59], v[120:123], a[108:111], v[56:59]
    v_mfma_f32_16x16x32_bf16 v[64:67], v[120:123], a[188:191], v[64:67]
    v_mfma_f32_16x16x32_bf16 v[72:75], v[120:123], v[204:207], v[72:75]
    s_waitcnt lgkmcnt(4)
    v_mfma_f32_16x16x32_bf16 v[52:55], v[124:127], a[28:31], v[52:55]
    v_mfma_f32_16x16x32_bf16 v[60:63], v[124:127], a[108:111], v[60:63]
    v_mfma_f32_16x16x32_bf16 v[68:71], v[124:127], a[188:191], v[68:71]
    v_mfma_f32_16x16x32_bf16 v[76:79], v[124:127], v[204:207], v[76:79]
    ds_read_b128 v[112:115], v10 offset:46080
    ds_read_b128 v[116:119], v12 offset:46080
    s_waitcnt lgkmcnt(5)
    v_mfma_f32_16x16x32_bf16 v[48:51], v[96:99], a[32:35], v[48:51]
    v_mfma_f32_16x16x32_bf16 v[56:59], v[96:99], a[112:115], v[56:59]
    v_mfma_f32_16x16x32_bf16 v[64:67], v[96:99], a[192:195], v[64:67]
    v_mfma_f32_16x16x32_bf16 v[72:75], v[96:99], v[208:211], v[72:75]
    s_waitcnt lgkmcnt(4)
    v_mfma_f32_16x16x32_bf16 v[52:55], v[100:103], a[32:35], v[52:55]
    v_mfma_f32_16x16x32_bf16 v[60:63], v[100:103], a[112:115], v[60:63]
    v_mfma_f32_16x16x32_bf16 v[68:71], v[100:103], a[192:195], v[68:71]
    v_mfma_f32_16x16x32_bf16 v[76:79], v[100:103], v[208:211], v[76:79]
    ds_read_b128 v[120:123], v11 offset:46080
    ds_read_b128 v[124:127], v13 offset:46080
    s_waitcnt lgkmcnt(5)
    v_mfma_f32_16x16x32_bf16 v[48:51], v[104:107], a[36:39], v[48:51]
    v_mfma_f32_16x16x32_bf16 v[56:59], v[104:107], a[116:119], v[56:59]
    v_mfma_f32_16x16x32_bf16 v[64:67], v[104:107], a[196:199], v[64:67]
    v_mfma_f32_16x16x32_bf16 v[72:75], v[104:107], v[212:215], v[72:75]
    s_waitcnt lgkmcnt(4)
    v_mfma_f32_16x16x32_bf16 v[52:55], v[108:111], a[36:39], v[52:55]
    v_mfma_f32_16x16x32_bf16 v[60:63], v[108:111], a[116:119], v[60:63]
    v_mfma_f32_16x16x32_bf16 v[68:71], v[108:111], a[196:199], v[68:71]
    v_mfma_f32_16x16x32_bf16 v[76:79], v[108:111], v[212:215], v[76:79]
    ds_read_b128 v[96:99], v10 offset:47104
    ds_read_b128 v[100:103], v12 offset:47104
    s_waitcnt lgkmcnt(5)
    v_mfma_f32_16x16x32_bf16 v[48:51], v[112:115], a[40:43], v[48:51]
    v_mfma_f32_16x16x32_bf16 v[56:59], v[112:115], a[120:123], v[56:59]
    v_mfma_f32_16x16x32_bf16 v[64:67], v[112:115], a[200:203], v[64:67]
    v_mfma_f32_16x16x32_bf16 v[72:75], v[112:115], v[216:219], v[72:75]
    s_waitcnt lgkmcnt(4)
    v_mfma_f32_16x16x32_bf16 v[52:55], v[116:119], a[40:43], v[52:55]
    v_mfma_f32_16x16x32_bf16 v[60:63], v[116:119], a[120:123], v[60:63]
    v_mfma_f32_16x16x32_bf16 v[68:71], v[116:119], a[200:203], v[68:71]
    v_mfma_f32_16x16x32_bf16 v[76:79], v[116:119], v[216:219], v[76:79]
    ds_read_b128 v[104:107], v11 offset:47104
    ds_read_b128 v[108:111], v13 offset:47104
    s_waitcnt lgkmcnt(5)
    v_mfma_f32_16x16x32_bf16 v[48:51], v[120:123], a[44:47], v[48:51]
    v_mfma_f32_16x16x32_bf16 v[56:59], v[120:123], a[124:127], v[56:59]
    v_mfma_f32_16x16x32_bf16 v[64:67], v[120:123], a[204:207], v[64:67]
    v_mfma_f32_16x16x32_bf16 v[72:75], v[120:123], v[220:223], v[72:75]
    s_waitcnt lgkmcnt(4)
    v_mfma_f32_16x16x32_bf16 v[52:55], v[124:127], a[44:47], v[52:55]
    v_mfma_f32_16x16x32_bf16 v[60:63], v[124:127], a[124:127], v[60:63]
    v_mfma_f32_16x16x32_bf16 v[68:71], v[124:127], a[204:207], v[68:71]
    v_mfma_f32_16x16x32_bf16 v[76:79], v[124:127], v[220:223], v[76:79]
    ds_read_b128 v[112:115], v10 offset:48128
    ds_read_b128 v[116:119], v12 offset:48128
    s_waitcnt lgkmcnt(5)
    v_mfma_f32_16x16x32_bf16 v[48:51], v[96:99], a[48:51], v[48:51]
    v_mfma_f32_16x16x32_bf16 v[56:59], v[96:99], a[128:131], v[56:59]
    v_mfma_f32_16x16x32_bf16 v[64:67], v[96:99], a[208:211], v[64:67]
    v_mfma_f32_16x16x32_bf16 v[72:75], v[96:99], v[224:227], v[72:75]
    s_waitcnt lgkmcnt(4)
    v_mfma_f32_16x16x32_bf16 v[52:55], v[100:103], a[48:51], v[52:55]
    v_mfma_f32_16x16x32_bf16 v[60:63], v[100:103], a[128:131], v[60:63]
    v_mfma_f32_16x16x32_bf16 v[68:71], v[100:103], a[208:211], v[68:71]
    v_mfma_f32_16x16x32_bf16 v[76:79], v[100:103], v[224:227], v[76:79]
    ds_read_b128 v[120:123], v11 offset:48128
    ds_read_b128 v[124:127], v13 offset:48128
    s_waitcnt lgkmcnt(5)
    v_mfma_f32_16x16x32_bf16 v[48:51], v[104:107], a[52:55], v[48:51]
    v_mfma_f32_16x16x32_bf16 v[56:59], v[104:107], a[132:135], v[56:59]
    v_mfma_f32_16x16x32_bf16 v[64:67], v[104:107], a[212:215], v[64:67]
    v_mfma_f32_16x16x32_bf16 v[72:75], v[104:107], v[228:231], v[72:75]
    s_waitcnt lgkmcnt(4)
    v_mfma_f32_16x16x32_bf16 v[52:55], v[108:111], a[52:55], v[52:55]
    v_mfma_f32_16x16x32_bf16 v[60:63], v[108:111], a[132:135], v[60:63]
    v_mfma_f32_16x16x32_bf16 v[68:71], v[108:111], a[212:215], v[68:71]
    v_mfma_f32_16x16x32_bf16 v[76:79], v[108:111], v[228:231], v[76:79]
    ds_read_b128 v[96:99], v10 offset:49152
    ds_read_b128 v[100:103], v12 offset:49152
    s_waitcnt lgkmcnt(5)
    v_mfma_f32_16x16x32_bf16 v[48:51], v[112:115], a[56:59], v[48:51]
    v_mfma_f32_16x16x32_bf16 v[56:59], v[112:115], a[136:139], v[56:59]
    v_mfma_f32_16x16x32_bf16 v[64:67], v[112:115], a[216:219], v[64:67]
    v_mfma_f32_16x16x32_bf16 v[72:75], v[112:115], v[232:235], v[72:75]
    s_waitcnt lgkmcnt(4)
    v_mfma_f32_16x16x32_bf16 v[52:55], v[116:119], a[56:59], v[52:55]
    v_mfma_f32_16x16x32_bf16 v[60:63], v[116:119], a[136:139], v[60:63]
    v_mfma_f32_16x16x32_bf16 v[68:71], v[116:119], a[216:219], v[68:71]
    v_mfma_f32_16x16x32_bf16 v[76:79], v[116:119], v[232:235], v[76:79]
    ds_read_b128 v[104:107], v11 offset:49152
    ds_read_b128 v[108:111], v13 offset:49152
    s_waitcnt lgkmcnt(5)
    v_mfma_f32_16x16x32_bf16 v[48:51], v[120:123], a[60:63], v[48:51]
    v_mfma_f32_16x16x32_bf16 v[56:59], v[120:123], a[140:143], v[56:59]
    v_mfma_f32_16x16x32_bf16 v[64:67], v[120:123], a[220:223], v[64:67]
    v_mfma_f32_16x16x32_bf16 v[72:75], v[120:123], v[236:239], v[72:75]
    s_waitcnt lgkmcnt(4)
    v_mfma_f32_16x16x32_bf16 v[52:55], v[124:127], a[60:63], v[52:55]
    v_mfma_f32_16x16x32_bf16 v[60:63], v[124:127], a[140:143], v[60:63]
    v_mfma_f32_16x16x32_bf16 v[68:71], v[124:127], a[220:223], v[68:71]
    v_mfma_f32_16x16x32_bf16 v[76:79], v[124:127], v[236:239], v[76:79]
    ds_read_b128 v[112:115], v10 offset:50176
    ds_read_b128 v[116:119], v12 offset:50176
    s_waitcnt lgkmcnt(5)
    v_mfma_f32_16x16x32_bf16 v[48:51], v[96:99], a[64:67], v[48:51]
    v_mfma_f32_16x16x32_bf16 v[56:59], v[96:99], a[144:147], v[56:59]
    v_mfma_f32_16x16x32_bf16 v[64:67], v[96:99], a[224:227], v[64:67]
    v_mfma_f32_16x16x32_bf16 v[72:75], v[96:99], v[240:243], v[72:75]
    s_waitcnt lgkmcnt(4)
    v_mfma_f32_16x16x32_bf16 v[52:55], v[100:103], a[64:67], v[52:55]
    v_mfma_f32_16x16x32_bf16 v[60:63], v[100:103], a[144:147], v[60:63]
    v_mfma_f32_16x16x32_bf16 v[68:71], v[100:103], a[224:227], v[68:71]
    v_mfma_f32_16x16x32_bf16 v[76:79], v[100:103], v[240:243], v[76:79]
    ds_read_b128 v[120:123], v11 offset:50176
    ds_read_b128 v[124:127], v13 offset:50176
    s_waitcnt lgkmcnt(5)
    v_mfma_f32_16x16x32_bf16 v[48:51], v[104:107], a[68:71], v[48:51]
    v_mfma_f32_16x16x32_bf16 v[56:59], v[104:107], a[148:151], v[56:59]
    v_mfma_f32_16x16x32_bf16 v[64:67], v[104:107], a[228:231], v[64:67]
    v_mfma_f32_16x16x32_bf16 v[72:75], v[104:107], v[244:247], v[72:75]
    s_waitcnt lgkmcnt(4)
    v_mfma_f32_16x16x32_bf16 v[52:55], v[108:111], a[68:71], v[52:55]
    v_mfma_f32_16x16x32_bf16 v[60:63], v[108:111], a[148:151], v[60:63]
    v_mfma_f32_16x16x32_bf16 v[68:71], v[108:111], a[228:231], v[68:71]
    v_mfma_f32_16x16x32_bf16 v[76:79], v[108:111], v[244:247], v[76:79]
    s_waitcnt lgkmcnt(3)
    v_mfma_f32_16x16x32_bf16 v[48:51], v[112:115], a[72:75], v[48:51]
    v_mfma_f32_16x16x32_bf16 v[56:59], v[112:115], a[152:155], v[56:59]
    v_mfma_f32_16x16x32_bf16 v[64:67], v[112:115], a[232:235], v[64:67]
    v_mfma_f32_16x16x32_bf16 v[72:75], v[112:115], v[248:251], v[72:75]
    s_waitcnt lgkmcnt(2)
    v_mfma_f32_16x16x32_bf16 v[52:55], v[116:119], a[72:75], v[52:55]
    v_mfma_f32_16x16x32_bf16 v[60:63], v[116:119], a[152:155], v[60:63]
    v_mfma_f32_16x16x32_bf16 v[68:71], v[116:119], a[232:235], v[68:71]
    v_mfma_f32_16x16x32_bf16 v[76:79], v[116:119], v[248:251], v[76:79]
    s_waitcnt lgkmcnt(1)
    v_mfma_f32_16x16x32_bf16 v[48:51], v[120:123], a[76:79], v[48:51]
    v_mfma_f32_16x16x32_bf16 v[56:59], v[120:123], a[156:159], v[56:59]
    v_mfma_f32_16x16x32_bf16 v[64:67], v[120:123], a[236:239], v[64:67]
    v_mfma_f32_16x16x32_bf16 v[72:75], v[120:123], v[252:255], v[72:75]
    s_waitcnt lgkmcnt(0)
    v_mfma_f32_16x16x32_bf16 v[52:55], v[124:127], a[76:79], v[52:55]
    v_mfma_f32_16x16x32_bf16 v[60:63], v[124:127], a[156:159], v[60:63]
    v_mfma_f32_16x16x32_bf16 v[68:71], v[124:127], a[236:239], v[68:71]
    v_mfma_f32_16x16x32_bf16 v[76:79], v[124:127], v[252:255], v[76:79]
    s_waitcnt vmcnt(0)
    v_cvt_pk_bf16_f32 v80, v48, v49
    v_cvt_pk_bf16_f32 v81, v50, v51
    v_cvt_pk_bf16_f32 v82, v56, v57
    v_cvt_pk_bf16_f32 v83, v58, v59
    v_cvt_pk_bf16_f32 v84, v52, v53
    v_cvt_pk_bf16_f32 v85, v54, v55
    v_cvt_pk_bf16_f32 v86, v60, v61
    v_cvt_pk_bf16_f32 v87, v62, v63
    v_permlane32_swap_b32 v80, v82
    v_permlane32_swap_b32 v81, v83
    v_permlane32_swap_b32 v84, v86
    v_permlane32_swap_b32 v85, v87
    v_cmp_gt_u32 vcc, s89, v3
    s_cbranch_vccz L_bp_202
L_poll_203:
    buffer_load_dword v3, v7, s[8:11], s82 offen offset:0 sc1
    s_waitcnt vmcnt(0)
    v_cmp_gt_u32 vcc, s89, v3
    s_cbranch_vccz L_pok_204
    s_sleep 1
    s_sub_u32 s6, s6, 1
    s_cbranch_scc0 L_poll_203
    s_branch L_fail
L_pok_204:
L_bp_202:
    s_cmp_eq_u32 s7, 0
    s_cbranch_scc1 L_sl_205
    buffer_store_dwordx4 v[80:83], v9, s[8:11], s88 offen offset:0
    buffer_store_dwordx4 v[84:87], v9, s[8:11], s88 offen offset:1024
    s_branch L_sd_206
L_sl_205:
    buffer_store_dwordx4 v[80:83], v9, s[8:11], s88 offen offset:0 sc1
    buffer_store_dwordx4 v[84:87], v9, s[8:11], s88 offen offset:1024 sc1
L_sd_206:
    v_cvt_pk_bf16_f32 v88, v64, v65
    v_cvt_pk_bf16_f32 v89, v66, v67
    v_cvt_pk_bf16_f32 v90, v72, v73
    v_cvt_pk_bf16_f32 v91, v74, v75
    v_cvt_pk_bf16_f32 v92, v68, v69
    v_cvt_pk_bf16_f32 v93, v70, v71
    v_cvt_pk_bf16_f32 v94, v76, v77
    v_cvt_pk_bf16_f32 v95, v78, v79
    v_permlane32_swap_b32 v88, v90
    v_permlane32_swap_b32 v89, v91
    v_permlane32_swap_b32 v92, v94
    v_permlane32_swap_b32 v93, v95
    s_cmp_eq_u32 s7, 0
    s_cbranch_scc1 L_sl_207
    buffer_store_dwordx4 v[88:91], v9, s[8:11], s88 offen offset:2048
    buffer_store_dwordx4 v[92:95], v9, s[8:11], s88 offen offset:3072
    s_branch L_sd_208
L_sl_207:
    buffer_store_dwordx4 v[88:91], v9, s[8:11], s88 offen offset:2048 sc1
    buffer_store_dwordx4 v[92:95], v9, s[8:11], s88 offen offset:3072 sc1
L_sd_208:
    s_add_u32 s75, s75, 1
    s_waitcnt vmcnt(0)
    v_mov_b32 v4, s75
    s_mov_b64 exec, 1
    s_cmp_eq_u32 s7, 0
    s_cbranch_scc1 L_sl_209
    buffer_store_dword v4, off, s[8:11], s65
    s_branch L_sd_210
L_sl_209:
    buffer_store_dword v4, off, s[8:11], s65 sc1
L_sd_210:
    s_mov_b64 exec, -1
    s_barrier
    s_cmp_lt_u32 s75, 7
    s_cbranch_scc1 L_qkv_a_v
    s_mov_b32 s87, 0
L_qkv_b_v:
    s_add_u32 s80, s76, 1
    s_mul_i32 s81, s76, 40960
    s_add_u32 s81, s81, 14680064
    s_cmp_eq_u32 s87, 0
    s_cbranch_scc1 L_h0_214
    v_cmp_gt_u32 vcc, s89, v3
    s_cbranch_vccz L_bp_216
L_poll_217:
    buffer_load_dword v3, v7, s[8:11], s82 offen offset:32 sc1
    s_waitcnt vmcnt(0)
    v_cmp_gt_u32 vcc, s89, v3
    s_cbranch_vccz L_pok_218
    s_sleep 1
    s_sub_u32 s6, s6, 1
    s_cbranch_scc0 L_poll_217
    s_branch L_fail
L_pok_218:
L_bp_216:
    ds_read_b128 v[96:99], v10 offset:0
    ds_read_b128 v[100:103], v12 offset:0
    ds_read_b128 v[104:107], v11 offset:0
    ds_read_b128 v[108:111], v13 offset:0
    ds_read_b128 v[112:115], v10 offset:1024
    ds_read_b128 v[116:119], v12 offset:1024
    s_waitcnt lgkmcnt(5)
    v_mfma_f32_16x16x32_bf16 v[16:19], v[96:99], a[0:3], 0
    v_mfma_f32_16x16x32_bf16 v[24:27], v[96:99], a[80:83], 0
    v_mfma_f32_16x16x32_bf16 v[32:35], v[96:99], a[160:163], 0
    v_mfma_f32_16x16x32_bf16 v[40:43], v[96:99], a[240:243], 0
    v_cvt_pk_bf16_f32 v80, v48, v49
    v_cvt_pk_bf16_f32 v82, v56, v57
    s_waitcnt lgkmcnt(4)
    v_mfma_f32_16x16x32_bf16 v[20:23], v[100:103], a[0:3], 0
    v_mfma_f32_16x16x32_bf16 v[28:31], v[100:103], a[80:83], 0
    v_mfma_f32_16x16x32_bf16 v[36:39], v[100:103], a[160:163], 0
    v_mfma_f32_16x16x32_bf16 v[44:47], v[100:103], a[240:243], 0
    v_cvt_pk_bf16_f32 v81, v50, v51
    v_cvt_pk_bf16_f32 v83, v58, v59
    ds_read_b128 v[120:123], v11 offset:1024
    ds_read_b128 v[124:127], v13 offset:1024
    s_waitcnt lgkmcnt(5)
    v_mfma_f32_16x16x32_bf16 v[16:19], v[104:107], a[4:7], v[16:19]
    v_mfma_f32_16x16x32_bf16 v[24:27], v[104:107], a[84:87], v[24:27]
    v_mfma_f32_16x16x32_bf16 v[32:35], v[104:107], a[164:167], v[32:35]
    v_mfma_f32_16x16x32_bf16 v[40:43], v[104:107], a[244:247], v[40:43]
    v_permlane32_swap_b32 v80, v82
    v_permlane32_swap_b32 v81, v83
    s_waitcnt lgkmcnt(4)
    v_mfma_f32_16x16x32_bf16 v[20:23], v[108:111], a[4:7], v[20:23]
    v_mfma_f32_16x16x32_bf16 v[28:31], v[108:111], a[84:87], v[28:31]
    v_mfma_f32_16x16x32_bf16 v[36:39], v[108:111], a[164:167], v[36:39]
    v_mfma_f32_16x16x32_bf16 v[44:47], v[108:111], a[244:247], v[44:47]
    buffer_store_dwordx4 v[80:83], v9, s[8:11], s88 offen offset:0
    v_cvt_pk_bf16_f32 v84, v52, v53
    v_cvt_pk_bf16_f32 v86, v60, v61
    ds_read_b128 v[96:99], v10 offset:2048
    ds_read_b128 v[100:103], v12 offset:2048
    s_waitcnt lgkmcnt(5)
    v_mfma_f32_16x16x32_bf16 v[16:19], v[112:115], a[8:11], v[16:19]
    v_mfma_f32_16x16x32_bf16 v[24:27], v[112:115], a[88:91], v[24:27]
    v_mfma_f32_16x16x32_bf16 v[32:35], v[112:115], a[168:171], v[32:35]
    v_mfma_f32_16x16x32_bf16 v[40:43], v[112:115], a[248:251], v[40:43]
    v_cvt_pk_bf16_f32 v85, v54, v55
    v_cvt_pk_bf16_f32 v87, v62, v63
    s_waitcnt lgkmcnt(4)
    v_mfma_f32_16x16x32_bf16 v[20:23], v[116:119], a[8:11], v[20:23]
    v_mfma_f32_16x16x32_bf16 v[28:31], v[116:119], a[88:91], v[28:31]
    v_mfma_f32_16x16x32_bf16 v[36:39], v[116:119], a[168:171], v[36:39]
    v_mfma_f32_16x16x32_bf16 v[44:47], v[116:119], a[248:251], v[44:47]
    v_permlane32_swap_b32 v84, v86
    v_permlane32_swap_b32 v85, v87
    ds_read_b128 v[104:107], v11 offset:2048
    ds_read_b128 v[108:111], v13 offset:2048
    s_waitcnt lgkmcnt(5)
    v_mfma_f32_16x16x32_bf16 v[16:19], v[120:123], a[12:15], v[16:19]
    v_mfma_f32_16x16x32_bf16 v[24:27], v[120:123], a[92:95], v[24:27]
    v_mfma_f32_16x16x32_bf16 v[32:35], v[120:123], a[172:175], v[32:35]
    v_mfma_f32_16x16x32_bf16 v[40:43], v[120:123], a[252:255], v[40:43]
    buffer_store_dwordx4 v[84:87], v9, s[8:11], s88 offen offset:1024
    v_cvt_pk_bf16_f32 v88, v64, v65
    v_cvt_pk_bf16_f32 v90, v72, v73
    s_waitcnt lgkmcnt(4)
    v_mfma_f32_16x16x32_bf16 v[20:23], v[124:127], a[12:15], v[20:23]
    v_mfma_f32_16x16x32_bf16 v[28:31], v[124:127], a[92:95], v[28:31]
    v_mfma_f32_16x16x32_bf16 v[36:39], v[124:127], a[172:175], v[36:39]
    v_mfma_f32_16x16x32_bf16 v[44:47], v[124:127], a[252:255], v[44:47]
    v_cvt_pk_bf16_f32 v89, v66, v67
    v_cvt_pk_bf16_f32 v91, v74, v75
    ds_read_b128 v[112:115], v10 offset:3072
    ds_read_b128 v[116:119], v12 offset:3072
    s_waitcnt lgkmcnt(5)
    v_mfma_f32_16x16x32_bf16 v[16:19], v[96:99], a[16:19], v[16:19]
    v_mfma_f32_16x16x32_bf16 v[24:27], v[96:99], a[96:99], v[24:27]
    v_mfma_f32_16x16x32_bf16 v[32:35], v[96:99], a[176:179], v[32:35]
    v_mfma_f32_16x16x32_bf16 v[40:43], v[96:99], v[192:195], v[40:43]
    v_permlane32_swap_b32 v88, v90
    v_permlane32_swap_b32 v89, v91
    s_waitcnt lgkmcnt(4)
    v_mfma_f32_16x16x32_bf16 v[20:23], v[100:103], a[16:19], v[20:23]
    v_mfma_f32_16x16x32_bf16 v[28:31], v[100:103], a[96:99], v[28:31]
    v_mfma_f32_16x16x32_bf16 v[36:39], v[100:103], a[176:179], v[36:39]
    v_mfma_f32_16x16x32_bf16 v[44:47], v[100:103], v[192:195], v[44:47]
    buffer_store_dwordx4 v[88:91], v9, s[8:11], s88 offen offset:2048
    v_cvt_pk_bf16_f32 v92, v68, v69
    v_cvt_pk_bf16_f32 v94, v76, v77
    ds_read_b128 v[120:123], v11 offset:3072
    ds_read_b128 v[124:127], v13 offset:3072
    s_waitcnt lgkmcnt(5)
    v_mfma_f32_16x16x32_bf16 v[16:19], v[104:107], a[20:23], v[16:19]
    v_mfma_f32_16x16x32_bf16 v[24:27], v[104:107], a[100:103], v[24:27]
    v_mfma_f32_16x16x32_bf16 v[32:35], v[104:107], a[180:183], v[32:35]
    v_mfma_f32_16x16x32_bf16 v[40:43], v[104:107], v[196:199], v[40:43]
    v_cvt_pk_bf16_f32 v93, v70, v71
    v_cvt_pk_bf16_f32 v95, v78, v79
    s_waitcnt lgkmcnt(4)
    v_mfma_f32_16x16x32_bf16 v[20:23], v[108:111], a[20:23], v[20:23]
    v_mfma_f32_16x16x32_bf16 v[28:31], v[108:111], a[100:103], v[28:31]
    v_mfma_f32_16x16x32_bf16 v[36:39], v[108:111], a[180:183], v[36:39]
    v_mfma_f32_16x16x32_bf16 v[44:47], v[108:111], v[196:199], v[44:47]
    v_permlane32_swap_b32 v92, v94
    v_permlane32_swap_b32 v93, v95
    ds_read_b128 v[96:99], v10 offset:4096
    ds_read_b128 v[100:103], v12 offset:4096
    s_waitcnt lgkmcnt(5)
    v_mfma_f32_16x16x32_bf16 v[16:19], v[112:115], a[24:27], v[16:19]
    v_mfma_f32_16x16x32_bf16 v[24:27], v[112:115], a[104:107], v[24:27]
    v_mfma_f32_16x16x32_bf16 v[32:35], v[112:115], a[184:187], v[32:35]
    v_mfma_f32_16x16x32_bf16 v[40:43], v[112:115], v[200:203], v[40:43]
    buffer_store_dwordx4 v[92:95], v9, s[8:11], s88 offen offset:3072
    s_waitcnt lgkmcnt(4)
    v_mfma_f32_16x16x32_bf16 v[20:23], v[116:119], a[24:27], v[20:23]
    v_mfma_f32_16x16x32_bf16 v[28:31], v[116:119], a[104:107], v[28:31]
    v_mfma_f32_16x16x32_bf16 v[36:39], v[116:119], a[184:187], v[36:39]
    v_mfma_f32_16x16x32_bf16 v[44:47], v[116:119], v[200:203], v[44:47]
    buffer_load_dword v5, v6, s[8:11], s84 offen sc1
    ds_read_b128 v[104:107], v11 offset:4096
    ds_read_b128 v[108:111], v13 offset:4096
    s_waitcnt lgkmcnt(5)
    v_mfma_f32_16x16x32_bf16 v[16:19], v[120:123], a[28:31], v[16:19]
    v_mfma_f32_16x16x32_bf16 v[24:27], v[120:123], a[108:111], v[24:27]
    v_mfma_f32_16x16x32_bf16 v[32:35], v[120:123], a[188:191], v[32:35]
    v_mfma_f32_16x16x32_bf16 v[40:43], v[120:123], v[204:207], v[40:43]
    s_waitcnt lgkmcnt(4)
    v_mfma_f32_16x16x32_bf16 v[20:23], v[124:127], a[28:31], v[20:23]
    v_mfma_f32_16x16x32_bf16 v[28:31], v[124:127], a[108:111], v[28:31]
    v_mfma_f32_16x16x32_bf16 v[36:39], v[124:127], a[188:191], v[36:39]
    v_mfma_f32_16x16x32_bf16 v[44:47], v[124:127], v[204:207], v[44:47]
    ds_read_b128 v[112:115], v10 offset:5120
    ds_read_b128 v[116:119], v12 offset:5120
    s_waitcnt lgkmcnt(5)
    v_mfma_f32_16x16x32_bf16 v[16:19], v[96:99], a[32:35], v[16:19]
    v_mfma_f32_16x16x32_bf16 v[24:27], v[96:99], a[112:115], v[24:27]
    v_mfma_f32_16x16x32_bf16 v[32:35], v[96:99], a[192:195], v[32:35]
    v_mfma_f32_16x16x32_bf16 v[40:43], v[96:99], v[208:211], v[40:43]
    s_waitcnt lgkmcnt(4)
    v_mfma_f32_16x16x32_bf16 v[20:23], v[100:103], a[32:35], v[20:23]
    v_mfma_f32_16x16x32_bf16 v[28:31], v[100:103], a[112:115], v[28:31]
    v_mfma_f32_16x16x32_bf16 v[36:39], v[100:103], a[192:195], v[36:39]
    v_mfma_f32_16x16x32_bf16 v[44:47], v[100:103], v[208:211], v[44:47]
    ds_read_b128 v[120:123], v11 offset:5120
    ds_read_b128 v[124:127], v13 offset:5120
    s_waitcnt lgkmcnt(5)
    v_mfma_f32_16x16x32_bf16 v[16:19], v[104:107], a[36:39], v[16:19]
    v_mfma_f32_16x16x32_bf16 v[24:27], v[104:107], a[116:119], v[24:27]
    v_mfma_f32_16x16x32_bf16 v[32:35], v[104:107], a[196:199], v[32:35]
    v_mfma_f32_16x16x32_bf16 v[40:43], v[104:107], v[212:215], v[40:43]
    s_waitcnt lgkmcnt(4)
    v_mfma_f32_16x16x32_bf16 v[20:23], v[108:111], a[36:39], v[20:23]
    v_mfma_f32_16x16x32_bf16 v[28:31], v[108:111], a[116:119], v[28:31]
    v_mfma_f32_16x16x32_bf16 v[36:39], v[108:111], a[196:199], v[36:39]
    v_mfma_f32_16x16x32_bf16 v[44:47], v[108:111], v[212:215], v[44:47]
    s_branch L_h1_215
L_h0_214:
    ds_read_b128 v[96:99], v10 offset:0
    ds_read_b128 v[100:103], v12 offset:0
    ds_read_b128 v[104:107], v11 offset:0
    ds_read_b128 v[108:111], v13 offset:0
    ds_read_b128 v[112:115], v10 offset:1024
    ds_read_b128 v[116:119], v12 offset:1024
    s_waitcnt lgkmcnt(5)
    v_mfma_f32_16x16x32_bf16 v[16:19], v[96:99], a[0:3], 0
    v_mfma_f32_16x16x32_bf16 v[24:27], v[96:99], a[80:83], 0
    v_mfma_f32_16x16x32_bf16 v[32:35], v[96:99], a[160:163], 0
    v_mfma_f32_16x16x32_bf16 v[40:43], v[96:99], a[240:243], 0
    s_waitcnt lgkmcnt(4)
    v_mfma_f32_16x16x32_bf16 v[20:23], v[100:103], a[0:3], 0
    v_mfma_f32_16x16x32_bf16 v[28:31], v[100:103], a[80:83], 0
    v_mfma_f32_16x16x32_bf16 v[36:39], v[100:103], a[160:163], 0
    v_mfma_f32_16x16x32_bf16 v[44:47], v[100:103], a[240:243], 0
    ds_read_b128 v[120:123], v11 offset:1024
    ds_read_b128 v[124:127], v13 offset:1024
    s_waitcnt lgkmcnt(5)
    v_mfma_f32_16x16x32_bf16 v[16:19], v[104:107], a[4:7], v[16:19]
    v_mfma_f32_16x16x32_bf16 v[24:27], v[104:107], a[84:87], v[24:27]
    v_mfma_f32_16x16x32_bf16 v[32:35], v[104:107], a[164:167], v[32:35]
    v_mfma_f32_16x16x32_bf16 v[40:43], v[104:107], a[244:247], v[40:43]
    s_waitcnt lgkmcnt(4)
    v_mfma_f32_16x16x32_bf16 v[20:23], v[108:111], a[4:7], v[20:23]
    v_mfma_f32_16x16x32_bf16 v[28:31], v[108:111], a[84:87], v[28:31]
    v_mfma_f32_16x16x32_bf16 v[36:39], v[108:111], a[164:167], v[36:39]
    v_mfma_f32_16x16x32_bf16 v[44:47], v[108:111], a[244:247], v[44:47]
    ds_read_b128 v[96:99], v10 offset:2048
    ds_read_b128 v[100:103], v12 offset:2048
    s_waitcnt lgkmcnt(5)
    v_mfma_f32_16x16x32_bf16 v[16:19], v[112:115], a[8:11], v[16:19]
    v_mfma_f32_16x16x32_bf16 v[24:27], v[112:115], a[88:91], v[24:27]
    v_mfma_f32_16x16x32_bf16 v[32:35], v[112:115], a[168:171], v[32:35]
    v_mfma_f32_16x16x32_bf16 v[40:43], v[112:115], a[248:251], v[40:43]
    s_waitcnt lgkmcnt(4)
    v_mfma_f32_16x16x32_bf16 v[20:23], v[116:119], a[8:11], v[20:23]
    v_mfma_f32_16x16x32_bf16 v[28:31], v[116:119], a[88:91], v[28:31]
    v_mfma_f32_16x16x32_bf16 v[36:39], v[116:119], a[168:171], v[36:39]
    v_mfma_f32_16x16x32_bf16 v[44:47], v[116:119], a[248:251], v[44:47]
    ds_read_b128 v[104:107], v11 offset:2048
    ds_read_b128 v[108:111], v13 offset:2048
    s_waitcnt lgkmcnt(5)
    v_mfma_f32_16x16x32_bf16 v[16:19], v[120:123], a[12:15], v[16:19]
    v_mfma_f32_16x16x32_bf16 v[24:27], v[120:123], a[92:95], v[24:27]
    v_mfma_f32_16x16x32_bf16 v[32:35], v[120:123], a[172:175], v[32:35]
    v_mfma_f32_16x16x32_bf16 v[40:43], v[120:123], a[252:255], v[40:43]
    s_waitcnt lgkmcnt(4)
    v_mfma_f32_16x16x32_bf16 v[20:23], v[124:127], a[12:15], v[20:23]
    v_mfma_f32_16x16x32_bf16 v[28:31], v[124:127], a[92:95], v[28:31]
    v_mfma_f32_16x16x32_bf16 v[36:39], v[124:127], a[172:175], v[36:39]
    v_mfma_f32_16x16x32_bf16 v[44:47], v[124:127], a[252:255], v[44:47]
    ds_read_b128 v[112:115], v10 offset:3072
    ds_read_b128 v[116:119], v12 offset:3072
    s_waitcnt lgkmcnt(5)
    v_mfma_f32_16x16x32_bf16 v[16:19], v[96:99], a[16:19], v[16:19]
    v_mfma_f32_16x16x32_bf16 v[24:27], v[96:99], a[96:99], v[24:27]
    v_mfma_f32_16x16x32_bf16 v[32:35], v[96:99], a[176:179], v[32:35]
    v_mfma_f32_16x16x32_bf16 v[40:43], v[96:99], v[192:195], v[40:43]
    s_waitcnt lgkmcnt(4)
    v_mfma_f32_16x16x32_bf16 v[20:23], v[100:103], a[16:19], v[20:23]
    v_mfma_f32_16x16x32_bf16 v[28:31], v[100:103], a[96:99], v[28:31]
    v_mfma_f32_16x16x32_bf16 v[36:39], v[100:103], a[176:179], v[36:39]
    v_mfma_f32_16x16x32_bf16 v[44:47], v[100:103], v[192:195], v[44:47]
    ds_read_b128 v[120:123], v11 offset:3072
    ds_read_b128 v[124:127], v13 offset:3072
    s_waitcnt lgkmcnt(5)
    v_mfma_f32_16x16x32_bf16 v[16:19], v[104:107], a[20:23], v[16:19]
    v_mfma_f32_16x16x32_bf16 v[24:27], v[104:107], a[100:103], v[24:27]
    v_mfma_f32_16x16x32_bf16 v[32:35], v[104:107], a[180:183], v[32:35]
    v_mfma_f32_16x16x32_bf16 v[40:43], v[104:107], v[196:199], v[40:43]
    s_waitcnt lgkmcnt(4)
    v_mfma_f32_16x16x32_bf16 v[20:23], v[108:111], a[20:23], v[20:23]
    v_mfma_f32_16x16x32_bf16 v[28:31], v[108:111], a[100:103], v[28:31]
    v_mfma_f32_16x16x32_bf16 v[36:39], v[108:111], a[180:183], v[36:39]
    v_mfma_f32_16x16x32_bf16 v[44:47], v[108:111], v[196:199], v[44:47]
    ds_read_b128 v[96:99], v10 offset:4096
    ds_read_b128 v[100:103], v12 offset:4096
    s_waitcnt lgkmcnt(5)
    v_mfma_f32_16x16x32_bf16 v[16:19], v[112:115], a[24:27], v[16:19]
    v_mfma_f32_16x16x32_bf16 v[24:27], v[112:115], a[104:107], v[24:27]
    v_mfma_f32_16x16x32_bf16 v[32:35], v[112:115], a[184:187], v[32:35]
    v_mfma_f32_16x16x32_bf16 v[40:43], v[112:115], v[200:203], v[40:43]
    s_waitcnt lgkmcnt(4)
    v_mfma_f32_16x16x32_bf16 v[20:23], v[116:119], a[24:27], v[20:23]
    v_mfma_f32_16x16x32_bf16 v[28:31], v[116:119], a[104:107], v[28:31]
    v_mfma_f32_16x16x32_bf16 v[36:39], v[116:119], a[184:187], v[36:39]
    v_mfma_f32_16x16x32_bf16 v[44:47], v[116:119], v[200:203], v[44:47]
    buffer_load_dword v5, v6, s[8:11], s84 offen sc1
    ds_read_b128 v[104:107], v11 offset:4096
    ds_read_b128 v[108:111], v13 offset:4096
    s_waitcnt lgkmcnt(5)
    v_mfma_f32_16x16x32_bf16 v[16:19], v[120:123], a[28:31], v[16:19]
    v_mfma_f32_16x16x32_bf16 v[24:27], v[120:123], a[108:111], v[24:27]
    v_mfma_f32_16x16x32_bf16 v[32:35], v[120:123], a[188:191], v[32:35]
    v_mfma_f32_16x16x32_bf16 v[40:43], v[120:123], v[204:207], v[40:43]
    s_waitcnt lgkmcnt(4)
    v_mfma_f32_16x16x32_bf16 v[20:23], v[124:127], a[28:31], v[20:23]
    v_mfma_f32_16x16x32_bf16 v[28:31], v[124:127], a[108:111], v[28:31]
    v_mfma_f32_16x16x32_bf16 v[36:39], v[124:127], a[188:191], v[36:39]
    v_mfma_f32_16x16x32_bf16 v[44:47], v[124:127], v[204:207], v[44:47]
    ds_read_b128 v[112:115], v10 offset:5120
    ds_read_b128 v[116:119], v12 offset:5120
    s_waitcnt lgkmcnt(5)
    v_mfma_f32_16x16x32_bf16 v[16:19], v[96:99], a[32:35], v[16:19]
    v_mfma_f32_16x16x32_bf16 v[24:27], v[96:99], a[112:115], v[24:27]
    v_mfma_f32_16x16x32_bf16 v[32:35], v[96:99], a[192:195], v[32:35]
    v_mfma_f32_16x16x32_bf16 v[40:43], v[96:99], v[208:211], v[40:43]
    s_waitcnt lgkmcnt(4)
    v_mfma_f32_16x16x32_bf16 v[20:23], v[100:103], a[32:35], v[20:23]
    v_mfma_f32_16x16x32_bf16 v[28:31], v[100:103], a[112:115], v[28:31]
    v_mfma_f32_16x16x32_bf16 v[36:39], v[100:103], a[192:195], v[36:39]
    v_mfma_f32_16x16x32_bf16 v[44:47], v[100:103], v[208:211], v[44:47]
    ds_read_b128 v[120:123], v11 offset:5120
    ds_read_b128 v[124:127], v13 offset:5120
    s_waitcnt lgkmcnt(5)
    v_mfma_f32_16x16x32_bf16 v[16:19], v[104:107], a[36:39], v[16:19]
    v_mfma_f32_16x16x32_bf16 v[24:27], v[104:107], a[116:119], v[24:27]
    v_mfma_f32_16x16x32_bf16 v[32:35], v[104:107], a[196:199], v[32:35]
    v_mfma_f32_16x16x32_bf16 v[40:43], v[104:107], v[212:215], v[40:43]
    s_waitcnt lgkmcnt(4)
    v_mfma_f32_16x16x32_bf16 v[20:23], v[108:111], a[36:39], v[20:23]
    v_mfma_f32_16x16x32_bf16 v[28:31], v[108:111], a[116:119], v[28:31]
    v_mfma_f32_16x16x32_bf16 v[36:39], v[108:111], a[196:199], v[36:39]
    v_mfma_f32_16x16x32_bf16 v[44:47], v[108:111], v[212:215], v[44:47]
L_h1_215:
    s_waitcnt vmcnt(0)
    v_mov_b32 v4, s76
    s_mov_b64 exec, 1
    s_cmp_eq_u32 s7, 0
    s_cbranch_scc1 L_sl_219
    buffer_store_dword v4, off, s[8:11], s66
    s_branch L_sd_220
L_sl_219:
    buffer_store_dword v4, off, s[8:11], s66 sc1
L_sd_220:
    s_mov_b64 exec, -1
    s_and_b32 s88, s75, 3
    s_mul_i32 s88, s88, 147456
    s_add_u32 s88, s88, s72
    s_sub_u32 s89, s75, 3
    s_cselect_b32 s89, 0, s89
    buffer_load_dword v3, v7, s[8:11], s82 offen offset:0 sc1
    v_cmp_gt_u32 vcc, s80, v5
    s_cbranch_vccz L_qa_221
    ds_read_b128 v[96:99], v10 offset:6144
    ds_read_b128 v[100:103], v12 offset:6144
    s_waitcnt lgkmcnt(5)
    v_mfma_f32_16x16x32_bf16 v[16:19], v[112:115], a[40:43], v[16:19]
    v_mfma_f32_16x16x32_bf16 v[24:27], v[112:115], a[120:123], v[24:27]
    v_mfma_f32_16x16x32_bf16 v[32:35], v[112:115], a[200:203], v[32:35]
    v_mfma_f32_16x16x32_bf16 v[40:43], v[112:115], v[216:219], v[40:43]
    s_waitcnt lgkmcnt(4)
    v_mfma_f32_16x16x32_bf16 v[20:23], v[116:119], a[40:43], v[20:23]
    v_mfma_f32_16x16x32_bf16 v[28:31], v[116:119], a[120:123], v[28:31]
    v_mfma_f32_16x16x32_bf16 v[36:39], v[116:119], a[200:203], v[36:39]
    v_mfma_f32_16x16x32_bf16 v[44:47], v[116:119], v[216:219], v[44:47]
    ds_read_b128 v[104:107], v11 offset:6144
    ds_read_b128 v[108:111], v13 offset:6144
    s_waitcnt lgkmcnt(5)
    v_mfma_f32_16x16x32_bf16 v[16:19], v[120:123], a[44:47], v[16:19]
    v_mfma_f32_16x16x32_bf16 v[24:27], v[120:123], a[124:127], v[24:27]
    v_mfma_f32_16x16x32_bf16 v[32:35], v[120:123], a[204:207], v[32:35]
    v_mfma_f32_16x16x32_bf16 v[40:43], v[120:123], v[220:223], v[40:43]
    s_waitcnt lgkmcnt(4)
    v_mfma_f32_16x16x32_bf16 v[20:23], v[124:127], a[44:47], v[20:23]
    v_mfma_f32_16x16x32_bf16 v[28:31], v[124:127], a[124:127], v[28:31]
    v_mfma_f32_16x16x32_bf16 v[36:39], v[124:127], a[204:207], v[36:39]
    v_mfma_f32_16x16x32_bf16 v[44:47], v[124:127], v[220:223], v[44:47]
    buffer_load_dword v5, v6, s[8:11], s84 offen sc1
    ds_read_b128 v[112:115], v10 offset:7168
    ds_read_b128 v[116:119], v12 offset:7168
    s_waitcnt lgkmcnt(5)
    v_mfma_f32_16x16x32_bf16 v[16:19], v[96:99], a[48:51], v[16:19]
    v_mfma_f32_16x16x32_bf16 v[24:27], v[96:99], a[128:131], v[24:27]
    v_mfma_f32_16x16x32_bf16 v[32:35], v[96:99], a[208:211], v[32:35]
    v_mfma_f32_16x16x32_bf16 v[40:43], v[96:99], v[224:227], v[40:43]
    s_waitcnt lgkmcnt(4)
    v_mfma_f32_16x16x32_bf16 v[20:23], v[100:103], a[48:51], v[20:23]
    v_mfma_f32_16x16x32_bf16 v[28:31], v[100:103], a[128:131], v[28:31]
    v_mfma_f32_16x16x32_bf16 v[36:39], v[100:103], a[208:211], v[36:39]
    v_mfma_f32_16x16x32_bf16 v[44:47], v[100:103], v[224:227], v[44:47]
    ds_read_b128 v[120:123], v11 offset:7168
    ds_read_b128 v[124:127], v13 offset:7168
    s_waitcnt lgkmcnt(5)
    v_mfma_f32_16x16x32_bf16 v[16:19], v[104:107], a[52:55], v[16:19]
    v_mfma_f32_16x16x32_bf16 v[24:27], v[104:107], a[132:135], v[24:27]
    v_mfma_f32_16x16x32_bf16 v[32:35], v[104:107], a[212:215], v[32:35]
    v_mfma_f32_16x16x32_bf16 v[40:43], v[104:107], v[228:231], v[40:43]
    s_waitcnt lgkmcnt(4)
    v_mfma_f32_16x16x32_bf16 v[20:23], v[108:111], a[52:55], v[20:23]
    v_mfma_f32_16x16x32_bf16 v[28:31], v[108:111], a[132:135], v[28:31]
    v_mfma_f32_16x16x32_bf16 v[36:39], v[108:111], a[212:215], v[36:39]
    v_mfma_f32_16x16x32_bf16 v[44:47], v[108:111], v[228:231], v[44:47]
    ds_read_b128 v[96:99], v10 offset:8192
    ds_read_b128 v[100:103], v12 offset:8192
    s_waitcnt lgkmcnt(5)
    v_mfma_f32_16x16x32_bf16 v[16:19], v[112:115], a[56:59], v[16:19]
    v_mfma_f32_16x16x32_bf16 v[24:27], v[112:115], a[136:139], v[24:27]
    v_mfma_f32_16x16x32_bf16 v[32:35], v[112:115], a[216:219], v[32:35]
    v_mfma_f32_16x16x32_bf16 v[40:43], v[112:115], v[232:235], v[40:43]
    s_waitcnt lgkmcnt(4)
    v_mfma_f32_16x16x32_bf16 v[20:23], v[116:119], a[56:59], v[20:23]
    v_mfma_f32_16x16x32_bf16 v[28:31], v[116:119], a[136:139], v[28:31]
    v_mfma_f32_16x16x32_bf16 v[36:39], v[116:119], a[216:219], v[36:39]
    v_mfma_f32_16x16x32_bf16 v[44:47], v[116:119], v[232:235], v[44:47]
    s_waitcnt vmcnt(0)
    v_cmp_gt_u32 vcc, s80, v5
    s_cbranch_vccz L_qb_222
    ds_read_b128 v[104:107], v11 offset:8192
    ds_read_b128 v[108:111], v13 offset:8192
    s_waitcnt lgkmcnt(5)
    v_mfma_f32_16x16x32_bf16 v[16:19], v[120:123], a[60:63], v[16:19]
    v_mfma_f32_16x16x32_bf16 v[24:27], v[120:123], a[140:143], v[24:27]
    v_mfma_f32_16x16x32_bf16 v[32:35], v[120:123], a[220:223], v[32:35]
    v_mfma_f32_16x16x32_bf16 v[40:43], v[120:123], v[236:239], v[40:43]
    s_waitcnt lgkmcnt(4)
    v_mfma_f32_16x16x32_bf16 v[20:23], v[124:127], a[60:63], v[20:23]
    v_mfma_f32_16x16x32_bf16 v[28:31], v[124:127], a[140:143], v[28:31]
    v_mfma_f32_16x16x32_bf16 v[36:39], v[124:127], a[220:223], v[36:39]
    v_mfma_f32_16x16x32_bf16 v[44:47], v[124:127], v[236:239], v[44:47]
    ds_read_b128 v[112:115], v10 offset:9216
    ds_read_b128 v[116:119], v12 offset:9216
    s_waitcnt lgkmcnt(5)
    v_mfma_f32_16x16x32_bf16 v[16:19], v[96:99], a[64:67], v[16:19]
    v_mfma_f32_16x16x32_bf16 v[24:27], v[96:99], a[144:147], v[24:27]
    v_mfma_f32_16x16x32_bf16 v[32:35], v[96:99], a[224:227], v[32:35]
    v_mfma_f32_16x16x32_bf16 v[40:43], v[96:99], v[240:243], v[40:43]
    s_waitcnt lgkmcnt(4)
    v_mfma_f32_16x16x32_bf16 v[20:23], v[100:103], a[64:67], v[20:23]
    v_mfma_f32_16x16x32_bf16 v[28:31], v[100:103], a[144:147], v[28:31]
    v_mfma_f32_16x16x32_bf16 v[36:39], v[100:103], a[224:227], v[36:39]
    v_mfma_f32_16x16x32_bf16 v[44:47], v[100:103], v[240:243], v[44:47]
    ds_read_b128 v[120:123], v11 offset:9216
    ds_read_b128 v[124:127], v13 offset:9216
    s_waitcnt lgkmcnt(5)
    v_mfma_f32_16x16x32_bf16 v[16:19], v[104:107], a[68:71], v[16:19]
    v_mfma_f32_16x16x32_bf16 v[24:27], v[104:107], a[148:151], v[24:27]
    v_mfma_f32_16x16x32_bf16 v[32:35], v[104:107], a[228:231], v[32:35]
    v_mfma_f32_16x16x32_bf16 v[40:43], v[104:107], v[244:247], v[40:43]
    buffer_load_dword v5, v6, s[8:11], s84 offen sc1
    s_waitcnt lgkmcnt(4)
    v_mfma_f32_16x16x32_bf16 v[20:23], v[108:111], a[68:71], v[20:23]
    v_mfma_f32_16x16x32_bf16 v[28:31], v[108:111], a[148:151], v[28:31]
    v_mfma_f32_16x16x32_bf16 v[36:39], v[108:111], a[228:231], v[36:39]
    v_mfma_f32_16x16x32_bf16 v[44:47], v[108:111], v[244:247], v[44:47]
    s_waitcnt lgkmcnt(3)
    v_mfma_f32_16x16x32_bf16 v[16:19], v[112:115], a[72:75], v[16:19]
    v_mfma_f32_16x16x32_bf16 v[24:27], v[112:115], a[152:155], v[24:27]
    v_mfma_f32_16x16x32_bf16 v[32:35], v[112:115], a[232:235], v[32:35]
    v_mfma_f32_16x16x32_bf16 v[40:43], v[112:115], v[248:251], v[40:43]
    s_waitcnt lgkmcnt(2)
    v_mfma_f32_16x16x32_bf16 v[20:23], v[116:119], a[72:75], v[20:23]
    v_mfma_f32_16x16x32_bf16 v[28:31], v[116:119], a[152:155], v[28:31]
    v_mfma_f32_16x16x32_bf16 v[36:39], v[116:119], a[232:235], v[36:39]
    v_mfma_f32_16x16x32_bf16 v[44:47], v[116:119], v[248:251], v[44:47]
    s_waitcnt lgkmcnt(1)
    v_mfma_f32_16x16x32_bf16 v[16:19], v[120:123], a[76:79], v[16:19]
    v_mfma_f32_16x16x32_bf16 v[24:27], v[120:123], a[156:159], v[24:27]
    v_mfma_f32_16x16x32_bf16 v[32:35], v[120:123], a[236:239], v[32:35]
    v_mfma_f32_16x16x32_bf16 v[40:43], v[120:123], v[252:255], v[40:43]
    s_waitcnt lgkmcnt(0)
    v_mfma_f32_16x16x32_bf16 v[20:23], v[124:127], a[76:79], v[20:23]
    v_mfma_f32_16x16x32_bf16 v[28:31], v[124:127], a[156:159], v[28:31]
    v_mfma_f32_16x16x32_bf16 v[36:39], v[124:127], a[236:239], v[36:39]
    v_mfma_f32_16x16x32_bf16 v[44:47], v[124:127], v[252:255], v[44:47]
    s_waitcnt vmcnt(0)
    s_add_u32 s75, s75, 1
    s_mov_b32 s87, s7
    v_cmp_gt_u32 vcc, s80, v5
    s_cmp_eq_u32 s7, 0
    s_cbranch_scc1 L_qd_224s
    s_cbranch_vccz L_qd_224
L_qd_224s:
    v_cvt_pk_bf16_f32 v80, v16, v17
    v_cvt_pk_bf16_f32 v81, v18, v19
    v_cvt_pk_bf16_f32 v82, v24, v25
    v_cvt_pk_bf16_f32 v83, v26, v27
    v_cvt_pk_bf16_f32 v84, v20, v21
    v_cvt_pk_bf16_f32 v85, v22, v23
    v_cvt_pk_bf16_f32 v86, v28, v29
    v_cvt_pk_bf16_f32 v87, v30, v31
    v_permlane32_swap_b32 v80, v82
    v_permlane32_swap_b32 v81, v83
    v_permlane32_swap_b32 v84, v86
    v_permlane32_swap_b32 v85, v87
    v_cmp_gt_u32 vcc, s89, v3
    s_cbranch_vccz L_bp_225
L_poll_226:
    buffer_load_dword v3, v7, s[8:11], s82 offen offset:0 sc1
    s_waitcnt vmcnt(0)
    v_cmp_gt_u32 vcc, s89, v3
    s_cbranch_vccz L_pok_227
    s_sleep 1
    s_sub_u32 s6, s6, 1
    s_cbranch_scc0 L_poll_226
    s_branch L_fail
L_pok_227:
L_bp_225:
    s_cmp_eq_u32 s7, 0
    s_cbranch_scc1 L_sl_228
    buffer_store_dwordx4 v[80:83], v9, s[8:11], s88 offen offset:0
    buffer_store_dwordx4 v[84:87], v9, s[8:11], s88 offen offset:1024
    s_branch L_sd_229
L_sl_228:
    buffer_store_dwordx4 v[80:83], v9, s[8:11], s88 offen offset:0 sc1
    buffer_store_dwordx4 v[84:87], v9, s[8:11], s88 offen offset:1024 sc1
L_sd_229:
    v_cvt_pk_bf16_f32 v88, v32, v33
    v_cvt_pk_bf16_f32 v89, v34, v35
    v_cvt_pk_bf16_f32 v90, v40, v41
    v_cvt_pk_bf16_f32 v91, v42, v43
    v_cvt_pk_bf16_f32 v92, v36, v37
    v_cvt_pk_bf16_f32 v93, v38, v39
    v_cvt_pk_bf16_f32 v94, v44, v45
    v_cvt_pk_bf16_f32 v95, v46, v47
    v_permlane32_swap_b32 v88, v90
    v_permlane32_swap_b32 v89, v91
    v_permlane32_swap_b32 v92, v94
    v_permlane32_swap_b32 v93, v95
    s_cmp_eq_u32 s7, 0
    s_cbranch_scc1 L_sl_230
    buffer_store_dwordx4 v[88:91], v9, s[8:11], s88 offen offset:2048
    buffer_store_dwordx4 v[92:95], v9, s[8:11], s88 offen offset:3072
    s_branch L_sd_231
L_sl_230:
    buffer_store_dwordx4 v[88:91], v9, s[8:11], s88 offen offset:2048 sc1
    buffer_store_dwordx4 v[92:95], v9, s[8:11], s88 offen offset:3072 sc1
L_sd_231:
    buffer_load_dword v5, v6, s[8:11], s84 offen sc1
    s_waitcnt vmcnt(0)
    v_mov_b32 v4, s75
    s_mov_b64 exec, 1
    s_cmp_eq_u32 s7, 0
    s_cbranch_scc1 L_sl_232
    buffer_store_dword v4, off, s[8:11], s65
    s_branch L_sd_233
L_sl_232:
    buffer_store_dword v4, off, s[8:11], s65 sc1
L_sd_233:
    s_mov_b64 exec, -1
    s_mov_b32 s87, 0
    v_cmp_gt_u32 vcc, s80, v5
    s_cbranch_vccz L_qd_224
L_blk_211:
    buffer_load_dword v5, v6, s[8:11], s84 offen sc1
    s_waitcnt vmcnt(0)
    v_cmp_gt_u32 vcc, s80, v5
    s_cbranch_vccz L_bok_234
    s_sleep 1
    s_sub_u32 s6, s6, 1
    s_cbranch_scc0 L_blk_211
    s_branch L_fail
L_bok_234:
L_qd_224:
    s_add_u32 m0, s83, 40960
    s_nop 0
    buffer_load_dwordx4 v8, s[8:11], s81 offen offset:0 sc1 lds
    s_add_u32 m0, m0, 896
    s_nop 0
    buffer_load_dwordx4 v8, s[8:11], s81 offen offset:128 sc1 lds
    s_add_u32 m0, m0, 896
    s_nop 0
    buffer_load_dwordx4 v8, s[8:11], s81 offen offset:256 sc1 lds
    s_add_u32 m0, m0, 896
    s_nop 0
    buffer_load_dwordx4 v8, s[8:11], s81 offen offset:384 sc1 lds
    s_add_u32 m0, m0, 896
    s_nop 0
    buffer_load_dwordx4 v8, s[8:11], s81 offen offset:512 sc1 lds
    s_add_u32 m0, m0, 896
    s_nop 0
    buffer_load_dwordx4 v8, s[8:11], s81 offen offset:640 sc1 lds
    s_add_u32 m0, m0, 896
    s_nop 0
    buffer_load_dwordx4 v8, s[8:11], s81 offen offset:768 sc1 lds
    s_add_u32 m0, m0, 896
    s_nop 0
    buffer_load_dwordx4 v8, s[8:11], s81 offen offset:896 sc1 lds
    s_add_u32 m0, m0, 896
    s_nop 0
    buffer_load_dwordx4 v8, s[8:11], s81 offen offset:1024 sc1 lds
    s_add_u32 m0, m0, 896
    s_nop 0
    buffer_load_dwordx4 v8, s[8:11], s81 offen offset:1152 sc1 lds
    s_branch L_got2_212
L_qb_222:
    ds_read_b128 v[104:107], v11 offset:8192
    ds_read_b128 v[108:111], v13 offset:8192
    s_waitcnt lgkmcnt(5)
    v_mfma_f32_16x16x32_bf16 v[16:19], v[120:123], a[60:63], v[16:19]
    v_mfma_f32_16x16x32_bf16 v[24:27], v[120:123], a[140:143], v[24:27]
    v_mfma_f32_16x16x32_bf16 v[32:35], v[120:123], a[220:223], v[32:35]
    v_mfma_f32_16x16x32_bf16 v[40:43], v[120:123], v[236:239], v[40:43]
    s_add_u32 m0, s83, 40960
    s_nop 0
    buffer_load_dwordx4 v8, s[8:11], s81 offen offset:0 sc1 lds
    s_waitcnt lgkmcnt(4)
    v_mfma_f32_16x16x32_bf16 v[20:23], v[124:127], a[60:63], v[20:23]
    v_mfma_f32_16x16x32_bf16 v[28:31], v[124:127], a[140:143], v[28:31]
    v_mfma_f32_16x16x32_bf16 v[36:39], v[124:127], a[220:223], v[36:39]
    v_mfma_f32_16x16x32_bf16 v[44:47], v[124:127], v[236:239], v[44:47]
    s_add_u32 m0, m0, 896
    s_nop 0
    buffer_load_dwordx4 v8, s[8:11], s81 offen offset:128 sc1 lds
    ds_read_b128 v[112:115], v10 offset:9216
    ds_read_b128 v[116:119], v12 offset:9216
    s_waitcnt lgkmcnt(5)
    v_mfma_f32_16x16x32_bf16 v[16:19], v[96:99], a[64:67], v[16:19]
    v_mfma_f32_16x16x32_bf16 v[24:27], v[96:99], a[144:147], v[24:27]
    v_mfma_f32_16x16x32_bf16 v[32:35], v[96:99], a[224:227], v[32:35]
    v_mfma_f32_16x16x32_bf16 v[40:43], v[96:99], v[240:243], v[40:43]
    s_add_u32 m0, m0, 896
    s_nop 0
    buffer_load_dwordx4 v8, s[8:11], s81 offen offset:256 sc1 lds
    s_waitcnt lgkmcnt(4)
    v_mfma_f32_16x16x32_bf16 v[20:23], v[100:103], a[64:67], v[20:23]
    v_mfma_f32_16x16x32_bf16 v[28:31], v[100:103], a[144:147], v[28:31]
    v_mfma_f32_16x16x32_bf16 v[36:39], v[100:103], a[224:227], v[36:39]
    v_mfma_f32_16x16x32_bf16 v[44:47], v[100:103], v[240:243], v[44:47]
    s_add_u32 m0, m0, 896
    s_nop 0
    buffer_load_dwordx4 v8, s[8:11], s81 offen offset:384 sc1 lds
    ds_read_b128 v[120:123], v11 offset:9216
    ds_read_b128 v[124:127], v13 offset:9216
    s_waitcnt lgkmcnt(5)
    v_mfma_f32_16x16x32_bf16 v[16:19], v[104:107], a[68:71], v[16:19]
    v_mfma_f32_16x16x32_bf16 v[24:27], v[104:107], a[148:151], v[24:27]
    v_mfma_f32_16x16x32_bf16 v[32:35], v[104:107], a[228:231], v[32:35]
    v_mfma_f32_16x16x32_bf16 v[40:43], v[104:107], v[244:247], v[40:43]
    s_add_u32 m0, m0, 896
    s_nop 0
    buffer_load_dwordx4 v8, s[8:11], s81 offen offset:512 sc1 lds
    s_waitcnt lgkmcnt(4)
    v_mfma_f32_16x16x32_bf16 v[20:23], v[108:111], a[68:71], v[20:23]
    v_mfma_f32_16x16x32_bf16 v[28:31], v[108:111], a[148:151], v[28:31]
    v_mfma_f32_16x16x32_bf16 v[36:39], v[108:111], a[228:231], v[36:39]
    v_mfma_f32_16x16x32_bf16 v[44:47], v[108:111], v[244:247], v[44:47]
    s_add_u32 m0, m0, 896
    s_nop 0
    buffer_load_dwordx4 v8, s[8:11], s81 offen offset:640 sc1 lds
    s_waitcnt lgkmcnt(3)
    v_mfma_f32_16x16x32_bf16 v[16:19], v[112:115], a[72:75], v[16:19]
    v_mfma_f32_16x16x32_bf16 v[24:27], v[112:115], a[152:155], v[24:27]
    v_mfma_f32_16x16x32_bf16 v[32:35], v[112:115], a[232:235], v[32:35]
    v_mfma_f32_16x16x32_bf16 v[40:43], v[112:115], v[248:251], v[40:43]
    s_add_u32 m0, m0, 896
    s_nop 0
    buffer_load_dwordx4 v8, s[8:11], s81 offen offset:768 sc1 lds
    s_waitcnt lgkmcnt(2)
    v_mfma_f32_16x16x32_bf16 v[20:23], v[116:119], a[72:75], v[20:23]
    v_mfma_f32_16x16x32_bf16 v[28:31], v[116:119], a[152:155], v[28:31]
    v_mfma_f32_16x16x32_bf16 v[36:39], v[116:119], a[232:235], v[36:39]
    v_mfma_f32_16x16x32_bf16 v[44:47], v[116:119], v[248:251], v[44:47]
    s_add_u32 m0, m0, 896
    s_nop 0
    buffer_load_dwordx4 v8, s[8:11], s81 offen offset:896 sc1 lds
    s_waitcnt lgkmcnt(1)
    v_mfma_f32_16x16x32_bf16 v[16:19], v[120:123], a[76:79], v[16:19]
    v_mfma_f32_16x16x32_bf16 v[24:27], v[120:123], a[156:159], v[24:27]
    v_mfma_f32_16x16x32_bf16 v[32:35], v[120:123], a[236:239], v[32:35]
    v_mfma_f32_16x16x32_bf16 v[40:43], v[120:123], v[252:255], v[40:43]
    s_add_u32 m0, m0, 896
    s_nop 0
    buffer_load_dwordx4 v8, s[8:11], s81 offen offset:1024 sc1 lds
    s_waitcnt lgkmcnt(0)
    v_mfma_f32_16x16x32_bf16 v[20:23], v[124:127], a[76:79], v[20:23]
    v_mfma_f32_16x16x32_bf16 v[28:31], v[124:127], a[156:159], v[28:31]
    v_mfma_f32_16x16x32_bf16 v[36:39], v[124:127], a[236:239], v[36:39]
    v_mfma_f32_16x16x32_bf16 v[44:47], v[124:127], v[252:255], v[44:47]
    s_add_u32 m0, m0, 896
    s_nop 0
    buffer_load_dwordx4 v8, s[8:11], s81 offen offset:1152 sc1 lds
    s_branch L_qc_223
L_qa_221:
    ds_read_b128 v[96:99], v10 offset:6144
    ds_read_b128 v[100:103], v12 offset:6144
    s_waitcnt lgkmcnt(5)
    v_mfma_f32_16x16x32_bf16 v[16:19], v[112:115], a[40:43], v[16:19]
    v_mfma_f32_16x16x32_bf16 v[24:27], v[112:115], a[120:123], v[24:27]
    v_mfma_f32_16x16x32_bf16 v[32:35], v[112:115], a[200:203], v[32:35]
    v_mfma_f32_16x16x32_bf16 v[40:43], v[112:115], v[216:219], v[40:43]
    s_add_u32 m0, s83, 40960
    s_nop 0
    buffer_load_dwordx4 v8, s[8:11], s81 offen offset:0 sc1 lds
    s_waitcnt lgkmcnt(4)
    v_mfma_f32_16x16x32_bf16 v[20:23], v[116:119], a[40:43], v[20:23]
    v_mfma_f32_16x16x32_bf16 v[28:31], v[116:119], a[120:123], v[28:31]
    v_mfma_f32_16x16x32_bf16 v[36:39], v[116:119], a[200:203], v[36:39]
    v_mfma_f32_16x16x32_bf16 v[44:47], v[116:119], v[216:219], v[44:47]
    s_add_u32 m0, m0, 896
    s_nop 0
    buffer_load_dwordx4 v8, s[8:11], s81 offen offset:128 sc1 lds
    ds_read_b128 v[104:107], v11 offset:6144
    ds_read_b128 v[108:111], v13 offset:6144
    s_waitcnt lgkmcnt(5)
    v_mfma_f32_16x16x32_bf16 v[16:19], v[120:123], a[44:47], v[16:19]
    v_mfma_f32_16x16x32_bf16 v[24:27], v[120:123], a[124:127], v[24:27]
    v_mfma_f32_16x16x32_bf16 v[32:35], v[120:123], a[204:207], v[32:35]
    v_mfma_f32_16x16x32_bf16 v[40:43], v[120:123], v[220:223], v[40:43]
    s_add_u32 m0, m0, 896
    s_nop 0
    buffer_load_dwordx4 v8, s[8:11], s81 offen offset:256 sc1 lds
    s_waitcnt lgkmcnt(4)
    v_mfma_f32_16x16x32_bf16 v[20:23], v[124:127], a[44:47], v[20:23]
    v_mfma_f32_16x16x32_bf16 v[28:31], v[124:127], a[124:127], v[28:31]
    v_mfma_f32_16x16x32_bf16 v[36:39], v[124:127], a[204:207], v[36:39]
    v_mfma_f32_16x16x32_bf16 v[44:47], v[124:127], v[220:223], v[44:47]
    s_add_u32 m0, m0, 896
    s_nop 0
    buffer_load_dwordx4 v8, s[8:11], s81 offen offset:384 sc1 lds
    ds_read_b128 v[112:115], v10 offset:7168
    ds_read_b128 v[116:119], v12 offset:7168
    s_waitcnt lgkmcnt(5)
    v_mfma_f32_16x16x32_bf16 v[16:19], v[96:99], a[48:51], v[16:19]
    v_mfma_f32_16x16x32_bf16 v[24:27], v[96:99], a[128:131], v[24:27]
    v_mfma_f32_16x16x32_bf16 v[32:35], v[96:99], a[208:211], v[32:35]
    v_mfma_f32_16x16x32_bf16 v[40:43], v[96:99], v[224:227], v[40:43]
    s_add_u32 m0, m0, 896
    s_nop 0
    buffer_load_dwordx4 v8, s[8:11], s81 offen offset:512 sc1 lds
    s_waitcnt lgkmcnt(4)
    v_mfma_f32_16x16x32_bf16 v[20:23], v[100:103], a[48:51], v[20:23]
    v_mfma_f32_16x16x32_bf16 v[28:31], v[100:103], a[128:131], v[28:31]
    v_mfma_f32_16x16x32_bf16 v[36:39], v[100:103], a[208:211], v[36:39]
    v_mfma_f32_16x16x32_bf16 v[44:47], v[100:103], v[224:227], v[44:47]
    s_add_u32 m0, m0, 896
    s_nop 0
    buffer_load_dwordx4 v8, s[8:11], s81 offen offset:640 sc1 lds
    ds_read_b128 v[120:123], v11 offset:7168
    ds_read_b128 v[124:127], v13 offset:7168
    s_waitcnt lgkmcnt(5)
    v_mfma_f32_16x16x32_bf16 v[16:19], v[104:107], a[52:55], v[16:19]
    v_mfma_f32_16x16x32_bf16 v[24:27], v[104:107], a[132:135], v[24:27]
    v_mfma_f32_16x16x32_bf16 v[32:35], v[104:107], a[212:215], v[32:35]
    v_mfma_f32_16x16x32_bf16 v[40:43], v[104:107], v[228:231], v[40:43]
    s_add_u32 m0, m0, 896
    s_nop 0
    buffer_load_dwordx4 v8, s[8:11], s81 offen offset:768 sc1 lds
    s_waitcnt lgkmcnt(4)
    v_mfma_f32_16x16x32_bf16 v[20:23], v[108:111], a[52:55], v[20:23]
    v_mfma_f32_16x16x32_bf16 v[28:31], v[108:111], a[132:135], v[28:31]
    v_mfma_f32_16x16x32_bf16 v[36:39], v[108:111], a[212:215], v[36:39]
    v_mfma_f32_16x16x32_bf16 v[44:47], v[108:111], v[228:231], v[44:47]
    s_add_u32 m0, m0, 896
    s_nop 0
    buffer_load_dwordx4 v8, s[8:11], s81 offen offset:896 sc1 lds
    ds_read_b128 v[96:99], v10 offset:8192
    ds_read_b128 v[100:103], v12 offset:8192
    s_waitcnt lgkmcnt(5)
    v_mfma_f32_16x16x32_bf16 v[16:19], v[112:115], a[56:59], v[16:19]
    v_mfma_f32_16x16x32_bf16 v[24:27], v[112:115], a[136:139], v[24:27]
    v_mfma_f32_16x16x32_bf16 v[32:35], v[112:115], a[216:219], v[32:35]
    v_mfma_f32_16x16x32_bf16 v[40:43], v[112:115], v[232:235], v[40:43]
    s_add_u32 m0, m0, 896
    s_nop 0
    buffer_load_dwordx4 v8, s[8:11], s81 offen offset:1024 sc1 lds
    s_waitcnt lgkmcnt(4)
    v_mfma_f32_16x16x32_bf16 v[20:23], v[116:119], a[56:59], v[20:23]
    v_mfma_f32_16x16x32_bf16 v[28:31], v[116:119], a[136:139], v[28:31]
    v_mfma_f32_16x16x32_bf16 v[36:39], v[116:119], a[216:219], v[36:39]
    v_mfma_f32_16x16x32_bf16 v[44:47], v[116:119], v[232:235], v[44:47]
    s_add_u32 m0, m0, 896
    s_nop 0
    buffer_load_dwordx4 v8, s[8:11], s81 offen offset:1152 sc1 lds
    ds_read_b128 v[104:107], v11 offset:8192
    ds_read_b128 v[108:111], v13 offset:8192
    s_waitcnt lgkmcnt(5)
    v_mfma_f32_16x16x32_bf16 v[16:19], v[120:123], a[60:63], v[16:19]
    v_mfma_f32_16x16x32_bf16 v[24:27], v[120:123], a[140:143], v[24:27]
    v_mfma_f32_16x16x32_bf16 v[32:35], v[120:123], a[220:223], v[32:35]
    v_mfma_f32_16x16x32_bf16 v[40:43], v[120:123], v[236:239], v[40:43]
    s_waitcnt lgkmcnt(4)
    v_mfma_f32_16x16x32_bf16 v[20:23], v[124:127], a[60:63], v[20:23]
    v_mfma_f32_16x16x32_bf16 v[28:31], v[124:127], a[140:143], v[28:31]
    v_mfma_f32_16x16x32_bf16 v[36:39], v[124:127], a[220:223], v[36:39]
    v_mfma_f32_16x16x32_bf16 v[44:47], v[124:127], v[236:239], v[44:47]
    ds_read_b128 v[112:115], v10 offset:9216
    ds_read_b128 v[116:119], v12 offset:9216
    s_waitcnt lgkmcnt(5)
    v_mfma_f32_16x16x32_bf16 v[16:19], v[96:99], a[64:67], v[16:19]
    v_mfma_f32_16x16x32_bf16 v[24:27], v[96:99], a[144:147], v[24:27]
    v_mfma_f32_16x16x32_bf16 v[32:35], v[96:99], a[224:227], v[32:35]
    v_mfma_f32_16x16x32_bf16 v[40:43], v[96:99], v[240:243], v[40:43]
    s_waitcnt lgkmcnt(4)
    v_mfma_f32_16x16x32_bf16 v[20:23], v[100:103], a[64:67], v[20:23]
    v_mfma_f32_16x16x32_bf16 v[28:31], v[100:103], a[144:147], v[28:31]
    v_mfma_f32_16x16x32_bf16 v[36:39], v[100:103], a[224:227], v[36:39]
    v_mfma_f32_16x16x32_bf16 v[44:47], v[100:103], v[240:243], v[44:47]
    ds_read_b128 v[120:123], v11 offset:9216
    ds_read_b128 v[124:127], v13 offset:9216
    s_waitcnt lgkmcnt(5)
    v_mfma_f32_16x16x32_bf16 v[16:19], v[104:107], a[68:71], v[16:19]
    v_mfma_f32_16x16x32_bf16 v[24:27], v[104:107], a[148:151], v[24:27]
    v_mfma_f32_16x16x32_bf16 v[32:35], v[104:107], a[228:231], v[32:35]
    v_mfma_f32_16x16x32_bf16 v[40:43], v[104:107], v[244:247], v[40:43]
    s_waitcnt lgkmcnt(4)
    v_mfma_f32_16x16x32_bf16 v[20:23], v[108:111], a[68:71], v[20:23]
    v_mfma_f32_16x16x32_bf16 v[28:31], v[108:111], a[148:151], v[28:31]
    v_mfma_f32_16x16x32_bf16 v[36:39], v[108:111], a[228:231], v[36:39]
    v_mfma_f32_16x16x32_bf16 v[44:47], v[108:111], v[244:247], v[44:47]
    s_waitcnt lgkmcnt(3)
    v_mfma_f32_16x16x32_bf16 v[16:19], v[112:115], a[72:75], v[16:19]
    v_mfma_f32_16x16x32_bf16 v[24:27], v[112:115], a[152:155], v[24:27]
    v_mfma_f32_16x16x32_bf16 v[32:35], v[112:115], a[232:235], v[32:35]
    v_mfma_f32_16x16x32_bf16 v[40:43], v[112:115], v[248:251], v[40:43]
    s_waitcnt lgkmcnt(2)
    v_mfma_f32_16x16x32_bf16 v[20:23], v[116:119], a[72:75], v[20:23]
    v_mfma_f32_16x16x32_bf16 v[28:31], v[116:119], a[152:155], v[28:31]
    v_mfma_f32_16x16x32_bf16 v[36:39], v[116:119], a[232:235], v[36:39]
    v_mfma_f32_16x16x32_bf16 v[44:47], v[116:119], v[248:251], v[44:47]
    s_waitcnt lgkmcnt(1)
    v_mfma_f32_16x16x32_bf16 v[16:19], v[120:123], a[76:79], v[16:19]
    v_mfma_f32_16x16x32_bf16 v[24:27], v[120:123], a[156:159], v[24:27]
    v_mfma_f32_16x16x32_bf16 v[32:35], v[120:123], a[236:239], v[32:35]
    v_mfma_f32_16x16x32_bf16 v[40:43], v[120:123], v[252:255], v[40:43]
    s_waitcnt lgkmcnt(0)
    v_mfma_f32_16x16x32_bf16 v[20:23], v[124:127], a[76:79], v[20:23]
    v_mfma_f32_16x16x32_bf16 v[28:31], v[124:127], a[156:159], v[28:31]
    v_mfma_f32_16x16x32_bf16 v[36:39], v[124:127], a[236:239], v[36:39]
    v_mfma_f32_16x16x32_bf16 v[44:47], v[124:127], v[252:255], v[44:47]
L_qc_223:
    s_add_u32 s75, s75, 1
    s_mov_b32 s87, s7
    s_cmp_lg_u32 s7, 0
    s_cbranch_scc1 L_df_235
    s_waitcnt vmcnt(0)
    v_cvt_pk_bf16_f32 v80, v16, v17
    v_cvt_pk_bf16_f32 v81, v18, v19
    v_cvt_pk_bf16_f32 v82, v24, v25
    v_cvt_pk_bf16_f32 v83, v26, v27
    v_cvt_pk_bf16_f32 v84, v20, v21
    v_cvt_pk_bf16_f32 v85, v22, v23
    v_cvt_pk_bf16_f32 v86, v28, v29
    v_cvt_pk_bf16_f32 v87, v30, v31
    v_permlane32_swap_b32 v80, v82
    v_permlane32_swap_b32 v81, v83
    v_permlane32_swap_b32 v84, v86
    v_permlane32_swap_b32 v85, v87
    v_cmp_gt_u32 vcc, s89, v3
    s_cbranch_vccz L_bp_236
L_poll_237:
    buffer_load_dword v3, v7, s[8:11], s82 offen offset:0 sc1
    s_waitcnt vmcnt(0)
    v_cmp_gt_u32 vcc, s89, v3
    s_cbranch_vccz L_pok_238
    s_sleep 1
    s_sub_u32 s6, s6, 1
    s_cbranch_scc0 L_poll_237
    s_branch L_fail
L_pok_238:
L_bp_236:
    s_cmp_eq_u32 s7, 0
    s_cbranch_scc1 L_sl_239
    buffer_store_dwordx4 v[80:83], v9, s[8:11], s88 offen offset:0
    buffer_store_dwordx4 v[84:87], v9, s[8:11], s88 offen offset:1024
    s_branch L_sd_240
L_sl_239:
    buffer_store_dwordx4 v[80:83], v9, s[8:11], s88 offen offset:0 sc1
    buffer_store_dwordx4 v[84:87], v9, s[8:11], s88 offen offset:1024 sc1
L_sd_240:
    v_cvt_pk_bf16_f32 v88, v32, v33
    v_cvt_pk_bf16_f32 v89, v34, v35
    v_cvt_pk_bf16_f32 v90, v40, v41
    v_cvt_pk_bf16_f32 v91, v42, v43
    v_cvt_pk_bf16_f32 v92, v36, v37
    v_cvt_pk_bf16_f32 v93, v38, v39
    v_cvt_pk_bf16_f32 v94, v44, v45
    v_cvt_pk_bf16_f32 v95, v46, v47
    v_permlane32_swap_b32 v88, v90
    v_permlane32_swap_b32 v89, v91
    v_permlane32_swap_b32 v92, v94
    v_permlane32_swap_b32 v93, v95
    s_cmp_eq_u32 s7, 0
    s_cbranch_scc1 L_sl_241
    buffer_store_dwordx4 v[88:91], v9, s[8:11], s88 offen offset:2048
    buffer_store_dwordx4 v[92:95], v9, s[8:11], s88 offen offset:3072
    s_branch L_sd_242
L_sl_241:
    buffer_store_dwordx4 v[88:91], v9, s[8:11], s88 offen offset:2048 sc1
    buffer_store_dwordx4 v[92:95], v9, s[8:11], s88 offen offset:3072 sc1
L_sd_242:
L_df_235:
L_got2_212:
    s_waitcnt vmcnt(0)
    s_barrier
    s_cmp_eq_u32 s87, 0
    s_cbranch_scc1 L_h0_243
    v_cmp_gt_u32 vcc, s89, v3
    s_cbranch_vccz L_bp_245
L_poll_246:
    buffer_load_dword v3, v7, s[8:11], s82 offen offset:0 sc1
    s_waitcnt vmcnt(0)
    v_cmp_gt_u32 vcc, s89, v3
    s_cbranch_vccz L_pok_247
    s_sleep 1
    s_sub_u32 s6, s6, 1
    s_cbranch_scc0 L_poll_246
    s_branch L_fail
L_pok_247:
L_bp_245:
    ds_read_b128 v[96:99], v10 offset:40960
    ds_read_b128 v[100:103], v12 offset:40960
    ds_read_b128 v[104:107], v11 offset:40960
    ds_read_b128 v[108:111], v13 offset:40960
    ds_read_b128 v[112:115], v10 offset:41984
    ds_read_b128 v[116:119], v12 offset:41984
    s_waitcnt lgkmcnt(5)
    v_mfma_f32_16x16x32_bf16 v[48:51], v[96:99], a[0:3], 0
    v_mfma_f32_16x16x32_bf16 v[56:59], v[96:99], a[80:83], 0
    v_mfma_f32_16x16x32_bf16 v[64:67], v[96:99], a[160:163], 0
    v_mfma_f32_16x16x32_bf16 v[72:75], v[96:99], a[240:243], 0
    v_cvt_pk_bf16_f32 v80, v16, v17
    v_cvt_pk_bf16_f32 v82, v24, v25
    s_waitcnt lgkmcnt(4)
    v_mfma_f32_16x16x32_bf16 v[52:55], v[100:103], a[0:3], 0
    v_mfma_f32_16x16x32_bf16 v[60:63], v[100:103], a[80:83], 0
    v_mfma_f32_16x16x32_bf16 v[68:71], v[100:103], a[160:163], 0
    v_mfma_f32_16x16x32_bf16 v[76:79], v[100:103], a[240:243], 0
    v_cvt_pk_bf16_f32 v81, v18, v19
    v_cvt_pk_bf16_f32 v83, v26, v27
    ds_read_b128 v[120:123], v11 offset:41984
    ds_read_b128 v[124:127], v13 offset:41984
    s_waitcnt lgkmcnt(5)
    v_mfma_f32_16x16x32_bf16 v[48:51], v[104:107], a[4:7], v[48:51]
    v_mfma_f32_16x16x32_bf16 v[56:59], v[104:107], a[84:87], v[56:59]
    v_mfma_f32_16x16x32_bf16 v[64:67], v[104:107], a[164:167], v[64:67]
    v_mfma_f32_16x16x32_bf16 v[72:75], v[104:107], a[244:247], v[72:75]
    v_permlane32_swap_b32 v80, v82
    v_permlane32_swap_b32 v81, v83
    s_waitcnt lgkmcnt(4)
    v_mfma_f32_16x16x32_bf16 v[52:55], v[108:111], a[4:7], v[52:55]
    v_mfma_f32_16x16x32_bf16 v[60:63], v[108:111], a[84:87], v[60:63]
    v_mfma_f32_16x16x32_bf16 v[68:71], v[108:111], a[164:167], v[68:71]
    v_mfma_f32_16x16x32_bf16 v[76:79], v[108:111], a[244:247], v[76:79]
    buffer_store_dwordx4 v[80:83], v9, s[8:11], s88 offen offset:0
    v_cvt_pk_bf16_f32 v84, v20, v21
    v_cvt_pk_bf16_f32 v86, v28, v29
    ds_read_b128 v[96:99], v10 offset:43008
    ds_read_b128 v[100:103], v12 offset:43008
    s_waitcnt lgkmcnt(5)
    v_mfma_f32_16x16x32_bf16 v[48:51], v[112:115], a[8:11], v[48:51]
    v_mfma_f32_16x16x32_bf16 v[56:59], v[112:115], a[88:91], v[56:59]
    v_mfma_f32_16x16x32_bf16 v[64:67], v[112:115], a[168:171], v[64:67]
    v_mfma_f32_16x16x32_bf16 v[72:75], v[112:115], a[248:251], v[72:75]
    v_cvt_pk_bf16_f32 v85, v22, v23
    v_cvt_pk_bf16_f32 v87, v30, v31
    s_waitcnt lgkmcnt(4)
    v_mfma_f32_16x16x32_bf16 v[52:55], v[116:119], a[8:11], v[52:55]
    v_mfma_f32_16x16x32_bf16 v[60:63], v[116:119], a[88:91], v[60:63]
    v_mfma_f32_16x16x32_bf16 v[68:71], v[116:119], a[168:171], v[68:71]
    v_mfma_f32_16x16x32_bf16 v[76:79], v[116:119], a[248:251], v[76:79]
    v_permlane32_swap_b32 v84, v86
    v_permlane32_swap_b32 v85, v87
    ds_read_b128 v[104:107], v11 offset:43008
    ds_read_b128 v[108:111], v13 offset:43008
    s_waitcnt lgkmcnt(5)
    v_mfma_f32_16x16x32_bf16 v[48:51], v[120:123], a[12:15], v[48:51]
    v_mfma_f32_16x16x32_bf16 v[56:59], v[120:123], a[92:95], v[56:59]
    v_mfma_f32_16x16x32_bf16 v[64:67], v[120:123], a[172:175], v[64:67]
    v_mfma_f32_16x16x32_bf16 v[72:75], v[120:123], a[252:255], v[72:75]
    buffer_store_dwordx4 v[84:87], v9, s[8:11], s88 offen offset:1024
    v_cvt_pk_bf16_f32 v88, v32, v33
    v_cvt_pk_bf16_f32 v90, v40, v41
    s_waitcnt lgkmcnt(4)
    v_mfma_f32_16x16x32_bf16 v[52:55], v[124:127], a[12:15], v[52:55]
    v_mfma_f32_16x16x32_bf16 v[60:63], v[124:127], a[92:95], v[60:63]
    v_mfma_f32_16x16x32_bf16 v[68:71], v[124:127], a[172:175], v[68:71]
    v_mfma_f32_16x16x32_bf16 v[76:79], v[124:127], a[252:255], v[76:79]
    v_cvt_pk_bf16_f32 v89, v34, v35
    v_cvt_pk_bf16_f32 v91, v42, v43
    ds_read_b128 v[112:115], v10 offset:44032
    ds_read_b128 v[116:119], v12 offset:44032
    s_waitcnt lgkmcnt(5)
    v_mfma_f32_16x16x32_bf16 v[48:51], v[96:99], a[16:19], v[48:51]
    v_mfma_f32_16x16x32_bf16 v[56:59], v[96:99], a[96:99], v[56:59]
    v_mfma_f32_16x16x32_bf16 v[64:67], v[96:99], a[176:179], v[64:67]
    v_mfma_f32_16x16x32_bf16 v[72:75], v[96:99], v[192:195], v[72:75]
    v_permlane32_swap_b32 v88, v90
    v_permlane32_swap_b32 v89, v91
    s_waitcnt lgkmcnt(4)
    v_mfma_f32_16x16x32_bf16 v[52:55], v[100:103], a[16:19], v[52:55]
    v_mfma_f32_16x16x32_bf16 v[60:63], v[100:103], a[96:99], v[60:63]
    v_mfma_f32_16x16x32_bf16 v[68:71], v[100:103], a[176:179], v[68:71]
    v_mfma_f32_16x16x32_bf16 v[76:79], v[100:103], v[192:195], v[76:79]
    buffer_store_dwordx4 v[88:91], v9, s[8:11], s88 offen offset:2048
    v_cvt_pk_bf16_f32 v92, v36, v37
    v_cvt_pk_bf16_f32 v94, v44, v45
    ds_read_b128 v[120:123], v11 offset:44032
    ds_read_b128 v[124:127], v13 offset:44032
    s_waitcnt lgkmcnt(5)
    v_mfma_f32_16x16x32_bf16 v[48:51], v[104:107], a[20:23], v[48:51]
    v_mfma_f32_16x16x32_bf16 v[56:59], v[104:107], a[100:103], v[56:59]
    v_mfma_f32_16x16x32_bf16 v[64:67], v[104:107], a[180:183], v[64:67]
    v_mfma_f32_16x16x32_bf16 v[72:75], v[104:107], v[196:199], v[72:75]
    v_cvt_pk_bf16_f32 v93, v38, v39
    v_cvt_pk_bf16_f32 v95, v46, v47
    s_waitcnt lgkmcnt(4)
    v_mfma_f32_16x16x32_bf16 v[52:55], v[108:111], a[20:23], v[52:55]
    v_mfma_f32_16x16x32_bf16 v[60:63], v[108:111], a[100:103], v[60:63]
    v_mfma_f32_16x16x32_bf16 v[68:71], v[108:111], a[180:183], v[68:71]
    v_mfma_f32_16x16x32_bf16 v[76:79], v[108:111], v[196:199], v[76:79]
    v_permlane32_swap_b32 v92, v94
    v_permlane32_swap_b32 v93, v95
    ds_read_b128 v[96:99], v10 offset:45056
    ds_read_b128 v[100:103], v12 offset:45056
    s_waitcnt lgkmcnt(5)
    v_mfma_f32_16x16x32_bf16 v[48:51], v[112:115], a[24:27], v[48:51]
    v_mfma_f32_16x16x32_bf16 v[56:59], v[112:115], a[104:107], v[56:59]
    v_mfma_f32_16x16x32_bf16 v[64:67], v[112:115], a[184:187], v[64:67]
    v_mfma_f32_16x16x32_bf16 v[72:75], v[112:115], v[200:203], v[72:75]
    buffer_store_dwordx4 v[92:95], v9, s[8:11], s88 offen offset:3072
    s_waitcnt lgkmcnt(4)
    v_mfma_f32_16x16x32_bf16 v[52:55], v[116:119], a[24:27], v[52:55]
    v_mfma_f32_16x16x32_bf16 v[60:63], v[116:119], a[104:107], v[60:63]
    v_mfma_f32_16x16x32_bf16 v[68:71], v[116:119], a[184:187], v[68:71]
    v_mfma_f32_16x16x32_bf16 v[76:79], v[116:119], v[200:203], v[76:79]
    ds_read_b128 v[104:107], v11 offset:45056
    ds_read_b128 v[108:111], v13 offset:45056
    s_waitcnt lgkmcnt(5)
    v_mfma_f32_16x16x32_bf16 v[48:51], v[120:123], a[28:31], v[48:51]
    v_mfma_f32_16x16x32_bf16 v[56:59], v[120:123], a[108:111], v[56:59]
    v_mfma_f32_16x16x32_bf16 v[64:67], v[120:123], a[188:191], v[64:67]
    v_mfma_f32_16x16x32_bf16 v[72:75], v[120:123], v[204:207], v[72:75]
    s_waitcnt lgkmcnt(4)
    v_mfma_f32_16x16x32_bf16 v[52:55], v[124:127], a[28:31], v[52:55]
    v_mfma_f32_16x16x32_bf16 v[60:63], v[124:127], a[108:111], v[60:63]
    v_mfma_f32_16x16x32_bf16 v[68:71], v[124:127], a[188:191], v[68:71]
    v_mfma_f32_16x16x32_bf16 v[76:79], v[124:127], v[204:207], v[76:79]
    ds_read_b128 v[112:115], v10 offset:46080
    ds_read_b128 v[116:119], v12 offset:46080
    s_waitcnt lgkmcnt(5)
    v_mfma_f32_16x16x32_bf16 v[48:51], v[96:99], a[32:35], v[48:51]
    v_mfma_f32_16x16x32_bf16 v[56:59], v[96:99], a[112:115], v[56:59]
    v_mfma_f32_16x16x32_bf16 v[64:67], v[96:99], a[192:195], v[64:67]
    v_mfma_f32_16x16x32_bf16 v[72:75], v[96:99], v[208:211], v[72:75]
    s_waitcnt lgkmcnt(4)
    v_mfma_f32_16x16x32_bf16 v[52:55], v[100:103], a[32:35], v[52:55]
    v_mfma_f32_16x16x32_bf16 v[60:63], v[100:103], a[112:115], v[60:63]
    v_mfma_f32_16x16x32_bf16 v[68:71], v[100:103], a[192:195], v[68:71]
    v_mfma_f32_16x16x32_bf16 v[76:79], v[100:103], v[208:211], v[76:79]
    ds_read_b128 v[120:123], v11 offset:46080
    ds_read_b128 v[124:127], v13 offset:46080
    s_waitcnt lgkmcnt(5)
    v_mfma_f32_16x16x32_bf16 v[48:51], v[104:107], a[36:39], v[48:51]
    v_mfma_f32_16x16x32_bf16 v[56:59], v[104:107], a[116:119], v[56:59]
    v_mfma_f32_16x16x32_bf16 v[64:67], v[104:107], a[196:199], v[64:67]
    v_mfma_f32_16x16x32_bf16 v[72:75], v[104:107], v[212:215], v[72:75]
    s_waitcnt lgkmcnt(4)
    v_mfma_f32_16x16x32_bf16 v[52:55], v[108:111], a[36:39], v[52:55]
    v_mfma_f32_16x16x32_bf16 v[60:63], v[108:111], a[116:119], v[60:63]
    v_mfma_f32_16x16x32_bf16 v[68:71], v[108:111], a[196:199], v[68:71]
    v_mfma_f32_16x16x32_bf16 v[76:79], v[108:111], v[212:215], v[76:79]
    s_branch L_h1_244
L_h0_243:
    ds_read_b128 v[96:99], v10 offset:40960
    ds_read_b128 v[100:103], v12 offset:40960
    ds_read_b128 v[104:107], v11 offset:40960
    ds_read_b128 v[108:111], v13 offset:40960
    ds_read_b128 v[112:115], v10 offset:41984
    ds_read_b128 v[116:119], v12 offset:41984
    s_waitcnt lgkmcnt(5)
    v_mfma_f32_16x16x32_bf16 v[48:51], v[96:99], a[0:3], 0
    v_mfma_f32_16x16x32_bf16 v[56:59], v[96:99], a[80:83], 0
    v_mfma_f32_16x16x32_bf16 v[64:67], v[96:99], a[160:163], 0
    v_mfma_f32_16x16x32_bf16 v[72:75], v[96:99], a[240:243], 0
    s_waitcnt lgkmcnt(4)
    v_mfma_f32_16x16x32_bf16 v[52:55], v[100:103], a[0:3], 0
    v_mfma_f32_16x16x32_bf16 v[60:63], v[100:103], a[80:83], 0
    v_mfma_f32_16x16x32_bf16 v[68:71], v[100:103], a[160:163], 0
    v_mfma_f32_16x16x32_bf16 v[76:79], v[100:103], a[240:243], 0
    ds_read_b128 v[120:123], v11 offset:41984
    ds_read_b128 v[124:127], v13 offset:41984
    s_waitcnt lgkmcnt(5)
    v_mfma_f32_16x16x32_bf16 v[48:51], v[104:107], a[4:7], v[48:51]
    v_mfma_f32_16x16x32_bf16 v[56:59], v[104:107], a[84:87], v[56:59]
    v_mfma_f32_16x16x32_bf16 v[64:67], v[104:107], a[164:167], v[64:67]
    v_mfma_f32_16x16x32_bf16 v[72:75], v[104:107], a[244:247], v[72:75]
    s_waitcnt lgkmcnt(4)
    v_mfma_f32_16x16x32_bf16 v[52:55], v[108:111], a[4:7], v[52:55]
    v_mfma_f32_16x16x32_bf16 v[60:63], v[108:111], a[84:87], v[60:63]
    v_mfma_f32_16x16x32_bf16 v[68:71], v[108:111], a[164:167], v[68:71]
    v_mfma_f32_16x16x32_bf16 v[76:79], v[108:111], a[244:247], v[76:79]
    ds_read_b128 v[96:99], v10 offset:43008
    ds_read_b128 v[100:103], v12 offset:43008
    s_waitcnt lgkmcnt(5)
    v_mfma_f32_16x16x32_bf16 v[48:51], v[112:115], a[8:11], v[48:51]
    v_mfma_f32_16x16x32_bf16 v[56:59], v[112:115], a[88:91], v[56:59]
    v_mfma_f32_16x16x32_bf16 v[64:67], v[112:115], a[168:171], v[64:67]
    v_mfma_f32_16x16x32_bf16 v[72:75], v[112:115], a[248:251], v[72:75]
    s_waitcnt lgkmcnt(4)
    v_mfma_f32_16x16x32_bf16 v[52:55], v[116:119], a[8:11], v[52:55]
    v_mfma_f32_16x16x32_bf16 v[60:63], v[116:119], a[88:91], v[60:63]
    v_mfma_f32_16x16x32_bf16 v[68:71], v[116:119], a[168:171], v[68:71]
    v_mfma_f32_16x16x32_bf16 v[76:79], v[116:119], a[248:251], v[76:79]
    ds_read_b128 v[104:107], v11 offset:43008
    ds_read_b128 v[108:111], v13 offset:43008
    s_waitcnt lgkmcnt(5)
    v_mfma_f32_16x16x32_bf16 v[48:51], v[120:123], a[12:15], v[48:51]
    v_mfma_f32_16x16x32_bf16 v[56:59], v[120:123], a[92:95], v[56:59]
    v_mfma_f32_16x16x32_bf16 v[64:67], v[120:123], a[172:175], v[64:67]
    v_mfma_f32_16x16x32_bf16 v[72:75], v[120:123], a[252:255], v[72:75]
    s_waitcnt lgkmcnt(4)
    v_mfma_f32_16x16x32_bf16 v[52:55], v[124:127], a[12:15], v[52:55]
    v_mfma_f32_16x16x32_bf16 v[60:63], v[124:127], a[92:95], v[60:63]
    v_mfma_f32_16x16x32_bf16 v[68:71], v[124:127], a[172:175], v[68:71]
    v_mfma_f32_16x16x32_bf16 v[76:79], v[124:127], a[252:255], v[76:79]
    ds_read_b128 v[112:115], v10 offset:44032
    ds_read_b128 v[116:119], v12 offset:44032
    s_waitcnt lgkmcnt(5)
    v_mfma_f32_16x16x32_bf16 v[48:51], v[96:99], a[16:19], v[48:51]
    v_mfma_f32_16x16x32_bf16 v[56:59], v[96:99], a[96:99], v[56:59]
    v_mfma_f32_16x16x32_bf16 v[64:67], v[96:99], a[176:179], v[64:67]
    v_mfma_f32_16x16x32_bf16 v[72:75], v[96:99], v[192:195], v[72:75]
    s_waitcnt lgkmcnt(4)
    v_mfma_f32_16x16x32_bf16 v[52:55], v[100:103], a[16:19], v[52:55]
    v_mfma_f32_16x16x32_bf16 v[60:63], v[100:103], a[96:99], v[60:63]
    v_mfma_f32_16x16x32_bf16 v[68:71], v[100:103], a[176:179], v[68:71]
    v_mfma_f32_16x16x32_bf16 v[76:79], v[100:103], v[192:195], v[76:79]
    ds_read_b128 v[120:123], v11 offset:44032
    ds_read_b128 v[124:127], v13 offset:44032
    s_waitcnt lgkmcnt(5)
    v_mfma_f32_16x16x32_bf16 v[48:51], v[104:107], a[20:23], v[48:51]
    v_mfma_f32_16x16x32_bf16 v[56:59], v[104:107], a[100:103], v[56:59]
    v_mfma_f32_16x16x32_bf16 v[64:67], v[104:107], a[180:183], v[64:67]
    v_mfma_f32_16x16x32_bf16 v[72:75], v[104:107], v[196:199], v[72:75]
    s_waitcnt lgkmcnt(4)
    v_mfma_f32_16x16x32_bf16 v[52:55], v[108:111], a[20:23], v[52:55]
    v_mfma_f32_16x16x32_bf16 v[60:63], v[108:111], a[100:103], v[60:63]
    v_mfma_f32_16x16x32_bf16 v[68:71], v[108:111], a[180:183], v[68:71]
    v_mfma_f32_16x16x32_bf16 v[76:79], v[108:111], v[196:199], v[76:79]
    ds_read_b128 v[96:99], v10 offset:45056
    ds_read_b128 v[100:103], v12 offset:45056
    s_waitcnt lgkmcnt(5)
    v_mfma_f32_16x16x32_bf16 v[48:51], v[112:115], a[24:27], v[48:51]
    v_mfma_f32_16x16x32_bf16 v[56:59], v[112:115], a[104:107], v[56:59]
    v_mfma_f32_16x16x32_bf16 v[64:67], v[112:115], a[184:187], v[64:67]
    v_mfma_f32_16x16x32_bf16 v[72:75], v[112:115], v[200:203], v[72:75]
    s_waitcnt lgkmcnt(4)
    v_mfma_f32_16x16x32_bf16 v[52:55], v[116:119], a[24:27], v[52:55]
    v_mfma_f32_16x16x32_bf16 v[60:63], v[116:119], a[104:107], v[60:63]
    v_mfma_f32_16x16x32_bf16 v[68:71], v[116:119], a[184:187], v[68:71]
    v_mfma_f32_16x16x32_bf16 v[76:79], v[116:119], v[200:203], v[76:79]
    ds_read_b128 v[104:107], v11 offset:45056
    ds_read_b128 v[108:111], v13 offset:45056
    s_waitcnt lgkmcnt(5)
    v_mfma_f32_16x16x32_bf16 v[48:51], v[120:123], a[28:31], v[48:51]
    v_mfma_f32_16x16x32_bf16 v[56:59], v[120:123], a[108:111], v[56:59]
    v_mfma_f32_16x16x32_bf16 v[64:67], v[120:123], a[188:191], v[64:67]
    v_mfma_f32_16x16x32_bf16 v[72:75], v[120:123], v[204:207], v[72:75]
    s_waitcnt lgkmcnt(4)
    v_mfma_f32_16x16x32_bf16 v[52:55], v[124:127], a[28:31], v[52:55]
    v_mfma_f32_16x16x32_bf16 v[60:63], v[124:127], a[108:111], v[60:63]
    v_mfma_f32_16x16x32_bf16 v[68:71], v[124:127], a[188:191], v[68:71]
    v_mfma_f32_16x16x32_bf16 v[76:79], v[124:127], v[204:207], v[76:79]
    ds_read_b128 v[112:115], v10 offset:46080
    ds_read_b128 v[116:119], v12 offset:46080
    s_waitcnt lgkmcnt(5)
    v_mfma_f32_16x16x32_bf16 v[48:51], v[96:99], a[32:35], v[48:51]
    v_mfma_f32_16x16x32_bf16 v[56:59], v[96:99], a[112:115], v[56:59]
    v_mfma_f32_16x16x32_bf16 v[64:67], v[96:99], a[192:195], v[64:67]
    v_mfma_f32_16x16x32_bf16 v[72:75], v[96:99], v[208:211], v[72:75]
    s_waitcnt lgkmcnt(4)
    v_mfma_f32_16x16x32_bf16 v[52:55], v[100:103], a[32:35], v[52:55]
    v_mfma_f32_16x16x32_bf16 v[60:63], v[100:103], a[112:115], v[60:63]
    v_mfma_f32_16x16x32_bf16 v[68:71], v[100:103], a[192:195], v[68:71]
    v_mfma_f32_16x16x32_bf16 v[76:79], v[100:103], v[208:211], v[76:79]
    ds_read_b128 v[120:123], v11 offset:46080
    ds_read_b128 v[124:127], v13 offset:46080
    s_waitcnt lgkmcnt(5)
    v_mfma_f32_16x16x32_bf16 v[48:51], v[104:107], a[36:39], v[48:51]
    v_mfma_f32_16x16x32_bf16 v[56:59], v[104:107], a[116:119], v[56:59]
    v_mfma_f32_16x16x32_bf16 v[64:67], v[104:107], a[196:199], v[64:67]
    v_mfma_f32_16x16x32_bf16 v[72:75], v[104:107], v[212:215], v[72:75]
    s_waitcnt lgkmcnt(4)
    v_mfma_f32_16x16x32_bf16 v[52:55], v[108:111], a[36:39], v[52:55]
    v_mfma_f32_16x16x32_bf16 v[60:63], v[108:111], a[116:119], v[60:63]
    v_mfma_f32_16x16x32_bf16 v[68:71], v[108:111], a[196:199], v[68:71]
    v_mfma_f32_16x16x32_bf16 v[76:79], v[108:111], v[212:215], v[76:79]
L_h1_244:
    s_waitcnt vmcnt(0)
    v_mov_b32 v4, s75
    s_mov_b64 exec, 1
    s_cmp_eq_u32 s7, 0
    s_cbranch_scc1 L_sl_248
    buffer_store_dword v4, off, s[8:11], s65
    s_branch L_sd_249
L_sl_248:
    buffer_store_dword v4, off, s[8:11], s65 sc1
L_sd_249:
    s_mov_b64 exec, -1
    s_and_b32 s88, s76, 3
    s_add_u32 s88, s88, 4
    s_mul_i32 s88, s88, 147456
    s_add_u32 s88, s88, s72
    s_sub_u32 s89, s76, 3
    s_cselect_b32 s89, 0, s89
    buffer_load_dword v3, v7, s[8:11], s82 offen offset:32 sc1
    s_add_u32 s76, s76, 1
    s_cmp_ge_u32 s75, 64
    s_cbranch_scc1 L_tail_213
    s_add_u32 s79, s79, 40960
    ds_read_b128 v[96:99], v10 offset:47104
    ds_read_b128 v[100:103], v12 offset:47104
    s_waitcnt lgkmcnt(5)
    v_mfma_f32_16x16x32_bf16 v[48:51], v[112:115], a[40:43], v[48:51]
    v_mfma_f32_16x16x32_bf16 v[56:59], v[112:115], a[120:123], v[56:59]
    v_mfma_f32_16x16x32_bf16 v[64:67], v[112:115], a[200:203], v[64:67]
    v_mfma_f32_16x16x32_bf16 v[72:75], v[112:115], v[216:219], v[72:75]
    s_add_u32 m0, s83, 0
    s_nop 0
    buffer_load_dwordx4 v8, s[8:11], s79 offen offset:0 sc1 lds
    s_waitcnt lgkmcnt(4)
    v_mfma_f32_16x16x32_bf16 v[52:55], v[116:119], a[40:43], v[52:55]
    v_mfma_f32_16x16x32_bf16 v[60:63], v[116:119], a[120:123], v[60:63]
    v_mfma_f32_16x16x32_bf16 v[68:71], v[116:119], a[200:203], v[68:71]
    v_mfma_f32_16x16x32_bf16 v[76:79], v[116:119], v[216:219], v[76:79]
    s_add_u32 m0, m0, 896
    s_nop 0
    buffer_load_dwordx4 v8, s[8:11], s79 offen offset:128 sc1 lds
    ds_read_b128 v[104:107], v11 offset:47104
    ds_read_b128 v[108:111], v13 offset:47104
    s_waitcnt lgkmcnt(5)
    v_mfma_f32_16x16x32_bf16 v[48:51], v[120:123], a[44:47], v[48:51]
    v_mfma_f32_16x16x32_bf16 v[56:59], v[120:123], a[124:127], v[56:59]
    v_mfma_f32_16x16x32_bf16 v[64:67], v[120:123], a[204:207], v[64:67]
    v_mfma_f32_16x16x32_bf16 v[72:75], v[120:123], v[220:223], v[72:75]
    s_add_u32 m0, m0, 896
    s_nop 0
    buffer_load_dwordx4 v8, s[8:11], s79 offen offset:256 sc1 lds
    s_waitcnt lgkmcnt(4)
    v_mfma_f32_16x16x32_bf16 v[52:55], v[124:127], a[44:47], v[52:55]
    v_mfma_f32_16x16x32_bf16 v[60:63], v[124:127], a[124:127], v[60:63]
    v_mfma_f32_16x16x32_bf16 v[68:71], v[124:127], a[204:207], v[68:71]
    v_mfma_f32_16x16x32_bf16 v[76:79], v[124:127], v[220:223], v[76:79]
    s_add_u32 m0, m0, 896
    s_nop 0
    buffer_load_dwordx4 v8, s[8:11], s79 offen offset:384 sc1 lds
    ds_read_b128 v[112:115], v10 offset:48128
    ds_read_b128 v[116:119], v12 offset:48128
    s_waitcnt lgkmcnt(5)
    v_mfma_f32_16x16x32_bf16 v[48:51], v[96:99], a[48:51], v[48:51]
    v_mfma_f32_16x16x32_bf16 v[56:59], v[96:99], a[128:131], v[56:59]
    v_mfma_f32_16x16x32_bf16 v[64:67], v[96:99], a[208:211], v[64:67]
    v_mfma_f32_16x16x32_bf16 v[72:75], v[96:99], v[224:227], v[72:75]
    s_add_u32 m0, m0, 896
    s_nop 0
    buffer_load_dwordx4 v8, s[8:11], s79 offen offset:512 sc1 lds
    s_waitcnt lgkmcnt(4)
    v_mfma_f32_16x16x32_bf16 v[52:55], v[100:103], a[48:51], v[52:55]
    v_mfma_f32_16x16x32_bf16 v[60:63], v[100:103], a[128:131], v[60:63]
    v_mfma_f32_16x16x32_bf16 v[68:71], v[100:103], a[208:211], v[68:71]
    v_mfma_f32_16x16x32_bf16 v[76:79], v[100:103], v[224:227], v[76:79]
    s_add_u32 m0, m0, 896
    s_nop 0
    buffer_load_dwordx4 v8, s[8:11], s79 offen offset:640 sc1 lds
    ds_read_b128 v[120:123], v11 offset:48128
    ds_read_b128 v[124:127], v13 offset:48128
    s_waitcnt lgkmcnt(5)
    v_mfma_f32_16x16x32_bf16 v[48:51], v[104:107], a[52:55], v[48:51]
    v_mfma_f32_16x16x32_bf16 v[56:59], v[104:107], a[132:135], v[56:59]
    v_mfma_f32_16x16x32_bf16 v[64:67], v[104:107], a[212:215], v[64:67]
    v_mfma_f32_16x16x32_bf16 v[72:75], v[104:107], v[228:231], v[72:75]
    s_add_u32 m0, m0, 896
    s_nop 0
    buffer_load_dwordx4 v8, s[8:11], s79 offen offset:768 sc1 lds
    s_waitcnt lgkmcnt(4)
    v_mfma_f32_16x16x32_bf16 v[52:55], v[108:111], a[52:55], v[52:55]
    v_mfma_f32_16x16x32_bf16 v[60:63], v[108:111], a[132:135], v[60:63]
    v_mfma_f32_16x16x32_bf16 v[68:71], v[108:111], a[212:215], v[68:71]
    v_mfma_f32_16x16x32_bf16 v[76:79], v[108:111], v[228:231], v[76:79]
    s_add_u32 m0, m0, 896
    s_nop 0
    buffer_load_dwordx4 v8, s[8:11], s79 offen offset:896 sc1 lds
    ds_read_b128 v[96:99], v10 offset:49152
    ds_read_b128 v[100:103], v12 offset:49152
    s_waitcnt lgkmcnt(5)
    v_mfma_f32_16x16x32_bf16 v[48:51], v[112:115], a[56:59], v[48:51]
    v_mfma_f32_16x16x32_bf16 v[56:59], v[112:115], a[136:139], v[56:59]
    v_mfma_f32_16x16x32_bf16 v[64:67], v[112:115], a[216:219], v[64:67]
    v_mfma_f32_16x16x32_bf16 v[72:75], v[112:115], v[232:235], v[72:75]
    s_add_u32 m0, m0, 896
    s_nop 0
    buffer_load_dwordx4 v8, s[8:11], s79 offen offset:1024 sc1 lds
    s_waitcnt lgkmcnt(4)
    v_mfma_f32_16x16x32_bf16 v[52:55], v[116:119], a[56:59], v[52:55]
    v_mfma_f32_16x16x32_bf16 v[60:63], v[116:119], a[136:139], v[60:63]
    v_mfma_f32_16x16x32_bf16 v[68:71], v[116:119], a[216:219], v[68:71]
    v_mfma_f32_16x16x32_bf16 v[76:79], v[116:119], v[232:235], v[76:79]
    s_add_u32 m0, m0, 896
    s_nop 0
    buffer_load_dwordx4 v8, s[8:11], s79 offen offset:1152 sc1 lds
    ds_read_b128 v[104:107], v11 offset:49152
    ds_read_b128 v[108:111], v13 offset:49152
    s_waitcnt lgkmcnt(5)
    v_mfma_f32_16x16x32_bf16 v[48:51], v[120:123], a[60:63], v[48:51]
    v_mfma_f32_16x16x32_bf16 v[56:59], v[120:123], a[140:143], v[56:59]
    v_mfma_f32_16x16x32_bf16 v[64:67], v[120:123], a[220:223], v[64:67]
    v_mfma_f32_16x16x32_bf16 v[72:75], v[120:123], v[236:239], v[72:75]
    s_waitcnt lgkmcnt(4)
    v_mfma_f32_16x16x32_bf16 v[52:55], v[124:127], a[60:63], v[52:55]
    v_mfma_f32_16x16x32_bf16 v[60:63], v[124:127], a[140:143], v[60:63]
    v_mfma_f32_16x16x32_bf16 v[68:71], v[124:127], a[220:223], v[68:71]
    v_mfma_f32_16x16x32_bf16 v[76:79], v[124:127], v[236:239], v[76:79]
    ds_read_b128 v[112:115], v10 offset:50176
    ds_read_b128 v[116:119], v12 offset:50176
    s_waitcnt lgkmcnt(5)
    v_mfma_f32_16x16x32_bf16 v[48:51], v[96:99], a[64:67], v[48:51]
    v_mfma_f32_16x16x32_bf16 v[56:59], v[96:99], a[144:147], v[56:59]
    v_mfma_f32_16x16x32_bf16 v[64:67], v[96:99], a[224:227], v[64:67]
    v_mfma_f32_16x16x32_bf16 v[72:75], v[96:99], v[240:243], v[72:75]
    s_waitcnt lgkmcnt(4)
    v_mfma_f32_16x16x32_bf16 v[52:55], v[100:103], a[64:67], v[52:55]
    v_mfma_f32_16x16x32_bf16 v[60:63], v[100:103], a[144:147], v[60:63]
    v_mfma_f32_16x16x32_bf16 v[68:71], v[100:103], a[224:227], v[68:71]
    v_mfma_f32_16x16x32_bf16 v[76:79], v[100:103], v[240:243], v[76:79]
    ds_read_b128 v[120:123], v11 offset:50176
    ds_read_b128 v[124:127], v13 offset:50176
    s_waitcnt lgkmcnt(5)
    v_mfma_f32_16x16x32_bf16 v[48:51], v[104:107], a[68:71], v[48:51]
    v_mfma_f32_16x16x32_bf16 v[56:59], v[104:107], a[148:151], v[56:59]
    v_mfma_f32_16x16x32_bf16 v[64:67], v[104:107], a[228:231], v[64:67]
    v_mfma_f32_16x16x32_bf16 v[72:75], v[104:107], v[244:247], v[72:75]
    s_waitcnt lgkmcnt(4)
    v_mfma_f32_16x16x32_bf16 v[52:55], v[108:111], a[68:71], v[52:55]
    v_mfma_f32_16x16x32_bf16 v[60:63], v[108:111], a[148:151], v[60:63]
    v_mfma_f32_16x16x32_bf16 v[68:71], v[108:111], a[228:231], v[68:71]
    v_mfma_f32_16x16x32_bf16 v[76:79], v[108:111], v[244:247], v[76:79]
    s_waitcnt lgkmcnt(3)
    v_mfma_f32_16x16x32_bf16 v[48:51], v[112:115], a[72:75], v[48:51]
    v_mfma_f32_16x16x32_bf16 v[56:59], v[112:115], a[152:155], v[56:59]
    v_mfma_f32_16x16x32_bf16 v[64:67], v[112:115], a[232:235], v[64:67]
    v_mfma_f32_16x16x32_bf16 v[72:75], v[112:115], v[248:251], v[72:75]
    s_waitcnt lgkmcnt(2)
    v_mfma_f32_16x16x32_bf16 v[52:55], v[116:119], a[72:75], v[52:55]
    v_mfma_f32_16x16x32_bf16 v[60:63], v[116:119], a[152:155], v[60:63]
    v_mfma_f32_16x16x32_bf16 v[68:71], v[116:119], a[232:235], v[68:71]
    v_mfma_f32_16x16x32_bf16 v[76:79], v[116:119], v[248:251], v[76:79]
    s_waitcnt lgkmcnt(1)
    v_mfma_f32_16x16x32_bf16 v[48:51], v[120:123], a[76:79], v[48:51]
    v_mfma_f32_16x16x32_bf16 v[56:59], v[120:123], a[156:159], v[56:59]
    v_mfma_f32_16x16x32_bf16 v[64:67], v[120:123], a[236:239], v[64:67]
    v_mfma_f32_16x16x32_bf16 v[72:75], v[120:123], v[252:255], v[72:75]
    s_waitcnt lgkmcnt(0)
    v_mfma_f32_16x16x32_bf16 v[52:55], v[124:127], a[76:79], v[52:55]
    v_mfma_f32_16x16x32_bf16 v[60:63], v[124:127], a[156:159], v[60:63]
    v_mfma_f32_16x16x32_bf16 v[68:71], v[124:127], a[236:239], v[68:71]
    v_mfma_f32_16x16x32_bf16 v[76:79], v[124:127], v[252:255], v[76:79]
    s_mov_b32 s87, s7
    s_cmp_lg_u32 s7, 0
    s_cbranch_scc1 L_df_250
    s_waitcnt vmcnt(0)
    v_cvt_pk_bf16_f32 v80, v48, v49
    v_cvt_pk_bf16_f32 v81, v50, v51
    v_cvt_pk_bf16_f32 v82, v56, v57
    v_cvt_pk_bf16_f32 v83, v58, v59
    v_cvt_pk_bf16_f32 v84, v52, v53
    v_cvt_pk_bf16_f32 v85, v54, v55
    v_cvt_pk_bf16_f32 v86, v60, v61
    v_cvt_pk_bf16_f32 v87, v62, v63
    v_permlane32_swap_b32 v80, v82
    v_permlane32_swap_b32 v81, v83
    v_permlane32_swap_b32 v84, v86
    v_permlane32_swap_b32 v85, v87
    v_cmp_gt_u32 vcc, s89, v3
    s_cbranch_vccz L_bp_251
L_poll_252:
    buffer_load_dword v3, v7, s[8:11], s82 offen offset:32 sc1
    s_waitcnt vmcnt(0)
    v_cmp_gt_u32 vcc, s89, v3
    s_cbranch_vccz L_pok_253
    s_sleep 1
    s_sub_u32 s6, s6, 1
    s_cbranch_scc0 L_poll_252
    s_branch L_fail
L_pok_253:
L_bp_251:
    s_cmp_eq_u32 s7, 0
    s_cbranch_scc1 L_sl_254
    buffer_store_dwordx4 v[80:83], v9, s[8:11], s88 offen offset:0
    buffer_store_dwordx4 v[84:87], v9, s[8:11], s88 offen offset:1024
    s_branch L_sd_255
L_sl_254:
    buffer_store_dwordx4 v[80:83], v9, s[8:11], s88 offen offset:0 sc1
    buffer_store_dwordx4 v[84:87], v9, s[8:11], s88 offen offset:1024 sc1
L_sd_255:
    v_cvt_pk_bf16_f32 v88, v64, v65
    v_cvt_pk_bf16_f32 v89, v66, v67
    v_cvt_pk_bf16_f32 v90, v72, v73
    v_cvt_pk_bf16_f32 v91, v74, v75
    v_cvt_pk_bf16_f32 v92, v68, v69
    v_cvt_pk_bf16_f32 v93, v70, v71
    v_cvt_pk_bf16_f32 v94, v76, v77
    v_cvt_pk_bf16_f32 v95, v78, v79
    v_permlane32_swap_b32 v88, v90
    v_permlane32_swap_b32 v89, v91
    v_permlane32_swap_b32 v92, v94
    v_permlane32_swap_b32 v93, v95
    s_cmp_eq_u32 s7, 0
    s_cbranch_scc1 L_sl_256
    buffer_store_dwordx4 v[88:91], v9, s[8:11], s88 offen offset:2048
    buffer_store_dwordx4 v[92:95], v9, s[8:11], s88 offen offset:3072
    s_branch L_sd_257
L_sl_256:
    buffer_store_dwordx4 v[88:91], v9, s[8:11], s88 offen offset:2048 sc1
    buffer_store_dwordx4 v[92:95], v9, s[8:11], s88 offen offset:3072 sc1
L_sd_257:
L_df_250:
    s_waitcnt vmcnt(0)
    s_barrier
    s_branch L_qkv_b_v
L_tail_213:
    ds_read_b128 v[96:99], v10 offset:47104
    ds_read_b128 v[100:103], v12 offset:47104
    s_waitcnt lgkmcnt(5)
    v_mfma_f32_16x16x32_bf16 v[48:51], v[112:115], a[40:43], v[48:51]
    v_mfma_f32_16x16x32_bf16 v[56:59], v[112:115], a[120:123], v[56:59]
    v_mfma_f32_16x16x32_bf16 v[64:67], v[112:115], a[200:203], v[64:67]
    v_mfma_f32_16x16x32_bf16 v[72:75], v[112:115], v[216:219], v[72:75]
    s_waitcnt lgkmcnt(4)
    v_mfma_f32_16x16x32_bf16 v[52:55], v[116:119], a[40:43], v[52:55]
    v_mfma_f32_16x16x32_bf16 v[60:63], v[116:119], a[120:123], v[60:63]
    v_mfma_f32_16x16x32_bf16 v[68:71], v[116:119], a[200:203], v[68:71]
    v_mfma_f32_16x16x32_bf16 v[76:79], v[116:119], v[216:219], v[76:79]
    ds_read_b128 v[104:107], v11 offset:47104
    ds_read_b128 v[108:111], v13 offset:47104
    s_waitcnt lgkmcnt(5)
    v_mfma_f32_16x16x32_bf16 v[48:51], v[120:123], a[44:47], v[48:51]
    v_mfma_f32_16x16x32_bf16 v[56:59], v[120:123], a[124:127], v[56:59]
    v_mfma_f32_16x16x32_bf16 v[64:67], v[120:123], a[204:207], v[64:67]
    v_mfma_f32_16x16x32_bf16 v[72:75], v[120:123], v[220:223], v[72:75]
    s_waitcnt lgkmcnt(4)
    v_mfma_f32_16x16x32_bf16 v[52:55], v[124:127], a[44:47], v[52:55]
    v_mfma_f32_16x16x32_bf16 v[60:63], v[124:127], a[124:127], v[60:63]
    v_mfma_f32_16x16x32_bf16 v[68:71], v[124:127], a[204:207], v[68:71]
    v_mfma_f32_16x16x32_bf16 v[76:79], v[124:127], v[220:223], v[76:79]
    ds_read_b128 v[112:115], v10 offset:48128
    ds_read_b128 v[116:119], v12 offset:48128
    s_waitcnt lgkmcnt(5)
    v_mfma_f32_16x16x32_bf16 v[48:51], v[96:99], a[48:51], v[48:51]
    v_mfma_f32_16x16x32_bf16 v[56:59], v[96:99], a[128:131], v[56:59]
    v_mfma_f32_16x16x32_bf16 v[64:67], v[96:99], a[208:211], v[64:67]
    v_mfma_f32_16x16x32_bf16 v[72:75], v[96:99], v[224:227], v[72:75]
    s_waitcnt lgkmcnt(4)
    v_mfma_f32_16x16x32_bf16 v[52:55], v[100:103], a[48:51], v[52:55]
    v_mfma_f32_16x16x32_bf16 v[60:63], v[100:103], a[128:131], v[60:63]
    v_mfma_f32_16x16x32_bf16 v[68:71], v[100:103], a[208:211], v[68:71]
    v_mfma_f32_16x16x32_bf16 v[76:79], v[100:103], v[224:227], v[76:79]
    ds_read_b128 v[120:123], v11 offset:48128
    ds_read_b128 v[124:127], v13 offset:48128
    s_waitcnt lgkmcnt(5)
    v_mfma_f32_16x16x32_bf16 v[48:51], v[104:107], a[52:55], v[48:51]
    v_mfma_f32_16x16x32_bf16 v[56:59], v[104:107], a[132:135], v[56:59]
    v_mfma_f32_16x16x32_bf16 v[64:67], v[104:107], a[212:215], v[64:67]
    v_mfma_f32_16x16x32_bf16 v[72:75], v[104:107], v[228:231], v[72:75]
    s_waitcnt lgkmcnt(4)
    v_mfma_f32_16x16x32_bf16 v[52:55], v[108:111], a[52:55], v[52:55]
    v_mfma_f32_16x16x32_bf16 v[60:63], v[108:111], a[132:135], v[60:63]
    v_mfma_f32_16x16x32_bf16 v[68:71], v[108:111], a[212:215], v[68:71]
    v_mfma_f32_16x16x32_bf16 v[76:79], v[108:111], v[228:231], v[76:79]
    ds_read_b128 v[96:99], v10 offset:49152
    ds_read_b128 v[100:103], v12 offset:49152
    s_waitcnt lgkmcnt(5)
    v_mfma_f32_16x16x32_bf16 v[48:51], v[112:115], a[56:59], v[48:51]
    v_mfma_f32_16x16x32_bf16 v[56:59], v[112:115], a[136:139], v[56:59]
    v_mfma_f32_16x16x32_bf16 v[64:67], v[112:115], a[216:219], v[64:67]
    v_mfma_f32_16x16x32_bf16 v[72:75], v[112:115], v[232:235], v[72:75]
    s_waitcnt lgkmcnt(4)
    v_mfma_f32_16x16x32_bf16 v[52:55], v[116:119], a[56:59], v[52:55]
    v_mfma_f32_16x16x32_bf16 v[60:63], v[116:119], a[136:139], v[60:63]
    v_mfma_f32_16x16x32_bf16 v[68:71], v[116:119], a[216:219], v[68:71]
    v_mfma_f32_16x16x32_bf16 v[76:79], v[116:119], v[232:235], v[76:79]
    ds_read_b128 v[104:107], v11 offset:49152
    ds_read_b128 v[108:111], v13 offset:49152
    s_waitcnt lgkmcnt(5)
    v_mfma_f32_16x16x32_bf16 v[48:51], v[120:123], a[60:63], v[48:51]
    v_mfma_f32_16x16x32_bf16 v[56:59], v[120:123], a[140:143], v[56:59]
    v_mfma_f32_16x16x32_bf16 v[64:67], v[120:123], a[220:223], v[64:67]
    v_mfma_f32_16x16x32_bf16 v[72:75], v[120:123], v[236:239], v[72:75]
    s_waitcnt lgkmcnt(4)
    v_mfma_f32_16x16x32_bf16 v[52:55], v[124:127], a[60:63], v[52:55]
    v_mfma_f32_16x16x32_bf16 v[60:63], v[124:127], a[140:143], v[60:63]
    v_mfma_f32_16x16x32_bf16 v[68:71], v[124:127], a[220:223], v[68:71]
    v_mfma_f32_16x16x32_bf16 v[76:79], v[124:127], v[236:239], v[76:79]
    ds_read_b128 v[112:115], v10 offset:50176
    ds_read_b128 v[116:119], v12 offset:50176
    s_waitcnt lgkmcnt(5)
    v_mfma_f32_16x16x32_bf16 v[48:51], v[96:99], a[64:67], v[48:51]
    v_mfma_f32_16x16x32_bf16 v[56:59], v[96:99], a[144:147], v[56:59]
    v_mfma_f32_16x16x32_bf16 v[64:67], v[96:99], a[224:227], v[64:67]
    v_mfma_f32_16x16x32_bf16 v[72:75], v[96:99], v[240:243], v[72:75]
    s_waitcnt lgkmcnt(4)
    v_mfma_f32_16x16x32_bf16 v[52:55], v[100:103], a[64:67], v[52:55]
    v_mfma_f32_16x16x32_bf16 v[60:63], v[100:103], a[144:147], v[60:63]
    v_mfma_f32_16x16x32_bf16 v[68:71], v[100:103], a[224:227], v[68:71]
    v_mfma_f32_16x16x32_bf16 v[76:79], v[100:103], v[240:243], v[76:79]
    ds_read_b128 v[120:123], v11 offset:50176
    ds_read_b128 v[124:127], v13 offset:50176
    s_waitcnt lgkmcnt(5)
    v_mfma_f32_16x16x32_bf16 v[48:51], v[104:107], a[68:71], v[48:51]
    v_mfma_f32_16x16x32_bf16 v[56:59], v[104:107], a[148:151], v[56:59]
    v_mfma_f32_16x16x32_bf16 v[64:67], v[104:107], a[228:231], v[64:67]
    v_mfma_f32_16x16x32_bf16 v[72:75], v[104:107], v[244:247], v[72:75]
    s_waitcnt lgkmcnt(4)
    v_mfma_f32_16x16x32_bf16 v[52:55], v[108:111], a[68:71], v[52:55]
    v_mfma_f32_16x16x32_bf16 v[60:63], v[108:111], a[148:151], v[60:63]
    v_mfma_f32_16x16x32_bf16 v[68:71], v[108:111], a[228:231], v[68:71]
    v_mfma_f32_16x16x32_bf16 v[76:79], v[108:111], v[244:247], v[76:79]
    s_waitcnt lgkmcnt(3)
    v_mfma_f32_16x16x32_bf16 v[48:51], v[112:115], a[72:75], v[48:51]
    v_mfma_f32_16x16x32_bf16 v[56:59], v[112:115], a[152:155], v[56:59]
    v_mfma_f32_16x16x32_bf16 v[64:67], v[112:115], a[232:235], v[64:67]
    v_mfma_f32_16x16x32_bf16 v[72:75], v[112:115], v[248:251], v[72:75]
    s_waitcnt lgkmcnt(2)
    v_mfma_f32_16x16x32_bf16 v[52:55], v[116:119], a[72:75], v[52:55]
    v_mfma_f32_16x16x32_bf16 v[60:63], v[116:119], a[152:155], v[60:63]
    v_mfma_f32_16x16x32_bf16 v[68:71], v[116:119], a[232:235], v[68:71]
    v_mfma_f32_16x16x32_bf16 v[76:79], v[116:119], v[248:251], v[76:79]
    s_waitcnt lgkmcnt(1)
    v_mfma_f32_16x16x32_bf16 v[48:51], v[120:123], a[76:79], v[48:51]
    v_mfma_f32_16x16x32_bf16 v[56:59], v[120:123], a[156:159], v[56:59]
    v_mfma_f32_16x16x32_bf16 v[64:67], v[120:123], a[236:239], v[64:67]
    v_mfma_f32_16x16x32_bf16 v[72:75], v[120:123], v[252:255], v[72:75]
    s_waitcnt lgkmcnt(0)
    v_mfma_f32_16x16x32_bf16 v[52:55], v[124:127], a[76:79], v[52:55]
    v_mfma_f32_16x16x32_bf16 v[60:63], v[124:127], a[156:159], v[60:63]
    v_mfma_f32_16x16x32_bf16 v[68:71], v[124:127], a[236:239], v[68:71]
    v_mfma_f32_16x16x32_bf16 v[76:79], v[124:127], v[252:255], v[76:79]
    s_waitcnt vmcnt(0)
    v_cvt_pk_bf16_f32 v80, v48, v49
    v_cvt_pk_bf16_f32 v81, v50, v51
    v_cvt_pk_bf16_f32 v82, v56, v57
    v_cvt_pk_bf16_f32 v83, v58, v59
    v_cvt_pk_bf16_f32 v84, v52, v53
    v_cvt_pk_bf16_f32 v85, v54, v55
    v_cvt_pk_bf16_f32 v86, v60, v61
    v_cvt_pk_bf16_f32 v87, v62, v63
    v_permlane32_swap_b32 v80, v82
    v_permlane32_swap_b32 v81, v83
    v_permlane32_swap_b32 v84, v86
    v_permlane32_swap_b32 v85, v87
    v_cmp_gt_u32 vcc, s89, v3
    s_cbranch_vccz L_bp_258
L_poll_259:
    buffer_load_dword v3, v7, s[8:11], s82 offen offset:32 sc1
    s_waitcnt vmcnt(0)
    v_cmp_gt_u32 vcc, s89, v3
    s_cbranch_vccz L_pok_260
    s_sleep 1
    s_sub_u32 s6, s6, 1
    s_cbranch_scc0 L_poll_259
    s_branch L_fail
L_pok_260:
L_bp_258:
    s_cmp_eq_u32 s7, 0
    s_cbranch_scc1 L_sl_261
    buffer_store_dwordx4 v[80:83], v9, s[8:11], s88 offen offset:0
    buffer_store_dwordx4 v[84:87], v9, s[8:11], s88 offen offset:1024
    s_branch L_sd_262
L_sl_261:
    buffer_store_dwordx4 v[80:83], v9, s[8:11], s88 offen offset:0 sc1
    buffer_store_dwordx4 v[84:87], v9, s[8:11], s88 offen offset:1024 sc1
L_sd_262:
    v_cvt_pk_bf16_f32 v88, v64, v65
    v_cvt_pk_bf16_f32 v89, v66, v67
    v_cvt_pk_bf16_f32 v90, v72, v73
    v_cvt_pk_bf16_f32 v91, v74, v75
    v_cvt_pk_bf16_f32 v92, v68, v69
    v_cvt_pk_bf16_f32 v93, v70, v71
    v_cvt_pk_bf16_f32 v94, v76, v77
    v_cvt_pk_bf16_f32 v95, v78, v79
    v_permlane32_swap_b32 v88, v90
    v_permlane32_swap_b32 v89, v91
    v_permlane32_swap_b32 v92, v94
    v_permlane32_swap_b32 v93, v95
    s_cmp_eq_u32 s7, 0
    s_cbranch_scc1 L_sl_263
    buffer_store_dwordx4 v[88:91], v9, s[8:11], s88 offen offset:2048
    buffer_store_dwordx4 v[92:95], v9, s[8:11], s88 offen offset:3072
    s_branch L_sd_264
L_sl_263:
    buffer_store_dwordx4 v[88:91], v9, s[8:11], s88 offen offset:2048 sc1
    buffer_store_dwordx4 v[92:95], v9, s[8:11], s88 offen offset:3072 sc1
L_sd_264:
    s_waitcnt vmcnt(0)
    v_mov_b32 v4, s76
    s_mov_b64 exec, 1
    s_cmp_eq_u32 s7, 0
    s_cbranch_scc1 L_sl_265
    buffer_store_dword v4, off, s[8:11], s66
    s_branch L_sd_266
L_sl_265:
    buffer_store_dword v4, off, s[8:11], s66 sc1
L_sd_266:
    s_mov_b64 exec, -1
    s_cmp_ge_u32 s76, 64
    s_cbranch_scc1 L_qkv_fin
    s_barrier
    s_mov_b32 s87, 0
    s_add_u32 s80, s76, 1
    s_mul_i32 s81, s76, 40960
    s_add_u32 s81, s81, 14680064
    s_branch L_blk_211
.section .rodata,"a"
.p2align 6
.amdhsa_kernel interleave_layers__memory_aug_recurrent_mem_tr__dense_activation_relu__prompt_kernel
  .amdhsa_next_free_vgpr 512
  .amdhsa_next_free_sgpr 102
  .amdhsa_accum_offset 256
  .amdhsa_group_segment_fixed_size 0
  .amdhsa_kernarg_size 104
  .amdhsa_user_sgpr_count 2
  .amdhsa_user_sgpr_kernarg_segment_ptr 1
  .amdhsa_system_sgpr_workgroup_id_x 1
.end_amdhsa_kernel
```
